```python
import torch

def _softmax(x, axis=-1):
    return torch.softmax(x, dim=axis)
def _gelu(x):
    return torch.nn.functional.gelu(x, approximate="tanh")
def _silu(x):
    return torch.nn.functional.silu(x)
def _sigmoid(x):
    return torch.sigmoid(x)
def _layernorm(x, axis=-1, eps=1e-5):
    m = x.mean(dim=axis, keepdim=True)
    v = x.var(dim=axis, keepdim=True, unbiased=False)
    return (x - m) / torch.sqrt(v + eps)
def _scatter_add(tgt, idx, src, axis=0):
    return tgt.clone().index_add_(axis, idx, src)
def _segment_sum(src, seg, n):
    out = torch.zeros((n,) + src.shape[1:], dtype=src.dtype)
    return out.index_add_(0, seg, src)
def _pad(x, pw):
    flat = tuple(v for pair in reversed(pw) for v in pair)
    return torch.nn.functional.pad(x, flat)

kernel_name = 'gated_mix__ssm_conv_s4d__grouped_kv_mqa__prompt'

def setup_inputs():

    _w = (lambda a: (lambda t: t.to(torch.bfloat16) if t.is_floating_point() else t)(torch.as_tensor(a)))
    def _A_setup():
        Bsz, L, D, N = 1, 2048, 640, 128
        return {
            "u": _w((lambda *s: torch.randn(*s, dtype=torch.bfloat16) * 0.05)(Bsz, L, D)),
            "log_A_real": _w((lambda *s: torch.randn(*s, dtype=torch.bfloat16) * 6.4)(D, N) * 0.5),
            "A_imag": _w((lambda *s: torch.randn(*s, dtype=torch.bfloat16) * 0.05)(D, N) * 3.14),
            "C_real": _w((lambda *s: torch.randn(*s, dtype=torch.bfloat16) * 0.05)(D, N) / N ** 0.5),
            "C_imag": _w((lambda *s: torch.randn(*s, dtype=torch.bfloat16) * 0.05)(D, N) / N ** 0.5),
            "log_dt": _w((lambda *s: torch.randn(*s, dtype=torch.bfloat16) * 0.05)(D) * 0.5 - 4.0),
            "D_skip": _w((lambda *s: torch.randn(*s, dtype=torch.bfloat16) * 0.05)(D)),
        }
    _A_in = _A_setup()

    def _B_setup():
        B, S, D, H = 1, 2048, 640, 32
        Dh = D // H
        return {
            "x": _w((lambda *s: torch.randn(*s, dtype=torch.bfloat16) * 0.05)(B, S, D)),
            "wq": _w((lambda *s: torch.randn(*s, dtype=torch.bfloat16) * 0.8)(D, H * Dh)),
            "wk": _w((lambda *s: torch.randn(*s, dtype=torch.bfloat16) * 0.8)(D, Dh)),
            "wv": _w((lambda *s: torch.randn(*s, dtype=torch.bfloat16) * 0.05)(D, Dh)),
            "wo": _w((lambda *s: torch.randn(*s, dtype=torch.bfloat16) * 0.05)(H * Dh, D)),
        }
    _B_in = _B_setup()

    return {
        "A_u": _A_in["u"],
        "A_log_A_real": _A_in["log_A_real"],
        "A_A_imag": _A_in["A_imag"],
        "A_C_real": _A_in["C_real"],
        "A_C_imag": _A_in["C_imag"],
        "A_log_dt": _A_in["log_dt"],
        "A_D_skip": _A_in["D_skip"],
        "B_x": _B_in["x"],
        "B_wq": _B_in["wq"],
        "B_wk": _B_in["wk"],
        "B_wv": _B_in["wv"],
        "B_wo": _B_in["wo"],
        "gate_w": _w((lambda *s: torch.randn(*s, dtype=torch.bfloat16) * 0.05)(640) * 16.0),
    }

def reference(A_u, A_log_A_real, A_A_imag, A_C_real, A_C_imag, A_log_dt, A_D_skip, B_x, B_wq, B_wk, B_wv, B_wo, gate_w):
    def _A_ref(u, log_A_real, A_imag, C_real, C_imag, log_dt, D_skip):
        L = u.shape[1]
        dt = torch.exp(log_dt)
        A = -torch.exp(log_A_real) + 1j * A_imag
        C = (C_real + 1j * C_imag) * dt[:, None]
        pos = (lambda x, dt: x.to(dt))(torch.arange(L), log_dt.dtype)
        P = torch.exp((A * dt[:, None])[:, :, None] * pos[None, None, :])
        K = 2.0 * torch.einsum("dn,dnl->dl", C, P).real
        L2 = 2 * L
        u_t = (lambda x, *d: x.permute(*d))(u, 0, 2, 1)
        Kf = (lambda x, *a, **k: torch.fft.rfft(x.float(), *a, **k))(K, L2)
        Uf = (lambda x, *a, **k: torch.fft.rfft(x.float(), *a, **k))(u_t, L2)
        y = (lambda x, *a, **k: torch.fft.irfft(x, *a, **k).to(torch.bfloat16))(Uf * Kf[None, :, :], L2)[:, :, :L]
        y = (lambda x, *d: x.permute(*d))(y, 0, 2, 1)
        return y + u * D_skip[None, None, :]

    def _B_ref(x, wq, wk, wv, wo):
        B, S, D = x.shape
        H = 32
        Dh = D // H
        q = (lambda x, *d: x.permute(*d))((x @ wq).reshape(B, S, H, Dh), 0, 2, 1, 3)
        k = x @ wk
        v = x @ wv
        scores = torch.einsum("bhqd,bkd->bhqk", q, k) * (Dh ** -0.5)
        p = _softmax(scores, axis=-1)
        o = torch.einsum("bhqk,bkd->bhqd", p, v)
        return (lambda x, *d: x.permute(*d))(o, 0, 2, 1, 3).reshape(B, S, H * Dh) @ wo

    x = A_u
    g = _sigmoid((x * gate_w).sum(-1, keepdims=True))
    a = _A_ref(x, A_log_A_real, A_A_imag, A_C_real, A_C_imag, A_log_dt, A_D_skip)
    b = _B_ref(x, B_wq, B_wk, B_wv, B_wo)
    return g * a + (1 - g) * b
```

```asm
; @launch grid=(256,1,1) block=(512,1,1) lds=163840
.amdgcn_target "amdgcn-amd-amdhsa--gfx950"
.text
.p2align 8
.type TABLES,@object
TABLES:
.long 0x1,0x2,0x3,0x4,0x5,0x6,0x7,0x8,0x9,0xa,0xb,0xc,0xd,0xe,0xf,0x10
.long 0x11,0x12,0x13,0x14,0x15,0x16,0x17,0x18,0x19,0x1a,0x1b,0x1c,0x1d,0x1e,0x1f,0x20
.long 0x21,0x22,0x23,0x24,0x25,0x26,0x27,0x28,0x29,0x2a,0x2b,0x2c,0x2d,0x2e,0x2f,0x30
.long 0x31,0x32,0x33,0x34,0x35,0x36,0x37,0x38,0x39,0x3a,0x3b,0x3c,0x3d,0x3e,0x3f,0x40
.long 0x0,0xbd00,0xbf80,0x24d00,0x80,0xbd28,0xbfa8,0x24d08,0x110,0xbd50,0xbfd0,0x24d00,0x190,0xbd78,0xbff8,0x24d08
.long 0x220,0xbda0,0xc020,0x24d10,0x2a0,0xbdc8,0xc048,0x24d18,0x330,0xbdf0,0xc070,0x24d10,0x3b0,0xbe18,0xc098,0x24d18
.long 0x440,0xbe40,0xc0c0,0x24d20,0x4c0,0xbe68,0xc0e8,0x24d28,0x550,0xbe90,0xc110,0x24d20,0x5d0,0xbeb8,0xc138,0x24d28
.long 0x660,0xbee0,0xc160,0x24d30,0x6e0,0xbf08,0xc188,0x24d38,0x770,0xbf30,0xc1b0,0x24d30,0x7f0,0xbf58,0xc1d8,0x24d38
.long 0x10,0xc480,0xc200,0x24d80,0x90,0xc4a8,0xc228,0x24d88,0x100,0xc4d0,0xc250,0x24d80,0x180,0xc4f8,0xc278,0x24d88
.long 0x230,0xc520,0xc2a0,0x24d90,0x2b0,0xc548,0xc2c8,0x24d98,0x320,0xc570,0xc2f0,0x24d90,0x3a0,0xc598,0xc318,0x24d98
.long 0x450,0xc5c0,0xc340,0x24da0,0x4d0,0xc5e8,0xc368,0x24da8,0x540,0xc610,0xc390,0x24da0,0x5c0,0xc638,0xc3b8,0x24da8
.long 0x670,0xc660,0xc3e0,0x24db0,0x6f0,0xc688,0xc408,0x24db8,0x760,0xc6b0,0xc430,0x24db0,0x7e0,0xc6d8,0xc458,0x24db8
.long 0x20,0xc700,0xc980,0x24e00,0xa0,0xc728,0xc9a8,0x24e08,0x130,0xc750,0xc9d0,0x24e00,0x1b0,0xc778,0xc9f8,0x24e08
.long 0x200,0xc7a0,0xca20,0x24e10,0x280,0xc7c8,0xca48,0x24e18,0x310,0xc7f0,0xca70,0x24e10,0x390,0xc818,0xca98,0x24e18
.long 0x460,0xc840,0xcac0,0x24e20,0x4e0,0xc868,0xcae8,0x24e28,0x570,0xc890,0xcb10,0x24e20,0x5f0,0xc8b8,0xcb38,0x24e28
.long 0x640,0xc8e0,0xcb60,0x24e30,0x6c0,0xc908,0xcb88,0x24e38,0x750,0xc930,0xcbb0,0x24e30,0x7d0,0xc958,0xcbd8,0x24e38
.long 0x30,0xce80,0xcc00,0x24e80,0xb0,0xcea8,0xcc28,0x24e88,0x120,0xced0,0xcc50,0x24e80,0x1a0,0xcef8,0xcc78,0x24e88
.long 0x210,0xcf20,0xcca0,0x24e90,0x290,0xcf48,0xccc8,0x24e98,0x300,0xcf70,0xccf0,0x24e90,0x380,0xcf98,0xcd18,0x24e98
.long 0x470,0xcfc0,0xcd40,0x24ea0,0x4f0,0xcfe8,0xcd68,0x24ea8,0x560,0xd010,0xcd90,0x24ea0,0x5e0,0xd038,0xcdb8,0x24ea8
.long 0x650,0xd060,0xcde0,0x24eb0,0x6d0,0xd088,0xce08,0x24eb8,0x740,0xd0b0,0xce30,0x24eb0,0x7c0,0xd0d8,0xce58,0x24eb8
.long 0x2800,0xbd00,0xbf80,0x24d00,0x2880,0xbd28,0xbfa8,0x24d08,0x2910,0xbd50,0xbfd0,0x24d00,0x2990,0xbd78,0xbff8,0x24d08
.long 0x2a20,0xbda0,0xc020,0x24d10,0x2aa0,0xbdc8,0xc048,0x24d18,0x2b30,0xbdf0,0xc070,0x24d10,0x2bb0,0xbe18,0xc098,0x24d18
.long 0x2c40,0xbe40,0xc0c0,0x24d20,0x2cc0,0xbe68,0xc0e8,0x24d28,0x2d50,0xbe90,0xc110,0x24d20,0x2dd0,0xbeb8,0xc138,0x24d28
.long 0x2e60,0xbee0,0xc160,0x24d30,0x2ee0,0xbf08,0xc188,0x24d38,0x2f70,0xbf30,0xc1b0,0x24d30,0x2ff0,0xbf58,0xc1d8,0x24d38
.long 0x2810,0xc480,0xc200,0x24d80,0x2890,0xc4a8,0xc228,0x24d88,0x2900,0xc4d0,0xc250,0x24d80,0x2980,0xc4f8,0xc278,0x24d88
.long 0x2a30,0xc520,0xc2a0,0x24d90,0x2ab0,0xc548,0xc2c8,0x24d98,0x2b20,0xc570,0xc2f0,0x24d90,0x2ba0,0xc598,0xc318,0x24d98
.long 0x2c50,0xc5c0,0xc340,0x24da0,0x2cd0,0xc5e8,0xc368,0x24da8,0x2d40,0xc610,0xc390,0x24da0,0x2dc0,0xc638,0xc3b8,0x24da8
.long 0x2e70,0xc660,0xc3e0,0x24db0,0x2ef0,0xc688,0xc408,0x24db8,0x2f60,0xc6b0,0xc430,0x24db0,0x2fe0,0xc6d8,0xc458,0x24db8
.long 0x2820,0xc700,0xc980,0x24e00,0x28a0,0xc728,0xc9a8,0x24e08,0x2930,0xc750,0xc9d0,0x24e00,0x29b0,0xc778,0xc9f8,0x24e08
.long 0x2a00,0xc7a0,0xca20,0x24e10,0x2a80,0xc7c8,0xca48,0x24e18,0x2b10,0xc7f0,0xca70,0x24e10,0x2b90,0xc818,0xca98,0x24e18
.long 0x2c60,0xc840,0xcac0,0x24e20,0x2ce0,0xc868,0xcae8,0x24e28,0x2d70,0xc890,0xcb10,0x24e20,0x2df0,0xc8b8,0xcb38,0x24e28
.long 0x2e40,0xc8e0,0xcb60,0x24e30,0x2ec0,0xc908,0xcb88,0x24e38,0x2f50,0xc930,0xcbb0,0x24e30,0x2fd0,0xc958,0xcbd8,0x24e38
.long 0x2830,0xce80,0xcc00,0x24e80,0x28b0,0xcea8,0xcc28,0x24e88,0x2920,0xced0,0xcc50,0x24e80,0x29a0,0xcef8,0xcc78,0x24e88
.long 0x2a10,0xcf20,0xcca0,0x24e90,0x2a90,0xcf48,0xccc8,0x24e98,0x2b00,0xcf70,0xccf0,0x24e90,0x2b80,0xcf98,0xcd18,0x24e98
.long 0x2c70,0xcfc0,0xcd40,0x24ea0,0x2cf0,0xcfe8,0xcd68,0x24ea8,0x2d60,0xd010,0xcd90,0x24ea0,0x2de0,0xd038,0xcdb8,0x24ea8
.long 0x2e50,0xd060,0xcde0,0x24eb0,0x2ed0,0xd088,0xce08,0x24eb8,0x2f40,0xd0b0,0xce30,0x24eb0,0x2fc0,0xd0d8,0xce58,0x24eb8
.long 0x5000,0xbd00,0xbf80,0x24d00,0x5080,0xbd28,0xbfa8,0x24d08,0x5110,0xbd50,0xbfd0,0x24d00,0x5190,0xbd78,0xbff8,0x24d08
.long 0x5220,0xbda0,0xc020,0x24d10,0x52a0,0xbdc8,0xc048,0x24d18,0x5330,0xbdf0,0xc070,0x24d10,0x53b0,0xbe18,0xc098,0x24d18
.long 0x5440,0xbe40,0xc0c0,0x24d20,0x54c0,0xbe68,0xc0e8,0x24d28,0x5550,0xbe90,0xc110,0x24d20,0x55d0,0xbeb8,0xc138,0x24d28
.long 0x5660,0xbee0,0xc160,0x24d30,0x56e0,0xbf08,0xc188,0x24d38,0x5770,0xbf30,0xc1b0,0x24d30,0x57f0,0xbf58,0xc1d8,0x24d38
.long 0x5010,0xc480,0xc200,0x24d80,0x5090,0xc4a8,0xc228,0x24d88,0x5100,0xc4d0,0xc250,0x24d80,0x5180,0xc4f8,0xc278,0x24d88
.long 0x5230,0xc520,0xc2a0,0x24d90,0x52b0,0xc548,0xc2c8,0x24d98,0x5320,0xc570,0xc2f0,0x24d90,0x53a0,0xc598,0xc318,0x24d98
.long 0x5450,0xc5c0,0xc340,0x24da0,0x54d0,0xc5e8,0xc368,0x24da8,0x5540,0xc610,0xc390,0x24da0,0x55c0,0xc638,0xc3b8,0x24da8
.long 0x5670,0xc660,0xc3e0,0x24db0,0x56f0,0xc688,0xc408,0x24db8,0x5760,0xc6b0,0xc430,0x24db0,0x57e0,0xc6d8,0xc458,0x24db8
.long 0x5020,0xc700,0xc980,0x24e00,0x50a0,0xc728,0xc9a8,0x24e08,0x5130,0xc750,0xc9d0,0x24e00,0x51b0,0xc778,0xc9f8,0x24e08
.long 0x5200,0xc7a0,0xca20,0x24e10,0x5280,0xc7c8,0xca48,0x24e18,0x5310,0xc7f0,0xca70,0x24e10,0x5390,0xc818,0xca98,0x24e18
.long 0x5460,0xc840,0xcac0,0x24e20,0x54e0,0xc868,0xcae8,0x24e28,0x5570,0xc890,0xcb10,0x24e20,0x55f0,0xc8b8,0xcb38,0x24e28
.long 0x5640,0xc8e0,0xcb60,0x24e30,0x56c0,0xc908,0xcb88,0x24e38,0x5750,0xc930,0xcbb0,0x24e30,0x57d0,0xc958,0xcbd8,0x24e38
.long 0x5030,0xce80,0xcc00,0x24e80,0x50b0,0xcea8,0xcc28,0x24e88,0x5120,0xced0,0xcc50,0x24e80,0x51a0,0xcef8,0xcc78,0x24e88
.long 0x5210,0xcf20,0xcca0,0x24e90,0x5290,0xcf48,0xccc8,0x24e98,0x5300,0xcf70,0xccf0,0x24e90,0x5380,0xcf98,0xcd18,0x24e98
.long 0x5470,0xcfc0,0xcd40,0x24ea0,0x54f0,0xcfe8,0xcd68,0x24ea8,0x5560,0xd010,0xcd90,0x24ea0,0x55e0,0xd038,0xcdb8,0x24ea8
.long 0x5650,0xd060,0xcde0,0x24eb0,0x56d0,0xd088,0xce08,0x24eb8,0x5740,0xd0b0,0xce30,0x24eb0,0x57c0,0xd0d8,0xce58,0x24eb8
.long 0x7800,0xbd00,0xbf80,0x24d00,0x7880,0xbd28,0xbfa8,0x24d08,0x7910,0xbd50,0xbfd0,0x24d00,0x7990,0xbd78,0xbff8,0x24d08
.long 0x7a20,0xbda0,0xc020,0x24d10,0x7aa0,0xbdc8,0xc048,0x24d18,0x7b30,0xbdf0,0xc070,0x24d10,0x7bb0,0xbe18,0xc098,0x24d18
.long 0x7c40,0xbe40,0xc0c0,0x24d20,0x7cc0,0xbe68,0xc0e8,0x24d28,0x7d50,0xbe90,0xc110,0x24d20,0x7dd0,0xbeb8,0xc138,0x24d28
.long 0x7e60,0xbee0,0xc160,0x24d30,0x7ee0,0xbf08,0xc188,0x24d38,0x7f70,0xbf30,0xc1b0,0x24d30,0x7ff0,0xbf58,0xc1d8,0x24d38
.long 0x7810,0xc480,0xc200,0x24d80,0x7890,0xc4a8,0xc228,0x24d88,0x7900,0xc4d0,0xc250,0x24d80,0x7980,0xc4f8,0xc278,0x24d88
.long 0x7a30,0xc520,0xc2a0,0x24d90,0x7ab0,0xc548,0xc2c8,0x24d98,0x7b20,0xc570,0xc2f0,0x24d90,0x7ba0,0xc598,0xc318,0x24d98
.long 0x7c50,0xc5c0,0xc340,0x24da0,0x7cd0,0xc5e8,0xc368,0x24da8,0x7d40,0xc610,0xc390,0x24da0,0x7dc0,0xc638,0xc3b8,0x24da8
.long 0x7e70,0xc660,0xc3e0,0x24db0,0x7ef0,0xc688,0xc408,0x24db8,0x7f60,0xc6b0,0xc430,0x24db0,0x7fe0,0xc6d8,0xc458,0x24db8
.long 0x7820,0xc700,0xc980,0x24e00,0x78a0,0xc728,0xc9a8,0x24e08,0x7930,0xc750,0xc9d0,0x24e00,0x79b0,0xc778,0xc9f8,0x24e08
.long 0x7a00,0xc7a0,0xca20,0x24e10,0x7a80,0xc7c8,0xca48,0x24e18,0x7b10,0xc7f0,0xca70,0x24e10,0x7b90,0xc818,0xca98,0x24e18
.long 0x7c60,0xc840,0xcac0,0x24e20,0x7ce0,0xc868,0xcae8,0x24e28,0x7d70,0xc890,0xcb10,0x24e20,0x7df0,0xc8b8,0xcb38,0x24e28
.long 0x7e40,0xc8e0,0xcb60,0x24e30,0x7ec0,0xc908,0xcb88,0x24e38,0x7f50,0xc930,0xcbb0,0x24e30,0x7fd0,0xc958,0xcbd8,0x24e38
.long 0x7830,0xce80,0xcc00,0x24e80,0x78b0,0xcea8,0xcc28,0x24e88,0x7920,0xced0,0xcc50,0x24e80,0x79a0,0xcef8,0xcc78,0x24e88
.long 0x7a10,0xcf20,0xcca0,0x24e90,0x7a90,0xcf48,0xccc8,0x24e98,0x7b00,0xcf70,0xccf0,0x24e90,0x7b80,0xcf98,0xcd18,0x24e98
.long 0x7c70,0xcfc0,0xcd40,0x24ea0,0x7cf0,0xcfe8,0xcd68,0x24ea8,0x7d60,0xd010,0xcd90,0x24ea0,0x7de0,0xd038,0xcdb8,0x24ea8
.long 0x7e50,0xd060,0xcde0,0x24eb0,0x7ed0,0xd088,0xce08,0x24eb8,0x7f40,0xd0b0,0xce30,0x24eb0,0x7fc0,0xd0d8,0xce58,0x24eb8
.long 0x27e00,0x0,0x24d00,0x27e00,0x27e04,0x10,0x24d28,0x27e00,0x27e08,0x20,0x24d50,0x27e00,0x27e0c,0x30,0x24d78,0x27e00
.long 0x27e00,0x80,0x24da0,0x27e00,0x27e04,0x90,0x24dc8,0x27e00,0x27e08,0xa0,0x24df0,0x27e00,0x27e0c,0xb0,0x24e18,0x27e00
.long 0x27e00,0x40,0x24e40,0x27e00,0x27e04,0x50,0x24e68,0x27e00,0x27e08,0x60,0x24e90,0x27e00,0x27e0c,0x70,0x24eb8,0x27e00
.long 0x27e00,0xc0,0x24ee0,0x27e00,0x27e04,0xd0,0x24f08,0x27e00,0x27e08,0xe0,0x24f30,0x27e00,0x27e0c,0xf0,0x24f58,0x27e00
.long 0x27e00,0x8,0x25700,0x27e00,0x27e04,0x18,0x25728,0x27e00,0x27e08,0x28,0x25750,0x27e00,0x27e0c,0x38,0x25778,0x27e00
.long 0x27e00,0x88,0x257a0,0x27e00,0x27e04,0x98,0x257c8,0x27e00,0x27e08,0xa8,0x257f0,0x27e00,0x27e0c,0xb8,0x25818,0x27e00
.long 0x27e00,0x48,0x25840,0x27e00,0x27e04,0x58,0x25868,0x27e00,0x27e08,0x68,0x25890,0x27e00,0x27e0c,0x78,0x258b8,0x27e00
.long 0x27e00,0xc8,0x258e0,0x27e00,0x27e04,0xd8,0x25908,0x27e00,0x27e08,0xe8,0x25930,0x27e00,0x27e0c,0xf8,0x25958,0x27e00
.long 0x27e00,0x40000000,0x26100,0x27e00,0x27e04,0x40000010,0x26128,0x27e00,0x27e08,0x40000020,0x26150,0x27e00,0x27e0c,0x40000030,0x26178,0x27e00
.long 0x27e00,0x40000080,0x261a0,0x27e00,0x27e04,0x40000090,0x261c8,0x27e00,0x27e08,0x400000a0,0x261f0,0x27e00,0x27e0c,0x400000b0,0x26218,0x27e00
.long 0x27e00,0x40000040,0x26240,0x27e00,0x27e04,0x40000050,0x26268,0x27e00,0x27e08,0x40000060,0x26290,0x27e00,0x27e0c,0x40000070,0x262b8,0x27e00
.long 0x27e00,0x400000c0,0x262e0,0x27e00,0x27e04,0x400000d0,0x26308,0x27e00,0x27e08,0x400000e0,0x26330,0x27e00,0x27e0c,0x400000f0,0x26358,0x27e00
.long 0x27e00,0x40000008,0x26b00,0x27e00,0x27e04,0x40000018,0x26b28,0x27e00,0x27e08,0x40000028,0x26b50,0x27e00,0x27e0c,0x40000038,0x26b78,0x27e00
.long 0x27e00,0x40000088,0x26ba0,0x27e00,0x27e04,0x40000098,0x26bc8,0x27e00,0x27e08,0x400000a8,0x26bf0,0x27e00,0x27e0c,0x400000b8,0x26c18,0x27e00
.long 0x27e00,0x40000048,0x26c40,0x27e00,0x27e04,0x40000058,0x26c68,0x27e00,0x27e08,0x40000068,0x26c90,0x27e00,0x27e0c,0x40000078,0x26cb8,0x27e00
.long 0x27e00,0x400000c8,0x26ce0,0x27e00,0x27e04,0x400000d8,0x26d08,0x27e00,0x27e08,0x400000e8,0x26d30,0x27e00,0x27e0c,0x400000f8,0x26d58,0x27e00
.long 0x27e00,0x100,0x24f80,0x27e04,0x27e04,0x110,0x24fa8,0x27e04,0x27e08,0x120,0x24fd0,0x27e04,0x27e0c,0x130,0x24ff8,0x27e04
.long 0x27e00,0x180,0x25020,0x27e04,0x27e04,0x190,0x25048,0x27e04,0x27e08,0x1a0,0x25070,0x27e04,0x27e0c,0x1b0,0x25098,0x27e04
.long 0x27e00,0x140,0x250c0,0x27e04,0x27e04,0x150,0x250e8,0x27e04,0x27e08,0x160,0x25110,0x27e04,0x27e0c,0x170,0x25138,0x27e04
.long 0x27e00,0x1c0,0x25160,0x27e04,0x27e04,0x1d0,0x25188,0x27e04,0x27e08,0x1e0,0x251b0,0x27e04,0x27e0c,0x1f0,0x251d8,0x27e04
.long 0x27e00,0x108,0x25980,0x27e04,0x27e04,0x118,0x259a8,0x27e04,0x27e08,0x128,0x259d0,0x27e04,0x27e0c,0x138,0x259f8,0x27e04
.long 0x27e00,0x188,0x25a20,0x27e04,0x27e04,0x198,0x25a48,0x27e04,0x27e08,0x1a8,0x25a70,0x27e04,0x27e0c,0x1b8,0x25a98,0x27e04
.long 0x27e00,0x148,0x25ac0,0x27e04,0x27e04,0x158,0x25ae8,0x27e04,0x27e08,0x168,0x25b10,0x27e04,0x27e0c,0x178,0x25b38,0x27e04
.long 0x27e00,0x1c8,0x25b60,0x27e04,0x27e04,0x1d8,0x25b88,0x27e04,0x27e08,0x1e8,0x25bb0,0x27e04,0x27e0c,0x1f8,0x25bd8,0x27e04
.long 0x27e00,0x40000100,0x26380,0x27e04,0x27e04,0x40000110,0x263a8,0x27e04,0x27e08,0x40000120,0x263d0,0x27e04,0x27e0c,0x40000130,0x263f8,0x27e04
.long 0x27e00,0x40000180,0x26420,0x27e04,0x27e04,0x40000190,0x26448,0x27e04,0x27e08,0x400001a0,0x26470,0x27e04,0x27e0c,0x400001b0,0x26498,0x27e04
.long 0x27e00,0x40000140,0x264c0,0x27e04,0x27e04,0x40000150,0x264e8,0x27e04,0x27e08,0x40000160,0x26510,0x27e04,0x27e0c,0x40000170,0x26538,0x27e04
.long 0x27e00,0x400001c0,0x26560,0x27e04,0x27e04,0x400001d0,0x26588,0x27e04,0x27e08,0x400001e0,0x265b0,0x27e04,0x27e0c,0x400001f0,0x265d8,0x27e04
.long 0x27e00,0x40000108,0x26d80,0x27e04,0x27e04,0x40000118,0x26da8,0x27e04,0x27e08,0x40000128,0x26dd0,0x27e04,0x27e0c,0x40000138,0x26df8,0x27e04
.long 0x27e00,0x40000188,0x26e20,0x27e04,0x27e04,0x40000198,0x26e48,0x27e04,0x27e08,0x400001a8,0x26e70,0x27e04,0x27e0c,0x400001b8,0x26e98,0x27e04
.long 0x27e00,0x40000148,0x26ec0,0x27e04,0x27e04,0x40000158,0x26ee8,0x27e04,0x27e08,0x40000168,0x26f10,0x27e04,0x27e0c,0x40000178,0x26f38,0x27e04
.long 0x27e00,0x400001c8,0x26f60,0x27e04,0x27e04,0x400001d8,0x26f88,0x27e04,0x27e08,0x400001e8,0x26fb0,0x27e04,0x27e0c,0x400001f8,0x26fd8,0x27e04
.long 0x27e00,0x400,0x25200,0x27e08,0x27e04,0x410,0x25228,0x27e08,0x27e08,0x420,0x25250,0x27e08,0x27e0c,0x430,0x25278,0x27e08
.long 0x27e00,0x480,0x252a0,0x27e08,0x27e04,0x490,0x252c8,0x27e08,0x27e08,0x4a0,0x252f0,0x27e08,0x27e0c,0x4b0,0x25318,0x27e08
.long 0x27e00,0x440,0x25340,0x27e08,0x27e04,0x450,0x25368,0x27e08,0x27e08,0x460,0x25390,0x27e08,0x27e0c,0x470,0x253b8,0x27e08
.long 0x27e00,0x4c0,0x253e0,0x27e08,0x27e04,0x4d0,0x25408,0x27e08,0x27e08,0x4e0,0x25430,0x27e08,0x27e0c,0x4f0,0x25458,0x27e08
.long 0x27e00,0x408,0x25c00,0x27e08,0x27e04,0x418,0x25c28,0x27e08,0x27e08,0x428,0x25c50,0x27e08,0x27e0c,0x438,0x25c78,0x27e08
.long 0x27e00,0x488,0x25ca0,0x27e08,0x27e04,0x498,0x25cc8,0x27e08,0x27e08,0x4a8,0x25cf0,0x27e08,0x27e0c,0x4b8,0x25d18,0x27e08
.long 0x27e00,0x448,0x25d40,0x27e08,0x27e04,0x458,0x25d68,0x27e08,0x27e08,0x468,0x25d90,0x27e08,0x27e0c,0x478,0x25db8,0x27e08
.long 0x27e00,0x4c8,0x25de0,0x27e08,0x27e04,0x4d8,0x25e08,0x27e08,0x27e08,0x4e8,0x25e30,0x27e08,0x27e0c,0x4f8,0x25e58,0x27e08
.long 0x27e00,0x40000400,0x26600,0x27e08,0x27e04,0x40000410,0x26628,0x27e08,0x27e08,0x40000420,0x26650,0x27e08,0x27e0c,0x40000430,0x26678,0x27e08
.long 0x27e00,0x40000480,0x266a0,0x27e08,0x27e04,0x40000490,0x266c8,0x27e08,0x27e08,0x400004a0,0x266f0,0x27e08,0x27e0c,0x400004b0,0x26718,0x27e08
.long 0x27e00,0x40000440,0x26740,0x27e08,0x27e04,0x40000450,0x26768,0x27e08,0x27e08,0x40000460,0x26790,0x27e08,0x27e0c,0x40000470,0x267b8,0x27e08
.long 0x27e00,0x400004c0,0x267e0,0x27e08,0x27e04,0x400004d0,0x26808,0x27e08,0x27e08,0x400004e0,0x26830,0x27e08,0x27e0c,0x400004f0,0x26858,0x27e08
.long 0x27e00,0x40000408,0x27000,0x27e08,0x27e04,0x40000418,0x27028,0x27e08,0x27e08,0x40000428,0x27050,0x27e08,0x27e0c,0x40000438,0x27078,0x27e08
.long 0x27e00,0x40000488,0x270a0,0x27e08,0x27e04,0x40000498,0x270c8,0x27e08,0x27e08,0x400004a8,0x270f0,0x27e08,0x27e0c,0x400004b8,0x27118,0x27e08
.long 0x27e00,0x40000448,0x27140,0x27e08,0x27e04,0x40000458,0x27168,0x27e08,0x27e08,0x40000468,0x27190,0x27e08,0x27e0c,0x40000478,0x271b8,0x27e08
.long 0x27e00,0x400004c8,0x271e0,0x27e08,0x27e04,0x400004d8,0x27208,0x27e08,0x27e08,0x400004e8,0x27230,0x27e08,0x27e0c,0x400004f8,0x27258,0x27e08
.long 0x27e00,0x500,0x25480,0x27e0c,0x27e04,0x510,0x254a8,0x27e0c,0x27e08,0x520,0x254d0,0x27e0c,0x27e0c,0x530,0x254f8,0x27e0c
.long 0x27e00,0x580,0x25520,0x27e0c,0x27e04,0x590,0x25548,0x27e0c,0x27e08,0x5a0,0x25570,0x27e0c,0x27e0c,0x5b0,0x25598,0x27e0c
.long 0x27e00,0x540,0x255c0,0x27e0c,0x27e04,0x550,0x255e8,0x27e0c,0x27e08,0x560,0x25610,0x27e0c,0x27e0c,0x570,0x25638,0x27e0c
.long 0x27e00,0x5c0,0x25660,0x27e0c,0x27e04,0x5d0,0x25688,0x27e0c,0x27e08,0x5e0,0x256b0,0x27e0c,0x27e0c,0x5f0,0x256d8,0x27e0c
.long 0x27e00,0x508,0x25e80,0x27e0c,0x27e04,0x518,0x25ea8,0x27e0c,0x27e08,0x528,0x25ed0,0x27e0c,0x27e0c,0x538,0x25ef8,0x27e0c
.long 0x27e00,0x588,0x25f20,0x27e0c,0x27e04,0x598,0x25f48,0x27e0c,0x27e08,0x5a8,0x25f70,0x27e0c,0x27e0c,0x5b8,0x25f98,0x27e0c
.long 0x27e00,0x548,0x25fc0,0x27e0c,0x27e04,0x558,0x25fe8,0x27e0c,0x27e08,0x568,0x26010,0x27e0c,0x27e0c,0x578,0x26038,0x27e0c
.long 0x27e00,0x5c8,0x26060,0x27e0c,0x27e04,0x5d8,0x26088,0x27e0c,0x27e08,0x5e8,0x260b0,0x27e0c,0x27e0c,0x5f8,0x260d8,0x27e0c
.long 0x27e00,0x40000500,0x26880,0x27e0c,0x27e04,0x40000510,0x268a8,0x27e0c,0x27e08,0x40000520,0x268d0,0x27e0c,0x27e0c,0x40000530,0x268f8,0x27e0c
.long 0x27e00,0x40000580,0x26920,0x27e0c,0x27e04,0x40000590,0x26948,0x27e0c,0x27e08,0x400005a0,0x26970,0x27e0c,0x27e0c,0x400005b0,0x26998,0x27e0c
.long 0x27e00,0x40000540,0x269c0,0x27e0c,0x27e04,0x40000550,0x269e8,0x27e0c,0x27e08,0x40000560,0x26a10,0x27e0c,0x27e0c,0x40000570,0x26a38,0x27e0c
.long 0x27e00,0x400005c0,0x26a60,0x27e0c,0x27e04,0x400005d0,0x26a88,0x27e0c,0x27e08,0x400005e0,0x26ab0,0x27e0c,0x27e0c,0x400005f0,0x26ad8,0x27e0c
.long 0x27e00,0x40000508,0x27280,0x27e0c,0x27e04,0x40000518,0x272a8,0x27e0c,0x27e08,0x40000528,0x272d0,0x27e0c,0x27e0c,0x40000538,0x272f8,0x27e0c
.long 0x27e00,0x40000588,0x27320,0x27e0c,0x27e04,0x40000598,0x27348,0x27e0c,0x27e08,0x400005a8,0x27370,0x27e0c,0x27e0c,0x400005b8,0x27398,0x27e0c
.long 0x27e00,0x40000548,0x273c0,0x27e0c,0x27e04,0x40000558,0x273e8,0x27e0c,0x27e08,0x40000568,0x27410,0x27e0c,0x27e0c,0x40000578,0x27438,0x27e0c
.long 0x27e00,0x400005c8,0x27460,0x27e0c,0x27e04,0x400005d8,0x27488,0x27e0c,0x27e08,0x400005e8,0x274b0,0x27e0c,0x27e0c,0x400005f8,0x274d8,0x27e0c
.long 0x27e00,0x200,0x24d00,0x27e00,0x27e04,0x210,0x24d28,0x27e00,0x27e08,0x220,0x24d50,0x27e00,0x27e0c,0x230,0x24d78,0x27e00
.long 0x27e00,0x280,0x24da0,0x27e00,0x27e04,0x290,0x24dc8,0x27e00,0x27e08,0x2a0,0x24df0,0x27e00,0x27e0c,0x2b0,0x24e18,0x27e00
.long 0x27e00,0x240,0x24e40,0x27e00,0x27e04,0x250,0x24e68,0x27e00,0x27e08,0x260,0x24e90,0x27e00,0x27e0c,0x270,0x24eb8,0x27e00
.long 0x27e00,0x2c0,0x24ee0,0x27e00,0x27e04,0x2d0,0x24f08,0x27e00,0x27e08,0x2e0,0x24f30,0x27e00,0x27e0c,0x2f0,0x24f58,0x27e00
.long 0x27e00,0x208,0x25700,0x27e00,0x27e04,0x218,0x25728,0x27e00,0x27e08,0x228,0x25750,0x27e00,0x27e0c,0x238,0x25778,0x27e00
.long 0x27e00,0x288,0x257a0,0x27e00,0x27e04,0x298,0x257c8,0x27e00,0x27e08,0x2a8,0x257f0,0x27e00,0x27e0c,0x2b8,0x25818,0x27e00
.long 0x27e00,0x248,0x25840,0x27e00,0x27e04,0x258,0x25868,0x27e00,0x27e08,0x268,0x25890,0x27e00,0x27e0c,0x278,0x258b8,0x27e00
.long 0x27e00,0x2c8,0x258e0,0x27e00,0x27e04,0x2d8,0x25908,0x27e00,0x27e08,0x2e8,0x25930,0x27e00,0x27e0c,0x2f8,0x25958,0x27e00
.long 0x27e00,0x40000200,0x26100,0x27e00,0x27e04,0x40000210,0x26128,0x27e00,0x27e08,0x40000220,0x26150,0x27e00,0x27e0c,0x40000230,0x26178,0x27e00
.long 0x27e00,0x40000280,0x261a0,0x27e00,0x27e04,0x40000290,0x261c8,0x27e00,0x27e08,0x400002a0,0x261f0,0x27e00,0x27e0c,0x400002b0,0x26218,0x27e00
.long 0x27e00,0x40000240,0x26240,0x27e00,0x27e04,0x40000250,0x26268,0x27e00,0x27e08,0x40000260,0x26290,0x27e00,0x27e0c,0x40000270,0x262b8,0x27e00
.long 0x27e00,0x400002c0,0x262e0,0x27e00,0x27e04,0x400002d0,0x26308,0x27e00,0x27e08,0x400002e0,0x26330,0x27e00,0x27e0c,0x400002f0,0x26358,0x27e00
.long 0x27e00,0x40000208,0x26b00,0x27e00,0x27e04,0x40000218,0x26b28,0x27e00,0x27e08,0x40000228,0x26b50,0x27e00,0x27e0c,0x40000238,0x26b78,0x27e00
.long 0x27e00,0x40000288,0x26ba0,0x27e00,0x27e04,0x40000298,0x26bc8,0x27e00,0x27e08,0x400002a8,0x26bf0,0x27e00,0x27e0c,0x400002b8,0x26c18,0x27e00
.long 0x27e00,0x40000248,0x26c40,0x27e00,0x27e04,0x40000258,0x26c68,0x27e00,0x27e08,0x40000268,0x26c90,0x27e00,0x27e0c,0x40000278,0x26cb8,0x27e00
.long 0x27e00,0x400002c8,0x26ce0,0x27e00,0x27e04,0x400002d8,0x26d08,0x27e00,0x27e08,0x400002e8,0x26d30,0x27e00,0x27e0c,0x400002f8,0x26d58,0x27e00
.long 0x27e00,0x300,0x24f80,0x27e04,0x27e04,0x310,0x24fa8,0x27e04,0x27e08,0x320,0x24fd0,0x27e04,0x27e0c,0x330,0x24ff8,0x27e04
.long 0x27e00,0x380,0x25020,0x27e04,0x27e04,0x390,0x25048,0x27e04,0x27e08,0x3a0,0x25070,0x27e04,0x27e0c,0x3b0,0x25098,0x27e04
.long 0x27e00,0x340,0x250c0,0x27e04,0x27e04,0x350,0x250e8,0x27e04,0x27e08,0x360,0x25110,0x27e04,0x27e0c,0x370,0x25138,0x27e04
.long 0x27e00,0x3c0,0x25160,0x27e04,0x27e04,0x3d0,0x25188,0x27e04,0x27e08,0x3e0,0x251b0,0x27e04,0x27e0c,0x3f0,0x251d8,0x27e04
.long 0x27e00,0x308,0x25980,0x27e04,0x27e04,0x318,0x259a8,0x27e04,0x27e08,0x328,0x259d0,0x27e04,0x27e0c,0x338,0x259f8,0x27e04
.long 0x27e00,0x388,0x25a20,0x27e04,0x27e04,0x398,0x25a48,0x27e04,0x27e08,0x3a8,0x25a70,0x27e04,0x27e0c,0x3b8,0x25a98,0x27e04
.long 0x27e00,0x348,0x25ac0,0x27e04,0x27e04,0x358,0x25ae8,0x27e04,0x27e08,0x368,0x25b10,0x27e04,0x27e0c,0x378,0x25b38,0x27e04
.long 0x27e00,0x3c8,0x25b60,0x27e04,0x27e04,0x3d8,0x25b88,0x27e04,0x27e08,0x3e8,0x25bb0,0x27e04,0x27e0c,0x3f8,0x25bd8,0x27e04
.long 0x27e00,0x40000300,0x26380,0x27e04,0x27e04,0x40000310,0x263a8,0x27e04,0x27e08,0x40000320,0x263d0,0x27e04,0x27e0c,0x40000330,0x263f8,0x27e04
.long 0x27e00,0x40000380,0x26420,0x27e04,0x27e04,0x40000390,0x26448,0x27e04,0x27e08,0x400003a0,0x26470,0x27e04,0x27e0c,0x400003b0,0x26498,0x27e04
.long 0x27e00,0x40000340,0x264c0,0x27e04,0x27e04,0x40000350,0x264e8,0x27e04,0x27e08,0x40000360,0x26510,0x27e04,0x27e0c,0x40000370,0x26538,0x27e04
.long 0x27e00,0x400003c0,0x26560,0x27e04,0x27e04,0x400003d0,0x26588,0x27e04,0x27e08,0x400003e0,0x265b0,0x27e04,0x27e0c,0x400003f0,0x265d8,0x27e04
.long 0x27e00,0x40000308,0x26d80,0x27e04,0x27e04,0x40000318,0x26da8,0x27e04,0x27e08,0x40000328,0x26dd0,0x27e04,0x27e0c,0x40000338,0x26df8,0x27e04
.long 0x27e00,0x40000388,0x26e20,0x27e04,0x27e04,0x40000398,0x26e48,0x27e04,0x27e08,0x400003a8,0x26e70,0x27e04,0x27e0c,0x400003b8,0x26e98,0x27e04
.long 0x27e00,0x40000348,0x26ec0,0x27e04,0x27e04,0x40000358,0x26ee8,0x27e04,0x27e08,0x40000368,0x26f10,0x27e04,0x27e0c,0x40000378,0x26f38,0x27e04
.long 0x27e00,0x400003c8,0x26f60,0x27e04,0x27e04,0x400003d8,0x26f88,0x27e04,0x27e08,0x400003e8,0x26fb0,0x27e04,0x27e0c,0x400003f8,0x26fd8,0x27e04
.long 0x27e00,0x600,0x25200,0x27e08,0x27e04,0x610,0x25228,0x27e08,0x27e08,0x620,0x25250,0x27e08,0x27e0c,0x630,0x25278,0x27e08
.long 0x27e00,0x680,0x252a0,0x27e08,0x27e04,0x690,0x252c8,0x27e08,0x27e08,0x6a0,0x252f0,0x27e08,0x27e0c,0x6b0,0x25318,0x27e08
.long 0x27e00,0x640,0x25340,0x27e08,0x27e04,0x650,0x25368,0x27e08,0x27e08,0x660,0x25390,0x27e08,0x27e0c,0x670,0x253b8,0x27e08
.long 0x27e00,0x6c0,0x253e0,0x27e08,0x27e04,0x6d0,0x25408,0x27e08,0x27e08,0x6e0,0x25430,0x27e08,0x27e0c,0x6f0,0x25458,0x27e08
.long 0x27e00,0x608,0x25c00,0x27e08,0x27e04,0x618,0x25c28,0x27e08,0x27e08,0x628,0x25c50,0x27e08,0x27e0c,0x638,0x25c78,0x27e08
.long 0x27e00,0x688,0x25ca0,0x27e08,0x27e04,0x698,0x25cc8,0x27e08,0x27e08,0x6a8,0x25cf0,0x27e08,0x27e0c,0x6b8,0x25d18,0x27e08
.long 0x27e00,0x648,0x25d40,0x27e08,0x27e04,0x658,0x25d68,0x27e08,0x27e08,0x668,0x25d90,0x27e08,0x27e0c,0x678,0x25db8,0x27e08
.long 0x27e00,0x6c8,0x25de0,0x27e08,0x27e04,0x6d8,0x25e08,0x27e08,0x27e08,0x6e8,0x25e30,0x27e08,0x27e0c,0x6f8,0x25e58,0x27e08
.long 0x27e00,0x40000600,0x26600,0x27e08,0x27e04,0x40000610,0x26628,0x27e08,0x27e08,0x40000620,0x26650,0x27e08,0x27e0c,0x40000630,0x26678,0x27e08
.long 0x27e00,0x40000680,0x266a0,0x27e08,0x27e04,0x40000690,0x266c8,0x27e08,0x27e08,0x400006a0,0x266f0,0x27e08,0x27e0c,0x400006b0,0x26718,0x27e08
.long 0x27e00,0x40000640,0x26740,0x27e08,0x27e04,0x40000650,0x26768,0x27e08,0x27e08,0x40000660,0x26790,0x27e08,0x27e0c,0x40000670,0x267b8,0x27e08
.long 0x27e00,0x400006c0,0x267e0,0x27e08,0x27e04,0x400006d0,0x26808,0x27e08,0x27e08,0x400006e0,0x26830,0x27e08,0x27e0c,0x400006f0,0x26858,0x27e08
.long 0x27e00,0x40000608,0x27000,0x27e08,0x27e04,0x40000618,0x27028,0x27e08,0x27e08,0x40000628,0x27050,0x27e08,0x27e0c,0x40000638,0x27078,0x27e08
.long 0x27e00,0x40000688,0x270a0,0x27e08,0x27e04,0x40000698,0x270c8,0x27e08,0x27e08,0x400006a8,0x270f0,0x27e08,0x27e0c,0x400006b8,0x27118,0x27e08
.long 0x27e00,0x40000648,0x27140,0x27e08,0x27e04,0x40000658,0x27168,0x27e08,0x27e08,0x40000668,0x27190,0x27e08,0x27e0c,0x40000678,0x271b8,0x27e08
.long 0x27e00,0x400006c8,0x271e0,0x27e08,0x27e04,0x400006d8,0x27208,0x27e08,0x27e08,0x400006e8,0x27230,0x27e08,0x27e0c,0x400006f8,0x27258,0x27e08
.long 0x27e00,0x700,0x25480,0x27e0c,0x27e04,0x710,0x254a8,0x27e0c,0x27e08,0x720,0x254d0,0x27e0c,0x27e0c,0x730,0x254f8,0x27e0c
.long 0x27e00,0x780,0x25520,0x27e0c,0x27e04,0x790,0x25548,0x27e0c,0x27e08,0x7a0,0x25570,0x27e0c,0x27e0c,0x7b0,0x25598,0x27e0c
.long 0x27e00,0x740,0x255c0,0x27e0c,0x27e04,0x750,0x255e8,0x27e0c,0x27e08,0x760,0x25610,0x27e0c,0x27e0c,0x770,0x25638,0x27e0c
.long 0x27e00,0x7c0,0x25660,0x27e0c,0x27e04,0x7d0,0x25688,0x27e0c,0x27e08,0x7e0,0x256b0,0x27e0c,0x27e0c,0x7f0,0x256d8,0x27e0c
.long 0x27e00,0x708,0x25e80,0x27e0c,0x27e04,0x718,0x25ea8,0x27e0c,0x27e08,0x728,0x25ed0,0x27e0c,0x27e0c,0x738,0x25ef8,0x27e0c
.long 0x27e00,0x788,0x25f20,0x27e0c,0x27e04,0x798,0x25f48,0x27e0c,0x27e08,0x7a8,0x25f70,0x27e0c,0x27e0c,0x7b8,0x25f98,0x27e0c
.long 0x27e00,0x748,0x25fc0,0x27e0c,0x27e04,0x758,0x25fe8,0x27e0c,0x27e08,0x768,0x26010,0x27e0c,0x27e0c,0x778,0x26038,0x27e0c
.long 0x27e00,0x7c8,0x26060,0x27e0c,0x27e04,0x7d8,0x26088,0x27e0c,0x27e08,0x7e8,0x260b0,0x27e0c,0x27e0c,0x7f8,0x260d8,0x27e0c
.long 0x27e00,0x40000700,0x26880,0x27e0c,0x27e04,0x40000710,0x268a8,0x27e0c,0x27e08,0x40000720,0x268d0,0x27e0c,0x27e0c,0x40000730,0x268f8,0x27e0c
.long 0x27e00,0x40000780,0x26920,0x27e0c,0x27e04,0x40000790,0x26948,0x27e0c,0x27e08,0x400007a0,0x26970,0x27e0c,0x27e0c,0x400007b0,0x26998,0x27e0c
.long 0x27e00,0x40000740,0x269c0,0x27e0c,0x27e04,0x40000750,0x269e8,0x27e0c,0x27e08,0x40000760,0x26a10,0x27e0c,0x27e0c,0x40000770,0x26a38,0x27e0c
.long 0x27e00,0x400007c0,0x26a60,0x27e0c,0x27e04,0x400007d0,0x26a88,0x27e0c,0x27e08,0x400007e0,0x26ab0,0x27e0c,0x27e0c,0x400007f0,0x26ad8,0x27e0c
.long 0x27e00,0x40000708,0x27280,0x27e0c,0x27e04,0x40000718,0x272a8,0x27e0c,0x27e08,0x40000728,0x272d0,0x27e0c,0x27e0c,0x40000738,0x272f8,0x27e0c
.long 0x27e00,0x40000788,0x27320,0x27e0c,0x27e04,0x40000798,0x27348,0x27e0c,0x27e08,0x400007a8,0x27370,0x27e0c,0x27e0c,0x400007b8,0x27398,0x27e0c
.long 0x27e00,0x40000748,0x273c0,0x27e0c,0x27e04,0x40000758,0x273e8,0x27e0c,0x27e08,0x40000768,0x27410,0x27e0c,0x27e0c,0x40000778,0x27438,0x27e0c
.long 0x27e00,0x400007c8,0x27460,0x27e0c,0x27e04,0x400007d8,0x27488,0x27e0c,0x27e08,0x400007e8,0x274b0,0x27e0c,0x27e0c,0x400007f8,0x274d8,0x27e0c
.long 0x27e00,0x800,0x24d00,0x27e00,0x27e04,0x810,0x24d28,0x27e00,0x27e08,0x820,0x24d50,0x27e00,0x27e0c,0x830,0x24d78,0x27e00
.long 0x27e00,0x880,0x24da0,0x27e00,0x27e04,0x890,0x24dc8,0x27e00,0x27e08,0x8a0,0x24df0,0x27e00,0x27e0c,0x8b0,0x24e18,0x27e00
.long 0x27e00,0x840,0x24e40,0x27e00,0x27e04,0x850,0x24e68,0x27e00,0x27e08,0x860,0x24e90,0x27e00,0x27e0c,0x870,0x24eb8,0x27e00
.long 0x27e00,0x8c0,0x24ee0,0x27e00,0x27e04,0x8d0,0x24f08,0x27e00,0x27e08,0x8e0,0x24f30,0x27e00,0x27e0c,0x8f0,0x24f58,0x27e00
.long 0x27e00,0x40000800,0x25700,0x27e00,0x27e04,0x40000810,0x25728,0x27e00,0x27e08,0x40000820,0x25750,0x27e00,0x27e0c,0x40000830,0x25778,0x27e00
.long 0x27e00,0x40000880,0x257a0,0x27e00,0x27e04,0x40000890,0x257c8,0x27e00,0x27e08,0x400008a0,0x257f0,0x27e00,0x27e0c,0x400008b0,0x25818,0x27e00
.long 0x27e00,0x40000840,0x25840,0x27e00,0x27e04,0x40000850,0x25868,0x27e00,0x27e08,0x40000860,0x25890,0x27e00,0x27e0c,0x40000870,0x258b8,0x27e00
.long 0x27e00,0x400008c0,0x258e0,0x27e00,0x27e04,0x400008d0,0x25908,0x27e00,0x27e08,0x400008e0,0x25930,0x27e00,0x27e0c,0x400008f0,0x25958,0x27e00
.long 0x27e00,0xa00,0x26100,0x27e00,0x27e04,0xa10,0x26128,0x27e00,0x27e08,0xa20,0x26150,0x27e00,0x27e0c,0xa30,0x26178,0x27e00
.long 0x27e00,0xa80,0x261a0,0x27e00,0x27e04,0xa90,0x261c8,0x27e00,0x27e08,0xaa0,0x261f0,0x27e00,0x27e0c,0xab0,0x26218,0x27e00
.long 0x27e00,0xa40,0x26240,0x27e00,0x27e04,0xa50,0x26268,0x27e00,0x27e08,0xa60,0x26290,0x27e00,0x27e0c,0xa70,0x262b8,0x27e00
.long 0x27e00,0xac0,0x262e0,0x27e00,0x27e04,0xad0,0x26308,0x27e00,0x27e08,0xae0,0x26330,0x27e00,0x27e0c,0xaf0,0x26358,0x27e00
.long 0x27e00,0x40000a00,0x26b00,0x27e00,0x27e04,0x40000a10,0x26b28,0x27e00,0x27e08,0x40000a20,0x26b50,0x27e00,0x27e0c,0x40000a30,0x26b78,0x27e00
.long 0x27e00,0x40000a80,0x26ba0,0x27e00,0x27e04,0x40000a90,0x26bc8,0x27e00,0x27e08,0x40000aa0,0x26bf0,0x27e00,0x27e0c,0x40000ab0,0x26c18,0x27e00
.long 0x27e00,0x40000a40,0x26c40,0x27e00,0x27e04,0x40000a50,0x26c68,0x27e00,0x27e08,0x40000a60,0x26c90,0x27e00,0x27e0c,0x40000a70,0x26cb8,0x27e00
.long 0x27e00,0x40000ac0,0x26ce0,0x27e00,0x27e04,0x40000ad0,0x26d08,0x27e00,0x27e08,0x40000ae0,0x26d30,0x27e00,0x27e0c,0x40000af0,0x26d58,0x27e00
.long 0x27e00,0x900,0x24f80,0x27e04,0x27e04,0x910,0x24fa8,0x27e04,0x27e08,0x920,0x24fd0,0x27e04,0x27e0c,0x930,0x24ff8,0x27e04
.long 0x27e00,0x980,0x25020,0x27e04,0x27e04,0x990,0x25048,0x27e04,0x27e08,0x9a0,0x25070,0x27e04,0x27e0c,0x9b0,0x25098,0x27e04
.long 0x27e00,0x940,0x250c0,0x27e04,0x27e04,0x950,0x250e8,0x27e04,0x27e08,0x960,0x25110,0x27e04,0x27e0c,0x970,0x25138,0x27e04
.long 0x27e00,0x9c0,0x25160,0x27e04,0x27e04,0x9d0,0x25188,0x27e04,0x27e08,0x9e0,0x251b0,0x27e04,0x27e0c,0x9f0,0x251d8,0x27e04
.long 0x27e00,0x40000900,0x25980,0x27e04,0x27e04,0x40000910,0x259a8,0x27e04,0x27e08,0x40000920,0x259d0,0x27e04,0x27e0c,0x40000930,0x259f8,0x27e04
.long 0x27e00,0x40000980,0x25a20,0x27e04,0x27e04,0x40000990,0x25a48,0x27e04,0x27e08,0x400009a0,0x25a70,0x27e04,0x27e0c,0x400009b0,0x25a98,0x27e04
.long 0x27e00,0x40000940,0x25ac0,0x27e04,0x27e04,0x40000950,0x25ae8,0x27e04,0x27e08,0x40000960,0x25b10,0x27e04,0x27e0c,0x40000970,0x25b38,0x27e04
.long 0x27e00,0x400009c0,0x25b60,0x27e04,0x27e04,0x400009d0,0x25b88,0x27e04,0x27e08,0x400009e0,0x25bb0,0x27e04,0x27e0c,0x400009f0,0x25bd8,0x27e04
.long 0x27e00,0xb00,0x26380,0x27e04,0x27e04,0xb10,0x263a8,0x27e04,0x27e08,0xb20,0x263d0,0x27e04,0x27e0c,0xb30,0x263f8,0x27e04
.long 0x27e00,0xb80,0x26420,0x27e04,0x27e04,0xb90,0x26448,0x27e04,0x27e08,0xba0,0x26470,0x27e04,0x27e0c,0xbb0,0x26498,0x27e04
.long 0x27e00,0xb40,0x264c0,0x27e04,0x27e04,0xb50,0x264e8,0x27e04,0x27e08,0xb60,0x26510,0x27e04,0x27e0c,0xb70,0x26538,0x27e04
.long 0x27e00,0xbc0,0x26560,0x27e04,0x27e04,0xbd0,0x26588,0x27e04,0x27e08,0xbe0,0x265b0,0x27e04,0x27e0c,0xbf0,0x265d8,0x27e04
.long 0x27e00,0x40000b00,0x26d80,0x27e04,0x27e04,0x40000b10,0x26da8,0x27e04,0x27e08,0x40000b20,0x26dd0,0x27e04,0x27e0c,0x40000b30,0x26df8,0x27e04
.long 0x27e00,0x40000b80,0x26e20,0x27e04,0x27e04,0x40000b90,0x26e48,0x27e04,0x27e08,0x40000ba0,0x26e70,0x27e04,0x27e0c,0x40000bb0,0x26e98,0x27e04
.long 0x27e00,0x40000b40,0x26ec0,0x27e04,0x27e04,0x40000b50,0x26ee8,0x27e04,0x27e08,0x40000b60,0x26f10,0x27e04,0x27e0c,0x40000b70,0x26f38,0x27e04
.long 0x27e00,0x40000bc0,0x26f60,0x27e04,0x27e04,0x40000bd0,0x26f88,0x27e04,0x27e08,0x40000be0,0x26fb0,0x27e04,0x27e0c,0x40000bf0,0x26fd8,0x27e04
.long 0x27e00,0x808,0x25200,0x27e08,0x27e04,0x818,0x25228,0x27e08,0x27e08,0x828,0x25250,0x27e08,0x27e0c,0x838,0x25278,0x27e08
.long 0x27e00,0x888,0x252a0,0x27e08,0x27e04,0x898,0x252c8,0x27e08,0x27e08,0x8a8,0x252f0,0x27e08,0x27e0c,0x8b8,0x25318,0x27e08
.long 0x27e00,0x848,0x25340,0x27e08,0x27e04,0x858,0x25368,0x27e08,0x27e08,0x868,0x25390,0x27e08,0x27e0c,0x878,0x253b8,0x27e08
.long 0x27e00,0x8c8,0x253e0,0x27e08,0x27e04,0x8d8,0x25408,0x27e08,0x27e08,0x8e8,0x25430,0x27e08,0x27e0c,0x8f8,0x25458,0x27e08
.long 0x27e00,0x40000808,0x25c00,0x27e08,0x27e04,0x40000818,0x25c28,0x27e08,0x27e08,0x40000828,0x25c50,0x27e08,0x27e0c,0x40000838,0x25c78,0x27e08
.long 0x27e00,0x40000888,0x25ca0,0x27e08,0x27e04,0x40000898,0x25cc8,0x27e08,0x27e08,0x400008a8,0x25cf0,0x27e08,0x27e0c,0x400008b8,0x25d18,0x27e08
.long 0x27e00,0x40000848,0x25d40,0x27e08,0x27e04,0x40000858,0x25d68,0x27e08,0x27e08,0x40000868,0x25d90,0x27e08,0x27e0c,0x40000878,0x25db8,0x27e08
.long 0x27e00,0x400008c8,0x25de0,0x27e08,0x27e04,0x400008d8,0x25e08,0x27e08,0x27e08,0x400008e8,0x25e30,0x27e08,0x27e0c,0x400008f8,0x25e58,0x27e08
.long 0x27e00,0xa08,0x26600,0x27e08,0x27e04,0xa18,0x26628,0x27e08,0x27e08,0xa28,0x26650,0x27e08,0x27e0c,0xa38,0x26678,0x27e08
.long 0x27e00,0xa88,0x266a0,0x27e08,0x27e04,0xa98,0x266c8,0x27e08,0x27e08,0xaa8,0x266f0,0x27e08,0x27e0c,0xab8,0x26718,0x27e08
.long 0x27e00,0xa48,0x26740,0x27e08,0x27e04,0xa58,0x26768,0x27e08,0x27e08,0xa68,0x26790,0x27e08,0x27e0c,0xa78,0x267b8,0x27e08
.long 0x27e00,0xac8,0x267e0,0x27e08,0x27e04,0xad8,0x26808,0x27e08,0x27e08,0xae8,0x26830,0x27e08,0x27e0c,0xaf8,0x26858,0x27e08
.long 0x27e00,0x40000a08,0x27000,0x27e08,0x27e04,0x40000a18,0x27028,0x27e08,0x27e08,0x40000a28,0x27050,0x27e08,0x27e0c,0x40000a38,0x27078,0x27e08
.long 0x27e00,0x40000a88,0x270a0,0x27e08,0x27e04,0x40000a98,0x270c8,0x27e08,0x27e08,0x40000aa8,0x270f0,0x27e08,0x27e0c,0x40000ab8,0x27118,0x27e08
.long 0x27e00,0x40000a48,0x27140,0x27e08,0x27e04,0x40000a58,0x27168,0x27e08,0x27e08,0x40000a68,0x27190,0x27e08,0x27e0c,0x40000a78,0x271b8,0x27e08
.long 0x27e00,0x40000ac8,0x271e0,0x27e08,0x27e04,0x40000ad8,0x27208,0x27e08,0x27e08,0x40000ae8,0x27230,0x27e08,0x27e0c,0x40000af8,0x27258,0x27e08
.long 0x27e00,0x908,0x25480,0x27e0c,0x27e04,0x918,0x254a8,0x27e0c,0x27e08,0x928,0x254d0,0x27e0c,0x27e0c,0x938,0x254f8,0x27e0c
.long 0x27e00,0x988,0x25520,0x27e0c,0x27e04,0x998,0x25548,0x27e0c,0x27e08,0x9a8,0x25570,0x27e0c,0x27e0c,0x9b8,0x25598,0x27e0c
.long 0x27e00,0x948,0x255c0,0x27e0c,0x27e04,0x958,0x255e8,0x27e0c,0x27e08,0x968,0x25610,0x27e0c,0x27e0c,0x978,0x25638,0x27e0c
.long 0x27e00,0x9c8,0x25660,0x27e0c,0x27e04,0x9d8,0x25688,0x27e0c,0x27e08,0x9e8,0x256b0,0x27e0c,0x27e0c,0x9f8,0x256d8,0x27e0c
.long 0x27e00,0x40000908,0x25e80,0x27e0c,0x27e04,0x40000918,0x25ea8,0x27e0c,0x27e08,0x40000928,0x25ed0,0x27e0c,0x27e0c,0x40000938,0x25ef8,0x27e0c
.long 0x27e00,0x40000988,0x25f20,0x27e0c,0x27e04,0x40000998,0x25f48,0x27e0c,0x27e08,0x400009a8,0x25f70,0x27e0c,0x27e0c,0x400009b8,0x25f98,0x27e0c
.long 0x27e00,0x40000948,0x25fc0,0x27e0c,0x27e04,0x40000958,0x25fe8,0x27e0c,0x27e08,0x40000968,0x26010,0x27e0c,0x27e0c,0x40000978,0x26038,0x27e0c
.long 0x27e00,0x400009c8,0x26060,0x27e0c,0x27e04,0x400009d8,0x26088,0x27e0c,0x27e08,0x400009e8,0x260b0,0x27e0c,0x27e0c,0x400009f8,0x260d8,0x27e0c
.long 0x27e00,0xb08,0x26880,0x27e0c,0x27e04,0xb18,0x268a8,0x27e0c,0x27e08,0xb28,0x268d0,0x27e0c,0x27e0c,0xb38,0x268f8,0x27e0c
.long 0x27e00,0xb88,0x26920,0x27e0c,0x27e04,0xb98,0x26948,0x27e0c,0x27e08,0xba8,0x26970,0x27e0c,0x27e0c,0xbb8,0x26998,0x27e0c
.long 0x27e00,0xb48,0x269c0,0x27e0c,0x27e04,0xb58,0x269e8,0x27e0c,0x27e08,0xb68,0x26a10,0x27e0c,0x27e0c,0xb78,0x26a38,0x27e0c
.long 0x27e00,0xbc8,0x26a60,0x27e0c,0x27e04,0xbd8,0x26a88,0x27e0c,0x27e08,0xbe8,0x26ab0,0x27e0c,0x27e0c,0xbf8,0x26ad8,0x27e0c
.long 0x27e00,0x40000b08,0x27280,0x27e0c,0x27e04,0x40000b18,0x272a8,0x27e0c,0x27e08,0x40000b28,0x272d0,0x27e0c,0x27e0c,0x40000b38,0x272f8,0x27e0c
.long 0x27e00,0x40000b88,0x27320,0x27e0c,0x27e04,0x40000b98,0x27348,0x27e0c,0x27e08,0x40000ba8,0x27370,0x27e0c,0x27e0c,0x40000bb8,0x27398,0x27e0c
.long 0x27e00,0x40000b48,0x273c0,0x27e0c,0x27e04,0x40000b58,0x273e8,0x27e0c,0x27e08,0x40000b68,0x27410,0x27e0c,0x27e0c,0x40000b78,0x27438,0x27e0c
.long 0x27e00,0x40000bc8,0x27460,0x27e0c,0x27e04,0x40000bd8,0x27488,0x27e0c,0x27e08,0x40000be8,0x274b0,0x27e0c,0x27e0c,0x40000bf8,0x274d8,0x27e0c
.long 0x27e00,0xc00,0x24d00,0x27e00,0x27e04,0xc10,0x24d28,0x27e00,0x27e08,0xc20,0x24d50,0x27e00,0x27e0c,0xc30,0x24d78,0x27e00
.long 0x27e00,0xc40,0x24da0,0x27e00,0x27e04,0xc50,0x24dc8,0x27e00,0x27e08,0xc60,0x24df0,0x27e00,0x27e0c,0xc70,0x24e18,0x27e00
.long 0x27e00,0x40000c00,0x24e40,0x27e00,0x27e04,0x40000c10,0x24e68,0x27e00,0x27e08,0x40000c20,0x24e90,0x27e00,0x27e0c,0x40000c30,0x24eb8,0x27e00
.long 0x27e00,0x40000c40,0x24ee0,0x27e00,0x27e04,0x40000c50,0x24f08,0x27e00,0x27e08,0x40000c60,0x24f30,0x27e00,0x27e0c,0x40000c70,0x24f58,0x27e00
.long 0x27e00,0xc08,0x25700,0x27e00,0x27e04,0xc18,0x25728,0x27e00,0x27e08,0xc28,0x25750,0x27e00,0x27e0c,0xc38,0x25778,0x27e00
.long 0x27e00,0xc48,0x257a0,0x27e00,0x27e04,0xc58,0x257c8,0x27e00,0x27e08,0xc68,0x257f0,0x27e00,0x27e0c,0xc78,0x25818,0x27e00
.long 0x27e00,0x40000c08,0x25840,0x27e00,0x27e04,0x40000c18,0x25868,0x27e00,0x27e08,0x40000c28,0x25890,0x27e00,0x27e0c,0x40000c38,0x258b8,0x27e00
.long 0x27e00,0x40000c48,0x258e0,0x27e00,0x27e04,0x40000c58,0x25908,0x27e00,0x27e08,0x40000c68,0x25930,0x27e00,0x27e0c,0x40000c78,0x25958,0x27e00
.long 0x27e00,0xd50,0x26100,0x27e00,0x27e04,0xd60,0x26128,0x27e00,0x27e08,0xd70,0x26150,0x27e00,0x27e0c,0xd80,0x26178,0x27e00
.long 0x27e00,0xd90,0x261a0,0x27e00,0x27e04,0xda0,0x261c8,0x27e00,0x27e08,0xdb0,0x261f0,0x27e00,0x27e0c,0xdc0,0x26218,0x27e00
.long 0x27e00,0x40000d50,0x26240,0x27e00,0x27e04,0x40000d60,0x26268,0x27e00,0x27e08,0x40000d70,0x26290,0x27e00,0x27e0c,0x40000d80,0x262b8,0x27e00
.long 0x27e00,0x40000d90,0x262e0,0x27e00,0x27e04,0x40000da0,0x26308,0x27e00,0x27e08,0x40000db0,0x26330,0x27e00,0x27e0c,0x40000dc0,0x26358,0x27e00
.long 0x27e00,0xd58,0x26b00,0x27e00,0x27e04,0xd68,0x26b28,0x27e00,0x27e08,0xd78,0x26b50,0x27e00,0x27e0c,0xd88,0x26b78,0x27e00
.long 0x27e00,0xd98,0x26ba0,0x27e00,0x27e04,0xda8,0x26bc8,0x27e00,0x27e08,0xdb8,0x26bf0,0x27e00,0x27e0c,0xdc8,0x26c18,0x27e00
.long 0x27e00,0x40000d58,0x26c40,0x27e00,0x27e04,0x40000d68,0x26c68,0x27e00,0x27e08,0x40000d78,0x26c90,0x27e00,0x27e0c,0x40000d88,0x26cb8,0x27e00
.long 0x27e00,0x40000d98,0x26ce0,0x27e00,0x27e04,0x40000da8,0x26d08,0x27e00,0x27e08,0x40000db8,0x26d30,0x27e00,0x27e0c,0x40000dc8,0x26d58,0x27e00
.long 0x27e00,0xea0,0x24f80,0x27e04,0x27e04,0xeb0,0x24fa8,0x27e04,0x27e08,0xec0,0x24fd0,0x27e04,0x27e0c,0xed0,0x24ff8,0x27e04
.long 0x27e00,0xee0,0x25020,0x27e04,0x27e04,0xef0,0x25048,0x27e04,0x27e08,0xf00,0x25070,0x27e04,0x27e0c,0xf10,0x25098,0x27e04
.long 0x27e00,0x40000ea0,0x250c0,0x27e04,0x27e04,0x40000eb0,0x250e8,0x27e04,0x27e08,0x40000ec0,0x25110,0x27e04,0x27e0c,0x40000ed0,0x25138,0x27e04
.long 0x27e00,0x40000ee0,0x25160,0x27e04,0x27e04,0x40000ef0,0x25188,0x27e04,0x27e08,0x40000f00,0x251b0,0x27e04,0x27e0c,0x40000f10,0x251d8,0x27e04
.long 0x27e00,0xea8,0x25980,0x27e04,0x27e04,0xeb8,0x259a8,0x27e04,0x27e08,0xec8,0x259d0,0x27e04,0x27e0c,0xed8,0x259f8,0x27e04
.long 0x27e00,0xee8,0x25a20,0x27e04,0x27e04,0xef8,0x25a48,0x27e04,0x27e08,0xf08,0x25a70,0x27e04,0x27e0c,0xf18,0x25a98,0x27e04
.long 0x27e00,0x40000ea8,0x25ac0,0x27e04,0x27e04,0x40000eb8,0x25ae8,0x27e04,0x27e08,0x40000ec8,0x25b10,0x27e04,0x27e0c,0x40000ed8,0x25b38,0x27e04
.long 0x27e00,0x40000ee8,0x25b60,0x27e04,0x27e04,0x40000ef8,0x25b88,0x27e04,0x27e08,0x40000f08,0x25bb0,0x27e04,0x27e0c,0x40000f18,0x25bd8,0x27e04
.long 0x27e00,0xff0,0x26380,0x27e04,0x27e04,0x1000,0x263a8,0x27e04,0x27e08,0x1010,0x263d0,0x27e04,0x27e0c,0x1020,0x263f8,0x27e04
.long 0x27e00,0x1030,0x26420,0x27e04,0x27e04,0x1040,0x26448,0x27e04,0x27e08,0x1050,0x26470,0x27e04,0x27e0c,0x1060,0x26498,0x27e04
.long 0x27e00,0x40000ff0,0x264c0,0x27e04,0x27e04,0x40001000,0x264e8,0x27e04,0x27e08,0x40001010,0x26510,0x27e04,0x27e0c,0x40001020,0x26538,0x27e04
.long 0x27e00,0x40001030,0x26560,0x27e04,0x27e04,0x40001040,0x26588,0x27e04,0x27e08,0x40001050,0x265b0,0x27e04,0x27e0c,0x40001060,0x265d8,0x27e04
.long 0x27e00,0xff8,0x26d80,0x27e04,0x27e04,0x1008,0x26da8,0x27e04,0x27e08,0x1018,0x26dd0,0x27e04,0x27e0c,0x1028,0x26df8,0x27e04
.long 0x27e00,0x1038,0x26e20,0x27e04,0x27e04,0x1048,0x26e48,0x27e04,0x27e08,0x1058,0x26e70,0x27e04,0x27e0c,0x1068,0x26e98,0x27e04
.long 0x27e00,0x40000ff8,0x26ec0,0x27e04,0x27e04,0x40001008,0x26ee8,0x27e04,0x27e08,0x40001018,0x26f10,0x27e04,0x27e0c,0x40001028,0x26f38,0x27e04
.long 0x27e00,0x40001038,0x26f60,0x27e04,0x27e04,0x40001048,0x26f88,0x27e04,0x27e08,0x40001058,0x26fb0,0x27e04,0x27e0c,0x40001068,0x26fd8,0x27e04
.long 0x27e00,0x1140,0x25200,0x27e08,0x27e04,0x1150,0x25228,0x27e08,0x27e08,0x1160,0x25250,0x27e08,0x27e0c,0x1170,0x25278,0x27e08
.long 0x27e00,0x1180,0x252a0,0x27e08,0x27e04,0x1190,0x252c8,0x27e08,0x27e08,0x11a0,0x252f0,0x27e08,0x27e0c,0x11b0,0x25318,0x27e08
.long 0x27e00,0x40001140,0x25340,0x27e08,0x27e04,0x40001150,0x25368,0x27e08,0x27e08,0x40001160,0x25390,0x27e08,0x27e0c,0x40001170,0x253b8,0x27e08
.long 0x27e00,0x40001180,0x253e0,0x27e08,0x27e04,0x40001190,0x25408,0x27e08,0x27e08,0x400011a0,0x25430,0x27e08,0x27e0c,0x400011b0,0x25458,0x27e08
.long 0x27e00,0x1148,0x25c00,0x27e08,0x27e04,0x1158,0x25c28,0x27e08,0x27e08,0x1168,0x25c50,0x27e08,0x27e0c,0x1178,0x25c78,0x27e08
.long 0x27e00,0x1188,0x25ca0,0x27e08,0x27e04,0x1198,0x25cc8,0x27e08,0x27e08,0x11a8,0x25cf0,0x27e08,0x27e0c,0x11b8,0x25d18,0x27e08
.long 0x27e00,0x40001148,0x25d40,0x27e08,0x27e04,0x40001158,0x25d68,0x27e08,0x27e08,0x40001168,0x25d90,0x27e08,0x27e0c,0x40001178,0x25db8,0x27e08
.long 0x27e00,0x40001188,0x25de0,0x27e08,0x27e04,0x40001198,0x25e08,0x27e08,0x27e08,0x400011a8,0x25e30,0x27e08,0x27e0c,0x400011b8,0x25e58,0x27e08
.long 0x27e00,0x1290,0x26600,0x27e08,0x27e04,0x12a0,0x26628,0x27e08,0x27e08,0x12b0,0x26650,0x27e08,0x27e0c,0x12c0,0x26678,0x27e08
.long 0x27e00,0x12d0,0x266a0,0x27e08,0x27e04,0x12e0,0x266c8,0x27e08,0x27e08,0x12f0,0x266f0,0x27e08,0x27e0c,0x1300,0x26718,0x27e08
.long 0x27e00,0x40001290,0x26740,0x27e08,0x27e04,0x400012a0,0x26768,0x27e08,0x27e08,0x400012b0,0x26790,0x27e08,0x27e0c,0x400012c0,0x267b8,0x27e08
.long 0x27e00,0x400012d0,0x267e0,0x27e08,0x27e04,0x400012e0,0x26808,0x27e08,0x27e08,0x400012f0,0x26830,0x27e08,0x27e0c,0x40001300,0x26858,0x27e08
.long 0x27e00,0x1298,0x27000,0x27e08,0x27e04,0x12a8,0x27028,0x27e08,0x27e08,0x12b8,0x27050,0x27e08,0x27e0c,0x12c8,0x27078,0x27e08
.long 0x27e00,0x12d8,0x270a0,0x27e08,0x27e04,0x12e8,0x270c8,0x27e08,0x27e08,0x12f8,0x270f0,0x27e08,0x27e0c,0x1308,0x27118,0x27e08
.long 0x27e00,0x40001298,0x27140,0x27e08,0x27e04,0x400012a8,0x27168,0x27e08,0x27e08,0x400012b8,0x27190,0x27e08,0x27e0c,0x400012c8,0x271b8,0x27e08
.long 0x27e00,0x400012d8,0x271e0,0x27e08,0x27e04,0x400012e8,0x27208,0x27e08,0x27e08,0x400012f8,0x27230,0x27e08,0x27e0c,0x40001308,0x27258,0x27e08
.long 0x27e00,0x13e0,0x25480,0x27e0c,0x27e04,0x13f0,0x254a8,0x27e0c,0x27e08,0x1400,0x254d0,0x27e0c,0x27e0c,0x1410,0x254f8,0x27e0c
.long 0x27e00,0x1420,0x25520,0x27e0c,0x27e04,0x1430,0x25548,0x27e0c,0x27e08,0x1440,0x25570,0x27e0c,0x27e0c,0x1450,0x25598,0x27e0c
.long 0x27e00,0x400013e0,0x255c0,0x27e0c,0x27e04,0x400013f0,0x255e8,0x27e0c,0x27e08,0x40001400,0x25610,0x27e0c,0x27e0c,0x40001410,0x25638,0x27e0c
.long 0x27e00,0x40001420,0x25660,0x27e0c,0x27e04,0x40001430,0x25688,0x27e0c,0x27e08,0x40001440,0x256b0,0x27e0c,0x27e0c,0x40001450,0x256d8,0x27e0c
.long 0x27e00,0x13e8,0x25e80,0x27e0c,0x27e04,0x13f8,0x25ea8,0x27e0c,0x27e08,0x1408,0x25ed0,0x27e0c,0x27e0c,0x1418,0x25ef8,0x27e0c
.long 0x27e00,0x1428,0x25f20,0x27e0c,0x27e04,0x1438,0x25f48,0x27e0c,0x27e08,0x1448,0x25f70,0x27e0c,0x27e0c,0x1458,0x25f98,0x27e0c
.long 0x27e00,0x400013e8,0x25fc0,0x27e0c,0x27e04,0x400013f8,0x25fe8,0x27e0c,0x27e08,0x40001408,0x26010,0x27e0c,0x27e0c,0x40001418,0x26038,0x27e0c
.long 0x27e00,0x40001428,0x26060,0x27e0c,0x27e04,0x40001438,0x26088,0x27e0c,0x27e08,0x40001448,0x260b0,0x27e0c,0x27e0c,0x40001458,0x260d8,0x27e0c
.long 0x27e00,0x1530,0x26880,0x27e0c,0x27e04,0x1540,0x268a8,0x27e0c,0x27e08,0x1550,0x268d0,0x27e0c,0x27e0c,0x1560,0x268f8,0x27e0c
.long 0x27e00,0x1570,0x26920,0x27e0c,0x27e04,0x1580,0x26948,0x27e0c,0x27e08,0x1590,0x26970,0x27e0c,0x27e0c,0x15a0,0x26998,0x27e0c
.long 0x27e00,0x40001530,0x269c0,0x27e0c,0x27e04,0x40001540,0x269e8,0x27e0c,0x27e08,0x40001550,0x26a10,0x27e0c,0x27e0c,0x40001560,0x26a38,0x27e0c
.long 0x27e00,0x40001570,0x26a60,0x27e0c,0x27e04,0x40001580,0x26a88,0x27e0c,0x27e08,0x40001590,0x26ab0,0x27e0c,0x27e0c,0x400015a0,0x26ad8,0x27e0c
.long 0x27e00,0x1538,0x27280,0x27e0c,0x27e04,0x1548,0x272a8,0x27e0c,0x27e08,0x1558,0x272d0,0x27e0c,0x27e0c,0x1568,0x272f8,0x27e0c
.long 0x27e00,0x1578,0x27320,0x27e0c,0x27e04,0x1588,0x27348,0x27e0c,0x27e08,0x1598,0x27370,0x27e0c,0x27e0c,0x15a8,0x27398,0x27e0c
.long 0x27e00,0x40001538,0x273c0,0x27e0c,0x27e04,0x40001548,0x273e8,0x27e0c,0x27e08,0x40001558,0x27410,0x27e0c,0x27e0c,0x40001568,0x27438,0x27e0c
.long 0x27e00,0x40001578,0x27460,0x27e0c,0x27e04,0x40001588,0x27488,0x27e0c,0x27e08,0x40001598,0x274b0,0x27e0c,0x27e0c,0x400015a8,0x274d8,0x27e0c
.long 0x27e00,0xc80,0x24d00,0x27e00,0x27e04,0xc90,0x24d28,0x27e00,0x27e08,0xca0,0x24d50,0x27e00,0x27e0c,0xcb0,0x24d78,0x27e00
.long 0x27e00,0xcc0,0x24da0,0x27e00,0x27e04,0xcd0,0x24dc8,0x27e00,0x27e08,0xce0,0x24df0,0x27e00,0x27e0c,0xcf0,0x24e18,0x27e00
.long 0x27e00,0x40000c80,0x24e40,0x27e00,0x27e04,0x40000c90,0x24e68,0x27e00,0x27e08,0x40000ca0,0x24e90,0x27e00,0x27e0c,0x40000cb0,0x24eb8,0x27e00
.long 0x27e00,0x40000cc0,0x24ee0,0x27e00,0x27e04,0x40000cd0,0x24f08,0x27e00,0x27e08,0x40000ce0,0x24f30,0x27e00,0x27e0c,0x40000cf0,0x24f58,0x27e00
.long 0x27e00,0xc88,0x25700,0x27e00,0x27e04,0xc98,0x25728,0x27e00,0x27e08,0xca8,0x25750,0x27e00,0x27e0c,0xcb8,0x25778,0x27e00
.long 0x27e00,0xcc8,0x257a0,0x27e00,0x27e04,0xcd8,0x257c8,0x27e00,0x27e08,0xce8,0x257f0,0x27e00,0x27e0c,0xcf8,0x25818,0x27e00
.long 0x27e00,0x40000c88,0x25840,0x27e00,0x27e04,0x40000c98,0x25868,0x27e00,0x27e08,0x40000ca8,0x25890,0x27e00,0x27e0c,0x40000cb8,0x258b8,0x27e00
.long 0x27e00,0x40000cc8,0x258e0,0x27e00,0x27e04,0x40000cd8,0x25908,0x27e00,0x27e08,0x40000ce8,0x25930,0x27e00,0x27e0c,0x40000cf8,0x25958,0x27e00
.long 0x27e00,0xdd0,0x26100,0x27e00,0x27e04,0xde0,0x26128,0x27e00,0x27e08,0xdf0,0x26150,0x27e00,0x27e0c,0xe00,0x26178,0x27e00
.long 0x27e00,0xe10,0x261a0,0x27e00,0x27e04,0xe20,0x261c8,0x27e00,0x27e08,0xe30,0x261f0,0x27e00,0x27e0c,0xe40,0x26218,0x27e00
.long 0x27e00,0x40000dd0,0x26240,0x27e00,0x27e04,0x40000de0,0x26268,0x27e00,0x27e08,0x40000df0,0x26290,0x27e00,0x27e0c,0x40000e00,0x262b8,0x27e00
.long 0x27e00,0x40000e10,0x262e0,0x27e00,0x27e04,0x40000e20,0x26308,0x27e00,0x27e08,0x40000e30,0x26330,0x27e00,0x27e0c,0x40000e40,0x26358,0x27e00
.long 0x27e00,0xdd8,0x26b00,0x27e00,0x27e04,0xde8,0x26b28,0x27e00,0x27e08,0xdf8,0x26b50,0x27e00,0x27e0c,0xe08,0x26b78,0x27e00
.long 0x27e00,0xe18,0x26ba0,0x27e00,0x27e04,0xe28,0x26bc8,0x27e00,0x27e08,0xe38,0x26bf0,0x27e00,0x27e0c,0xe48,0x26c18,0x27e00
.long 0x27e00,0x40000dd8,0x26c40,0x27e00,0x27e04,0x40000de8,0x26c68,0x27e00,0x27e08,0x40000df8,0x26c90,0x27e00,0x27e0c,0x40000e08,0x26cb8,0x27e00
.long 0x27e00,0x40000e18,0x26ce0,0x27e00,0x27e04,0x40000e28,0x26d08,0x27e00,0x27e08,0x40000e38,0x26d30,0x27e00,0x27e0c,0x40000e48,0x26d58,0x27e00
.long 0x27e00,0xf20,0x24f80,0x27e04,0x27e04,0xf30,0x24fa8,0x27e04,0x27e08,0xf40,0x24fd0,0x27e04,0x27e0c,0xf50,0x24ff8,0x27e04
.long 0x27e00,0xf60,0x25020,0x27e04,0x27e04,0xf70,0x25048,0x27e04,0x27e08,0xf80,0x25070,0x27e04,0x27e0c,0xf90,0x25098,0x27e04
.long 0x27e00,0x40000f20,0x250c0,0x27e04,0x27e04,0x40000f30,0x250e8,0x27e04,0x27e08,0x40000f40,0x25110,0x27e04,0x27e0c,0x40000f50,0x25138,0x27e04
.long 0x27e00,0x40000f60,0x25160,0x27e04,0x27e04,0x40000f70,0x25188,0x27e04,0x27e08,0x40000f80,0x251b0,0x27e04,0x27e0c,0x40000f90,0x251d8,0x27e04
.long 0x27e00,0xf28,0x25980,0x27e04,0x27e04,0xf38,0x259a8,0x27e04,0x27e08,0xf48,0x259d0,0x27e04,0x27e0c,0xf58,0x259f8,0x27e04
.long 0x27e00,0xf68,0x25a20,0x27e04,0x27e04,0xf78,0x25a48,0x27e04,0x27e08,0xf88,0x25a70,0x27e04,0x27e0c,0xf98,0x25a98,0x27e04
.long 0x27e00,0x40000f28,0x25ac0,0x27e04,0x27e04,0x40000f38,0x25ae8,0x27e04,0x27e08,0x40000f48,0x25b10,0x27e04,0x27e0c,0x40000f58,0x25b38,0x27e04
.long 0x27e00,0x40000f68,0x25b60,0x27e04,0x27e04,0x40000f78,0x25b88,0x27e04,0x27e08,0x40000f88,0x25bb0,0x27e04,0x27e0c,0x40000f98,0x25bd8,0x27e04
.long 0x27e00,0x1070,0x26380,0x27e04,0x27e04,0x1080,0x263a8,0x27e04,0x27e08,0x1090,0x263d0,0x27e04,0x27e0c,0x10a0,0x263f8,0x27e04
.long 0x27e00,0x10b0,0x26420,0x27e04,0x27e04,0x10c0,0x26448,0x27e04,0x27e08,0x10d0,0x26470,0x27e04,0x27e0c,0x10e0,0x26498,0x27e04
.long 0x27e00,0x40001070,0x264c0,0x27e04,0x27e04,0x40001080,0x264e8,0x27e04,0x27e08,0x40001090,0x26510,0x27e04,0x27e0c,0x400010a0,0x26538,0x27e04
.long 0x27e00,0x400010b0,0x26560,0x27e04,0x27e04,0x400010c0,0x26588,0x27e04,0x27e08,0x400010d0,0x265b0,0x27e04,0x27e0c,0x400010e0,0x265d8,0x27e04
.long 0x27e00,0x1078,0x26d80,0x27e04,0x27e04,0x1088,0x26da8,0x27e04,0x27e08,0x1098,0x26dd0,0x27e04,0x27e0c,0x10a8,0x26df8,0x27e04
.long 0x27e00,0x10b8,0x26e20,0x27e04,0x27e04,0x10c8,0x26e48,0x27e04,0x27e08,0x10d8,0x26e70,0x27e04,0x27e0c,0x10e8,0x26e98,0x27e04
.long 0x27e00,0x40001078,0x26ec0,0x27e04,0x27e04,0x40001088,0x26ee8,0x27e04,0x27e08,0x40001098,0x26f10,0x27e04,0x27e0c,0x400010a8,0x26f38,0x27e04
.long 0x27e00,0x400010b8,0x26f60,0x27e04,0x27e04,0x400010c8,0x26f88,0x27e04,0x27e08,0x400010d8,0x26fb0,0x27e04,0x27e0c,0x400010e8,0x26fd8,0x27e04
.long 0x27e00,0x11c0,0x25200,0x27e08,0x27e04,0x11d0,0x25228,0x27e08,0x27e08,0x11e0,0x25250,0x27e08,0x27e0c,0x11f0,0x25278,0x27e08
.long 0x27e00,0x1200,0x252a0,0x27e08,0x27e04,0x1210,0x252c8,0x27e08,0x27e08,0x1220,0x252f0,0x27e08,0x27e0c,0x1230,0x25318,0x27e08
.long 0x27e00,0x400011c0,0x25340,0x27e08,0x27e04,0x400011d0,0x25368,0x27e08,0x27e08,0x400011e0,0x25390,0x27e08,0x27e0c,0x400011f0,0x253b8,0x27e08
.long 0x27e00,0x40001200,0x253e0,0x27e08,0x27e04,0x40001210,0x25408,0x27e08,0x27e08,0x40001220,0x25430,0x27e08,0x27e0c,0x40001230,0x25458,0x27e08
.long 0x27e00,0x11c8,0x25c00,0x27e08,0x27e04,0x11d8,0x25c28,0x27e08,0x27e08,0x11e8,0x25c50,0x27e08,0x27e0c,0x11f8,0x25c78,0x27e08
.long 0x27e00,0x1208,0x25ca0,0x27e08,0x27e04,0x1218,0x25cc8,0x27e08,0x27e08,0x1228,0x25cf0,0x27e08,0x27e0c,0x1238,0x25d18,0x27e08
.long 0x27e00,0x400011c8,0x25d40,0x27e08,0x27e04,0x400011d8,0x25d68,0x27e08,0x27e08,0x400011e8,0x25d90,0x27e08,0x27e0c,0x400011f8,0x25db8,0x27e08
.long 0x27e00,0x40001208,0x25de0,0x27e08,0x27e04,0x40001218,0x25e08,0x27e08,0x27e08,0x40001228,0x25e30,0x27e08,0x27e0c,0x40001238,0x25e58,0x27e08
.long 0x27e00,0x1310,0x26600,0x27e08,0x27e04,0x1320,0x26628,0x27e08,0x27e08,0x1330,0x26650,0x27e08,0x27e0c,0x1340,0x26678,0x27e08
.long 0x27e00,0x1350,0x266a0,0x27e08,0x27e04,0x1360,0x266c8,0x27e08,0x27e08,0x1370,0x266f0,0x27e08,0x27e0c,0x1380,0x26718,0x27e08
.long 0x27e00,0x40001310,0x26740,0x27e08,0x27e04,0x40001320,0x26768,0x27e08,0x27e08,0x40001330,0x26790,0x27e08,0x27e0c,0x40001340,0x267b8,0x27e08
.long 0x27e00,0x40001350,0x267e0,0x27e08,0x27e04,0x40001360,0x26808,0x27e08,0x27e08,0x40001370,0x26830,0x27e08,0x27e0c,0x40001380,0x26858,0x27e08
.long 0x27e00,0x1318,0x27000,0x27e08,0x27e04,0x1328,0x27028,0x27e08,0x27e08,0x1338,0x27050,0x27e08,0x27e0c,0x1348,0x27078,0x27e08
.long 0x27e00,0x1358,0x270a0,0x27e08,0x27e04,0x1368,0x270c8,0x27e08,0x27e08,0x1378,0x270f0,0x27e08,0x27e0c,0x1388,0x27118,0x27e08
.long 0x27e00,0x40001318,0x27140,0x27e08,0x27e04,0x40001328,0x27168,0x27e08,0x27e08,0x40001338,0x27190,0x27e08,0x27e0c,0x40001348,0x271b8,0x27e08
.long 0x27e00,0x40001358,0x271e0,0x27e08,0x27e04,0x40001368,0x27208,0x27e08,0x27e08,0x40001378,0x27230,0x27e08,0x27e0c,0x40001388,0x27258,0x27e08
.long 0x27e00,0x1460,0x25480,0x27e0c,0x27e04,0x1470,0x254a8,0x27e0c,0x27e08,0x1480,0x254d0,0x27e0c,0x27e0c,0x1490,0x254f8,0x27e0c
.long 0x27e00,0x14a0,0x25520,0x27e0c,0x27e04,0x14b0,0x25548,0x27e0c,0x27e08,0x14c0,0x25570,0x27e0c,0x27e0c,0x14d0,0x25598,0x27e0c
.long 0x27e00,0x40001460,0x255c0,0x27e0c,0x27e04,0x40001470,0x255e8,0x27e0c,0x27e08,0x40001480,0x25610,0x27e0c,0x27e0c,0x40001490,0x25638,0x27e0c
.long 0x27e00,0x400014a0,0x25660,0x27e0c,0x27e04,0x400014b0,0x25688,0x27e0c,0x27e08,0x400014c0,0x256b0,0x27e0c,0x27e0c,0x400014d0,0x256d8,0x27e0c
.long 0x27e00,0x1468,0x25e80,0x27e0c,0x27e04,0x1478,0x25ea8,0x27e0c,0x27e08,0x1488,0x25ed0,0x27e0c,0x27e0c,0x1498,0x25ef8,0x27e0c
.long 0x27e00,0x14a8,0x25f20,0x27e0c,0x27e04,0x14b8,0x25f48,0x27e0c,0x27e08,0x14c8,0x25f70,0x27e0c,0x27e0c,0x14d8,0x25f98,0x27e0c
.long 0x27e00,0x40001468,0x25fc0,0x27e0c,0x27e04,0x40001478,0x25fe8,0x27e0c,0x27e08,0x40001488,0x26010,0x27e0c,0x27e0c,0x40001498,0x26038,0x27e0c
.long 0x27e00,0x400014a8,0x26060,0x27e0c,0x27e04,0x400014b8,0x26088,0x27e0c,0x27e08,0x400014c8,0x260b0,0x27e0c,0x27e0c,0x400014d8,0x260d8,0x27e0c
.long 0x27e00,0x15b0,0x26880,0x27e0c,0x27e04,0x15c0,0x268a8,0x27e0c,0x27e08,0x15d0,0x268d0,0x27e0c,0x27e0c,0x15e0,0x268f8,0x27e0c
.long 0x27e00,0x15f0,0x26920,0x27e0c,0x27e04,0x1600,0x26948,0x27e0c,0x27e08,0x1610,0x26970,0x27e0c,0x27e0c,0x1620,0x26998,0x27e0c
.long 0x27e00,0x400015b0,0x269c0,0x27e0c,0x27e04,0x400015c0,0x269e8,0x27e0c,0x27e08,0x400015d0,0x26a10,0x27e0c,0x27e0c,0x400015e0,0x26a38,0x27e0c
.long 0x27e00,0x400015f0,0x26a60,0x27e0c,0x27e04,0x40001600,0x26a88,0x27e0c,0x27e08,0x40001610,0x26ab0,0x27e0c,0x27e0c,0x40001620,0x26ad8,0x27e0c
.long 0x27e00,0x15b8,0x27280,0x27e0c,0x27e04,0x15c8,0x272a8,0x27e0c,0x27e08,0x15d8,0x272d0,0x27e0c,0x27e0c,0x15e8,0x272f8,0x27e0c
.long 0x27e00,0x15f8,0x27320,0x27e0c,0x27e04,0x1608,0x27348,0x27e0c,0x27e08,0x1618,0x27370,0x27e0c,0x27e0c,0x1628,0x27398,0x27e0c
.long 0x27e00,0x400015b8,0x273c0,0x27e0c,0x27e04,0x400015c8,0x273e8,0x27e0c,0x27e08,0x400015d8,0x27410,0x27e0c,0x27e0c,0x400015e8,0x27438,0x27e0c
.long 0x27e00,0x400015f8,0x27460,0x27e0c,0x27e04,0x40001608,0x27488,0x27e0c,0x27e08,0x40001618,0x274b0,0x27e0c,0x27e0c,0x40001628,0x274d8,0x27e0c
.long 0x27e00,0xd00,0x24d00,0x27e00,0x27e04,0xd10,0x24d28,0x27e00,0x27e08,0xd20,0x24d50,0x27e00,0x27e0c,0xd30,0x24d78,0x27e00
.long 0x27e00,0x40000d40,0x24da0,0x27e00,0x27e04,0x40000d50,0x24dc8,0x27e00,0x27e08,0x40000d60,0x24df0,0x27e00,0x27e0c,0x40000d70,0x24e18,0x27e00
.long 0x27e00,0x40000d00,0x24e40,0x27e00,0x27e04,0x40000d10,0x24e68,0x27e00,0x27e08,0x40000d20,0x24e90,0x27e00,0x27e0c,0x40000d30,0x24eb8,0x27e00
.long 0x27e00,0x40000d40,0x24ee0,0x27e00,0x27e04,0x40000d50,0x24f08,0x27e00,0x27e08,0x40000d60,0x24f30,0x27e00,0x27e0c,0x40000d70,0x24f58,0x27e00
.long 0x27e00,0xd08,0x25700,0x27e00,0x27e04,0xd18,0x25728,0x27e00,0x27e08,0xd28,0x25750,0x27e00,0x27e0c,0xd38,0x25778,0x27e00
.long 0x27e00,0x40000d48,0x257a0,0x27e00,0x27e04,0x40000d58,0x257c8,0x27e00,0x27e08,0x40000d68,0x257f0,0x27e00,0x27e0c,0x40000d78,0x25818,0x27e00
.long 0x27e00,0x40000d08,0x25840,0x27e00,0x27e04,0x40000d18,0x25868,0x27e00,0x27e08,0x40000d28,0x25890,0x27e00,0x27e0c,0x40000d38,0x258b8,0x27e00
.long 0x27e00,0x40000d48,0x258e0,0x27e00,0x27e04,0x40000d58,0x25908,0x27e00,0x27e08,0x40000d68,0x25930,0x27e00,0x27e0c,0x40000d78,0x25958,0x27e00
.long 0x27e00,0xe50,0x26100,0x27e00,0x27e04,0xe60,0x26128,0x27e00,0x27e08,0xe70,0x26150,0x27e00,0x27e0c,0xe80,0x26178,0x27e00
.long 0x27e00,0x40000e90,0x261a0,0x27e00,0x27e04,0x40000ea0,0x261c8,0x27e00,0x27e08,0x40000eb0,0x261f0,0x27e00,0x27e0c,0x40000ec0,0x26218,0x27e00
.long 0x27e00,0x40000e50,0x26240,0x27e00,0x27e04,0x40000e60,0x26268,0x27e00,0x27e08,0x40000e70,0x26290,0x27e00,0x27e0c,0x40000e80,0x262b8,0x27e00
.long 0x27e00,0x40000e90,0x262e0,0x27e00,0x27e04,0x40000ea0,0x26308,0x27e00,0x27e08,0x40000eb0,0x26330,0x27e00,0x27e0c,0x40000ec0,0x26358,0x27e00
.long 0x27e00,0xe58,0x26b00,0x27e00,0x27e04,0xe68,0x26b28,0x27e00,0x27e08,0xe78,0x26b50,0x27e00,0x27e0c,0xe88,0x26b78,0x27e00
.long 0x27e00,0x40000e98,0x26ba0,0x27e00,0x27e04,0x40000ea8,0x26bc8,0x27e00,0x27e08,0x40000eb8,0x26bf0,0x27e00,0x27e0c,0x40000ec8,0x26c18,0x27e00
.long 0x27e00,0x40000e58,0x26c40,0x27e00,0x27e04,0x40000e68,0x26c68,0x27e00,0x27e08,0x40000e78,0x26c90,0x27e00,0x27e0c,0x40000e88,0x26cb8,0x27e00
.long 0x27e00,0x40000e98,0x26ce0,0x27e00,0x27e04,0x40000ea8,0x26d08,0x27e00,0x27e08,0x40000eb8,0x26d30,0x27e00,0x27e0c,0x40000ec8,0x26d58,0x27e00
.long 0x27e00,0xfa0,0x24f80,0x27e04,0x27e04,0xfb0,0x24fa8,0x27e04,0x27e08,0xfc0,0x24fd0,0x27e04,0x27e0c,0xfd0,0x24ff8,0x27e04
.long 0x27e00,0x40000fe0,0x25020,0x27e04,0x27e04,0x40000ff0,0x25048,0x27e04,0x27e08,0x40001000,0x25070,0x27e04,0x27e0c,0x40001010,0x25098,0x27e04
.long 0x27e00,0x40000fa0,0x250c0,0x27e04,0x27e04,0x40000fb0,0x250e8,0x27e04,0x27e08,0x40000fc0,0x25110,0x27e04,0x27e0c,0x40000fd0,0x25138,0x27e04
.long 0x27e00,0x40000fe0,0x25160,0x27e04,0x27e04,0x40000ff0,0x25188,0x27e04,0x27e08,0x40001000,0x251b0,0x27e04,0x27e0c,0x40001010,0x251d8,0x27e04
.long 0x27e00,0xfa8,0x25980,0x27e04,0x27e04,0xfb8,0x259a8,0x27e04,0x27e08,0xfc8,0x259d0,0x27e04,0x27e0c,0xfd8,0x259f8,0x27e04
.long 0x27e00,0x40000fe8,0x25a20,0x27e04,0x27e04,0x40000ff8,0x25a48,0x27e04,0x27e08,0x40001008,0x25a70,0x27e04,0x27e0c,0x40001018,0x25a98,0x27e04
.long 0x27e00,0x40000fa8,0x25ac0,0x27e04,0x27e04,0x40000fb8,0x25ae8,0x27e04,0x27e08,0x40000fc8,0x25b10,0x27e04,0x27e0c,0x40000fd8,0x25b38,0x27e04
.long 0x27e00,0x40000fe8,0x25b60,0x27e04,0x27e04,0x40000ff8,0x25b88,0x27e04,0x27e08,0x40001008,0x25bb0,0x27e04,0x27e0c,0x40001018,0x25bd8,0x27e04
.long 0x27e00,0x10f0,0x26380,0x27e04,0x27e04,0x1100,0x263a8,0x27e04,0x27e08,0x1110,0x263d0,0x27e04,0x27e0c,0x1120,0x263f8,0x27e04
.long 0x27e00,0x40001130,0x26420,0x27e04,0x27e04,0x40001140,0x26448,0x27e04,0x27e08,0x40001150,0x26470,0x27e04,0x27e0c,0x40001160,0x26498,0x27e04
.long 0x27e00,0x400010f0,0x264c0,0x27e04,0x27e04,0x40001100,0x264e8,0x27e04,0x27e08,0x40001110,0x26510,0x27e04,0x27e0c,0x40001120,0x26538,0x27e04
.long 0x27e00,0x40001130,0x26560,0x27e04,0x27e04,0x40001140,0x26588,0x27e04,0x27e08,0x40001150,0x265b0,0x27e04,0x27e0c,0x40001160,0x265d8,0x27e04
.long 0x27e00,0x10f8,0x26d80,0x27e04,0x27e04,0x1108,0x26da8,0x27e04,0x27e08,0x1118,0x26dd0,0x27e04,0x27e0c,0x1128,0x26df8,0x27e04
.long 0x27e00,0x40001138,0x26e20,0x27e04,0x27e04,0x40001148,0x26e48,0x27e04,0x27e08,0x40001158,0x26e70,0x27e04,0x27e0c,0x40001168,0x26e98,0x27e04
.long 0x27e00,0x400010f8,0x26ec0,0x27e04,0x27e04,0x40001108,0x26ee8,0x27e04,0x27e08,0x40001118,0x26f10,0x27e04,0x27e0c,0x40001128,0x26f38,0x27e04
.long 0x27e00,0x40001138,0x26f60,0x27e04,0x27e04,0x40001148,0x26f88,0x27e04,0x27e08,0x40001158,0x26fb0,0x27e04,0x27e0c,0x40001168,0x26fd8,0x27e04
.long 0x27e00,0x1240,0x25200,0x27e08,0x27e04,0x1250,0x25228,0x27e08,0x27e08,0x1260,0x25250,0x27e08,0x27e0c,0x1270,0x25278,0x27e08
.long 0x27e00,0x40001280,0x252a0,0x27e08,0x27e04,0x40001290,0x252c8,0x27e08,0x27e08,0x400012a0,0x252f0,0x27e08,0x27e0c,0x400012b0,0x25318,0x27e08
.long 0x27e00,0x40001240,0x25340,0x27e08,0x27e04,0x40001250,0x25368,0x27e08,0x27e08,0x40001260,0x25390,0x27e08,0x27e0c,0x40001270,0x253b8,0x27e08
.long 0x27e00,0x40001280,0x253e0,0x27e08,0x27e04,0x40001290,0x25408,0x27e08,0x27e08,0x400012a0,0x25430,0x27e08,0x27e0c,0x400012b0,0x25458,0x27e08
.long 0x27e00,0x1248,0x25c00,0x27e08,0x27e04,0x1258,0x25c28,0x27e08,0x27e08,0x1268,0x25c50,0x27e08,0x27e0c,0x1278,0x25c78,0x27e08
.long 0x27e00,0x40001288,0x25ca0,0x27e08,0x27e04,0x40001298,0x25cc8,0x27e08,0x27e08,0x400012a8,0x25cf0,0x27e08,0x27e0c,0x400012b8,0x25d18,0x27e08
.long 0x27e00,0x40001248,0x25d40,0x27e08,0x27e04,0x40001258,0x25d68,0x27e08,0x27e08,0x40001268,0x25d90,0x27e08,0x27e0c,0x40001278,0x25db8,0x27e08
.long 0x27e00,0x40001288,0x25de0,0x27e08,0x27e04,0x40001298,0x25e08,0x27e08,0x27e08,0x400012a8,0x25e30,0x27e08,0x27e0c,0x400012b8,0x25e58,0x27e08
.long 0x27e00,0x1390,0x26600,0x27e08,0x27e04,0x13a0,0x26628,0x27e08,0x27e08,0x13b0,0x26650,0x27e08,0x27e0c,0x13c0,0x26678,0x27e08
.long 0x27e00,0x400013d0,0x266a0,0x27e08,0x27e04,0x400013e0,0x266c8,0x27e08,0x27e08,0x400013f0,0x266f0,0x27e08,0x27e0c,0x40001400,0x26718,0x27e08
.long 0x27e00,0x40001390,0x26740,0x27e08,0x27e04,0x400013a0,0x26768,0x27e08,0x27e08,0x400013b0,0x26790,0x27e08,0x27e0c,0x400013c0,0x267b8,0x27e08
.long 0x27e00,0x400013d0,0x267e0,0x27e08,0x27e04,0x400013e0,0x26808,0x27e08,0x27e08,0x400013f0,0x26830,0x27e08,0x27e0c,0x40001400,0x26858,0x27e08
.long 0x27e00,0x1398,0x27000,0x27e08,0x27e04,0x13a8,0x27028,0x27e08,0x27e08,0x13b8,0x27050,0x27e08,0x27e0c,0x13c8,0x27078,0x27e08
.long 0x27e00,0x400013d8,0x270a0,0x27e08,0x27e04,0x400013e8,0x270c8,0x27e08,0x27e08,0x400013f8,0x270f0,0x27e08,0x27e0c,0x40001408,0x27118,0x27e08
.long 0x27e00,0x40001398,0x27140,0x27e08,0x27e04,0x400013a8,0x27168,0x27e08,0x27e08,0x400013b8,0x27190,0x27e08,0x27e0c,0x400013c8,0x271b8,0x27e08
.long 0x27e00,0x400013d8,0x271e0,0x27e08,0x27e04,0x400013e8,0x27208,0x27e08,0x27e08,0x400013f8,0x27230,0x27e08,0x27e0c,0x40001408,0x27258,0x27e08
.long 0x27e00,0x14e0,0x25480,0x27e0c,0x27e04,0x14f0,0x254a8,0x27e0c,0x27e08,0x1500,0x254d0,0x27e0c,0x27e0c,0x1510,0x254f8,0x27e0c
.long 0x27e00,0x40001520,0x25520,0x27e0c,0x27e04,0x40001530,0x25548,0x27e0c,0x27e08,0x40001540,0x25570,0x27e0c,0x27e0c,0x40001550,0x25598,0x27e0c
.long 0x27e00,0x400014e0,0x255c0,0x27e0c,0x27e04,0x400014f0,0x255e8,0x27e0c,0x27e08,0x40001500,0x25610,0x27e0c,0x27e0c,0x40001510,0x25638,0x27e0c
.long 0x27e00,0x40001520,0x25660,0x27e0c,0x27e04,0x40001530,0x25688,0x27e0c,0x27e08,0x40001540,0x256b0,0x27e0c,0x27e0c,0x40001550,0x256d8,0x27e0c
.long 0x27e00,0x14e8,0x25e80,0x27e0c,0x27e04,0x14f8,0x25ea8,0x27e0c,0x27e08,0x1508,0x25ed0,0x27e0c,0x27e0c,0x1518,0x25ef8,0x27e0c
.long 0x27e00,0x40001528,0x25f20,0x27e0c,0x27e04,0x40001538,0x25f48,0x27e0c,0x27e08,0x40001548,0x25f70,0x27e0c,0x27e0c,0x40001558,0x25f98,0x27e0c
.long 0x27e00,0x400014e8,0x25fc0,0x27e0c,0x27e04,0x400014f8,0x25fe8,0x27e0c,0x27e08,0x40001508,0x26010,0x27e0c,0x27e0c,0x40001518,0x26038,0x27e0c
.long 0x27e00,0x40001528,0x26060,0x27e0c,0x27e04,0x40001538,0x26088,0x27e0c,0x27e08,0x40001548,0x260b0,0x27e0c,0x27e0c,0x40001558,0x260d8,0x27e0c
.long 0x27e00,0x1630,0x26880,0x27e0c,0x27e04,0x1640,0x268a8,0x27e0c,0x27e08,0x1650,0x268d0,0x27e0c,0x27e0c,0x1660,0x268f8,0x27e0c
.long 0x27e00,0x40001670,0x26920,0x27e0c,0x27e04,0x40001680,0x26948,0x27e0c,0x27e08,0x40001690,0x26970,0x27e0c,0x27e0c,0x400016a0,0x26998,0x27e0c
.long 0x27e00,0x40001630,0x269c0,0x27e0c,0x27e04,0x40001640,0x269e8,0x27e0c,0x27e08,0x40001650,0x26a10,0x27e0c,0x27e0c,0x40001660,0x26a38,0x27e0c
.long 0x27e00,0x40001670,0x26a60,0x27e0c,0x27e04,0x40001680,0x26a88,0x27e0c,0x27e08,0x40001690,0x26ab0,0x27e0c,0x27e0c,0x400016a0,0x26ad8,0x27e0c
.long 0x27e00,0x1638,0x27280,0x27e0c,0x27e04,0x1648,0x272a8,0x27e0c,0x27e08,0x1658,0x272d0,0x27e0c,0x27e0c,0x1668,0x272f8,0x27e0c
.long 0x27e00,0x40001678,0x27320,0x27e0c,0x27e04,0x40001688,0x27348,0x27e0c,0x27e08,0x40001698,0x27370,0x27e0c,0x27e0c,0x400016a8,0x27398,0x27e0c
.long 0x27e00,0x40001638,0x273c0,0x27e0c,0x27e04,0x40001648,0x273e8,0x27e0c,0x27e08,0x40001658,0x27410,0x27e0c,0x27e0c,0x40001668,0x27438,0x27e0c
.long 0x27e00,0x40001678,0x27460,0x27e0c,0x27e04,0x40001688,0x27488,0x27e0c,0x27e08,0x40001698,0x274b0,0x27e0c,0x27e0c,0x400016a8,0x274d8,0x27e0c
.long 0x27e00,0x0,0x24d00,0x27e00,0x27e04,0x4,0x24d28,0x27e00,0x27e08,0x8,0x24d50,0x27e00,0x27e0c,0xc,0x24d78,0x27e00
.long 0x27e00,0x10,0x24da0,0x27e00,0x27e04,0x14,0x24dc8,0x27e00,0x27e08,0x18,0x24df0,0x27e00,0x27e0c,0x1c,0x24e18,0x27e00
.long 0x27e00,0x20,0x24e40,0x27e00,0x27e04,0x24,0x24e68,0x27e00,0x27e08,0x28,0x24e90,0x27e00,0x27e0c,0x2c,0x24eb8,0x27e00
.long 0x27e00,0x30,0x24ee0,0x27e00,0x27e04,0x34,0x24f08,0x27e00,0x27e08,0x38,0x24f30,0x27e00,0x27e0c,0x3c,0x24f58,0x27e00
.long 0x27e00,0x40000000,0x25700,0x27e00,0x27e04,0x40000004,0x25728,0x27e00,0x27e08,0x40000008,0x25750,0x27e00,0x27e0c,0x4000000c,0x25778,0x27e00
.long 0x27e00,0x40000010,0x257a0,0x27e00,0x27e04,0x40000014,0x257c8,0x27e00,0x27e08,0x40000018,0x257f0,0x27e00,0x27e0c,0x4000001c,0x25818,0x27e00
.long 0x27e00,0x40000020,0x25840,0x27e00,0x27e04,0x40000024,0x25868,0x27e00,0x27e08,0x40000028,0x25890,0x27e00,0x27e0c,0x4000002c,0x258b8,0x27e00
.long 0x27e00,0x40000030,0x258e0,0x27e00,0x27e04,0x40000034,0x25908,0x27e00,0x27e08,0x40000038,0x25930,0x27e00,0x27e0c,0x4000003c,0x25958,0x27e00
.long 0x27e00,0x2000,0x26100,0x27e00,0x27e04,0x2004,0x26128,0x27e00,0x27e08,0x2008,0x26150,0x27e00,0x27e0c,0x200c,0x26178,0x27e00
.long 0x27e00,0x2010,0x261a0,0x27e00,0x27e04,0x2014,0x261c8,0x27e00,0x27e08,0x2018,0x261f0,0x27e00,0x27e0c,0x201c,0x26218,0x27e00
.long 0x27e00,0x2020,0x26240,0x27e00,0x27e04,0x2024,0x26268,0x27e00,0x27e08,0x2028,0x26290,0x27e00,0x27e0c,0x202c,0x262b8,0x27e00
.long 0x27e00,0x2030,0x262e0,0x27e00,0x27e04,0x2034,0x26308,0x27e00,0x27e08,0x2038,0x26330,0x27e00,0x27e0c,0x203c,0x26358,0x27e00
.long 0x27e00,0x40002000,0x26b00,0x27e00,0x27e04,0x40002004,0x26b28,0x27e00,0x27e08,0x40002008,0x26b50,0x27e00,0x27e0c,0x4000200c,0x26b78,0x27e00
.long 0x27e00,0x40002010,0x26ba0,0x27e00,0x27e04,0x40002014,0x26bc8,0x27e00,0x27e08,0x40002018,0x26bf0,0x27e00,0x27e0c,0x4000201c,0x26c18,0x27e00
.long 0x27e00,0x40002020,0x26c40,0x27e00,0x27e04,0x40002024,0x26c68,0x27e00,0x27e08,0x40002028,0x26c90,0x27e00,0x27e0c,0x4000202c,0x26cb8,0x27e00
.long 0x27e00,0x40002030,0x26ce0,0x27e00,0x27e04,0x40002034,0x26d08,0x27e00,0x27e08,0x40002038,0x26d30,0x27e00,0x27e0c,0x4000203c,0x26d58,0x27e00
.long 0x27e00,0x40,0x24f80,0x27e04,0x27e04,0x44,0x24fa8,0x27e04,0x27e08,0x48,0x24fd0,0x27e04,0x27e0c,0x4c,0x24ff8,0x27e04
.long 0x27e00,0x50,0x25020,0x27e04,0x27e04,0x54,0x25048,0x27e04,0x27e08,0x58,0x25070,0x27e04,0x27e0c,0x5c,0x25098,0x27e04
.long 0x27e00,0x60,0x250c0,0x27e04,0x27e04,0x64,0x250e8,0x27e04,0x27e08,0x68,0x25110,0x27e04,0x27e0c,0x6c,0x25138,0x27e04
.long 0x27e00,0x70,0x25160,0x27e04,0x27e04,0x74,0x25188,0x27e04,0x27e08,0x78,0x251b0,0x27e04,0x27e0c,0x7c,0x251d8,0x27e04
.long 0x27e00,0x40000040,0x25980,0x27e04,0x27e04,0x40000044,0x259a8,0x27e04,0x27e08,0x40000048,0x259d0,0x27e04,0x27e0c,0x4000004c,0x259f8,0x27e04
.long 0x27e00,0x40000050,0x25a20,0x27e04,0x27e04,0x40000054,0x25a48,0x27e04,0x27e08,0x40000058,0x25a70,0x27e04,0x27e0c,0x4000005c,0x25a98,0x27e04
.long 0x27e00,0x40000060,0x25ac0,0x27e04,0x27e04,0x40000064,0x25ae8,0x27e04,0x27e08,0x40000068,0x25b10,0x27e04,0x27e0c,0x4000006c,0x25b38,0x27e04
.long 0x27e00,0x40000070,0x25b60,0x27e04,0x27e04,0x40000074,0x25b88,0x27e04,0x27e08,0x40000078,0x25bb0,0x27e04,0x27e0c,0x4000007c,0x25bd8,0x27e04
.long 0x27e00,0x2040,0x26380,0x27e04,0x27e04,0x2044,0x263a8,0x27e04,0x27e08,0x2048,0x263d0,0x27e04,0x27e0c,0x204c,0x263f8,0x27e04
.long 0x27e00,0x2050,0x26420,0x27e04,0x27e04,0x2054,0x26448,0x27e04,0x27e08,0x2058,0x26470,0x27e04,0x27e0c,0x205c,0x26498,0x27e04
.long 0x27e00,0x2060,0x264c0,0x27e04,0x27e04,0x2064,0x264e8,0x27e04,0x27e08,0x2068,0x26510,0x27e04,0x27e0c,0x206c,0x26538,0x27e04
.long 0x27e00,0x2070,0x26560,0x27e04,0x27e04,0x2074,0x26588,0x27e04,0x27e08,0x2078,0x265b0,0x27e04,0x27e0c,0x207c,0x265d8,0x27e04
.long 0x27e00,0x40002040,0x26d80,0x27e04,0x27e04,0x40002044,0x26da8,0x27e04,0x27e08,0x40002048,0x26dd0,0x27e04,0x27e0c,0x4000204c,0x26df8,0x27e04
.long 0x27e00,0x40002050,0x26e20,0x27e04,0x27e04,0x40002054,0x26e48,0x27e04,0x27e08,0x40002058,0x26e70,0x27e04,0x27e0c,0x4000205c,0x26e98,0x27e04
.long 0x27e00,0x40002060,0x26ec0,0x27e04,0x27e04,0x40002064,0x26ee8,0x27e04,0x27e08,0x40002068,0x26f10,0x27e04,0x27e0c,0x4000206c,0x26f38,0x27e04
.long 0x27e00,0x40002070,0x26f60,0x27e04,0x27e04,0x40002074,0x26f88,0x27e04,0x27e08,0x40002078,0x26fb0,0x27e04,0x27e0c,0x4000207c,0x26fd8,0x27e04
.long 0x27e00,0x80,0x25200,0x27e08,0x27e04,0x84,0x25228,0x27e08,0x27e08,0x88,0x25250,0x27e08,0x27e0c,0x8c,0x25278,0x27e08
.long 0x27e00,0x90,0x252a0,0x27e08,0x27e04,0x94,0x252c8,0x27e08,0x27e08,0x98,0x252f0,0x27e08,0x27e0c,0x9c,0x25318,0x27e08
.long 0x27e00,0xa0,0x25340,0x27e08,0x27e04,0xa4,0x25368,0x27e08,0x27e08,0xa8,0x25390,0x27e08,0x27e0c,0xac,0x253b8,0x27e08
.long 0x27e00,0xb0,0x253e0,0x27e08,0x27e04,0xb4,0x25408,0x27e08,0x27e08,0xb8,0x25430,0x27e08,0x27e0c,0xbc,0x25458,0x27e08
.long 0x27e00,0x40000080,0x25c00,0x27e08,0x27e04,0x40000084,0x25c28,0x27e08,0x27e08,0x40000088,0x25c50,0x27e08,0x27e0c,0x4000008c,0x25c78,0x27e08
.long 0x27e00,0x40000090,0x25ca0,0x27e08,0x27e04,0x40000094,0x25cc8,0x27e08,0x27e08,0x40000098,0x25cf0,0x27e08,0x27e0c,0x4000009c,0x25d18,0x27e08
.long 0x27e00,0x400000a0,0x25d40,0x27e08,0x27e04,0x400000a4,0x25d68,0x27e08,0x27e08,0x400000a8,0x25d90,0x27e08,0x27e0c,0x400000ac,0x25db8,0x27e08
.long 0x27e00,0x400000b0,0x25de0,0x27e08,0x27e04,0x400000b4,0x25e08,0x27e08,0x27e08,0x400000b8,0x25e30,0x27e08,0x27e0c,0x400000bc,0x25e58,0x27e08
.long 0x27e00,0x2080,0x26600,0x27e08,0x27e04,0x2084,0x26628,0x27e08,0x27e08,0x2088,0x26650,0x27e08,0x27e0c,0x208c,0x26678,0x27e08
.long 0x27e00,0x2090,0x266a0,0x27e08,0x27e04,0x2094,0x266c8,0x27e08,0x27e08,0x2098,0x266f0,0x27e08,0x27e0c,0x209c,0x26718,0x27e08
.long 0x27e00,0x20a0,0x26740,0x27e08,0x27e04,0x20a4,0x26768,0x27e08,0x27e08,0x20a8,0x26790,0x27e08,0x27e0c,0x20ac,0x267b8,0x27e08
.long 0x27e00,0x20b0,0x267e0,0x27e08,0x27e04,0x20b4,0x26808,0x27e08,0x27e08,0x20b8,0x26830,0x27e08,0x27e0c,0x20bc,0x26858,0x27e08
.long 0x27e00,0x40002080,0x27000,0x27e08,0x27e04,0x40002084,0x27028,0x27e08,0x27e08,0x40002088,0x27050,0x27e08,0x27e0c,0x4000208c,0x27078,0x27e08
.long 0x27e00,0x40002090,0x270a0,0x27e08,0x27e04,0x40002094,0x270c8,0x27e08,0x27e08,0x40002098,0x270f0,0x27e08,0x27e0c,0x4000209c,0x27118,0x27e08
.long 0x27e00,0x400020a0,0x27140,0x27e08,0x27e04,0x400020a4,0x27168,0x27e08,0x27e08,0x400020a8,0x27190,0x27e08,0x27e0c,0x400020ac,0x271b8,0x27e08
.long 0x27e00,0x400020b0,0x271e0,0x27e08,0x27e04,0x400020b4,0x27208,0x27e08,0x27e08,0x400020b8,0x27230,0x27e08,0x27e0c,0x400020bc,0x27258,0x27e08
.long 0x27e00,0xc0,0x25480,0x27e0c,0x27e04,0xc4,0x254a8,0x27e0c,0x27e08,0xc8,0x254d0,0x27e0c,0x27e0c,0xcc,0x254f8,0x27e0c
.long 0x27e00,0xd0,0x25520,0x27e0c,0x27e04,0xd4,0x25548,0x27e0c,0x27e08,0xd8,0x25570,0x27e0c,0x27e0c,0xdc,0x25598,0x27e0c
.long 0x27e00,0xe0,0x255c0,0x27e0c,0x27e04,0xe4,0x255e8,0x27e0c,0x27e08,0xe8,0x25610,0x27e0c,0x27e0c,0xec,0x25638,0x27e0c
.long 0x27e00,0xf0,0x25660,0x27e0c,0x27e04,0xf4,0x25688,0x27e0c,0x27e08,0xf8,0x256b0,0x27e0c,0x27e0c,0xfc,0x256d8,0x27e0c
.long 0x27e00,0x400000c0,0x25e80,0x27e0c,0x27e04,0x400000c4,0x25ea8,0x27e0c,0x27e08,0x400000c8,0x25ed0,0x27e0c,0x27e0c,0x400000cc,0x25ef8,0x27e0c
.long 0x27e00,0x400000d0,0x25f20,0x27e0c,0x27e04,0x400000d4,0x25f48,0x27e0c,0x27e08,0x400000d8,0x25f70,0x27e0c,0x27e0c,0x400000dc,0x25f98,0x27e0c
.long 0x27e00,0x400000e0,0x25fc0,0x27e0c,0x27e04,0x400000e4,0x25fe8,0x27e0c,0x27e08,0x400000e8,0x26010,0x27e0c,0x27e0c,0x400000ec,0x26038,0x27e0c
.long 0x27e00,0x400000f0,0x26060,0x27e0c,0x27e04,0x400000f4,0x26088,0x27e0c,0x27e08,0x400000f8,0x260b0,0x27e0c,0x27e0c,0x400000fc,0x260d8,0x27e0c
.long 0x27e00,0x20c0,0x26880,0x27e0c,0x27e04,0x20c4,0x268a8,0x27e0c,0x27e08,0x20c8,0x268d0,0x27e0c,0x27e0c,0x20cc,0x268f8,0x27e0c
.long 0x27e00,0x20d0,0x26920,0x27e0c,0x27e04,0x20d4,0x26948,0x27e0c,0x27e08,0x20d8,0x26970,0x27e0c,0x27e0c,0x20dc,0x26998,0x27e0c
.long 0x27e00,0x20e0,0x269c0,0x27e0c,0x27e04,0x20e4,0x269e8,0x27e0c,0x27e08,0x20e8,0x26a10,0x27e0c,0x27e0c,0x20ec,0x26a38,0x27e0c
.long 0x27e00,0x20f0,0x26a60,0x27e0c,0x27e04,0x20f4,0x26a88,0x27e0c,0x27e08,0x20f8,0x26ab0,0x27e0c,0x27e0c,0x20fc,0x26ad8,0x27e0c
.long 0x27e00,0x400020c0,0x27280,0x27e0c,0x27e04,0x400020c4,0x272a8,0x27e0c,0x27e08,0x400020c8,0x272d0,0x27e0c,0x27e0c,0x400020cc,0x272f8,0x27e0c
.long 0x27e00,0x400020d0,0x27320,0x27e0c,0x27e04,0x400020d4,0x27348,0x27e0c,0x27e08,0x400020d8,0x27370,0x27e0c,0x27e0c,0x400020dc,0x27398,0x27e0c
.long 0x27e00,0x400020e0,0x273c0,0x27e0c,0x27e04,0x400020e4,0x273e8,0x27e0c,0x27e08,0x400020e8,0x27410,0x27e0c,0x27e0c,0x400020ec,0x27438,0x27e0c
.long 0x27e00,0x400020f0,0x27460,0x27e0c,0x27e04,0x400020f4,0x27488,0x27e0c,0x27e08,0x400020f8,0x274b0,0x27e0c,0x27e0c,0x400020fc,0x274d8,0x27e0c
.long 0x27e00,0xd40,0x24d00,0x27e00,0x27e04,0x40000d40,0x24d28,0x27e00,0x27e08,0x40000d40,0x24d50,0x27e00,0x27e0c,0x40000d40,0x24d78,0x27e00
.long 0x27e00,0x40000d40,0x24da0,0x27e00,0x27e04,0x40000d40,0x24dc8,0x27e00,0x27e08,0x40000d40,0x24df0,0x27e00,0x27e0c,0x40000d40,0x24e18,0x27e00
.long 0x27e00,0x40000d40,0x24e40,0x27e00,0x27e04,0x40000d40,0x24e68,0x27e00,0x27e08,0x40000d40,0x24e90,0x27e00,0x27e0c,0x40000d40,0x24eb8,0x27e00
.long 0x27e00,0x40000d40,0x24ee0,0x27e00,0x27e04,0x40000d40,0x24f08,0x27e00,0x27e08,0x40000d40,0x24f30,0x27e00,0x27e0c,0x40000d40,0x24f58,0x27e00
.long 0x27e00,0xd48,0x25700,0x27e00,0x27e04,0x40000d48,0x25728,0x27e00,0x27e08,0x40000d48,0x25750,0x27e00,0x27e0c,0x40000d48,0x25778,0x27e00
.long 0x27e00,0x40000d48,0x257a0,0x27e00,0x27e04,0x40000d48,0x257c8,0x27e00,0x27e08,0x40000d48,0x257f0,0x27e00,0x27e0c,0x40000d48,0x25818,0x27e00
.long 0x27e00,0x40000d48,0x25840,0x27e00,0x27e04,0x40000d48,0x25868,0x27e00,0x27e08,0x40000d48,0x25890,0x27e00,0x27e0c,0x40000d48,0x258b8,0x27e00
.long 0x27e00,0x40000d48,0x258e0,0x27e00,0x27e04,0x40000d48,0x25908,0x27e00,0x27e08,0x40000d48,0x25930,0x27e00,0x27e0c,0x40000d48,0x25958,0x27e00
.long 0x27e00,0xe90,0x26100,0x27e00,0x27e04,0x40000e90,0x26128,0x27e00,0x27e08,0x40000e90,0x26150,0x27e00,0x27e0c,0x40000e90,0x26178,0x27e00
.long 0x27e00,0x40000e90,0x261a0,0x27e00,0x27e04,0x40000e90,0x261c8,0x27e00,0x27e08,0x40000e90,0x261f0,0x27e00,0x27e0c,0x40000e90,0x26218,0x27e00
.long 0x27e00,0x40000e90,0x26240,0x27e00,0x27e04,0x40000e90,0x26268,0x27e00,0x27e08,0x40000e90,0x26290,0x27e00,0x27e0c,0x40000e90,0x262b8,0x27e00
.long 0x27e00,0x40000e90,0x262e0,0x27e00,0x27e04,0x40000e90,0x26308,0x27e00,0x27e08,0x40000e90,0x26330,0x27e00,0x27e0c,0x40000e90,0x26358,0x27e00
.long 0x27e00,0xe98,0x26b00,0x27e00,0x27e04,0x40000e98,0x26b28,0x27e00,0x27e08,0x40000e98,0x26b50,0x27e00,0x27e0c,0x40000e98,0x26b78,0x27e00
.long 0x27e00,0x40000e98,0x26ba0,0x27e00,0x27e04,0x40000e98,0x26bc8,0x27e00,0x27e08,0x40000e98,0x26bf0,0x27e00,0x27e0c,0x40000e98,0x26c18,0x27e00
.long 0x27e00,0x40000e98,0x26c40,0x27e00,0x27e04,0x40000e98,0x26c68,0x27e00,0x27e08,0x40000e98,0x26c90,0x27e00,0x27e0c,0x40000e98,0x26cb8,0x27e00
.long 0x27e00,0x40000e98,0x26ce0,0x27e00,0x27e04,0x40000e98,0x26d08,0x27e00,0x27e08,0x40000e98,0x26d30,0x27e00,0x27e0c,0x40000e98,0x26d58,0x27e00
.long 0x27e00,0xfe0,0x24f80,0x27e04,0x27e04,0x40000fe0,0x24fa8,0x27e04,0x27e08,0x40000fe0,0x24fd0,0x27e04,0x27e0c,0x40000fe0,0x24ff8,0x27e04
.long 0x27e00,0x40000fe0,0x25020,0x27e04,0x27e04,0x40000fe0,0x25048,0x27e04,0x27e08,0x40000fe0,0x25070,0x27e04,0x27e0c,0x40000fe0,0x25098,0x27e04
.long 0x27e00,0x40000fe0,0x250c0,0x27e04,0x27e04,0x40000fe0,0x250e8,0x27e04,0x27e08,0x40000fe0,0x25110,0x27e04,0x27e0c,0x40000fe0,0x25138,0x27e04
.long 0x27e00,0x40000fe0,0x25160,0x27e04,0x27e04,0x40000fe0,0x25188,0x27e04,0x27e08,0x40000fe0,0x251b0,0x27e04,0x27e0c,0x40000fe0,0x251d8,0x27e04
.long 0x27e00,0xfe8,0x25980,0x27e04,0x27e04,0x40000fe8,0x259a8,0x27e04,0x27e08,0x40000fe8,0x259d0,0x27e04,0x27e0c,0x40000fe8,0x259f8,0x27e04
.long 0x27e00,0x40000fe8,0x25a20,0x27e04,0x27e04,0x40000fe8,0x25a48,0x27e04,0x27e08,0x40000fe8,0x25a70,0x27e04,0x27e0c,0x40000fe8,0x25a98,0x27e04
.long 0x27e00,0x40000fe8,0x25ac0,0x27e04,0x27e04,0x40000fe8,0x25ae8,0x27e04,0x27e08,0x40000fe8,0x25b10,0x27e04,0x27e0c,0x40000fe8,0x25b38,0x27e04
.long 0x27e00,0x40000fe8,0x25b60,0x27e04,0x27e04,0x40000fe8,0x25b88,0x27e04,0x27e08,0x40000fe8,0x25bb0,0x27e04,0x27e0c,0x40000fe8,0x25bd8,0x27e04
.long 0x27e00,0x1130,0x26380,0x27e04,0x27e04,0x40001130,0x263a8,0x27e04,0x27e08,0x40001130,0x263d0,0x27e04,0x27e0c,0x40001130,0x263f8,0x27e04
.long 0x27e00,0x40001130,0x26420,0x27e04,0x27e04,0x40001130,0x26448,0x27e04,0x27e08,0x40001130,0x26470,0x27e04,0x27e0c,0x40001130,0x26498,0x27e04
.long 0x27e00,0x40001130,0x264c0,0x27e04,0x27e04,0x40001130,0x264e8,0x27e04,0x27e08,0x40001130,0x26510,0x27e04,0x27e0c,0x40001130,0x26538,0x27e04
.long 0x27e00,0x40001130,0x26560,0x27e04,0x27e04,0x40001130,0x26588,0x27e04,0x27e08,0x40001130,0x265b0,0x27e04,0x27e0c,0x40001130,0x265d8,0x27e04
.long 0x27e00,0x1138,0x26d80,0x27e04,0x27e04,0x40001138,0x26da8,0x27e04,0x27e08,0x40001138,0x26dd0,0x27e04,0x27e0c,0x40001138,0x26df8,0x27e04
.long 0x27e00,0x40001138,0x26e20,0x27e04,0x27e04,0x40001138,0x26e48,0x27e04,0x27e08,0x40001138,0x26e70,0x27e04,0x27e0c,0x40001138,0x26e98,0x27e04
.long 0x27e00,0x40001138,0x26ec0,0x27e04,0x27e04,0x40001138,0x26ee8,0x27e04,0x27e08,0x40001138,0x26f10,0x27e04,0x27e0c,0x40001138,0x26f38,0x27e04
.long 0x27e00,0x40001138,0x26f60,0x27e04,0x27e04,0x40001138,0x26f88,0x27e04,0x27e08,0x40001138,0x26fb0,0x27e04,0x27e0c,0x40001138,0x26fd8,0x27e04
.long 0x27e00,0x1280,0x25200,0x27e08,0x27e04,0x40001280,0x25228,0x27e08,0x27e08,0x40001280,0x25250,0x27e08,0x27e0c,0x40001280,0x25278,0x27e08
.long 0x27e00,0x40001280,0x252a0,0x27e08,0x27e04,0x40001280,0x252c8,0x27e08,0x27e08,0x40001280,0x252f0,0x27e08,0x27e0c,0x40001280,0x25318,0x27e08
.long 0x27e00,0x40001280,0x25340,0x27e08,0x27e04,0x40001280,0x25368,0x27e08,0x27e08,0x40001280,0x25390,0x27e08,0x27e0c,0x40001280,0x253b8,0x27e08
.long 0x27e00,0x40001280,0x253e0,0x27e08,0x27e04,0x40001280,0x25408,0x27e08,0x27e08,0x40001280,0x25430,0x27e08,0x27e0c,0x40001280,0x25458,0x27e08
.long 0x27e00,0x1288,0x25c00,0x27e08,0x27e04,0x40001288,0x25c28,0x27e08,0x27e08,0x40001288,0x25c50,0x27e08,0x27e0c,0x40001288,0x25c78,0x27e08
.long 0x27e00,0x40001288,0x25ca0,0x27e08,0x27e04,0x40001288,0x25cc8,0x27e08,0x27e08,0x40001288,0x25cf0,0x27e08,0x27e0c,0x40001288,0x25d18,0x27e08
.long 0x27e00,0x40001288,0x25d40,0x27e08,0x27e04,0x40001288,0x25d68,0x27e08,0x27e08,0x40001288,0x25d90,0x27e08,0x27e0c,0x40001288,0x25db8,0x27e08
.long 0x27e00,0x40001288,0x25de0,0x27e08,0x27e04,0x40001288,0x25e08,0x27e08,0x27e08,0x40001288,0x25e30,0x27e08,0x27e0c,0x40001288,0x25e58,0x27e08
.long 0x27e00,0x13d0,0x26600,0x27e08,0x27e04,0x400013d0,0x26628,0x27e08,0x27e08,0x400013d0,0x26650,0x27e08,0x27e0c,0x400013d0,0x26678,0x27e08
.long 0x27e00,0x400013d0,0x266a0,0x27e08,0x27e04,0x400013d0,0x266c8,0x27e08,0x27e08,0x400013d0,0x266f0,0x27e08,0x27e0c,0x400013d0,0x26718,0x27e08
.long 0x27e00,0x400013d0,0x26740,0x27e08,0x27e04,0x400013d0,0x26768,0x27e08,0x27e08,0x400013d0,0x26790,0x27e08,0x27e0c,0x400013d0,0x267b8,0x27e08
.long 0x27e00,0x400013d0,0x267e0,0x27e08,0x27e04,0x400013d0,0x26808,0x27e08,0x27e08,0x400013d0,0x26830,0x27e08,0x27e0c,0x400013d0,0x26858,0x27e08
.long 0x27e00,0x13d8,0x27000,0x27e08,0x27e04,0x400013d8,0x27028,0x27e08,0x27e08,0x400013d8,0x27050,0x27e08,0x27e0c,0x400013d8,0x27078,0x27e08
.long 0x27e00,0x400013d8,0x270a0,0x27e08,0x27e04,0x400013d8,0x270c8,0x27e08,0x27e08,0x400013d8,0x270f0,0x27e08,0x27e0c,0x400013d8,0x27118,0x27e08
.long 0x27e00,0x400013d8,0x27140,0x27e08,0x27e04,0x400013d8,0x27168,0x27e08,0x27e08,0x400013d8,0x27190,0x27e08,0x27e0c,0x400013d8,0x271b8,0x27e08
.long 0x27e00,0x400013d8,0x271e0,0x27e08,0x27e04,0x400013d8,0x27208,0x27e08,0x27e08,0x400013d8,0x27230,0x27e08,0x27e0c,0x400013d8,0x27258,0x27e08
.long 0x27e00,0x1520,0x25480,0x27e0c,0x27e04,0x40001520,0x254a8,0x27e0c,0x27e08,0x40001520,0x254d0,0x27e0c,0x27e0c,0x40001520,0x254f8,0x27e0c
.long 0x27e00,0x40001520,0x25520,0x27e0c,0x27e04,0x40001520,0x25548,0x27e0c,0x27e08,0x40001520,0x25570,0x27e0c,0x27e0c,0x40001520,0x25598,0x27e0c
.long 0x27e00,0x40001520,0x255c0,0x27e0c,0x27e04,0x40001520,0x255e8,0x27e0c,0x27e08,0x40001520,0x25610,0x27e0c,0x27e0c,0x40001520,0x25638,0x27e0c
.long 0x27e00,0x40001520,0x25660,0x27e0c,0x27e04,0x40001520,0x25688,0x27e0c,0x27e08,0x40001520,0x256b0,0x27e0c,0x27e0c,0x40001520,0x256d8,0x27e0c
.long 0x27e00,0x1528,0x25e80,0x27e0c,0x27e04,0x40001528,0x25ea8,0x27e0c,0x27e08,0x40001528,0x25ed0,0x27e0c,0x27e0c,0x40001528,0x25ef8,0x27e0c
.long 0x27e00,0x40001528,0x25f20,0x27e0c,0x27e04,0x40001528,0x25f48,0x27e0c,0x27e08,0x40001528,0x25f70,0x27e0c,0x27e0c,0x40001528,0x25f98,0x27e0c
.long 0x27e00,0x40001528,0x25fc0,0x27e0c,0x27e04,0x40001528,0x25fe8,0x27e0c,0x27e08,0x40001528,0x26010,0x27e0c,0x27e0c,0x40001528,0x26038,0x27e0c
.long 0x27e00,0x40001528,0x26060,0x27e0c,0x27e04,0x40001528,0x26088,0x27e0c,0x27e08,0x40001528,0x260b0,0x27e0c,0x27e0c,0x40001528,0x260d8,0x27e0c
.long 0x27e00,0x1670,0x26880,0x27e0c,0x27e04,0x40001670,0x268a8,0x27e0c,0x27e08,0x40001670,0x268d0,0x27e0c,0x27e0c,0x40001670,0x268f8,0x27e0c
.long 0x27e00,0x40001670,0x26920,0x27e0c,0x27e04,0x40001670,0x26948,0x27e0c,0x27e08,0x40001670,0x26970,0x27e0c,0x27e0c,0x40001670,0x26998,0x27e0c
.long 0x27e00,0x40001670,0x269c0,0x27e0c,0x27e04,0x40001670,0x269e8,0x27e0c,0x27e08,0x40001670,0x26a10,0x27e0c,0x27e0c,0x40001670,0x26a38,0x27e0c
.long 0x27e00,0x40001670,0x26a60,0x27e0c,0x27e04,0x40001670,0x26a88,0x27e0c,0x27e08,0x40001670,0x26ab0,0x27e0c,0x27e0c,0x40001670,0x26ad8,0x27e0c
.long 0x27e00,0x1678,0x27280,0x27e0c,0x27e04,0x40001678,0x272a8,0x27e0c,0x27e08,0x40001678,0x272d0,0x27e0c,0x27e0c,0x40001678,0x272f8,0x27e0c
.long 0x27e00,0x40001678,0x27320,0x27e0c,0x27e04,0x40001678,0x27348,0x27e0c,0x27e08,0x40001678,0x27370,0x27e0c,0x27e0c,0x40001678,0x27398,0x27e0c
.long 0x27e00,0x40001678,0x273c0,0x27e0c,0x27e04,0x40001678,0x273e8,0x27e0c,0x27e08,0x40001678,0x27410,0x27e0c,0x27e0c,0x40001678,0x27438,0x27e0c
.long 0x27e00,0x40001678,0x27460,0x27e0c,0x27e04,0x40001678,0x27488,0x27e0c,0x27e08,0x40001678,0x274b0,0x27e0c,0x27e0c,0x40001678,0x274d8,0x27e0c
.long 0x0,0x2970,0x0,0x3f0,0x110,0x2860,0x0,0x3e0,0x220,0x2750,0x0,0x3d0,0x330,0x2640,0x0,0x3c0
.long 0x440,0x2ec0,0x0,0x3b0,0x550,0x2db0,0x0,0x3a0,0x660,0x2ca0,0x0,0x390,0x770,0x2ca0,0x0,0x380
.long 0x880,0x2530,0x0,0x370,0x990,0x2420,0x0,0x360,0xaa0,0x2310,0x0,0x350,0xbb0,0x2200,0x0,0x340
.long 0xcc0,0x2ca0,0x0,0x330,0xdd0,0x2b90,0x0,0x320,0xee0,0x2a80,0x0,0x310,0xff0,0x2a80,0x0,0x300
.long 0x1100,0x2fd0,0x0,0x2f0,0x1210,0x30e0,0x0,0x2e0,0x1320,0x31f0,0x0,0x2d0,0x1430,0x31f0,0x0,0x2c0
.long 0x1540,0x3300,0x0,0x2b0,0x1650,0x3410,0x0,0x2a0,0x1760,0x3520,0x0,0x290,0x1870,0x3520,0x0,0x280
.long 0x1980,0x3630,0x0,0x270,0x1a90,0x3740,0x0,0x260,0x1ba0,0x3a70,0x0,0x250,0x1cb0,0x3b80,0x0,0x240
.long 0x1dc0,0x3850,0x0,0x230,0x1ed0,0x3960,0x0,0x220,0x1fe0,0x3c90,0x0,0x210,0x20f0,0x3da0,0x0,0x200
.long 0x10,0x2980,0x0,0x1f0,0x120,0x2870,0x0,0x1e0,0x230,0x2760,0x0,0x1d0,0x340,0x2650,0x0,0x1c0
.long 0x450,0x2ed0,0x0,0x1b0,0x560,0x2dc0,0x0,0x1a0,0x670,0x2cb0,0x0,0x190,0x780,0x2cb0,0x0,0x180
.long 0x890,0x2540,0x0,0x170,0x9a0,0x2430,0x0,0x160,0xab0,0x2320,0x0,0x150,0xbc0,0x2210,0x0,0x140
.long 0xcd0,0x2cb0,0x0,0x130,0xde0,0x2ba0,0x0,0x120,0xef0,0x2a90,0x0,0x110,0x1000,0x2a90,0x0,0x100
.long 0x1110,0x2fe0,0x0,0xf0,0x1220,0x30f0,0x0,0xe0,0x1330,0x3200,0x0,0xd0,0x1440,0x3200,0x0,0xc0
.long 0x1550,0x3310,0x0,0xb0,0x1660,0x3420,0x0,0xa0,0x1770,0x3530,0x0,0x90,0x1880,0x3530,0x0,0x80
.long 0x1990,0x3640,0x0,0x70,0x1aa0,0x3750,0x0,0x60,0x1bb0,0x3a80,0x0,0x50,0x1cc0,0x3b90,0x0,0x40
.long 0x1dd0,0x3860,0x0,0x30,0x1ee0,0x3970,0x0,0x20,0x1ff0,0x3ca0,0x0,0x10,0x2100,0x3db0,0x0,0x0
.long 0x146c,0x1000,0x27e30,0x27e70,0x145c,0x1004,0x27e34,0x27e70,0x144c,0x1008,0x27e38,0x27e70,0x143c,0x100c,0x27e3c,0x27e70
.long 0x142c,0x1010,0x27e30,0x27e70,0x141c,0x1014,0x27e34,0x27e70,0x140c,0x1018,0x27e38,0x27e70,0x13fc,0x101c,0x27e3c,0x27e70
.long 0x13ec,0x1020,0x27e30,0x27e70,0x13dc,0x1024,0x27e34,0x27e70,0x13cc,0x1028,0x27e38,0x27e70,0x13bc,0x102c,0x27e3c,0x27e70
.long 0x13ac,0x1030,0x27e30,0x27e70,0x139c,0x1034,0x27e34,0x27e70,0x138c,0x1038,0x27e38,0x27e70,0x137c,0x103c,0x27e3c,0x27e70
.long 0x136c,0x1040,0x27e30,0x27e70,0x135c,0x1044,0x27e34,0x27e70,0x134c,0x1048,0x27e38,0x27e70,0x133c,0x104c,0x27e3c,0x27e70
.long 0x132c,0x1050,0x27e30,0x27e70,0x131c,0x1054,0x27e34,0x27e70,0x130c,0x1058,0x27e38,0x27e70,0x12fc,0x105c,0x27e3c,0x27e70
.long 0x12ec,0x1060,0x27e30,0x27e70,0x12dc,0x1064,0x27e34,0x27e70,0x12cc,0x1068,0x27e38,0x27e70,0x12bc,0x106c,0x27e3c,0x27e70
.long 0x12ac,0x1070,0x27e30,0x27e70,0x129c,0x1074,0x27e34,0x27e70,0x128c,0x1078,0x27e38,0x27e70,0x127c,0x1078,0x27e3c,0x27e70
.long 0x126c,0x207c,0x27e30,0x27e70,0x125c,0x2080,0x27e34,0x27e70,0x124c,0x2084,0x27e38,0x27e70,0x123c,0x2088,0x27e3c,0x27e70
.long 0x122c,0x208c,0x27e30,0x27e70,0x121c,0x2090,0x27e34,0x27e70,0x120c,0x2094,0x27e38,0x27e70,0x11fc,0x2098,0x27e3c,0x27e70
.long 0x11ec,0x209c,0x27e30,0x27e70,0x11dc,0x20a0,0x27e34,0x27e70,0x11cc,0x20a4,0x27e38,0x27e70,0x11bc,0x20a8,0x27e3c,0x27e70
.long 0x11ac,0x20ac,0x27e30,0x27e70,0x119c,0x20b0,0x27e34,0x27e70,0x118c,0x20b4,0x27e38,0x27e70,0x117c,0x20b8,0x27e3c,0x27e70
.long 0x116c,0x20bc,0x27e30,0x27e70,0x115c,0x20c0,0x27e34,0x27e70,0x114c,0x20c4,0x27e38,0x27e70,0x113c,0x20c8,0x27e3c,0x27e70
.long 0x112c,0x20cc,0x27e30,0x27e70,0x111c,0x20d0,0x27e34,0x27e70,0x110c,0x20d4,0x27e38,0x27e70,0x10fc,0x20d8,0x27e3c,0x27e70
.long 0x10ec,0x20dc,0x27e30,0x27e70,0x10dc,0x20e0,0x27e34,0x27e70,0x10cc,0x20e4,0x27e38,0x27e70,0x10bc,0x20e8,0x27e3c,0x27e70
.long 0x10ac,0x20ec,0x27e30,0x27e70,0x109c,0x20f0,0x27e34,0x27e70,0x108c,0x20f4,0x27e38,0x27e70,0x107c,0x20f4,0x27e3c,0x27e70
.long 0x3f00,0x6870,0x0,0x60f0,0x4010,0x6760,0x0,0x60e0,0x4120,0x6650,0x0,0x60d0,0x4230,0x6540,0x0,0x60c0
.long 0x4340,0x6dc0,0x0,0x60b0,0x4450,0x6cb0,0x0,0x60a0,0x4560,0x6ba0,0x0,0x6090,0x4670,0x6ba0,0x0,0x6080
.long 0x4780,0x6430,0x0,0x6070,0x4890,0x6320,0x0,0x6060,0x49a0,0x6210,0x0,0x6050,0x4ab0,0x6100,0x0,0x6040
.long 0x4bc0,0x6ba0,0x0,0x6030,0x4cd0,0x6a90,0x0,0x6020,0x4de0,0x6980,0x0,0x6010,0x4ef0,0x6980,0x0,0x6000
.long 0x5000,0x6ed0,0x0,0x5ff0,0x5110,0x6fe0,0x0,0x5fe0,0x5220,0x70f0,0x0,0x5fd0,0x5330,0x70f0,0x0,0x5fc0
.long 0x5440,0x7200,0x0,0x5fb0,0x5550,0x7310,0x0,0x5fa0,0x5660,0x7420,0x0,0x5f90,0x5770,0x7420,0x0,0x5f80
.long 0x5880,0x7530,0x0,0x5f70,0x5990,0x7640,0x0,0x5f60,0x5aa0,0x7970,0x0,0x5f50,0x5bb0,0x7a80,0x0,0x5f40
.long 0x5cc0,0x7750,0x0,0x5f30,0x5dd0,0x7860,0x0,0x5f20,0x5ee0,0x7b90,0x0,0x5f10,0x5ff0,0x7ca0,0x0,0x5f00
.long 0x3f10,0x6880,0x0,0x5ef0,0x4020,0x6770,0x0,0x5ee0,0x4130,0x6660,0x0,0x5ed0,0x4240,0x6550,0x0,0x5ec0
.long 0x4350,0x6dd0,0x0,0x5eb0,0x4460,0x6cc0,0x0,0x5ea0,0x4570,0x6bb0,0x0,0x5e90,0x4680,0x6bb0,0x0,0x5e80
.long 0x4790,0x6440,0x0,0x5e70,0x48a0,0x6330,0x0,0x5e60,0x49b0,0x6220,0x0,0x5e50,0x4ac0,0x6110,0x0,0x5e40
.long 0x4bd0,0x6bb0,0x0,0x5e30,0x4ce0,0x6aa0,0x0,0x5e20,0x4df0,0x6990,0x0,0x5e10,0x4f00,0x6990,0x0,0x5e00
.long 0x5010,0x6ee0,0x0,0x5df0,0x5120,0x6ff0,0x0,0x5de0,0x5230,0x7100,0x0,0x5dd0,0x5340,0x7100,0x0,0x5dc0
.long 0x5450,0x7210,0x0,0x5db0,0x5560,0x7320,0x0,0x5da0,0x5670,0x7430,0x0,0x5d90,0x5780,0x7430,0x0,0x5d80
.long 0x5890,0x7540,0x0,0x5d70,0x59a0,0x7650,0x0,0x5d60,0x5ab0,0x7980,0x0,0x5d50,0x5bc0,0x7a90,0x0,0x5d40
.long 0x5cd0,0x7760,0x0,0x5d30,0x5de0,0x7870,0x0,0x5d20,0x5ef0,0x7ba0,0x0,0x5d10,0x6000,0x7cb0,0x0,0x5d00
.long 0x716c,0x6d00,0x27e30,0x27e74,0x715c,0x6d04,0x27e34,0x27e74,0x714c,0x6d08,0x27e38,0x27e74,0x713c,0x6d0c,0x27e3c,0x27e74
.long 0x712c,0x6d10,0x27e30,0x27e74,0x711c,0x6d14,0x27e34,0x27e74,0x710c,0x6d18,0x27e38,0x27e74,0x70fc,0x6d1c,0x27e3c,0x27e74
.long 0x70ec,0x6d20,0x27e30,0x27e74,0x70dc,0x6d24,0x27e34,0x27e74,0x70cc,0x6d28,0x27e38,0x27e74,0x70bc,0x6d2c,0x27e3c,0x27e74
.long 0x70ac,0x6d30,0x27e30,0x27e74,0x709c,0x6d34,0x27e34,0x27e74,0x708c,0x6d38,0x27e38,0x27e74,0x707c,0x6d3c,0x27e3c,0x27e74
.long 0x706c,0x6d40,0x27e30,0x27e74,0x705c,0x6d44,0x27e34,0x27e74,0x704c,0x6d48,0x27e38,0x27e74,0x703c,0x6d4c,0x27e3c,0x27e74
.long 0x702c,0x6d50,0x27e30,0x27e74,0x701c,0x6d54,0x27e34,0x27e74,0x700c,0x6d58,0x27e38,0x27e74,0x6ffc,0x6d5c,0x27e3c,0x27e74
.long 0x6fec,0x6d60,0x27e30,0x27e74,0x6fdc,0x6d64,0x27e34,0x27e74,0x6fcc,0x6d68,0x27e38,0x27e74,0x6fbc,0x6d6c,0x27e3c,0x27e74
.long 0x6fac,0x6d70,0x27e30,0x27e74,0x6f9c,0x6d74,0x27e34,0x27e74,0x6f8c,0x6d78,0x27e38,0x27e74,0x6f7c,0x6d78,0x27e3c,0x27e74
.long 0x6f6c,0x7d7c,0x27e30,0x27e74,0x6f5c,0x7d80,0x27e34,0x27e74,0x6f4c,0x7d84,0x27e38,0x27e74,0x6f3c,0x7d88,0x27e3c,0x27e74
.long 0x6f2c,0x7d8c,0x27e30,0x27e74,0x6f1c,0x7d90,0x27e34,0x27e74,0x6f0c,0x7d94,0x27e38,0x27e74,0x6efc,0x7d98,0x27e3c,0x27e74
.long 0x6eec,0x7d9c,0x27e30,0x27e74,0x6edc,0x7da0,0x27e34,0x27e74,0x6ecc,0x7da4,0x27e38,0x27e74,0x6ebc,0x7da8,0x27e3c,0x27e74
.long 0x6eac,0x7dac,0x27e30,0x27e74,0x6e9c,0x7db0,0x27e34,0x27e74,0x6e8c,0x7db4,0x27e38,0x27e74,0x6e7c,0x7db8,0x27e3c,0x27e74
.long 0x6e6c,0x7dbc,0x27e30,0x27e74,0x6e5c,0x7dc0,0x27e34,0x27e74,0x6e4c,0x7dc4,0x27e38,0x27e74,0x6e3c,0x7dc8,0x27e3c,0x27e74
.long 0x6e2c,0x7dcc,0x27e30,0x27e74,0x6e1c,0x7dd0,0x27e34,0x27e74,0x6e0c,0x7dd4,0x27e38,0x27e74,0x6dfc,0x7dd8,0x27e3c,0x27e74
.long 0x6dec,0x7ddc,0x27e30,0x27e74,0x6ddc,0x7de0,0x27e34,0x27e74,0x6dcc,0x7de4,0x27e38,0x27e74,0x6dbc,0x7de8,0x27e3c,0x27e74
.long 0x6dac,0x7dec,0x27e30,0x27e74,0x6d9c,0x7df0,0x27e34,0x27e74,0x6d8c,0x7df4,0x27e38,0x27e74,0x6d7c,0x7df4,0x27e3c,0x27e74
.long 0x7e00,0xa770,0x0,0x81f0,0x7f10,0xa660,0x0,0x81e0,0x8020,0xa550,0x0,0x81d0,0x8130,0xa440,0x0,0x81c0
.long 0x8240,0xacc0,0x0,0x81b0,0x8350,0xabb0,0x0,0x81a0,0x8460,0xaaa0,0x0,0x8190,0x8570,0xaaa0,0x0,0x8180
.long 0x8680,0xa330,0x0,0x8170,0x8790,0xa220,0x0,0x8160,0x88a0,0xa110,0x0,0x8150,0x89b0,0xa000,0x0,0x8140
.long 0x8ac0,0xaaa0,0x0,0x8130,0x8bd0,0xa990,0x0,0x8120,0x8ce0,0xa880,0x0,0x8110,0x8df0,0xa880,0x0,0x8100
.long 0x8f00,0xadd0,0x0,0x80f0,0x9010,0xaee0,0x0,0x80e0,0x9120,0xaff0,0x0,0x80d0,0x9230,0xaff0,0x0,0x80c0
.long 0x9340,0xb100,0x0,0x80b0,0x9450,0xb210,0x0,0x80a0,0x9560,0xb320,0x0,0x8090,0x9670,0xb320,0x0,0x8080
.long 0x9780,0xb430,0x0,0x8070,0x9890,0xb540,0x0,0x8060,0x99a0,0xb870,0x0,0x8050,0x9ab0,0xb980,0x0,0x8040
.long 0x9bc0,0xb650,0x0,0x8030,0x9cd0,0xb760,0x0,0x8020,0x9de0,0xba90,0x0,0x8010,0x9ef0,0xbba0,0x0,0x8000
.long 0x7e10,0xa780,0x0,0x7ff0,0x7f20,0xa670,0x0,0x7fe0,0x8030,0xa560,0x0,0x7fd0,0x8140,0xa450,0x0,0x7fc0
.long 0x8250,0xacd0,0x0,0x7fb0,0x8360,0xabc0,0x0,0x7fa0,0x8470,0xaab0,0x0,0x7f90,0x8580,0xaab0,0x0,0x7f80
.long 0x8690,0xa340,0x0,0x7f70,0x87a0,0xa230,0x0,0x7f60,0x88b0,0xa120,0x0,0x7f50,0x89c0,0xa010,0x0,0x7f40
.long 0x8ad0,0xaab0,0x0,0x7f30,0x8be0,0xa9a0,0x0,0x7f20,0x8cf0,0xa890,0x0,0x7f10,0x8e00,0xa890,0x0,0x7f00
.long 0x8f10,0xade0,0x0,0x7ef0,0x9020,0xaef0,0x0,0x7ee0,0x9130,0xb000,0x0,0x7ed0,0x9240,0xb000,0x0,0x7ec0
.long 0x9350,0xb110,0x0,0x7eb0,0x9460,0xb220,0x0,0x7ea0,0x9570,0xb330,0x0,0x7e90,0x9680,0xb330,0x0,0x7e80
.long 0x9790,0xb440,0x0,0x7e70,0x98a0,0xb550,0x0,0x7e60,0x99b0,0xb880,0x0,0x7e50,0x9ac0,0xb990,0x0,0x7e40
.long 0x9bd0,0xb660,0x0,0x7e30,0x9ce0,0xb770,0x0,0x7e20,0x9df0,0xbaa0,0x0,0x7e10,0x9f00,0xbbb0,0x0,0x7e00
.long 0x926c,0x8e00,0x27e30,0x27e78,0x925c,0x8e04,0x27e34,0x27e78,0x924c,0x8e08,0x27e38,0x27e78,0x923c,0x8e0c,0x27e3c,0x27e78
.long 0x922c,0x8e10,0x27e30,0x27e78,0x921c,0x8e14,0x27e34,0x27e78,0x920c,0x8e18,0x27e38,0x27e78,0x91fc,0x8e1c,0x27e3c,0x27e78
.long 0x91ec,0x8e20,0x27e30,0x27e78,0x91dc,0x8e24,0x27e34,0x27e78,0x91cc,0x8e28,0x27e38,0x27e78,0x91bc,0x8e2c,0x27e3c,0x27e78
.long 0x91ac,0x8e30,0x27e30,0x27e78,0x919c,0x8e34,0x27e34,0x27e78,0x918c,0x8e38,0x27e38,0x27e78,0x917c,0x8e3c,0x27e3c,0x27e78
.long 0x916c,0x8e40,0x27e30,0x27e78,0x915c,0x8e44,0x27e34,0x27e78,0x914c,0x8e48,0x27e38,0x27e78,0x913c,0x8e4c,0x27e3c,0x27e78
.long 0x912c,0x8e50,0x27e30,0x27e78,0x911c,0x8e54,0x27e34,0x27e78,0x910c,0x8e58,0x27e38,0x27e78,0x90fc,0x8e5c,0x27e3c,0x27e78
.long 0x90ec,0x8e60,0x27e30,0x27e78,0x90dc,0x8e64,0x27e34,0x27e78,0x90cc,0x8e68,0x27e38,0x27e78,0x90bc,0x8e6c,0x27e3c,0x27e78
.long 0x90ac,0x8e70,0x27e30,0x27e78,0x909c,0x8e74,0x27e34,0x27e78,0x908c,0x8e78,0x27e38,0x27e78,0x907c,0x8e78,0x27e3c,0x27e78
.long 0x906c,0x9e7c,0x27e30,0x27e78,0x905c,0x9e80,0x27e34,0x27e78,0x904c,0x9e84,0x27e38,0x27e78,0x903c,0x9e88,0x27e3c,0x27e78
.long 0x902c,0x9e8c,0x27e30,0x27e78,0x901c,0x9e90,0x27e34,0x27e78,0x900c,0x9e94,0x27e38,0x27e78,0x8ffc,0x9e98,0x27e3c,0x27e78
.long 0x8fec,0x9e9c,0x27e30,0x27e78,0x8fdc,0x9ea0,0x27e34,0x27e78,0x8fcc,0x9ea4,0x27e38,0x27e78,0x8fbc,0x9ea8,0x27e3c,0x27e78
.long 0x8fac,0x9eac,0x27e30,0x27e78,0x8f9c,0x9eb0,0x27e34,0x27e78,0x8f8c,0x9eb4,0x27e38,0x27e78,0x8f7c,0x9eb8,0x27e3c,0x27e78
.long 0x8f6c,0x9ebc,0x27e30,0x27e78,0x8f5c,0x9ec0,0x27e34,0x27e78,0x8f4c,0x9ec4,0x27e38,0x27e78,0x8f3c,0x9ec8,0x27e3c,0x27e78
.long 0x8f2c,0x9ecc,0x27e30,0x27e78,0x8f1c,0x9ed0,0x27e34,0x27e78,0x8f0c,0x9ed4,0x27e38,0x27e78,0x8efc,0x9ed8,0x27e3c,0x27e78
.long 0x8eec,0x9edc,0x27e30,0x27e78,0x8edc,0x9ee0,0x27e34,0x27e78,0x8ecc,0x9ee4,0x27e38,0x27e78,0x8ebc,0x9ee8,0x27e3c,0x27e78
.long 0x8eac,0x9eec,0x27e30,0x27e78,0x8e9c,0x9ef0,0x27e34,0x27e78,0x8e8c,0x9ef4,0x27e38,0x27e78,0x8e7c,0x9ef4,0x27e3c,0x27e78
.long 0x0,0x1a40,0x2080,0x5320,0x10,0x1a50,0x2090,0x5330,0x20,0x1a60,0x2500,0x5340,0x30,0x1a70,0x2510,0x5350
.long 0x40,0x1a80,0x2520,0x5360,0x50,0x1a90,0x2530,0x5370,0x60,0x1f00,0x2540,0x5380,0x70,0x1f10,0x2550,0x5390
.long 0x80,0x1f20,0x2560,0x5800,0x90,0x1f30,0x2570,0x5810,0x500,0x1f40,0x2580,0x5820,0x510,0x1f50,0x2590,0x5830
.long 0x520,0x1f60,0x2a00,0x5840,0x530,0x1f70,0x2a10,0x5850,0x540,0x1f80,0x2a20,0x5860,0x550,0x1f90,0x2a30,0x5870
.long 0x560,0x3800,0x2a40,0x5880,0x570,0x3810,0x2a50,0x5890,0x580,0x3820,0x2a60,0x5d00,0x590,0x3830,0x2a70,0x5d10
.long 0xa00,0x3840,0x2a80,0x5d20,0xa10,0x3850,0x2a90,0x5d30,0xa20,0x3860,0x2f00,0x5d40,0xa30,0x3870,0x2f10,0x5d50
.long 0xa40,0x3880,0x2f20,0x5d60,0xa50,0x3890,0x2f30,0x5d70,0xa60,0x3d00,0x2f40,0x5d80,0xa70,0x3d10,0x2f50,0x5d90
.long 0xa80,0x3d20,0x2f60,0x6200,0xa90,0x3d30,0x2f70,0x6210,0xf00,0x3d40,0x2f80,0x6220,0xf10,0x3d50,0x2f90,0x6230
.long 0xf20,0x3d60,0x4800,0x6240,0xf30,0x3d70,0x4810,0x6250,0xf40,0x3d80,0x4820,0x6260,0xf50,0x3d90,0x4830,0x6270
.long 0xf60,0x4200,0x4840,0x6280,0xf70,0x4210,0x4850,0x6290,0xf80,0x4220,0x4860,0x6700,0xf90,0x4230,0x4870,0x6710
.long 0x1400,0x4240,0x4880,0x6720,0x1410,0x4250,0x4890,0x6730,0x1420,0x4260,0x4d00,0x6740,0x1430,0x4270,0x4d10,0x6750
.long 0x1440,0x4280,0x4d20,0x6760,0x1450,0x4290,0x4d30,0x6770,0x1460,0x4700,0x4d40,0x6780,0x1470,0x4710,0x4d50,0x6790
.long 0x1480,0x4720,0x4d60,0x8000,0x1490,0x4730,0x4d70,0x8010,0x1900,0x4740,0x4d80,0x8020,0x1910,0x4750,0x4d90,0x8030
.long 0x1920,0x4760,0x5200,0x8040,0x1930,0x4770,0x5210,0x8050,0x1940,0x4780,0x5220,0x8060,0x1950,0x4790,0x5230,0x8070
.long 0x1960,0x2400,0x5240,0x8080,0x1970,0x2410,0x5250,0x8090,0x1980,0x2420,0x5260,0x8500,0x1990,0x2430,0x5270,0x8510
.long 0x1e00,0x2440,0x5280,0x8520,0x1e10,0x2450,0x5290,0x8530,0x1e20,0x2460,0x5700,0x8540,0x1e30,0x2470,0x5710,0x8550
.long 0x9160,0x0,0x27e00,0x12600,0x9170,0x10,0x27e04,0x16000,0x9180,0x20,0x27e08,0x19a00,0x9190,0x30,0x27e0c,0x19a00
.long 0x9600,0x40,0x27e00,0x19a00,0x9610,0x50,0x27e04,0x19a00,0x9620,0x60,0x27e08,0x19a00,0x9630,0x70,0x27e0c,0x19a00
.long 0x9640,0x80,0x27e00,0x19a00,0x9650,0x80,0x27e04,0x19a00,0x9660,0x90,0x27e08,0x19a00,0x9670,0xa0,0x27e0c,0x19a00
.long 0x9680,0xb0,0x27e00,0x19a00,0x9690,0xc0,0x27e04,0x19a00,0x9b00,0xd0,0x27e08,0x19a00,0x9b10,0xe0,0x27e0c,0x19a00
.long 0x9b20,0xf0,0x27e00,0x19a00,0x9b30,0x100,0x27e04,0x19a00,0x9b40,0x100,0x27e08,0x19a00,0x9b50,0x110,0x27e0c,0x19a00
.long 0x9b60,0x120,0x27e00,0x19a00,0x9b70,0x130,0x27e04,0x19a00,0x9b80,0x140,0x27e08,0x19a00,0x9b90,0x150,0x27e0c,0x19a00
.long 0x7800,0x160,0x27e00,0x19a00,0x7810,0x170,0x27e04,0x19a00,0x7820,0x180,0x27e08,0x19a00,0x7830,0x180,0x27e0c,0x19a00
.long 0x7840,0x190,0x27e00,0x19a00,0x7850,0x1a0,0x27e04,0x19a00,0x7860,0x1b0,0x27e08,0x19a00,0x7870,0x1c0,0x27e0c,0x19a00
.long 0x7880,0x1d0,0x27e00,0x19a00,0x7890,0x1e0,0x27e04,0x19a00,0x7d00,0x1f0,0x27e08,0x19a00,0x7d10,0x200,0x27e0c,0x19a00
.long 0x7d20,0x200,0x27e00,0x19a00,0x7d30,0x210,0x27e04,0x19a00,0x7d40,0x220,0x27e08,0x19a00,0x7d50,0x230,0x27e0c,0x19a00
.long 0x7d60,0x240,0x27e00,0x19a00,0x7d70,0x250,0x27e04,0x19a00,0x7d80,0x260,0x27e08,0x19a00,0x7d90,0x270,0x27e0c,0x19a00
.long 0x8200,0x280,0x27e00,0x19a00,0x8210,0x280,0x27e04,0x19a00,0x8220,0x290,0x27e08,0x19a00,0x8230,0x2a0,0x27e0c,0x19a00
.long 0x8240,0x2b0,0x27e00,0x19a00,0x8250,0x2c0,0x27e04,0x19a00,0x8260,0x2d0,0x27e08,0x19a00,0x8270,0x2e0,0x27e0c,0x19a00
.long 0x8280,0x2f0,0x27e00,0x19a00,0x8290,0x300,0x27e04,0x19a00,0x8700,0x300,0x27e08,0x19a00,0x8710,0x310,0x27e0c,0x19a00
.long 0x8720,0x320,0x27e00,0x19a00,0x8730,0x330,0x27e04,0x19a00,0x8740,0x340,0x27e08,0x19a00,0x8750,0x350,0x27e0c,0x19a00
.long 0x8760,0x360,0x27e00,0x19a00,0x8770,0x370,0x27e04,0x19a00,0x8780,0x380,0x27e08,0x19a00,0x8790,0x380,0x27e0c,0x19a00
.long 0x0,0x220,0x800,0xa20,0x8,0x228,0x808,0xa28,0x10,0x230,0x810,0xa30,0x18,0x238,0x818,0xa38
.long 0x80,0x2a0,0x880,0xaa0,0x88,0x2a8,0x888,0xaa8,0x90,0x2b0,0x890,0xab0,0x98,0x2b8,0x898,0xab8
.long 0x110,0x330,0x910,0xb30,0x118,0x338,0x918,0xb38,0x100,0x320,0x900,0xb20,0x108,0x328,0x908,0xb28
.long 0x190,0x3b0,0x990,0xbb0,0x198,0x3b8,0x998,0xbb8,0x180,0x3a0,0x980,0xba0,0x188,0x3a8,0x988,0xba8
.long 0x440,0x660,0xc40,0xe60,0x448,0x668,0xc48,0xe68,0x450,0x670,0xc50,0xe70,0x458,0x678,0xc58,0xe78
.long 0x4c0,0x6e0,0xcc0,0xee0,0x4c8,0x6e8,0xcc8,0xee8,0x4d0,0x6f0,0xcd0,0xef0,0x4d8,0x6f8,0xcd8,0xef8
.long 0x550,0x770,0xd50,0xf70,0x558,0x778,0xd58,0xf78,0x540,0x760,0xd40,0xf60,0x548,0x768,0xd48,0xf68
.long 0x5d0,0x7f0,0xdd0,0xff0,0x5d8,0x7f8,0xdd8,0xff8,0x5c0,0x7e0,0xdc0,0xfe0,0x5c8,0x7e8,0xdc8,0xfe8
.long 0x2800,0x2a20,0x3000,0x3220,0x2808,0x2a28,0x3008,0x3228,0x2810,0x2a30,0x3010,0x3230,0x2818,0x2a38,0x3018,0x3238
.long 0x2880,0x2aa0,0x3080,0x32a0,0x2888,0x2aa8,0x3088,0x32a8,0x2890,0x2ab0,0x3090,0x32b0,0x2898,0x2ab8,0x3098,0x32b8
.long 0x2910,0x2b30,0x3110,0x3330,0x2918,0x2b38,0x3118,0x3338,0x2900,0x2b20,0x3100,0x3320,0x2908,0x2b28,0x3108,0x3328
.long 0x2990,0x2bb0,0x3190,0x33b0,0x2998,0x2bb8,0x3198,0x33b8,0x2980,0x2ba0,0x3180,0x33a0,0x2988,0x2ba8,0x3188,0x33a8
.long 0x2c40,0x2e60,0x3440,0x3660,0x2c48,0x2e68,0x3448,0x3668,0x2c50,0x2e70,0x3450,0x3670,0x2c58,0x2e78,0x3458,0x3678
.long 0x2cc0,0x2ee0,0x34c0,0x36e0,0x2cc8,0x2ee8,0x34c8,0x36e8,0x2cd0,0x2ef0,0x34d0,0x36f0,0x2cd8,0x2ef8,0x34d8,0x36f8
.long 0x2d50,0x2f70,0x3550,0x3770,0x2d58,0x2f78,0x3558,0x3778,0x2d40,0x2f60,0x3540,0x3760,0x2d48,0x2f68,0x3548,0x3768
.long 0x2dd0,0x2ff0,0x35d0,0x37f0,0x2dd8,0x2ff8,0x35d8,0x37f8,0x2dc0,0x2fe0,0x35c0,0x37e0,0x2dc8,0x2fe8,0x35c8,0x37e8
.long 0xa000,0xa000,0x0,0x27e40,0xa090,0xa010,0x10,0x27e44,0xa120,0xa020,0x20,0x27e48,0xa1b0,0xa030,0x30,0x27e48
.long 0xa240,0xa040,0x40,0x27e48,0xa2d0,0xa050,0x50,0x27e48,0xa360,0xa060,0x60,0x27e48,0xa3f0,0xa070,0x70,0x27e48
.long 0xa480,0xa090,0x1080,0x27e48,0xa510,0xa0a0,0x1090,0x27e48,0xa5a0,0xa0b0,0x10a0,0x27e48,0xa630,0xa0c0,0x10b0,0x27e48
.long 0xa6c0,0xa0d0,0x10c0,0x27e48,0xa750,0xa0e0,0x10d0,0x27e48,0xa7e0,0xa0f0,0x10e0,0x27e48,0xa870,0xa100,0x10f0,0x27e48
.long 0xa010,0xa120,0x2100,0x27e48,0xa0a0,0xa130,0x2110,0x27e48,0xa130,0xa140,0x2120,0x27e48,0xa1c0,0xa150,0x2130,0x27e48
.long 0xa250,0xa160,0x2140,0x27e48,0xa2e0,0xa170,0x2150,0x27e48,0xa370,0xa180,0x2160,0x27e48,0xa400,0xa190,0x2170,0x27e48
.long 0xa490,0xa1b0,0x3180,0x27e48,0xa520,0xa1c0,0x3190,0x27e48,0xa5b0,0xa1d0,0x31a0,0x27e48,0xa640,0xa1e0,0x31b0,0x27e48
.long 0xa6d0,0xa1f0,0x31c0,0x27e48,0xa760,0xa200,0x31d0,0x27e48,0xa7f0,0xa210,0x31e0,0x27e48,0xa880,0xa220,0x31f0,0x27e48
.long 0xa020,0xa240,0x4200,0x27e48,0xa0b0,0xa250,0x4210,0x27e48,0xa140,0xa260,0x4220,0x27e48,0xa1d0,0xa270,0x4230,0x27e48
.long 0xa260,0xa280,0x4240,0x27e48,0xa2f0,0xa290,0x4250,0x27e48,0xa380,0xa2a0,0x4260,0x27e48,0xa410,0xa2b0,0x4270,0x27e48
.long 0xa4a0,0xa2d0,0x5280,0x27e48,0xa530,0xa2e0,0x5290,0x27e48,0xa5c0,0xa2f0,0x52a0,0x27e48,0xa650,0xa300,0x52b0,0x27e48
.long 0xa6e0,0xa310,0x52c0,0x27e48,0xa770,0xa320,0x52d0,0x27e48,0xa800,0xa330,0x52e0,0x27e48,0xa890,0xa340,0x52f0,0x27e48
.long 0xa030,0xa360,0x6300,0x27e48,0xa0c0,0xa370,0x6310,0x27e48,0xa150,0xa380,0x6320,0x27e48,0xa1e0,0xa390,0x6330,0x27e48
.long 0xa270,0xa3a0,0x6340,0x27e48,0xa300,0xa3b0,0x6350,0x27e48,0xa390,0xa3c0,0x6360,0x27e48,0xa420,0xa3d0,0x6370,0x27e48
.long 0xa4b0,0xa3f0,0x7380,0x27e48,0xa540,0xa400,0x7390,0x27e48,0xa5d0,0xa410,0x73a0,0x27e48,0xa660,0xa420,0x73b0,0x27e48
.long 0xa6f0,0xa430,0x73c0,0x27e48,0xa780,0xa440,0x73d0,0x27e48,0xa810,0xa450,0x73e0,0x27e48,0xa8a0,0xa460,0x73f0,0x27e48
.long 0x20,0x200,0x800,0xa20,0x28,0x208,0x808,0xa28,0x30,0x210,0x810,0xa30,0x38,0x218,0x818,0xa38
.long 0xa0,0x280,0x880,0xaa0,0xa8,0x288,0x888,0xaa8,0xb0,0x290,0x890,0xab0,0xb8,0x298,0x898,0xab8
.long 0x130,0x310,0x910,0xb30,0x138,0x318,0x918,0xb38,0x120,0x300,0x900,0xb20,0x128,0x308,0x908,0xb28
.long 0x1b0,0x390,0x990,0xbb0,0x1b8,0x398,0x998,0xbb8,0x1a0,0x380,0x980,0xba0,0x1a8,0x388,0x988,0xba8
.long 0x460,0x640,0xc40,0xe60,0x468,0x648,0xc48,0xe68,0x470,0x650,0xc50,0xe70,0x478,0x658,0xc58,0xe78
.long 0x4e0,0x6c0,0xcc0,0xee0,0x4e8,0x6c8,0xcc8,0xee8,0x4f0,0x6d0,0xcd0,0xef0,0x4f8,0x6d8,0xcd8,0xef8
.long 0x570,0x750,0xd50,0xf70,0x578,0x758,0xd58,0xf78,0x560,0x740,0xd40,0xf60,0x568,0x748,0xd48,0xf68
.long 0x5f0,0x7d0,0xdd0,0xff0,0x5f8,0x7d8,0xdd8,0xff8,0x5e0,0x7c0,0xdc0,0xfe0,0x5e8,0x7c8,0xdc8,0xfe8
.long 0x2820,0x2a00,0x3000,0x3220,0x2828,0x2a08,0x3008,0x3228,0x2830,0x2a10,0x3010,0x3230,0x2838,0x2a18,0x3018,0x3238
.long 0x28a0,0x2a80,0x3080,0x32a0,0x28a8,0x2a88,0x3088,0x32a8,0x28b0,0x2a90,0x3090,0x32b0,0x28b8,0x2a98,0x3098,0x32b8
.long 0x2930,0x2b10,0x3110,0x3330,0x2938,0x2b18,0x3118,0x3338,0x2920,0x2b00,0x3100,0x3320,0x2928,0x2b08,0x3108,0x3328
.long 0x29b0,0x2b90,0x3190,0x33b0,0x29b8,0x2b98,0x3198,0x33b8,0x29a0,0x2b80,0x3180,0x33a0,0x29a8,0x2b88,0x3188,0x33a8
.long 0x2c60,0x2e40,0x3440,0x3660,0x2c68,0x2e48,0x3448,0x3668,0x2c70,0x2e50,0x3450,0x3670,0x2c78,0x2e58,0x3458,0x3678
.long 0x2ce0,0x2ec0,0x34c0,0x36e0,0x2ce8,0x2ec8,0x34c8,0x36e8,0x2cf0,0x2ed0,0x34d0,0x36f0,0x2cf8,0x2ed8,0x34d8,0x36f8
.long 0x2d70,0x2f50,0x3550,0x3770,0x2d78,0x2f58,0x3558,0x3778,0x2d60,0x2f40,0x3540,0x3760,0x2d68,0x2f48,0x3548,0x3768
.long 0x2df0,0x2fd0,0x35d0,0x37f0,0x2df8,0x2fd8,0x35d8,0x37f8,0x2de0,0x2fc0,0x35c0,0x37e0,0x2de8,0x2fc8,0x35c8,0x37e8
.long 0xa900,0xa900,0x0,0x27e40,0xa990,0xa910,0x10,0x27e44,0xaa20,0xa920,0x20,0x27e48,0xaab0,0xa930,0x30,0x27e48
.long 0xab40,0xa940,0x40,0x27e48,0xabd0,0xa950,0x50,0x27e48,0xac60,0xa960,0x60,0x27e48,0xacf0,0xa970,0x70,0x27e48
.long 0xad80,0xa990,0x1080,0x27e48,0xae10,0xa9a0,0x1090,0x27e48,0xaea0,0xa9b0,0x10a0,0x27e48,0xaf30,0xa9c0,0x10b0,0x27e48
.long 0xafc0,0xa9d0,0x10c0,0x27e48,0xb050,0xa9e0,0x10d0,0x27e48,0xb0e0,0xa9f0,0x10e0,0x27e48,0xb170,0xaa00,0x10f0,0x27e48
.long 0xa910,0xaa20,0x2100,0x27e48,0xa9a0,0xaa30,0x2110,0x27e48,0xaa30,0xaa40,0x2120,0x27e48,0xaac0,0xaa50,0x2130,0x27e48
.long 0xab50,0xaa60,0x2140,0x27e48,0xabe0,0xaa70,0x2150,0x27e48,0xac70,0xaa80,0x2160,0x27e48,0xad00,0xaa90,0x2170,0x27e48
.long 0xad90,0xaab0,0x3180,0x27e48,0xae20,0xaac0,0x3190,0x27e48,0xaeb0,0xaad0,0x31a0,0x27e48,0xaf40,0xaae0,0x31b0,0x27e48
.long 0xafd0,0xaaf0,0x31c0,0x27e48,0xb060,0xab00,0x31d0,0x27e48,0xb0f0,0xab10,0x31e0,0x27e48,0xb180,0xab20,0x31f0,0x27e48
.long 0xa920,0xab40,0x4200,0x27e48,0xa9b0,0xab50,0x4210,0x27e48,0xaa40,0xab60,0x4220,0x27e48,0xaad0,0xab70,0x4230,0x27e48
.long 0xab60,0xab80,0x4240,0x27e48,0xabf0,0xab90,0x4250,0x27e48,0xac80,0xaba0,0x4260,0x27e48,0xad10,0xabb0,0x4270,0x27e48
.long 0xada0,0xabd0,0x5280,0x27e48,0xae30,0xabe0,0x5290,0x27e48,0xaec0,0xabf0,0x52a0,0x27e48,0xaf50,0xac00,0x52b0,0x27e48
.long 0xafe0,0xac10,0x52c0,0x27e48,0xb070,0xac20,0x52d0,0x27e48,0xb100,0xac30,0x52e0,0x27e48,0xb190,0xac40,0x52f0,0x27e48
.long 0xa930,0xac60,0x6300,0x27e48,0xa9c0,0xac70,0x6310,0x27e48,0xaa50,0xac80,0x6320,0x27e48,0xaae0,0xac90,0x6330,0x27e48
.long 0xab70,0xaca0,0x6340,0x27e48,0xac00,0xacb0,0x6350,0x27e48,0xac90,0xacc0,0x6360,0x27e48,0xad20,0xacd0,0x6370,0x27e48
.long 0xadb0,0xacf0,0x7380,0x27e48,0xae40,0xad00,0x7390,0x27e48,0xaed0,0xad10,0x73a0,0x27e48,0xaf60,0xad20,0x73b0,0x27e48
.long 0xaff0,0xad30,0x73c0,0x27e48,0xb080,0xad40,0x73d0,0x27e48,0xb110,0xad50,0x73e0,0x27e48,0xb1a0,0xad60,0x73f0,0x27e48
.long 0x40,0x260,0x800,0xa20,0x48,0x268,0x808,0xa28,0x50,0x270,0x810,0xa30,0x58,0x278,0x818,0xa38
.long 0xc0,0x2e0,0x880,0xaa0,0xc8,0x2e8,0x888,0xaa8,0xd0,0x2f0,0x890,0xab0,0xd8,0x2f8,0x898,0xab8
.long 0x150,0x370,0x910,0xb30,0x158,0x378,0x918,0xb38,0x140,0x360,0x900,0xb20,0x148,0x368,0x908,0xb28
.long 0x1d0,0x3f0,0x990,0xbb0,0x1d8,0x3f8,0x998,0xbb8,0x1c0,0x3e0,0x980,0xba0,0x1c8,0x3e8,0x988,0xba8
.long 0x400,0x620,0xc40,0xe60,0x408,0x628,0xc48,0xe68,0x410,0x630,0xc50,0xe70,0x418,0x638,0xc58,0xe78
.long 0x480,0x6a0,0xcc0,0xee0,0x488,0x6a8,0xcc8,0xee8,0x490,0x6b0,0xcd0,0xef0,0x498,0x6b8,0xcd8,0xef8
.long 0x510,0x730,0xd50,0xf70,0x518,0x738,0xd58,0xf78,0x500,0x720,0xd40,0xf60,0x508,0x728,0xd48,0xf68
.long 0x590,0x7b0,0xdd0,0xff0,0x598,0x7b8,0xdd8,0xff8,0x580,0x7a0,0xdc0,0xfe0,0x588,0x7a8,0xdc8,0xfe8
.long 0x2840,0x2a60,0x3000,0x3220,0x2848,0x2a68,0x3008,0x3228,0x2850,0x2a70,0x3010,0x3230,0x2858,0x2a78,0x3018,0x3238
.long 0x28c0,0x2ae0,0x3080,0x32a0,0x28c8,0x2ae8,0x3088,0x32a8,0x28d0,0x2af0,0x3090,0x32b0,0x28d8,0x2af8,0x3098,0x32b8
.long 0x2950,0x2b70,0x3110,0x3330,0x2958,0x2b78,0x3118,0x3338,0x2940,0x2b60,0x3100,0x3320,0x2948,0x2b68,0x3108,0x3328
.long 0x29d0,0x2bf0,0x3190,0x33b0,0x29d8,0x2bf8,0x3198,0x33b8,0x29c0,0x2be0,0x3180,0x33a0,0x29c8,0x2be8,0x3188,0x33a8
.long 0x2c00,0x2e20,0x3440,0x3660,0x2c08,0x2e28,0x3448,0x3668,0x2c10,0x2e30,0x3450,0x3670,0x2c18,0x2e38,0x3458,0x3678
.long 0x2c80,0x2ea0,0x34c0,0x36e0,0x2c88,0x2ea8,0x34c8,0x36e8,0x2c90,0x2eb0,0x34d0,0x36f0,0x2c98,0x2eb8,0x34d8,0x36f8
.long 0x2d10,0x2f30,0x3550,0x3770,0x2d18,0x2f38,0x3558,0x3778,0x2d00,0x2f20,0x3540,0x3760,0x2d08,0x2f28,0x3548,0x3768
.long 0x2d90,0x2fb0,0x35d0,0x37f0,0x2d98,0x2fb8,0x35d8,0x37f8,0x2d80,0x2fa0,0x35c0,0x37e0,0x2d88,0x2fa8,0x35c8,0x37e8
.long 0xb200,0xb200,0x0,0x27e40,0xb290,0xb210,0x10,0x27e44,0xb320,0xb220,0x20,0x27e48,0xb3b0,0xb230,0x30,0x27e48
.long 0xb440,0xb240,0x40,0x27e48,0xb4d0,0xb250,0x50,0x27e48,0xb560,0xb260,0x60,0x27e48,0xb5f0,0xb270,0x70,0x27e48
.long 0xb680,0xb290,0x1080,0x27e48,0xb710,0xb2a0,0x1090,0x27e48,0xb7a0,0xb2b0,0x10a0,0x27e48,0xb830,0xb2c0,0x10b0,0x27e48
.long 0xb8c0,0xb2d0,0x10c0,0x27e48,0xb950,0xb2e0,0x10d0,0x27e48,0xb9e0,0xb2f0,0x10e0,0x27e48,0xba70,0xb300,0x10f0,0x27e48
.long 0xb210,0xb320,0x2100,0x27e48,0xb2a0,0xb330,0x2110,0x27e48,0xb330,0xb340,0x2120,0x27e48,0xb3c0,0xb350,0x2130,0x27e48
.long 0xb450,0xb360,0x2140,0x27e48,0xb4e0,0xb370,0x2150,0x27e48,0xb570,0xb380,0x2160,0x27e48,0xb600,0xb390,0x2170,0x27e48
.long 0xb690,0xb3b0,0x3180,0x27e48,0xb720,0xb3c0,0x3190,0x27e48,0xb7b0,0xb3d0,0x31a0,0x27e48,0xb840,0xb3e0,0x31b0,0x27e48
.long 0xb8d0,0xb3f0,0x31c0,0x27e48,0xb960,0xb400,0x31d0,0x27e48,0xb9f0,0xb410,0x31e0,0x27e48,0xba80,0xb420,0x31f0,0x27e48
.long 0xb220,0xb440,0x4200,0x27e48,0xb2b0,0xb450,0x4210,0x27e48,0xb340,0xb460,0x4220,0x27e48,0xb3d0,0xb470,0x4230,0x27e48
.long 0xb460,0xb480,0x4240,0x27e48,0xb4f0,0xb490,0x4250,0x27e48,0xb580,0xb4a0,0x4260,0x27e48,0xb610,0xb4b0,0x4270,0x27e48
.long 0xb6a0,0xb4d0,0x5280,0x27e48,0xb730,0xb4e0,0x5290,0x27e48,0xb7c0,0xb4f0,0x52a0,0x27e48,0xb850,0xb500,0x52b0,0x27e48
.long 0xb8e0,0xb510,0x52c0,0x27e48,0xb970,0xb520,0x52d0,0x27e48,0xba00,0xb530,0x52e0,0x27e48,0xba90,0xb540,0x52f0,0x27e48
.long 0xb230,0xb560,0x6300,0x27e48,0xb2c0,0xb570,0x6310,0x27e48,0xb350,0xb580,0x6320,0x27e48,0xb3e0,0xb590,0x6330,0x27e48
.long 0xb470,0xb5a0,0x6340,0x27e48,0xb500,0xb5b0,0x6350,0x27e48,0xb590,0xb5c0,0x6360,0x27e48,0xb620,0xb5d0,0x6370,0x27e48
.long 0xb6b0,0xb5f0,0x7380,0x27e48,0xb740,0xb600,0x7390,0x27e48,0xb7d0,0xb610,0x73a0,0x27e48,0xb860,0xb620,0x73b0,0x27e48
.long 0xb8f0,0xb630,0x73c0,0x27e48,0xb980,0xb640,0x73d0,0x27e48,0xba10,0xb650,0x73e0,0x27e48,0xbaa0,0xb660,0x73f0,0x27e48
.long 0x60,0x240,0x800,0xa20,0x68,0x248,0x808,0xa28,0x70,0x250,0x810,0xa30,0x78,0x258,0x818,0xa38
.long 0xe0,0x2c0,0x880,0xaa0,0xe8,0x2c8,0x888,0xaa8,0xf0,0x2d0,0x890,0xab0,0xf8,0x2d8,0x898,0xab8
.long 0x170,0x350,0x910,0xb30,0x178,0x358,0x918,0xb38,0x160,0x340,0x900,0xb20,0x168,0x348,0x908,0xb28
.long 0x1f0,0x3d0,0x990,0xbb0,0x1f8,0x3d8,0x998,0xbb8,0x1e0,0x3c0,0x980,0xba0,0x1e8,0x3c8,0x988,0xba8
.long 0x420,0x600,0xc40,0xe60,0x428,0x608,0xc48,0xe68,0x430,0x610,0xc50,0xe70,0x438,0x618,0xc58,0xe78
.long 0x4a0,0x680,0xcc0,0xee0,0x4a8,0x688,0xcc8,0xee8,0x4b0,0x690,0xcd0,0xef0,0x4b8,0x698,0xcd8,0xef8
.long 0x530,0x710,0xd50,0xf70,0x538,0x718,0xd58,0xf78,0x520,0x700,0xd40,0xf60,0x528,0x708,0xd48,0xf68
.long 0x5b0,0x790,0xdd0,0xff0,0x5b8,0x798,0xdd8,0xff8,0x5a0,0x780,0xdc0,0xfe0,0x5a8,0x788,0xdc8,0xfe8
.long 0x2860,0x2a40,0x3000,0x3220,0x2868,0x2a48,0x3008,0x3228,0x2870,0x2a50,0x3010,0x3230,0x2878,0x2a58,0x3018,0x3238
.long 0x28e0,0x2ac0,0x3080,0x32a0,0x28e8,0x2ac8,0x3088,0x32a8,0x28f0,0x2ad0,0x3090,0x32b0,0x28f8,0x2ad8,0x3098,0x32b8
.long 0x2970,0x2b50,0x3110,0x3330,0x2978,0x2b58,0x3118,0x3338,0x2960,0x2b40,0x3100,0x3320,0x2968,0x2b48,0x3108,0x3328
.long 0x29f0,0x2bd0,0x3190,0x33b0,0x29f8,0x2bd8,0x3198,0x33b8,0x29e0,0x2bc0,0x3180,0x33a0,0x29e8,0x2bc8,0x3188,0x33a8
.long 0x2c20,0x2e00,0x3440,0x3660,0x2c28,0x2e08,0x3448,0x3668,0x2c30,0x2e10,0x3450,0x3670,0x2c38,0x2e18,0x3458,0x3678
.long 0x2ca0,0x2e80,0x34c0,0x36e0,0x2ca8,0x2e88,0x34c8,0x36e8,0x2cb0,0x2e90,0x34d0,0x36f0,0x2cb8,0x2e98,0x34d8,0x36f8
.long 0x2d30,0x2f10,0x3550,0x3770,0x2d38,0x2f18,0x3558,0x3778,0x2d20,0x2f00,0x3540,0x3760,0x2d28,0x2f08,0x3548,0x3768
.long 0x2db0,0x2f90,0x35d0,0x37f0,0x2db8,0x2f98,0x35d8,0x37f8,0x2da0,0x2f80,0x35c0,0x37e0,0x2da8,0x2f88,0x35c8,0x37e8
.long 0x27500,0x27500,0x0,0x27e40,0x27590,0x27510,0x10,0x27e44,0x27620,0x27520,0x20,0x27e48,0x276b0,0x27530,0x30,0x27e48
.long 0x27740,0x27540,0x40,0x27e48,0x277d0,0x27550,0x50,0x27e48,0x27860,0x27560,0x60,0x27e48,0x278f0,0x27570,0x70,0x27e48
.long 0x27980,0x27590,0x1080,0x27e48,0x27a10,0x275a0,0x1090,0x27e48,0x27aa0,0x275b0,0x10a0,0x27e48,0x27b30,0x275c0,0x10b0,0x27e48
.long 0x27bc0,0x275d0,0x10c0,0x27e48,0x27c50,0x275e0,0x10d0,0x27e48,0x27ce0,0x275f0,0x10e0,0x27e48,0x27d70,0x27600,0x10f0,0x27e48
.long 0x27510,0x27620,0x2100,0x27e48,0x275a0,0x27630,0x2110,0x27e48,0x27630,0x27640,0x2120,0x27e48,0x276c0,0x27650,0x2130,0x27e48
.long 0x27750,0x27660,0x2140,0x27e48,0x277e0,0x27670,0x2150,0x27e48,0x27870,0x27680,0x2160,0x27e48,0x27900,0x27690,0x2170,0x27e48
.long 0x27990,0x276b0,0x3180,0x27e48,0x27a20,0x276c0,0x3190,0x27e48,0x27ab0,0x276d0,0x31a0,0x27e48,0x27b40,0x276e0,0x31b0,0x27e48
.long 0x27bd0,0x276f0,0x31c0,0x27e48,0x27c60,0x27700,0x31d0,0x27e48,0x27cf0,0x27710,0x31e0,0x27e48,0x27d80,0x27720,0x31f0,0x27e48
.long 0x27520,0x27740,0x4200,0x27e48,0x275b0,0x27750,0x4210,0x27e48,0x27640,0x27760,0x4220,0x27e48,0x276d0,0x27770,0x4230,0x27e48
.long 0x27760,0x27780,0x4240,0x27e48,0x277f0,0x27790,0x4250,0x27e48,0x27880,0x277a0,0x4260,0x27e48,0x27910,0x277b0,0x4270,0x27e48
.long 0x279a0,0x277d0,0x5280,0x27e48,0x27a30,0x277e0,0x5290,0x27e48,0x27ac0,0x277f0,0x52a0,0x27e48,0x27b50,0x27800,0x52b0,0x27e48
.long 0x27be0,0x27810,0x52c0,0x27e48,0x27c70,0x27820,0x52d0,0x27e48,0x27d00,0x27830,0x52e0,0x27e48,0x27d90,0x27840,0x52f0,0x27e48
.long 0x27530,0x27860,0x6300,0x27e48,0x275c0,0x27870,0x6310,0x27e48,0x27650,0x27880,0x6320,0x27e48,0x276e0,0x27890,0x6330,0x27e48
.long 0x27770,0x278a0,0x6340,0x27e48,0x27800,0x278b0,0x6350,0x27e48,0x27890,0x278c0,0x6360,0x27e48,0x27920,0x278d0,0x6370,0x27e48
.long 0x279b0,0x278f0,0x7380,0x27e48,0x27a40,0x27900,0x7390,0x27e48,0x27ad0,0x27910,0x73a0,0x27e48,0x27b60,0x27920,0x73b0,0x27e48
.long 0x27bf0,0x27930,0x73c0,0x27e48,0x27c80,0x27940,0x73d0,0x27e48,0x27d10,0x27950,0x73e0,0x27e48,0x27da0,0x27960,0x73f0,0x27e48
.long 0x20,0x200,0x820,0xa00,0x28,0x208,0x828,0xa08,0x30,0x210,0x830,0xa10,0x38,0x218,0x838,0xa18
.long 0xa0,0x280,0x8a0,0xa80,0xa8,0x288,0x8a8,0xa88,0xb0,0x290,0x8b0,0xa90,0xb8,0x298,0x8b8,0xa98
.long 0x130,0x310,0x930,0xb10,0x138,0x318,0x938,0xb18,0x120,0x300,0x920,0xb00,0x128,0x308,0x928,0xb08
.long 0x1b0,0x390,0x9b0,0xb90,0x1b8,0x398,0x9b8,0xb98,0x1a0,0x380,0x9a0,0xb80,0x1a8,0x388,0x9a8,0xb88
.long 0x460,0x640,0xc60,0xe40,0x468,0x648,0xc68,0xe48,0x470,0x650,0xc70,0xe50,0x478,0x658,0xc78,0xe58
.long 0x4e0,0x6c0,0xce0,0xec0,0x4e8,0x6c8,0xce8,0xec8,0x4f0,0x6d0,0xcf0,0xed0,0x4f8,0x6d8,0xcf8,0xed8
.long 0x570,0x750,0xd70,0xf50,0x578,0x758,0xd78,0xf58,0x560,0x740,0xd60,0xf40,0x568,0x748,0xd68,0xf48
.long 0x5f0,0x7d0,0xdf0,0xfd0,0x5f8,0x7d8,0xdf8,0xfd8,0x5e0,0x7c0,0xde0,0xfc0,0x5e8,0x7c8,0xde8,0xfc8
.long 0x2820,0x2a00,0x3020,0x3200,0x2828,0x2a08,0x3028,0x3208,0x2830,0x2a10,0x3030,0x3210,0x2838,0x2a18,0x3038,0x3218
.long 0x28a0,0x2a80,0x30a0,0x3280,0x28a8,0x2a88,0x30a8,0x3288,0x28b0,0x2a90,0x30b0,0x3290,0x28b8,0x2a98,0x30b8,0x3298
.long 0x2930,0x2b10,0x3130,0x3310,0x2938,0x2b18,0x3138,0x3318,0x2920,0x2b00,0x3120,0x3300,0x2928,0x2b08,0x3128,0x3308
.long 0x29b0,0x2b90,0x31b0,0x3390,0x29b8,0x2b98,0x31b8,0x3398,0x29a0,0x2b80,0x31a0,0x3380,0x29a8,0x2b88,0x31a8,0x3388
.long 0x2c60,0x2e40,0x3460,0x3640,0x2c68,0x2e48,0x3468,0x3648,0x2c70,0x2e50,0x3470,0x3650,0x2c78,0x2e58,0x3478,0x3658
.long 0x2ce0,0x2ec0,0x34e0,0x36c0,0x2ce8,0x2ec8,0x34e8,0x36c8,0x2cf0,0x2ed0,0x34f0,0x36d0,0x2cf8,0x2ed8,0x34f8,0x36d8
.long 0x2d70,0x2f50,0x3570,0x3750,0x2d78,0x2f58,0x3578,0x3758,0x2d60,0x2f40,0x3560,0x3740,0x2d68,0x2f48,0x3568,0x3748
.long 0x2df0,0x2fd0,0x35f0,0x37d0,0x2df8,0x2fd8,0x35f8,0x37d8,0x2de0,0x2fc0,0x35e0,0x37c0,0x2de8,0x2fc8,0x35e8,0x37c8
.long 0xa000,0xa000,0x0,0x27e40,0xa090,0xa010,0x10,0x27e44,0xa120,0xa020,0x20,0x27e48,0xa1b0,0xa030,0x30,0x27e48
.long 0xa240,0xa040,0x40,0x27e48,0xa2d0,0xa050,0x50,0x27e48,0xa360,0xa060,0x60,0x27e48,0xa3f0,0xa070,0x70,0x27e48
.long 0xa480,0xa090,0x1080,0x27e48,0xa510,0xa0a0,0x1090,0x27e48,0xa5a0,0xa0b0,0x10a0,0x27e48,0xa630,0xa0c0,0x10b0,0x27e48
.long 0xa6c0,0xa0d0,0x10c0,0x27e48,0xa750,0xa0e0,0x10d0,0x27e48,0xa7e0,0xa0f0,0x10e0,0x27e48,0xa870,0xa100,0x10f0,0x27e48
.long 0xa010,0xa120,0x2100,0x27e48,0xa0a0,0xa130,0x2110,0x27e48,0xa130,0xa140,0x2120,0x27e48,0xa1c0,0xa150,0x2130,0x27e48
.long 0xa250,0xa160,0x2140,0x27e48,0xa2e0,0xa170,0x2150,0x27e48,0xa370,0xa180,0x2160,0x27e48,0xa400,0xa190,0x2170,0x27e48
.long 0xa490,0xa1b0,0x3180,0x27e48,0xa520,0xa1c0,0x3190,0x27e48,0xa5b0,0xa1d0,0x31a0,0x27e48,0xa640,0xa1e0,0x31b0,0x27e48
.long 0xa6d0,0xa1f0,0x31c0,0x27e48,0xa760,0xa200,0x31d0,0x27e48,0xa7f0,0xa210,0x31e0,0x27e48,0xa880,0xa220,0x31f0,0x27e48
.long 0xa020,0xa240,0x4200,0x27e48,0xa0b0,0xa250,0x4210,0x27e48,0xa140,0xa260,0x4220,0x27e48,0xa1d0,0xa270,0x4230,0x27e48
.long 0xa260,0xa280,0x4240,0x27e48,0xa2f0,0xa290,0x4250,0x27e48,0xa380,0xa2a0,0x4260,0x27e48,0xa410,0xa2b0,0x4270,0x27e48
.long 0xa4a0,0xa2d0,0x5280,0x27e48,0xa530,0xa2e0,0x5290,0x27e48,0xa5c0,0xa2f0,0x52a0,0x27e48,0xa650,0xa300,0x52b0,0x27e48
.long 0xa6e0,0xa310,0x52c0,0x27e48,0xa770,0xa320,0x52d0,0x27e48,0xa800,0xa330,0x52e0,0x27e48,0xa890,0xa340,0x52f0,0x27e48
.long 0xa030,0xa360,0x6300,0x27e48,0xa0c0,0xa370,0x6310,0x27e48,0xa150,0xa380,0x6320,0x27e48,0xa1e0,0xa390,0x6330,0x27e48
.long 0xa270,0xa3a0,0x6340,0x27e48,0xa300,0xa3b0,0x6350,0x27e48,0xa390,0xa3c0,0x6360,0x27e48,0xa420,0xa3d0,0x6370,0x27e48
.long 0xa4b0,0xa3f0,0x7380,0x27e48,0xa540,0xa400,0x7390,0x27e48,0xa5d0,0xa410,0x73a0,0x27e48,0xa660,0xa420,0x73b0,0x27e48
.long 0xa6f0,0xa430,0x73c0,0x27e48,0xa780,0xa440,0x73d0,0x27e48,0xa810,0xa450,0x73e0,0x27e48,0xa8a0,0xa460,0x73f0,0x27e48
.long 0x40,0x260,0x820,0xa00,0x48,0x268,0x828,0xa08,0x50,0x270,0x830,0xa10,0x58,0x278,0x838,0xa18
.long 0xc0,0x2e0,0x8a0,0xa80,0xc8,0x2e8,0x8a8,0xa88,0xd0,0x2f0,0x8b0,0xa90,0xd8,0x2f8,0x8b8,0xa98
.long 0x150,0x370,0x930,0xb10,0x158,0x378,0x938,0xb18,0x140,0x360,0x920,0xb00,0x148,0x368,0x928,0xb08
.long 0x1d0,0x3f0,0x9b0,0xb90,0x1d8,0x3f8,0x9b8,0xb98,0x1c0,0x3e0,0x9a0,0xb80,0x1c8,0x3e8,0x9a8,0xb88
.long 0x400,0x620,0xc60,0xe40,0x408,0x628,0xc68,0xe48,0x410,0x630,0xc70,0xe50,0x418,0x638,0xc78,0xe58
.long 0x480,0x6a0,0xce0,0xec0,0x488,0x6a8,0xce8,0xec8,0x490,0x6b0,0xcf0,0xed0,0x498,0x6b8,0xcf8,0xed8
.long 0x510,0x730,0xd70,0xf50,0x518,0x738,0xd78,0xf58,0x500,0x720,0xd60,0xf40,0x508,0x728,0xd68,0xf48
.long 0x590,0x7b0,0xdf0,0xfd0,0x598,0x7b8,0xdf8,0xfd8,0x580,0x7a0,0xde0,0xfc0,0x588,0x7a8,0xde8,0xfc8
.long 0x2840,0x2a60,0x3020,0x3200,0x2848,0x2a68,0x3028,0x3208,0x2850,0x2a70,0x3030,0x3210,0x2858,0x2a78,0x3038,0x3218
.long 0x28c0,0x2ae0,0x30a0,0x3280,0x28c8,0x2ae8,0x30a8,0x3288,0x28d0,0x2af0,0x30b0,0x3290,0x28d8,0x2af8,0x30b8,0x3298
.long 0x2950,0x2b70,0x3130,0x3310,0x2958,0x2b78,0x3138,0x3318,0x2940,0x2b60,0x3120,0x3300,0x2948,0x2b68,0x3128,0x3308
.long 0x29d0,0x2bf0,0x31b0,0x3390,0x29d8,0x2bf8,0x31b8,0x3398,0x29c0,0x2be0,0x31a0,0x3380,0x29c8,0x2be8,0x31a8,0x3388
.long 0x2c00,0x2e20,0x3460,0x3640,0x2c08,0x2e28,0x3468,0x3648,0x2c10,0x2e30,0x3470,0x3650,0x2c18,0x2e38,0x3478,0x3658
.long 0x2c80,0x2ea0,0x34e0,0x36c0,0x2c88,0x2ea8,0x34e8,0x36c8,0x2c90,0x2eb0,0x34f0,0x36d0,0x2c98,0x2eb8,0x34f8,0x36d8
.long 0x2d10,0x2f30,0x3570,0x3750,0x2d18,0x2f38,0x3578,0x3758,0x2d00,0x2f20,0x3560,0x3740,0x2d08,0x2f28,0x3568,0x3748
.long 0x2d90,0x2fb0,0x35f0,0x37d0,0x2d98,0x2fb8,0x35f8,0x37d8,0x2d80,0x2fa0,0x35e0,0x37c0,0x2d88,0x2fa8,0x35e8,0x37c8
.long 0xa900,0xa900,0x0,0x27e40,0xa990,0xa910,0x10,0x27e44,0xaa20,0xa920,0x20,0x27e48,0xaab0,0xa930,0x30,0x27e48
.long 0xab40,0xa940,0x40,0x27e48,0xabd0,0xa950,0x50,0x27e48,0xac60,0xa960,0x60,0x27e48,0xacf0,0xa970,0x70,0x27e48
.long 0xad80,0xa990,0x1080,0x27e48,0xae10,0xa9a0,0x1090,0x27e48,0xaea0,0xa9b0,0x10a0,0x27e48,0xaf30,0xa9c0,0x10b0,0x27e48
.long 0xafc0,0xa9d0,0x10c0,0x27e48,0xb050,0xa9e0,0x10d0,0x27e48,0xb0e0,0xa9f0,0x10e0,0x27e48,0xb170,0xaa00,0x10f0,0x27e48
.long 0xa910,0xaa20,0x2100,0x27e48,0xa9a0,0xaa30,0x2110,0x27e48,0xaa30,0xaa40,0x2120,0x27e48,0xaac0,0xaa50,0x2130,0x27e48
.long 0xab50,0xaa60,0x2140,0x27e48,0xabe0,0xaa70,0x2150,0x27e48,0xac70,0xaa80,0x2160,0x27e48,0xad00,0xaa90,0x2170,0x27e48
.long 0xad90,0xaab0,0x3180,0x27e48,0xae20,0xaac0,0x3190,0x27e48,0xaeb0,0xaad0,0x31a0,0x27e48,0xaf40,0xaae0,0x31b0,0x27e48
.long 0xafd0,0xaaf0,0x31c0,0x27e48,0xb060,0xab00,0x31d0,0x27e48,0xb0f0,0xab10,0x31e0,0x27e48,0xb180,0xab20,0x31f0,0x27e48
.long 0xa920,0xab40,0x4200,0x27e48,0xa9b0,0xab50,0x4210,0x27e48,0xaa40,0xab60,0x4220,0x27e48,0xaad0,0xab70,0x4230,0x27e48
.long 0xab60,0xab80,0x4240,0x27e48,0xabf0,0xab90,0x4250,0x27e48,0xac80,0xaba0,0x4260,0x27e48,0xad10,0xabb0,0x4270,0x27e48
.long 0xada0,0xabd0,0x5280,0x27e48,0xae30,0xabe0,0x5290,0x27e48,0xaec0,0xabf0,0x52a0,0x27e48,0xaf50,0xac00,0x52b0,0x27e48
.long 0xafe0,0xac10,0x52c0,0x27e48,0xb070,0xac20,0x52d0,0x27e48,0xb100,0xac30,0x52e0,0x27e48,0xb190,0xac40,0x52f0,0x27e48
.long 0xa930,0xac60,0x6300,0x27e48,0xa9c0,0xac70,0x6310,0x27e48,0xaa50,0xac80,0x6320,0x27e48,0xaae0,0xac90,0x6330,0x27e48
.long 0xab70,0xaca0,0x6340,0x27e48,0xac00,0xacb0,0x6350,0x27e48,0xac90,0xacc0,0x6360,0x27e48,0xad20,0xacd0,0x6370,0x27e48
.long 0xadb0,0xacf0,0x7380,0x27e48,0xae40,0xad00,0x7390,0x27e48,0xaed0,0xad10,0x73a0,0x27e48,0xaf60,0xad20,0x73b0,0x27e48
.long 0xaff0,0xad30,0x73c0,0x27e48,0xb080,0xad40,0x73d0,0x27e48,0xb110,0xad50,0x73e0,0x27e48,0xb1a0,0xad60,0x73f0,0x27e48
.long 0x60,0x240,0x820,0xa00,0x68,0x248,0x828,0xa08,0x70,0x250,0x830,0xa10,0x78,0x258,0x838,0xa18
.long 0xe0,0x2c0,0x8a0,0xa80,0xe8,0x2c8,0x8a8,0xa88,0xf0,0x2d0,0x8b0,0xa90,0xf8,0x2d8,0x8b8,0xa98
.long 0x170,0x350,0x930,0xb10,0x178,0x358,0x938,0xb18,0x160,0x340,0x920,0xb00,0x168,0x348,0x928,0xb08
.long 0x1f0,0x3d0,0x9b0,0xb90,0x1f8,0x3d8,0x9b8,0xb98,0x1e0,0x3c0,0x9a0,0xb80,0x1e8,0x3c8,0x9a8,0xb88
.long 0x420,0x600,0xc60,0xe40,0x428,0x608,0xc68,0xe48,0x430,0x610,0xc70,0xe50,0x438,0x618,0xc78,0xe58
.long 0x4a0,0x680,0xce0,0xec0,0x4a8,0x688,0xce8,0xec8,0x4b0,0x690,0xcf0,0xed0,0x4b8,0x698,0xcf8,0xed8
.long 0x530,0x710,0xd70,0xf50,0x538,0x718,0xd78,0xf58,0x520,0x700,0xd60,0xf40,0x528,0x708,0xd68,0xf48
.long 0x5b0,0x790,0xdf0,0xfd0,0x5b8,0x798,0xdf8,0xfd8,0x5a0,0x780,0xde0,0xfc0,0x5a8,0x788,0xde8,0xfc8
.long 0x2860,0x2a40,0x3020,0x3200,0x2868,0x2a48,0x3028,0x3208,0x2870,0x2a50,0x3030,0x3210,0x2878,0x2a58,0x3038,0x3218
.long 0x28e0,0x2ac0,0x30a0,0x3280,0x28e8,0x2ac8,0x30a8,0x3288,0x28f0,0x2ad0,0x30b0,0x3290,0x28f8,0x2ad8,0x30b8,0x3298
.long 0x2970,0x2b50,0x3130,0x3310,0x2978,0x2b58,0x3138,0x3318,0x2960,0x2b40,0x3120,0x3300,0x2968,0x2b48,0x3128,0x3308
.long 0x29f0,0x2bd0,0x31b0,0x3390,0x29f8,0x2bd8,0x31b8,0x3398,0x29e0,0x2bc0,0x31a0,0x3380,0x29e8,0x2bc8,0x31a8,0x3388
.long 0x2c20,0x2e00,0x3460,0x3640,0x2c28,0x2e08,0x3468,0x3648,0x2c30,0x2e10,0x3470,0x3650,0x2c38,0x2e18,0x3478,0x3658
.long 0x2ca0,0x2e80,0x34e0,0x36c0,0x2ca8,0x2e88,0x34e8,0x36c8,0x2cb0,0x2e90,0x34f0,0x36d0,0x2cb8,0x2e98,0x34f8,0x36d8
.long 0x2d30,0x2f10,0x3570,0x3750,0x2d38,0x2f18,0x3578,0x3758,0x2d20,0x2f00,0x3560,0x3740,0x2d28,0x2f08,0x3568,0x3748
.long 0x2db0,0x2f90,0x35f0,0x37d0,0x2db8,0x2f98,0x35f8,0x37d8,0x2da0,0x2f80,0x35e0,0x37c0,0x2da8,0x2f88,0x35e8,0x37c8
.long 0xb200,0xb200,0x0,0x27e40,0xb290,0xb210,0x10,0x27e44,0xb320,0xb220,0x20,0x27e48,0xb3b0,0xb230,0x30,0x27e48
.long 0xb440,0xb240,0x40,0x27e48,0xb4d0,0xb250,0x50,0x27e48,0xb560,0xb260,0x60,0x27e48,0xb5f0,0xb270,0x70,0x27e48
.long 0xb680,0xb290,0x1080,0x27e48,0xb710,0xb2a0,0x1090,0x27e48,0xb7a0,0xb2b0,0x10a0,0x27e48,0xb830,0xb2c0,0x10b0,0x27e48
.long 0xb8c0,0xb2d0,0x10c0,0x27e48,0xb950,0xb2e0,0x10d0,0x27e48,0xb9e0,0xb2f0,0x10e0,0x27e48,0xba70,0xb300,0x10f0,0x27e48
.long 0xb210,0xb320,0x2100,0x27e48,0xb2a0,0xb330,0x2110,0x27e48,0xb330,0xb340,0x2120,0x27e48,0xb3c0,0xb350,0x2130,0x27e48
.long 0xb450,0xb360,0x2140,0x27e48,0xb4e0,0xb370,0x2150,0x27e48,0xb570,0xb380,0x2160,0x27e48,0xb600,0xb390,0x2170,0x27e48
.long 0xb690,0xb3b0,0x3180,0x27e48,0xb720,0xb3c0,0x3190,0x27e48,0xb7b0,0xb3d0,0x31a0,0x27e48,0xb840,0xb3e0,0x31b0,0x27e48
.long 0xb8d0,0xb3f0,0x31c0,0x27e48,0xb960,0xb400,0x31d0,0x27e48,0xb9f0,0xb410,0x31e0,0x27e48,0xba80,0xb420,0x31f0,0x27e48
.long 0xb220,0xb440,0x4200,0x27e48,0xb2b0,0xb450,0x4210,0x27e48,0xb340,0xb460,0x4220,0x27e48,0xb3d0,0xb470,0x4230,0x27e48
.long 0xb460,0xb480,0x4240,0x27e48,0xb4f0,0xb490,0x4250,0x27e48,0xb580,0xb4a0,0x4260,0x27e48,0xb610,0xb4b0,0x4270,0x27e48
.long 0xb6a0,0xb4d0,0x5280,0x27e48,0xb730,0xb4e0,0x5290,0x27e48,0xb7c0,0xb4f0,0x52a0,0x27e48,0xb850,0xb500,0x52b0,0x27e48
.long 0xb8e0,0xb510,0x52c0,0x27e48,0xb970,0xb520,0x52d0,0x27e48,0xba00,0xb530,0x52e0,0x27e48,0xba90,0xb540,0x52f0,0x27e48
.long 0xb230,0xb560,0x6300,0x27e48,0xb2c0,0xb570,0x6310,0x27e48,0xb350,0xb580,0x6320,0x27e48,0xb3e0,0xb590,0x6330,0x27e48
.long 0xb470,0xb5a0,0x6340,0x27e48,0xb500,0xb5b0,0x6350,0x27e48,0xb590,0xb5c0,0x6360,0x27e48,0xb620,0xb5d0,0x6370,0x27e48
.long 0xb6b0,0xb5f0,0x7380,0x27e48,0xb740,0xb600,0x7390,0x27e48,0xb7d0,0xb610,0x73a0,0x27e48,0xb860,0xb620,0x73b0,0x27e48
.long 0xb8f0,0xb630,0x73c0,0x27e48,0xb980,0xb640,0x73d0,0x27e48,0xba10,0xb650,0x73e0,0x27e48,0xbaa0,0xb660,0x73f0,0x27e48
.long 0x800,0xa20,0x820,0xa00,0x808,0xa28,0x828,0xa08,0x810,0xa30,0x830,0xa10,0x818,0xa38,0x838,0xa18
.long 0x880,0xaa0,0x8a0,0xa80,0x888,0xaa8,0x8a8,0xa88,0x890,0xab0,0x8b0,0xa90,0x898,0xab8,0x8b8,0xa98
.long 0x910,0xb30,0x930,0xb10,0x918,0xb38,0x938,0xb18,0x900,0xb20,0x920,0xb00,0x908,0xb28,0x928,0xb08
.long 0x990,0xbb0,0x9b0,0xb90,0x998,0xbb8,0x9b8,0xb98,0x980,0xba0,0x9a0,0xb80,0x988,0xba8,0x9a8,0xb88
.long 0xc40,0xe60,0xc60,0xe40,0xc48,0xe68,0xc68,0xe48,0xc50,0xe70,0xc70,0xe50,0xc58,0xe78,0xc78,0xe58
.long 0xcc0,0xee0,0xce0,0xec0,0xcc8,0xee8,0xce8,0xec8,0xcd0,0xef0,0xcf0,0xed0,0xcd8,0xef8,0xcf8,0xed8
.long 0xd50,0xf70,0xd70,0xf50,0xd58,0xf78,0xd78,0xf58,0xd40,0xf60,0xd60,0xf40,0xd48,0xf68,0xd68,0xf48
.long 0xdd0,0xff0,0xdf0,0xfd0,0xdd8,0xff8,0xdf8,0xfd8,0xdc0,0xfe0,0xde0,0xfc0,0xdc8,0xfe8,0xde8,0xfc8
.long 0x3000,0x3220,0x3020,0x3200,0x3008,0x3228,0x3028,0x3208,0x3010,0x3230,0x3030,0x3210,0x3018,0x3238,0x3038,0x3218
.long 0x3080,0x32a0,0x30a0,0x3280,0x3088,0x32a8,0x30a8,0x3288,0x3090,0x32b0,0x30b0,0x3290,0x3098,0x32b8,0x30b8,0x3298
.long 0x3110,0x3330,0x3130,0x3310,0x3118,0x3338,0x3138,0x3318,0x3100,0x3320,0x3120,0x3300,0x3108,0x3328,0x3128,0x3308
.long 0x3190,0x33b0,0x31b0,0x3390,0x3198,0x33b8,0x31b8,0x3398,0x3180,0x33a0,0x31a0,0x3380,0x3188,0x33a8,0x31a8,0x3388
.long 0x3440,0x3660,0x3460,0x3640,0x3448,0x3668,0x3468,0x3648,0x3450,0x3670,0x3470,0x3650,0x3458,0x3678,0x3478,0x3658
.long 0x34c0,0x36e0,0x34e0,0x36c0,0x34c8,0x36e8,0x34e8,0x36c8,0x34d0,0x36f0,0x34f0,0x36d0,0x34d8,0x36f8,0x34f8,0x36d8
.long 0x3550,0x3770,0x3570,0x3750,0x3558,0x3778,0x3578,0x3758,0x3540,0x3760,0x3560,0x3740,0x3548,0x3768,0x3568,0x3748
.long 0x35d0,0x37f0,0x35f0,0x37d0,0x35d8,0x37f8,0x35f8,0x37d8,0x35c0,0x37e0,0x35e0,0x37c0,0x35c8,0x37e8,0x35e8,0x37c8
.long 0x27500,0x27500,0x0,0x27e40,0x27590,0x27510,0x10,0x27e44,0x27620,0x27520,0x20,0x27e48,0x276b0,0x27530,0x30,0x27e48
.long 0x27740,0x27540,0x40,0x27e48,0x277d0,0x27550,0x50,0x27e48,0x27860,0x27560,0x60,0x27e48,0x278f0,0x27570,0x70,0x27e48
.long 0x27980,0x27590,0x1080,0x27e48,0x27a10,0x275a0,0x1090,0x27e48,0x27aa0,0x275b0,0x10a0,0x27e48,0x27b30,0x275c0,0x10b0,0x27e48
.long 0x27bc0,0x275d0,0x10c0,0x27e48,0x27c50,0x275e0,0x10d0,0x27e48,0x27ce0,0x275f0,0x10e0,0x27e48,0x27d70,0x27600,0x10f0,0x27e48
.long 0x27510,0x27620,0x2100,0x27e48,0x275a0,0x27630,0x2110,0x27e48,0x27630,0x27640,0x2120,0x27e48,0x276c0,0x27650,0x2130,0x27e48
.long 0x27750,0x27660,0x2140,0x27e48,0x277e0,0x27670,0x2150,0x27e48,0x27870,0x27680,0x2160,0x27e48,0x27900,0x27690,0x2170,0x27e48
.long 0x27990,0x276b0,0x3180,0x27e48,0x27a20,0x276c0,0x3190,0x27e48,0x27ab0,0x276d0,0x31a0,0x27e48,0x27b40,0x276e0,0x31b0,0x27e48
.long 0x27bd0,0x276f0,0x31c0,0x27e48,0x27c60,0x27700,0x31d0,0x27e48,0x27cf0,0x27710,0x31e0,0x27e48,0x27d80,0x27720,0x31f0,0x27e48
.long 0x27520,0x27740,0x4200,0x27e48,0x275b0,0x27750,0x4210,0x27e48,0x27640,0x27760,0x4220,0x27e48,0x276d0,0x27770,0x4230,0x27e48
.long 0x27760,0x27780,0x4240,0x27e48,0x277f0,0x27790,0x4250,0x27e48,0x27880,0x277a0,0x4260,0x27e48,0x27910,0x277b0,0x4270,0x27e48
.long 0x279a0,0x277d0,0x5280,0x27e48,0x27a30,0x277e0,0x5290,0x27e48,0x27ac0,0x277f0,0x52a0,0x27e48,0x27b50,0x27800,0x52b0,0x27e48
.long 0x27be0,0x27810,0x52c0,0x27e48,0x27c70,0x27820,0x52d0,0x27e48,0x27d00,0x27830,0x52e0,0x27e48,0x27d90,0x27840,0x52f0,0x27e48
.long 0x27530,0x27860,0x6300,0x27e48,0x275c0,0x27870,0x6310,0x27e48,0x27650,0x27880,0x6320,0x27e48,0x276e0,0x27890,0x6330,0x27e48
.long 0x27770,0x278a0,0x6340,0x27e48,0x27800,0x278b0,0x6350,0x27e48,0x27890,0x278c0,0x6360,0x27e48,0x27920,0x278d0,0x6370,0x27e48
.long 0x279b0,0x278f0,0x7380,0x27e48,0x27a40,0x27900,0x7390,0x27e48,0x27ad0,0x27910,0x73a0,0x27e48,0x27b60,0x27920,0x73b0,0x27e48
.long 0x27bf0,0x27930,0x73c0,0x27e48,0x27c80,0x27940,0x73d0,0x27e48,0x27d10,0x27950,0x73e0,0x27e48,0x27da0,0x27960,0x73f0,0x27e48
.long 0x40,0x260,0x840,0xa60,0x48,0x268,0x848,0xa68,0x50,0x270,0x850,0xa70,0x58,0x278,0x858,0xa78
.long 0xc0,0x2e0,0x8c0,0xae0,0xc8,0x2e8,0x8c8,0xae8,0xd0,0x2f0,0x8d0,0xaf0,0xd8,0x2f8,0x8d8,0xaf8
.long 0x150,0x370,0x950,0xb70,0x158,0x378,0x958,0xb78,0x140,0x360,0x940,0xb60,0x148,0x368,0x948,0xb68
.long 0x1d0,0x3f0,0x9d0,0xbf0,0x1d8,0x3f8,0x9d8,0xbf8,0x1c0,0x3e0,0x9c0,0xbe0,0x1c8,0x3e8,0x9c8,0xbe8
.long 0x400,0x620,0xc00,0xe20,0x408,0x628,0xc08,0xe28,0x410,0x630,0xc10,0xe30,0x418,0x638,0xc18,0xe38
.long 0x480,0x6a0,0xc80,0xea0,0x488,0x6a8,0xc88,0xea8,0x490,0x6b0,0xc90,0xeb0,0x498,0x6b8,0xc98,0xeb8
.long 0x510,0x730,0xd10,0xf30,0x518,0x738,0xd18,0xf38,0x500,0x720,0xd00,0xf20,0x508,0x728,0xd08,0xf28
.long 0x590,0x7b0,0xd90,0xfb0,0x598,0x7b8,0xd98,0xfb8,0x580,0x7a0,0xd80,0xfa0,0x588,0x7a8,0xd88,0xfa8
.long 0x2840,0x2a60,0x3040,0x3260,0x2848,0x2a68,0x3048,0x3268,0x2850,0x2a70,0x3050,0x3270,0x2858,0x2a78,0x3058,0x3278
.long 0x28c0,0x2ae0,0x30c0,0x32e0,0x28c8,0x2ae8,0x30c8,0x32e8,0x28d0,0x2af0,0x30d0,0x32f0,0x28d8,0x2af8,0x30d8,0x32f8
.long 0x2950,0x2b70,0x3150,0x3370,0x2958,0x2b78,0x3158,0x3378,0x2940,0x2b60,0x3140,0x3360,0x2948,0x2b68,0x3148,0x3368
.long 0x29d0,0x2bf0,0x31d0,0x33f0,0x29d8,0x2bf8,0x31d8,0x33f8,0x29c0,0x2be0,0x31c0,0x33e0,0x29c8,0x2be8,0x31c8,0x33e8
.long 0x2c00,0x2e20,0x3400,0x3620,0x2c08,0x2e28,0x3408,0x3628,0x2c10,0x2e30,0x3410,0x3630,0x2c18,0x2e38,0x3418,0x3638
.long 0x2c80,0x2ea0,0x3480,0x36a0,0x2c88,0x2ea8,0x3488,0x36a8,0x2c90,0x2eb0,0x3490,0x36b0,0x2c98,0x2eb8,0x3498,0x36b8
.long 0x2d10,0x2f30,0x3510,0x3730,0x2d18,0x2f38,0x3518,0x3738,0x2d00,0x2f20,0x3500,0x3720,0x2d08,0x2f28,0x3508,0x3728
.long 0x2d90,0x2fb0,0x3590,0x37b0,0x2d98,0x2fb8,0x3598,0x37b8,0x2d80,0x2fa0,0x3580,0x37a0,0x2d88,0x2fa8,0x3588,0x37a8
.long 0xa000,0xa000,0x0,0x27e40,0xa090,0xa010,0x10,0x27e44,0xa120,0xa020,0x20,0x27e48,0xa1b0,0xa030,0x30,0x27e48
.long 0xa240,0xa040,0x40,0x27e48,0xa2d0,0xa050,0x50,0x27e48,0xa360,0xa060,0x60,0x27e48,0xa3f0,0xa070,0x70,0x27e48
.long 0xa480,0xa090,0x1080,0x27e48,0xa510,0xa0a0,0x1090,0x27e48,0xa5a0,0xa0b0,0x10a0,0x27e48,0xa630,0xa0c0,0x10b0,0x27e48
.long 0xa6c0,0xa0d0,0x10c0,0x27e48,0xa750,0xa0e0,0x10d0,0x27e48,0xa7e0,0xa0f0,0x10e0,0x27e48,0xa870,0xa100,0x10f0,0x27e48
.long 0xa010,0xa120,0x2100,0x27e48,0xa0a0,0xa130,0x2110,0x27e48,0xa130,0xa140,0x2120,0x27e48,0xa1c0,0xa150,0x2130,0x27e48
.long 0xa250,0xa160,0x2140,0x27e48,0xa2e0,0xa170,0x2150,0x27e48,0xa370,0xa180,0x2160,0x27e48,0xa400,0xa190,0x2170,0x27e48
.long 0xa490,0xa1b0,0x3180,0x27e48,0xa520,0xa1c0,0x3190,0x27e48,0xa5b0,0xa1d0,0x31a0,0x27e48,0xa640,0xa1e0,0x31b0,0x27e48
.long 0xa6d0,0xa1f0,0x31c0,0x27e48,0xa760,0xa200,0x31d0,0x27e48,0xa7f0,0xa210,0x31e0,0x27e48,0xa880,0xa220,0x31f0,0x27e48
.long 0xa020,0xa240,0x4200,0x27e48,0xa0b0,0xa250,0x4210,0x27e48,0xa140,0xa260,0x4220,0x27e48,0xa1d0,0xa270,0x4230,0x27e48
.long 0xa260,0xa280,0x4240,0x27e48,0xa2f0,0xa290,0x4250,0x27e48,0xa380,0xa2a0,0x4260,0x27e48,0xa410,0xa2b0,0x4270,0x27e48
.long 0xa4a0,0xa2d0,0x5280,0x27e48,0xa530,0xa2e0,0x5290,0x27e48,0xa5c0,0xa2f0,0x52a0,0x27e48,0xa650,0xa300,0x52b0,0x27e48
.long 0xa6e0,0xa310,0x52c0,0x27e48,0xa770,0xa320,0x52d0,0x27e48,0xa800,0xa330,0x52e0,0x27e48,0xa890,0xa340,0x52f0,0x27e48
.long 0xa030,0xa360,0x6300,0x27e48,0xa0c0,0xa370,0x6310,0x27e48,0xa150,0xa380,0x6320,0x27e48,0xa1e0,0xa390,0x6330,0x27e48
.long 0xa270,0xa3a0,0x6340,0x27e48,0xa300,0xa3b0,0x6350,0x27e48,0xa390,0xa3c0,0x6360,0x27e48,0xa420,0xa3d0,0x6370,0x27e48
.long 0xa4b0,0xa3f0,0x7380,0x27e48,0xa540,0xa400,0x7390,0x27e48,0xa5d0,0xa410,0x73a0,0x27e48,0xa660,0xa420,0x73b0,0x27e48
.long 0xa6f0,0xa430,0x73c0,0x27e48,0xa780,0xa440,0x73d0,0x27e48,0xa810,0xa450,0x73e0,0x27e48,0xa8a0,0xa460,0x73f0,0x27e48
.long 0x60,0x240,0x840,0xa60,0x68,0x248,0x848,0xa68,0x70,0x250,0x850,0xa70,0x78,0x258,0x858,0xa78
.long 0xe0,0x2c0,0x8c0,0xae0,0xe8,0x2c8,0x8c8,0xae8,0xf0,0x2d0,0x8d0,0xaf0,0xf8,0x2d8,0x8d8,0xaf8
.long 0x170,0x350,0x950,0xb70,0x178,0x358,0x958,0xb78,0x160,0x340,0x940,0xb60,0x168,0x348,0x948,0xb68
.long 0x1f0,0x3d0,0x9d0,0xbf0,0x1f8,0x3d8,0x9d8,0xbf8,0x1e0,0x3c0,0x9c0,0xbe0,0x1e8,0x3c8,0x9c8,0xbe8
.long 0x420,0x600,0xc00,0xe20,0x428,0x608,0xc08,0xe28,0x430,0x610,0xc10,0xe30,0x438,0x618,0xc18,0xe38
.long 0x4a0,0x680,0xc80,0xea0,0x4a8,0x688,0xc88,0xea8,0x4b0,0x690,0xc90,0xeb0,0x4b8,0x698,0xc98,0xeb8
.long 0x530,0x710,0xd10,0xf30,0x538,0x718,0xd18,0xf38,0x520,0x700,0xd00,0xf20,0x528,0x708,0xd08,0xf28
.long 0x5b0,0x790,0xd90,0xfb0,0x5b8,0x798,0xd98,0xfb8,0x5a0,0x780,0xd80,0xfa0,0x5a8,0x788,0xd88,0xfa8
.long 0x2860,0x2a40,0x3040,0x3260,0x2868,0x2a48,0x3048,0x3268,0x2870,0x2a50,0x3050,0x3270,0x2878,0x2a58,0x3058,0x3278
.long 0x28e0,0x2ac0,0x30c0,0x32e0,0x28e8,0x2ac8,0x30c8,0x32e8,0x28f0,0x2ad0,0x30d0,0x32f0,0x28f8,0x2ad8,0x30d8,0x32f8
.long 0x2970,0x2b50,0x3150,0x3370,0x2978,0x2b58,0x3158,0x3378,0x2960,0x2b40,0x3140,0x3360,0x2968,0x2b48,0x3148,0x3368
.long 0x29f0,0x2bd0,0x31d0,0x33f0,0x29f8,0x2bd8,0x31d8,0x33f8,0x29e0,0x2bc0,0x31c0,0x33e0,0x29e8,0x2bc8,0x31c8,0x33e8
.long 0x2c20,0x2e00,0x3400,0x3620,0x2c28,0x2e08,0x3408,0x3628,0x2c30,0x2e10,0x3410,0x3630,0x2c38,0x2e18,0x3418,0x3638
.long 0x2ca0,0x2e80,0x3480,0x36a0,0x2ca8,0x2e88,0x3488,0x36a8,0x2cb0,0x2e90,0x3490,0x36b0,0x2cb8,0x2e98,0x3498,0x36b8
.long 0x2d30,0x2f10,0x3510,0x3730,0x2d38,0x2f18,0x3518,0x3738,0x2d20,0x2f00,0x3500,0x3720,0x2d28,0x2f08,0x3508,0x3728
.long 0x2db0,0x2f90,0x3590,0x37b0,0x2db8,0x2f98,0x3598,0x37b8,0x2da0,0x2f80,0x3580,0x37a0,0x2da8,0x2f88,0x3588,0x37a8
.long 0xa900,0xa900,0x0,0x27e40,0xa990,0xa910,0x10,0x27e44,0xaa20,0xa920,0x20,0x27e48,0xaab0,0xa930,0x30,0x27e48
.long 0xab40,0xa940,0x40,0x27e48,0xabd0,0xa950,0x50,0x27e48,0xac60,0xa960,0x60,0x27e48,0xacf0,0xa970,0x70,0x27e48
.long 0xad80,0xa990,0x1080,0x27e48,0xae10,0xa9a0,0x1090,0x27e48,0xaea0,0xa9b0,0x10a0,0x27e48,0xaf30,0xa9c0,0x10b0,0x27e48
.long 0xafc0,0xa9d0,0x10c0,0x27e48,0xb050,0xa9e0,0x10d0,0x27e48,0xb0e0,0xa9f0,0x10e0,0x27e48,0xb170,0xaa00,0x10f0,0x27e48
.long 0xa910,0xaa20,0x2100,0x27e48,0xa9a0,0xaa30,0x2110,0x27e48,0xaa30,0xaa40,0x2120,0x27e48,0xaac0,0xaa50,0x2130,0x27e48
.long 0xab50,0xaa60,0x2140,0x27e48,0xabe0,0xaa70,0x2150,0x27e48,0xac70,0xaa80,0x2160,0x27e48,0xad00,0xaa90,0x2170,0x27e48
.long 0xad90,0xaab0,0x3180,0x27e48,0xae20,0xaac0,0x3190,0x27e48,0xaeb0,0xaad0,0x31a0,0x27e48,0xaf40,0xaae0,0x31b0,0x27e48
.long 0xafd0,0xaaf0,0x31c0,0x27e48,0xb060,0xab00,0x31d0,0x27e48,0xb0f0,0xab10,0x31e0,0x27e48,0xb180,0xab20,0x31f0,0x27e48
.long 0xa920,0xab40,0x4200,0x27e48,0xa9b0,0xab50,0x4210,0x27e48,0xaa40,0xab60,0x4220,0x27e48,0xaad0,0xab70,0x4230,0x27e48
.long 0xab60,0xab80,0x4240,0x27e48,0xabf0,0xab90,0x4250,0x27e48,0xac80,0xaba0,0x4260,0x27e48,0xad10,0xabb0,0x4270,0x27e48
.long 0xada0,0xabd0,0x5280,0x27e48,0xae30,0xabe0,0x5290,0x27e48,0xaec0,0xabf0,0x52a0,0x27e48,0xaf50,0xac00,0x52b0,0x27e48
.long 0xafe0,0xac10,0x52c0,0x27e48,0xb070,0xac20,0x52d0,0x27e48,0xb100,0xac30,0x52e0,0x27e48,0xb190,0xac40,0x52f0,0x27e48
.long 0xa930,0xac60,0x6300,0x27e48,0xa9c0,0xac70,0x6310,0x27e48,0xaa50,0xac80,0x6320,0x27e48,0xaae0,0xac90,0x6330,0x27e48
.long 0xab70,0xaca0,0x6340,0x27e48,0xac00,0xacb0,0x6350,0x27e48,0xac90,0xacc0,0x6360,0x27e48,0xad20,0xacd0,0x6370,0x27e48
.long 0xadb0,0xacf0,0x7380,0x27e48,0xae40,0xad00,0x7390,0x27e48,0xaed0,0xad10,0x73a0,0x27e48,0xaf60,0xad20,0x73b0,0x27e48
.long 0xaff0,0xad30,0x73c0,0x27e48,0xb080,0xad40,0x73d0,0x27e48,0xb110,0xad50,0x73e0,0x27e48,0xb1a0,0xad60,0x73f0,0x27e48
.long 0x800,0xa20,0x840,0xa60,0x808,0xa28,0x848,0xa68,0x810,0xa30,0x850,0xa70,0x818,0xa38,0x858,0xa78
.long 0x880,0xaa0,0x8c0,0xae0,0x888,0xaa8,0x8c8,0xae8,0x890,0xab0,0x8d0,0xaf0,0x898,0xab8,0x8d8,0xaf8
.long 0x910,0xb30,0x950,0xb70,0x918,0xb38,0x958,0xb78,0x900,0xb20,0x940,0xb60,0x908,0xb28,0x948,0xb68
.long 0x990,0xbb0,0x9d0,0xbf0,0x998,0xbb8,0x9d8,0xbf8,0x980,0xba0,0x9c0,0xbe0,0x988,0xba8,0x9c8,0xbe8
.long 0xc40,0xe60,0xc00,0xe20,0xc48,0xe68,0xc08,0xe28,0xc50,0xe70,0xc10,0xe30,0xc58,0xe78,0xc18,0xe38
.long 0xcc0,0xee0,0xc80,0xea0,0xcc8,0xee8,0xc88,0xea8,0xcd0,0xef0,0xc90,0xeb0,0xcd8,0xef8,0xc98,0xeb8
.long 0xd50,0xf70,0xd10,0xf30,0xd58,0xf78,0xd18,0xf38,0xd40,0xf60,0xd00,0xf20,0xd48,0xf68,0xd08,0xf28
.long 0xdd0,0xff0,0xd90,0xfb0,0xdd8,0xff8,0xd98,0xfb8,0xdc0,0xfe0,0xd80,0xfa0,0xdc8,0xfe8,0xd88,0xfa8
.long 0x3000,0x3220,0x3040,0x3260,0x3008,0x3228,0x3048,0x3268,0x3010,0x3230,0x3050,0x3270,0x3018,0x3238,0x3058,0x3278
.long 0x3080,0x32a0,0x30c0,0x32e0,0x3088,0x32a8,0x30c8,0x32e8,0x3090,0x32b0,0x30d0,0x32f0,0x3098,0x32b8,0x30d8,0x32f8
.long 0x3110,0x3330,0x3150,0x3370,0x3118,0x3338,0x3158,0x3378,0x3100,0x3320,0x3140,0x3360,0x3108,0x3328,0x3148,0x3368
.long 0x3190,0x33b0,0x31d0,0x33f0,0x3198,0x33b8,0x31d8,0x33f8,0x3180,0x33a0,0x31c0,0x33e0,0x3188,0x33a8,0x31c8,0x33e8
.long 0x3440,0x3660,0x3400,0x3620,0x3448,0x3668,0x3408,0x3628,0x3450,0x3670,0x3410,0x3630,0x3458,0x3678,0x3418,0x3638
.long 0x34c0,0x36e0,0x3480,0x36a0,0x34c8,0x36e8,0x3488,0x36a8,0x34d0,0x36f0,0x3490,0x36b0,0x34d8,0x36f8,0x3498,0x36b8
.long 0x3550,0x3770,0x3510,0x3730,0x3558,0x3778,0x3518,0x3738,0x3540,0x3760,0x3500,0x3720,0x3548,0x3768,0x3508,0x3728
.long 0x35d0,0x37f0,0x3590,0x37b0,0x35d8,0x37f8,0x3598,0x37b8,0x35c0,0x37e0,0x3580,0x37a0,0x35c8,0x37e8,0x3588,0x37a8
.long 0xb200,0xb200,0x0,0x27e40,0xb290,0xb210,0x10,0x27e44,0xb320,0xb220,0x20,0x27e48,0xb3b0,0xb230,0x30,0x27e48
.long 0xb440,0xb240,0x40,0x27e48,0xb4d0,0xb250,0x50,0x27e48,0xb560,0xb260,0x60,0x27e48,0xb5f0,0xb270,0x70,0x27e48
.long 0xb680,0xb290,0x1080,0x27e48,0xb710,0xb2a0,0x1090,0x27e48,0xb7a0,0xb2b0,0x10a0,0x27e48,0xb830,0xb2c0,0x10b0,0x27e48
.long 0xb8c0,0xb2d0,0x10c0,0x27e48,0xb950,0xb2e0,0x10d0,0x27e48,0xb9e0,0xb2f0,0x10e0,0x27e48,0xba70,0xb300,0x10f0,0x27e48
.long 0xb210,0xb320,0x2100,0x27e48,0xb2a0,0xb330,0x2110,0x27e48,0xb330,0xb340,0x2120,0x27e48,0xb3c0,0xb350,0x2130,0x27e48
.long 0xb450,0xb360,0x2140,0x27e48,0xb4e0,0xb370,0x2150,0x27e48,0xb570,0xb380,0x2160,0x27e48,0xb600,0xb390,0x2170,0x27e48
.long 0xb690,0xb3b0,0x3180,0x27e48,0xb720,0xb3c0,0x3190,0x27e48,0xb7b0,0xb3d0,0x31a0,0x27e48,0xb840,0xb3e0,0x31b0,0x27e48
.long 0xb8d0,0xb3f0,0x31c0,0x27e48,0xb960,0xb400,0x31d0,0x27e48,0xb9f0,0xb410,0x31e0,0x27e48,0xba80,0xb420,0x31f0,0x27e48
.long 0xb220,0xb440,0x4200,0x27e48,0xb2b0,0xb450,0x4210,0x27e48,0xb340,0xb460,0x4220,0x27e48,0xb3d0,0xb470,0x4230,0x27e48
.long 0xb460,0xb480,0x4240,0x27e48,0xb4f0,0xb490,0x4250,0x27e48,0xb580,0xb4a0,0x4260,0x27e48,0xb610,0xb4b0,0x4270,0x27e48
.long 0xb6a0,0xb4d0,0x5280,0x27e48,0xb730,0xb4e0,0x5290,0x27e48,0xb7c0,0xb4f0,0x52a0,0x27e48,0xb850,0xb500,0x52b0,0x27e48
.long 0xb8e0,0xb510,0x52c0,0x27e48,0xb970,0xb520,0x52d0,0x27e48,0xba00,0xb530,0x52e0,0x27e48,0xba90,0xb540,0x52f0,0x27e48
.long 0xb230,0xb560,0x6300,0x27e48,0xb2c0,0xb570,0x6310,0x27e48,0xb350,0xb580,0x6320,0x27e48,0xb3e0,0xb590,0x6330,0x27e48
.long 0xb470,0xb5a0,0x6340,0x27e48,0xb500,0xb5b0,0x6350,0x27e48,0xb590,0xb5c0,0x6360,0x27e48,0xb620,0xb5d0,0x6370,0x27e48
.long 0xb6b0,0xb5f0,0x7380,0x27e48,0xb740,0xb600,0x7390,0x27e48,0xb7d0,0xb610,0x73a0,0x27e48,0xb860,0xb620,0x73b0,0x27e48
.long 0xb8f0,0xb630,0x73c0,0x27e48,0xb980,0xb640,0x73d0,0x27e48,0xba10,0xb650,0x73e0,0x27e48,0xbaa0,0xb660,0x73f0,0x27e48
.long 0x820,0xa00,0x840,0xa60,0x828,0xa08,0x848,0xa68,0x830,0xa10,0x850,0xa70,0x838,0xa18,0x858,0xa78
.long 0x8a0,0xa80,0x8c0,0xae0,0x8a8,0xa88,0x8c8,0xae8,0x8b0,0xa90,0x8d0,0xaf0,0x8b8,0xa98,0x8d8,0xaf8
.long 0x930,0xb10,0x950,0xb70,0x938,0xb18,0x958,0xb78,0x920,0xb00,0x940,0xb60,0x928,0xb08,0x948,0xb68
.long 0x9b0,0xb90,0x9d0,0xbf0,0x9b8,0xb98,0x9d8,0xbf8,0x9a0,0xb80,0x9c0,0xbe0,0x9a8,0xb88,0x9c8,0xbe8
.long 0xc60,0xe40,0xc00,0xe20,0xc68,0xe48,0xc08,0xe28,0xc70,0xe50,0xc10,0xe30,0xc78,0xe58,0xc18,0xe38
.long 0xce0,0xec0,0xc80,0xea0,0xce8,0xec8,0xc88,0xea8,0xcf0,0xed0,0xc90,0xeb0,0xcf8,0xed8,0xc98,0xeb8
.long 0xd70,0xf50,0xd10,0xf30,0xd78,0xf58,0xd18,0xf38,0xd60,0xf40,0xd00,0xf20,0xd68,0xf48,0xd08,0xf28
.long 0xdf0,0xfd0,0xd90,0xfb0,0xdf8,0xfd8,0xd98,0xfb8,0xde0,0xfc0,0xd80,0xfa0,0xde8,0xfc8,0xd88,0xfa8
.long 0x3020,0x3200,0x3040,0x3260,0x3028,0x3208,0x3048,0x3268,0x3030,0x3210,0x3050,0x3270,0x3038,0x3218,0x3058,0x3278
.long 0x30a0,0x3280,0x30c0,0x32e0,0x30a8,0x3288,0x30c8,0x32e8,0x30b0,0x3290,0x30d0,0x32f0,0x30b8,0x3298,0x30d8,0x32f8
.long 0x3130,0x3310,0x3150,0x3370,0x3138,0x3318,0x3158,0x3378,0x3120,0x3300,0x3140,0x3360,0x3128,0x3308,0x3148,0x3368
.long 0x31b0,0x3390,0x31d0,0x33f0,0x31b8,0x3398,0x31d8,0x33f8,0x31a0,0x3380,0x31c0,0x33e0,0x31a8,0x3388,0x31c8,0x33e8
.long 0x3460,0x3640,0x3400,0x3620,0x3468,0x3648,0x3408,0x3628,0x3470,0x3650,0x3410,0x3630,0x3478,0x3658,0x3418,0x3638
.long 0x34e0,0x36c0,0x3480,0x36a0,0x34e8,0x36c8,0x3488,0x36a8,0x34f0,0x36d0,0x3490,0x36b0,0x34f8,0x36d8,0x3498,0x36b8
.long 0x3570,0x3750,0x3510,0x3730,0x3578,0x3758,0x3518,0x3738,0x3560,0x3740,0x3500,0x3720,0x3568,0x3748,0x3508,0x3728
.long 0x35f0,0x37d0,0x3590,0x37b0,0x35f8,0x37d8,0x3598,0x37b8,0x35e0,0x37c0,0x3580,0x37a0,0x35e8,0x37c8,0x3588,0x37a8
.long 0x27500,0x27500,0x0,0x27e40,0x27590,0x27510,0x10,0x27e44,0x27620,0x27520,0x20,0x27e48,0x276b0,0x27530,0x30,0x27e48
.long 0x27740,0x27540,0x40,0x27e48,0x277d0,0x27550,0x50,0x27e48,0x27860,0x27560,0x60,0x27e48,0x278f0,0x27570,0x70,0x27e48
.long 0x27980,0x27590,0x1080,0x27e48,0x27a10,0x275a0,0x1090,0x27e48,0x27aa0,0x275b0,0x10a0,0x27e48,0x27b30,0x275c0,0x10b0,0x27e48
.long 0x27bc0,0x275d0,0x10c0,0x27e48,0x27c50,0x275e0,0x10d0,0x27e48,0x27ce0,0x275f0,0x10e0,0x27e48,0x27d70,0x27600,0x10f0,0x27e48
.long 0x27510,0x27620,0x2100,0x27e48,0x275a0,0x27630,0x2110,0x27e48,0x27630,0x27640,0x2120,0x27e48,0x276c0,0x27650,0x2130,0x27e48
.long 0x27750,0x27660,0x2140,0x27e48,0x277e0,0x27670,0x2150,0x27e48,0x27870,0x27680,0x2160,0x27e48,0x27900,0x27690,0x2170,0x27e48
.long 0x27990,0x276b0,0x3180,0x27e48,0x27a20,0x276c0,0x3190,0x27e48,0x27ab0,0x276d0,0x31a0,0x27e48,0x27b40,0x276e0,0x31b0,0x27e48
.long 0x27bd0,0x276f0,0x31c0,0x27e48,0x27c60,0x27700,0x31d0,0x27e48,0x27cf0,0x27710,0x31e0,0x27e48,0x27d80,0x27720,0x31f0,0x27e48
.long 0x27520,0x27740,0x4200,0x27e48,0x275b0,0x27750,0x4210,0x27e48,0x27640,0x27760,0x4220,0x27e48,0x276d0,0x27770,0x4230,0x27e48
.long 0x27760,0x27780,0x4240,0x27e48,0x277f0,0x27790,0x4250,0x27e48,0x27880,0x277a0,0x4260,0x27e48,0x27910,0x277b0,0x4270,0x27e48
.long 0x279a0,0x277d0,0x5280,0x27e48,0x27a30,0x277e0,0x5290,0x27e48,0x27ac0,0x277f0,0x52a0,0x27e48,0x27b50,0x27800,0x52b0,0x27e48
.long 0x27be0,0x27810,0x52c0,0x27e48,0x27c70,0x27820,0x52d0,0x27e48,0x27d00,0x27830,0x52e0,0x27e48,0x27d90,0x27840,0x52f0,0x27e48
.long 0x27530,0x27860,0x6300,0x27e48,0x275c0,0x27870,0x6310,0x27e48,0x27650,0x27880,0x6320,0x27e48,0x276e0,0x27890,0x6330,0x27e48
.long 0x27770,0x278a0,0x6340,0x27e48,0x27800,0x278b0,0x6350,0x27e48,0x27890,0x278c0,0x6360,0x27e48,0x27920,0x278d0,0x6370,0x27e48
.long 0x279b0,0x278f0,0x7380,0x27e48,0x27a40,0x27900,0x7390,0x27e48,0x27ad0,0x27910,0x73a0,0x27e48,0x27b60,0x27920,0x73b0,0x27e48
.long 0x27bf0,0x27930,0x73c0,0x27e48,0x27c80,0x27940,0x73d0,0x27e48,0x27d10,0x27950,0x73e0,0x27e48,0x27da0,0x27960,0x73f0,0x27e48
.long 0x60,0x240,0x860,0xa40,0x68,0x248,0x868,0xa48,0x70,0x250,0x870,0xa50,0x78,0x258,0x878,0xa58
.long 0xe0,0x2c0,0x8e0,0xac0,0xe8,0x2c8,0x8e8,0xac8,0xf0,0x2d0,0x8f0,0xad0,0xf8,0x2d8,0x8f8,0xad8
.long 0x170,0x350,0x970,0xb50,0x178,0x358,0x978,0xb58,0x160,0x340,0x960,0xb40,0x168,0x348,0x968,0xb48
.long 0x1f0,0x3d0,0x9f0,0xbd0,0x1f8,0x3d8,0x9f8,0xbd8,0x1e0,0x3c0,0x9e0,0xbc0,0x1e8,0x3c8,0x9e8,0xbc8
.long 0x420,0x600,0xc20,0xe00,0x428,0x608,0xc28,0xe08,0x430,0x610,0xc30,0xe10,0x438,0x618,0xc38,0xe18
.long 0x4a0,0x680,0xca0,0xe80,0x4a8,0x688,0xca8,0xe88,0x4b0,0x690,0xcb0,0xe90,0x4b8,0x698,0xcb8,0xe98
.long 0x530,0x710,0xd30,0xf10,0x538,0x718,0xd38,0xf18,0x520,0x700,0xd20,0xf00,0x528,0x708,0xd28,0xf08
.long 0x5b0,0x790,0xdb0,0xf90,0x5b8,0x798,0xdb8,0xf98,0x5a0,0x780,0xda0,0xf80,0x5a8,0x788,0xda8,0xf88
.long 0x2860,0x2a40,0x3060,0x3240,0x2868,0x2a48,0x3068,0x3248,0x2870,0x2a50,0x3070,0x3250,0x2878,0x2a58,0x3078,0x3258
.long 0x28e0,0x2ac0,0x30e0,0x32c0,0x28e8,0x2ac8,0x30e8,0x32c8,0x28f0,0x2ad0,0x30f0,0x32d0,0x28f8,0x2ad8,0x30f8,0x32d8
.long 0x2970,0x2b50,0x3170,0x3350,0x2978,0x2b58,0x3178,0x3358,0x2960,0x2b40,0x3160,0x3340,0x2968,0x2b48,0x3168,0x3348
.long 0x29f0,0x2bd0,0x31f0,0x33d0,0x29f8,0x2bd8,0x31f8,0x33d8,0x29e0,0x2bc0,0x31e0,0x33c0,0x29e8,0x2bc8,0x31e8,0x33c8
.long 0x2c20,0x2e00,0x3420,0x3600,0x2c28,0x2e08,0x3428,0x3608,0x2c30,0x2e10,0x3430,0x3610,0x2c38,0x2e18,0x3438,0x3618
.long 0x2ca0,0x2e80,0x34a0,0x3680,0x2ca8,0x2e88,0x34a8,0x3688,0x2cb0,0x2e90,0x34b0,0x3690,0x2cb8,0x2e98,0x34b8,0x3698
.long 0x2d30,0x2f10,0x3530,0x3710,0x2d38,0x2f18,0x3538,0x3718,0x2d20,0x2f00,0x3520,0x3700,0x2d28,0x2f08,0x3528,0x3708
.long 0x2db0,0x2f90,0x35b0,0x3790,0x2db8,0x2f98,0x35b8,0x3798,0x2da0,0x2f80,0x35a0,0x3780,0x2da8,0x2f88,0x35a8,0x3788
.long 0xa000,0xa000,0x0,0x27e40,0xa090,0xa010,0x10,0x27e44,0xa120,0xa020,0x20,0x27e48,0xa1b0,0xa030,0x30,0x27e48
.long 0xa240,0xa040,0x40,0x27e48,0xa2d0,0xa050,0x50,0x27e48,0xa360,0xa060,0x60,0x27e48,0xa3f0,0xa070,0x70,0x27e48
.long 0xa480,0xa090,0x1080,0x27e48,0xa510,0xa0a0,0x1090,0x27e48,0xa5a0,0xa0b0,0x10a0,0x27e48,0xa630,0xa0c0,0x10b0,0x27e48
.long 0xa6c0,0xa0d0,0x10c0,0x27e48,0xa750,0xa0e0,0x10d0,0x27e48,0xa7e0,0xa0f0,0x10e0,0x27e48,0xa870,0xa100,0x10f0,0x27e48
.long 0xa010,0xa120,0x2100,0x27e48,0xa0a0,0xa130,0x2110,0x27e48,0xa130,0xa140,0x2120,0x27e48,0xa1c0,0xa150,0x2130,0x27e48
.long 0xa250,0xa160,0x2140,0x27e48,0xa2e0,0xa170,0x2150,0x27e48,0xa370,0xa180,0x2160,0x27e48,0xa400,0xa190,0x2170,0x27e48
.long 0xa490,0xa1b0,0x3180,0x27e48,0xa520,0xa1c0,0x3190,0x27e48,0xa5b0,0xa1d0,0x31a0,0x27e48,0xa640,0xa1e0,0x31b0,0x27e48
.long 0xa6d0,0xa1f0,0x31c0,0x27e48,0xa760,0xa200,0x31d0,0x27e48,0xa7f0,0xa210,0x31e0,0x27e48,0xa880,0xa220,0x31f0,0x27e48
.long 0xa020,0xa240,0x4200,0x27e48,0xa0b0,0xa250,0x4210,0x27e48,0xa140,0xa260,0x4220,0x27e48,0xa1d0,0xa270,0x4230,0x27e48
.long 0xa260,0xa280,0x4240,0x27e48,0xa2f0,0xa290,0x4250,0x27e48,0xa380,0xa2a0,0x4260,0x27e48,0xa410,0xa2b0,0x4270,0x27e48
.long 0xa4a0,0xa2d0,0x5280,0x27e48,0xa530,0xa2e0,0x5290,0x27e48,0xa5c0,0xa2f0,0x52a0,0x27e48,0xa650,0xa300,0x52b0,0x27e48
.long 0xa6e0,0xa310,0x52c0,0x27e48,0xa770,0xa320,0x52d0,0x27e48,0xa800,0xa330,0x52e0,0x27e48,0xa890,0xa340,0x52f0,0x27e48
.long 0xa030,0xa360,0x6300,0x27e48,0xa0c0,0xa370,0x6310,0x27e48,0xa150,0xa380,0x6320,0x27e48,0xa1e0,0xa390,0x6330,0x27e48
.long 0xa270,0xa3a0,0x6340,0x27e48,0xa300,0xa3b0,0x6350,0x27e48,0xa390,0xa3c0,0x6360,0x27e48,0xa420,0xa3d0,0x6370,0x27e48
.long 0xa4b0,0xa3f0,0x7380,0x27e48,0xa540,0xa400,0x7390,0x27e48,0xa5d0,0xa410,0x73a0,0x27e48,0xa660,0xa420,0x73b0,0x27e48
.long 0xa6f0,0xa430,0x73c0,0x27e48,0xa780,0xa440,0x73d0,0x27e48,0xa810,0xa450,0x73e0,0x27e48,0xa8a0,0xa460,0x73f0,0x27e48
.long 0x800,0xa20,0x860,0xa40,0x808,0xa28,0x868,0xa48,0x810,0xa30,0x870,0xa50,0x818,0xa38,0x878,0xa58
.long 0x880,0xaa0,0x8e0,0xac0,0x888,0xaa8,0x8e8,0xac8,0x890,0xab0,0x8f0,0xad0,0x898,0xab8,0x8f8,0xad8
.long 0x910,0xb30,0x970,0xb50,0x918,0xb38,0x978,0xb58,0x900,0xb20,0x960,0xb40,0x908,0xb28,0x968,0xb48
.long 0x990,0xbb0,0x9f0,0xbd0,0x998,0xbb8,0x9f8,0xbd8,0x980,0xba0,0x9e0,0xbc0,0x988,0xba8,0x9e8,0xbc8
.long 0xc40,0xe60,0xc20,0xe00,0xc48,0xe68,0xc28,0xe08,0xc50,0xe70,0xc30,0xe10,0xc58,0xe78,0xc38,0xe18
.long 0xcc0,0xee0,0xca0,0xe80,0xcc8,0xee8,0xca8,0xe88,0xcd0,0xef0,0xcb0,0xe90,0xcd8,0xef8,0xcb8,0xe98
.long 0xd50,0xf70,0xd30,0xf10,0xd58,0xf78,0xd38,0xf18,0xd40,0xf60,0xd20,0xf00,0xd48,0xf68,0xd28,0xf08
.long 0xdd0,0xff0,0xdb0,0xf90,0xdd8,0xff8,0xdb8,0xf98,0xdc0,0xfe0,0xda0,0xf80,0xdc8,0xfe8,0xda8,0xf88
.long 0x3000,0x3220,0x3060,0x3240,0x3008,0x3228,0x3068,0x3248,0x3010,0x3230,0x3070,0x3250,0x3018,0x3238,0x3078,0x3258
.long 0x3080,0x32a0,0x30e0,0x32c0,0x3088,0x32a8,0x30e8,0x32c8,0x3090,0x32b0,0x30f0,0x32d0,0x3098,0x32b8,0x30f8,0x32d8
.long 0x3110,0x3330,0x3170,0x3350,0x3118,0x3338,0x3178,0x3358,0x3100,0x3320,0x3160,0x3340,0x3108,0x3328,0x3168,0x3348
.long 0x3190,0x33b0,0x31f0,0x33d0,0x3198,0x33b8,0x31f8,0x33d8,0x3180,0x33a0,0x31e0,0x33c0,0x3188,0x33a8,0x31e8,0x33c8
.long 0x3440,0x3660,0x3420,0x3600,0x3448,0x3668,0x3428,0x3608,0x3450,0x3670,0x3430,0x3610,0x3458,0x3678,0x3438,0x3618
.long 0x34c0,0x36e0,0x34a0,0x3680,0x34c8,0x36e8,0x34a8,0x3688,0x34d0,0x36f0,0x34b0,0x3690,0x34d8,0x36f8,0x34b8,0x3698
.long 0x3550,0x3770,0x3530,0x3710,0x3558,0x3778,0x3538,0x3718,0x3540,0x3760,0x3520,0x3700,0x3548,0x3768,0x3528,0x3708
.long 0x35d0,0x37f0,0x35b0,0x3790,0x35d8,0x37f8,0x35b8,0x3798,0x35c0,0x37e0,0x35a0,0x3780,0x35c8,0x37e8,0x35a8,0x3788
.long 0xa900,0xa900,0x0,0x27e40,0xa990,0xa910,0x10,0x27e44,0xaa20,0xa920,0x20,0x27e48,0xaab0,0xa930,0x30,0x27e48
.long 0xab40,0xa940,0x40,0x27e48,0xabd0,0xa950,0x50,0x27e48,0xac60,0xa960,0x60,0x27e48,0xacf0,0xa970,0x70,0x27e48
.long 0xad80,0xa990,0x1080,0x27e48,0xae10,0xa9a0,0x1090,0x27e48,0xaea0,0xa9b0,0x10a0,0x27e48,0xaf30,0xa9c0,0x10b0,0x27e48
.long 0xafc0,0xa9d0,0x10c0,0x27e48,0xb050,0xa9e0,0x10d0,0x27e48,0xb0e0,0xa9f0,0x10e0,0x27e48,0xb170,0xaa00,0x10f0,0x27e48
.long 0xa910,0xaa20,0x2100,0x27e48,0xa9a0,0xaa30,0x2110,0x27e48,0xaa30,0xaa40,0x2120,0x27e48,0xaac0,0xaa50,0x2130,0x27e48
.long 0xab50,0xaa60,0x2140,0x27e48,0xabe0,0xaa70,0x2150,0x27e48,0xac70,0xaa80,0x2160,0x27e48,0xad00,0xaa90,0x2170,0x27e48
.long 0xad90,0xaab0,0x3180,0x27e48,0xae20,0xaac0,0x3190,0x27e48,0xaeb0,0xaad0,0x31a0,0x27e48,0xaf40,0xaae0,0x31b0,0x27e48
.long 0xafd0,0xaaf0,0x31c0,0x27e48,0xb060,0xab00,0x31d0,0x27e48,0xb0f0,0xab10,0x31e0,0x27e48,0xb180,0xab20,0x31f0,0x27e48
.long 0xa920,0xab40,0x4200,0x27e48,0xa9b0,0xab50,0x4210,0x27e48,0xaa40,0xab60,0x4220,0x27e48,0xaad0,0xab70,0x4230,0x27e48
.long 0xab60,0xab80,0x4240,0x27e48,0xabf0,0xab90,0x4250,0x27e48,0xac80,0xaba0,0x4260,0x27e48,0xad10,0xabb0,0x4270,0x27e48
.long 0xada0,0xabd0,0x5280,0x27e48,0xae30,0xabe0,0x5290,0x27e48,0xaec0,0xabf0,0x52a0,0x27e48,0xaf50,0xac00,0x52b0,0x27e48
.long 0xafe0,0xac10,0x52c0,0x27e48,0xb070,0xac20,0x52d0,0x27e48,0xb100,0xac30,0x52e0,0x27e48,0xb190,0xac40,0x52f0,0x27e48
.long 0xa930,0xac60,0x6300,0x27e48,0xa9c0,0xac70,0x6310,0x27e48,0xaa50,0xac80,0x6320,0x27e48,0xaae0,0xac90,0x6330,0x27e48
.long 0xab70,0xaca0,0x6340,0x27e48,0xac00,0xacb0,0x6350,0x27e48,0xac90,0xacc0,0x6360,0x27e48,0xad20,0xacd0,0x6370,0x27e48
.long 0xadb0,0xacf0,0x7380,0x27e48,0xae40,0xad00,0x7390,0x27e48,0xaed0,0xad10,0x73a0,0x27e48,0xaf60,0xad20,0x73b0,0x27e48
.long 0xaff0,0xad30,0x73c0,0x27e48,0xb080,0xad40,0x73d0,0x27e48,0xb110,0xad50,0x73e0,0x27e48,0xb1a0,0xad60,0x73f0,0x27e48
.long 0x820,0xa00,0x860,0xa40,0x828,0xa08,0x868,0xa48,0x830,0xa10,0x870,0xa50,0x838,0xa18,0x878,0xa58
.long 0x8a0,0xa80,0x8e0,0xac0,0x8a8,0xa88,0x8e8,0xac8,0x8b0,0xa90,0x8f0,0xad0,0x8b8,0xa98,0x8f8,0xad8
.long 0x930,0xb10,0x970,0xb50,0x938,0xb18,0x978,0xb58,0x920,0xb00,0x960,0xb40,0x928,0xb08,0x968,0xb48
.long 0x9b0,0xb90,0x9f0,0xbd0,0x9b8,0xb98,0x9f8,0xbd8,0x9a0,0xb80,0x9e0,0xbc0,0x9a8,0xb88,0x9e8,0xbc8
.long 0xc60,0xe40,0xc20,0xe00,0xc68,0xe48,0xc28,0xe08,0xc70,0xe50,0xc30,0xe10,0xc78,0xe58,0xc38,0xe18
.long 0xce0,0xec0,0xca0,0xe80,0xce8,0xec8,0xca8,0xe88,0xcf0,0xed0,0xcb0,0xe90,0xcf8,0xed8,0xcb8,0xe98
.long 0xd70,0xf50,0xd30,0xf10,0xd78,0xf58,0xd38,0xf18,0xd60,0xf40,0xd20,0xf00,0xd68,0xf48,0xd28,0xf08
.long 0xdf0,0xfd0,0xdb0,0xf90,0xdf8,0xfd8,0xdb8,0xf98,0xde0,0xfc0,0xda0,0xf80,0xde8,0xfc8,0xda8,0xf88
.long 0x3020,0x3200,0x3060,0x3240,0x3028,0x3208,0x3068,0x3248,0x3030,0x3210,0x3070,0x3250,0x3038,0x3218,0x3078,0x3258
.long 0x30a0,0x3280,0x30e0,0x32c0,0x30a8,0x3288,0x30e8,0x32c8,0x30b0,0x3290,0x30f0,0x32d0,0x30b8,0x3298,0x30f8,0x32d8
.long 0x3130,0x3310,0x3170,0x3350,0x3138,0x3318,0x3178,0x3358,0x3120,0x3300,0x3160,0x3340,0x3128,0x3308,0x3168,0x3348
.long 0x31b0,0x3390,0x31f0,0x33d0,0x31b8,0x3398,0x31f8,0x33d8,0x31a0,0x3380,0x31e0,0x33c0,0x31a8,0x3388,0x31e8,0x33c8
.long 0x3460,0x3640,0x3420,0x3600,0x3468,0x3648,0x3428,0x3608,0x3470,0x3650,0x3430,0x3610,0x3478,0x3658,0x3438,0x3618
.long 0x34e0,0x36c0,0x34a0,0x3680,0x34e8,0x36c8,0x34a8,0x3688,0x34f0,0x36d0,0x34b0,0x3690,0x34f8,0x36d8,0x34b8,0x3698
.long 0x3570,0x3750,0x3530,0x3710,0x3578,0x3758,0x3538,0x3718,0x3560,0x3740,0x3520,0x3700,0x3568,0x3748,0x3528,0x3708
.long 0x35f0,0x37d0,0x35b0,0x3790,0x35f8,0x37d8,0x35b8,0x3798,0x35e0,0x37c0,0x35a0,0x3780,0x35e8,0x37c8,0x35a8,0x3788
.long 0xb200,0xb200,0x0,0x27e40,0xb290,0xb210,0x10,0x27e44,0xb320,0xb220,0x20,0x27e48,0xb3b0,0xb230,0x30,0x27e48
.long 0xb440,0xb240,0x40,0x27e48,0xb4d0,0xb250,0x50,0x27e48,0xb560,0xb260,0x60,0x27e48,0xb5f0,0xb270,0x70,0x27e48
.long 0xb680,0xb290,0x1080,0x27e48,0xb710,0xb2a0,0x1090,0x27e48,0xb7a0,0xb2b0,0x10a0,0x27e48,0xb830,0xb2c0,0x10b0,0x27e48
.long 0xb8c0,0xb2d0,0x10c0,0x27e48,0xb950,0xb2e0,0x10d0,0x27e48,0xb9e0,0xb2f0,0x10e0,0x27e48,0xba70,0xb300,0x10f0,0x27e48
.long 0xb210,0xb320,0x2100,0x27e48,0xb2a0,0xb330,0x2110,0x27e48,0xb330,0xb340,0x2120,0x27e48,0xb3c0,0xb350,0x2130,0x27e48
.long 0xb450,0xb360,0x2140,0x27e48,0xb4e0,0xb370,0x2150,0x27e48,0xb570,0xb380,0x2160,0x27e48,0xb600,0xb390,0x2170,0x27e48
.long 0xb690,0xb3b0,0x3180,0x27e48,0xb720,0xb3c0,0x3190,0x27e48,0xb7b0,0xb3d0,0x31a0,0x27e48,0xb840,0xb3e0,0x31b0,0x27e48
.long 0xb8d0,0xb3f0,0x31c0,0x27e48,0xb960,0xb400,0x31d0,0x27e48,0xb9f0,0xb410,0x31e0,0x27e48,0xba80,0xb420,0x31f0,0x27e48
.long 0xb220,0xb440,0x4200,0x27e48,0xb2b0,0xb450,0x4210,0x27e48,0xb340,0xb460,0x4220,0x27e48,0xb3d0,0xb470,0x4230,0x27e48
.long 0xb460,0xb480,0x4240,0x27e48,0xb4f0,0xb490,0x4250,0x27e48,0xb580,0xb4a0,0x4260,0x27e48,0xb610,0xb4b0,0x4270,0x27e48
.long 0xb6a0,0xb4d0,0x5280,0x27e48,0xb730,0xb4e0,0x5290,0x27e48,0xb7c0,0xb4f0,0x52a0,0x27e48,0xb850,0xb500,0x52b0,0x27e48
.long 0xb8e0,0xb510,0x52c0,0x27e48,0xb970,0xb520,0x52d0,0x27e48,0xba00,0xb530,0x52e0,0x27e48,0xba90,0xb540,0x52f0,0x27e48
.long 0xb230,0xb560,0x6300,0x27e48,0xb2c0,0xb570,0x6310,0x27e48,0xb350,0xb580,0x6320,0x27e48,0xb3e0,0xb590,0x6330,0x27e48
.long 0xb470,0xb5a0,0x6340,0x27e48,0xb500,0xb5b0,0x6350,0x27e48,0xb590,0xb5c0,0x6360,0x27e48,0xb620,0xb5d0,0x6370,0x27e48
.long 0xb6b0,0xb5f0,0x7380,0x27e48,0xb740,0xb600,0x7390,0x27e48,0xb7d0,0xb610,0x73a0,0x27e48,0xb860,0xb620,0x73b0,0x27e48
.long 0xb8f0,0xb630,0x73c0,0x27e48,0xb980,0xb640,0x73d0,0x27e48,0xba10,0xb650,0x73e0,0x27e48,0xbaa0,0xb660,0x73f0,0x27e48
.long 0x840,0xa60,0x860,0xa40,0x848,0xa68,0x868,0xa48,0x850,0xa70,0x870,0xa50,0x858,0xa78,0x878,0xa58
.long 0x8c0,0xae0,0x8e0,0xac0,0x8c8,0xae8,0x8e8,0xac8,0x8d0,0xaf0,0x8f0,0xad0,0x8d8,0xaf8,0x8f8,0xad8
.long 0x950,0xb70,0x970,0xb50,0x958,0xb78,0x978,0xb58,0x940,0xb60,0x960,0xb40,0x948,0xb68,0x968,0xb48
.long 0x9d0,0xbf0,0x9f0,0xbd0,0x9d8,0xbf8,0x9f8,0xbd8,0x9c0,0xbe0,0x9e0,0xbc0,0x9c8,0xbe8,0x9e8,0xbc8
.long 0xc00,0xe20,0xc20,0xe00,0xc08,0xe28,0xc28,0xe08,0xc10,0xe30,0xc30,0xe10,0xc18,0xe38,0xc38,0xe18
.long 0xc80,0xea0,0xca0,0xe80,0xc88,0xea8,0xca8,0xe88,0xc90,0xeb0,0xcb0,0xe90,0xc98,0xeb8,0xcb8,0xe98
.long 0xd10,0xf30,0xd30,0xf10,0xd18,0xf38,0xd38,0xf18,0xd00,0xf20,0xd20,0xf00,0xd08,0xf28,0xd28,0xf08
.long 0xd90,0xfb0,0xdb0,0xf90,0xd98,0xfb8,0xdb8,0xf98,0xd80,0xfa0,0xda0,0xf80,0xd88,0xfa8,0xda8,0xf88
.long 0x3040,0x3260,0x3060,0x3240,0x3048,0x3268,0x3068,0x3248,0x3050,0x3270,0x3070,0x3250,0x3058,0x3278,0x3078,0x3258
.long 0x30c0,0x32e0,0x30e0,0x32c0,0x30c8,0x32e8,0x30e8,0x32c8,0x30d0,0x32f0,0x30f0,0x32d0,0x30d8,0x32f8,0x30f8,0x32d8
.long 0x3150,0x3370,0x3170,0x3350,0x3158,0x3378,0x3178,0x3358,0x3140,0x3360,0x3160,0x3340,0x3148,0x3368,0x3168,0x3348
.long 0x31d0,0x33f0,0x31f0,0x33d0,0x31d8,0x33f8,0x31f8,0x33d8,0x31c0,0x33e0,0x31e0,0x33c0,0x31c8,0x33e8,0x31e8,0x33c8
.long 0x3400,0x3620,0x3420,0x3600,0x3408,0x3628,0x3428,0x3608,0x3410,0x3630,0x3430,0x3610,0x3418,0x3638,0x3438,0x3618
.long 0x3480,0x36a0,0x34a0,0x3680,0x3488,0x36a8,0x34a8,0x3688,0x3490,0x36b0,0x34b0,0x3690,0x3498,0x36b8,0x34b8,0x3698
.long 0x3510,0x3730,0x3530,0x3710,0x3518,0x3738,0x3538,0x3718,0x3500,0x3720,0x3520,0x3700,0x3508,0x3728,0x3528,0x3708
.long 0x3590,0x37b0,0x35b0,0x3790,0x3598,0x37b8,0x35b8,0x3798,0x3580,0x37a0,0x35a0,0x3780,0x3588,0x37a8,0x35a8,0x3788
.long 0x27500,0x27500,0x0,0x27e40,0x27590,0x27510,0x10,0x27e44,0x27620,0x27520,0x20,0x27e48,0x276b0,0x27530,0x30,0x27e48
.long 0x27740,0x27540,0x40,0x27e48,0x277d0,0x27550,0x50,0x27e48,0x27860,0x27560,0x60,0x27e48,0x278f0,0x27570,0x70,0x27e48
.long 0x27980,0x27590,0x1080,0x27e48,0x27a10,0x275a0,0x1090,0x27e48,0x27aa0,0x275b0,0x10a0,0x27e48,0x27b30,0x275c0,0x10b0,0x27e48
.long 0x27bc0,0x275d0,0x10c0,0x27e48,0x27c50,0x275e0,0x10d0,0x27e48,0x27ce0,0x275f0,0x10e0,0x27e48,0x27d70,0x27600,0x10f0,0x27e48
.long 0x27510,0x27620,0x2100,0x27e48,0x275a0,0x27630,0x2110,0x27e48,0x27630,0x27640,0x2120,0x27e48,0x276c0,0x27650,0x2130,0x27e48
.long 0x27750,0x27660,0x2140,0x27e48,0x277e0,0x27670,0x2150,0x27e48,0x27870,0x27680,0x2160,0x27e48,0x27900,0x27690,0x2170,0x27e48
.long 0x27990,0x276b0,0x3180,0x27e48,0x27a20,0x276c0,0x3190,0x27e48,0x27ab0,0x276d0,0x31a0,0x27e48,0x27b40,0x276e0,0x31b0,0x27e48
.long 0x27bd0,0x276f0,0x31c0,0x27e48,0x27c60,0x27700,0x31d0,0x27e48,0x27cf0,0x27710,0x31e0,0x27e48,0x27d80,0x27720,0x31f0,0x27e48
.long 0x27520,0x27740,0x4200,0x27e48,0x275b0,0x27750,0x4210,0x27e48,0x27640,0x27760,0x4220,0x27e48,0x276d0,0x27770,0x4230,0x27e48
.long 0x27760,0x27780,0x4240,0x27e48,0x277f0,0x27790,0x4250,0x27e48,0x27880,0x277a0,0x4260,0x27e48,0x27910,0x277b0,0x4270,0x27e48
.long 0x279a0,0x277d0,0x5280,0x27e48,0x27a30,0x277e0,0x5290,0x27e48,0x27ac0,0x277f0,0x52a0,0x27e48,0x27b50,0x27800,0x52b0,0x27e48
.long 0x27be0,0x27810,0x52c0,0x27e48,0x27c70,0x27820,0x52d0,0x27e48,0x27d00,0x27830,0x52e0,0x27e48,0x27d90,0x27840,0x52f0,0x27e48
.long 0x27530,0x27860,0x6300,0x27e48,0x275c0,0x27870,0x6310,0x27e48,0x27650,0x27880,0x6320,0x27e48,0x276e0,0x27890,0x6330,0x27e48
.long 0x27770,0x278a0,0x6340,0x27e48,0x27800,0x278b0,0x6350,0x27e48,0x27890,0x278c0,0x6360,0x27e48,0x27920,0x278d0,0x6370,0x27e48
.long 0x279b0,0x278f0,0x7380,0x27e48,0x27a40,0x27900,0x7390,0x27e48,0x27ad0,0x27910,0x73a0,0x27e48,0x27b60,0x27920,0x73b0,0x27e48
.long 0x27bf0,0x27930,0x73c0,0x27e48,0x27c80,0x27940,0x73d0,0x27e48,0x27d10,0x27950,0x73e0,0x27e48,0x27da0,0x27960,0x73f0,0x27e48
.long 0x0,0x27ec0,0x24d00,0x24d00,0x10,0x27ec4,0x24d28,0x24d28,0x20,0x27ec8,0x24d50,0x24d50,0x30,0x27ecc,0x24d78,0x24d78
.long 0x80,0x27ec0,0x24da0,0x24da0,0x90,0x27ec4,0x24dc8,0x24dc8,0xa0,0x27ec8,0x24df0,0x24df0,0xb0,0x27ecc,0x24e18,0x24e18
.long 0x40,0x27ec0,0x24e40,0x24e40,0x50,0x27ec4,0x24e68,0x24e68,0x60,0x27ec8,0x24e90,0x24e90,0x70,0x27ecc,0x24eb8,0x24eb8
.long 0xc0,0x27ec0,0x24ee0,0x24ee0,0xd0,0x27ec4,0x24f08,0x24f08,0xe0,0x27ec8,0x24f30,0x24f30,0xf0,0x27ecc,0x24f58,0x24f58
.long 0x100,0x27ec0,0x24f80,0x24f80,0x110,0x27ec4,0x24fa8,0x24fa8,0x120,0x27ec8,0x24fd0,0x24fd0,0x130,0x27ecc,0x24ff8,0x24ff8
.long 0x40000,0x27ec0,0x25020,0x25020,0x40000,0x27ec4,0x25048,0x25048,0x40000,0x27ec8,0x25070,0x25070,0x40000,0x27ecc,0x25098,0x25098
.long 0x140,0x27ec0,0x250c0,0x250c0,0x40000,0x27ec4,0x250e8,0x250e8,0x40000,0x27ec8,0x25110,0x25110,0x40000,0x27ecc,0x25138,0x25138
.long 0x140,0x27ec0,0x25160,0x25160,0x40000,0x27ec4,0x25188,0x25188,0x40000,0x27ec8,0x251b0,0x251b0,0x40000,0x27ecc,0x251d8,0x251d8
.long 0x150,0x27ed0,0x24d10,0x64d00,0x160,0x27ed4,0x24d38,0x64d28,0x170,0x27ed8,0x24d60,0x64d50,0x180,0x27edc,0x24d88,0x64d78
.long 0x1d0,0x27ed0,0x24db0,0x64da0,0x1e0,0x27ed4,0x24dd8,0x64dc8,0x1f0,0x27ed8,0x24e00,0x64df0,0x200,0x27edc,0x24e28,0x64e18
.long 0x190,0x27ed0,0x24e50,0x64e40,0x1a0,0x27ed4,0x24e78,0x64e68,0x1b0,0x27ed8,0x24ea0,0x64e90,0x1c0,0x27edc,0x24ec8,0x64eb8
.long 0x210,0x27ed0,0x24ef0,0x64ee0,0x220,0x27ed4,0x24f18,0x64f08,0x230,0x27ed8,0x24f40,0x64f30,0x240,0x27edc,0x24f68,0x64f58
.long 0x250,0x27ed0,0x24f90,0x64f80,0x260,0x27ed4,0x24fb8,0x64fa8,0x270,0x27ed8,0x24fe0,0x64fd0,0x280,0x27edc,0x25008,0x64ff8
.long 0x40150,0x27ed0,0x25030,0x65020,0x40150,0x27ed4,0x25058,0x65048,0x40150,0x27ed8,0x25080,0x65070,0x40150,0x27edc,0x250a8,0x65098
.long 0x290,0x27ed0,0x250d0,0x650c0,0x40150,0x27ed4,0x250f8,0x650e8,0x40150,0x27ed8,0x25120,0x65110,0x40150,0x27edc,0x25148,0x65138
.long 0x290,0x27ed0,0x25170,0x65160,0x40150,0x27ed4,0x25198,0x65188,0x40150,0x27ed8,0x251c0,0x651b0,0x40150,0x27edc,0x251e8,0x651d8
.long 0x27ec0,0x0,0x27e50,0x27500,0x27ec0,0x4,0x27e54,0x27504,0x27ec0,0x8,0x27e58,0x27508,0x27ec0,0xc,0x27e5c,0x2750c
.long 0x27ec0,0x10,0x27e60,0x27510,0x27ec0,0x14,0x27e60,0x27514,0x27ec0,0x18,0x27e60,0x27518,0x27ec0,0x1c,0x27e60,0x2751c
.long 0x27ec0,0x20,0x27e50,0x27520,0x27ec0,0x24,0x27e54,0x27524,0x27ec0,0x28,0x27e58,0x27528,0x27ec0,0x2c,0x27e5c,0x2752c
.long 0x27ec0,0x30,0x27e60,0x27530,0x27ec0,0x34,0x27e60,0x27534,0x27ec0,0x38,0x27e60,0x27538,0x27ec0,0x3c,0x27e60,0x2753c
.long 0x27ec0,0x40,0x27e50,0x27540,0x27ec0,0x44,0x27e54,0x27544,0x27ec0,0x48,0x27e58,0x27548,0x27ec0,0x4c,0x27e5c,0x2754c
.long 0x27ec0,0x50,0x27e60,0x27550,0x27ec0,0x54,0x27e60,0x27554,0x27ec0,0x58,0x27e60,0x27558,0x27ec0,0x5c,0x27e60,0x2755c
.long 0x27ec0,0x60,0x27e50,0x27560,0x27ec0,0x64,0x27e54,0x27564,0x27ec0,0x68,0x27e58,0x27568,0x27ec0,0x6c,0x27e5c,0x2756c
.long 0x27ec0,0x70,0x27e60,0x27570,0x27ec0,0x74,0x27e60,0x27574,0x27ec0,0x78,0x27e60,0x27578,0x27ec0,0x7c,0x27e60,0x2757c
.long 0x27ec0,0x0,0x27e50,0x27580,0x27ec0,0x4,0x27e54,0x27584,0x27ec0,0x8,0x27e58,0x27588,0x27ec0,0xc,0x27e5c,0x2758c
.long 0x27ec0,0x10,0x27e60,0x27590,0x27ec0,0x14,0x27e60,0x27594,0x27ec0,0x18,0x27e60,0x27598,0x27ec0,0x1c,0x27e60,0x2759c
.long 0x27ec0,0x20,0x27e50,0x275a0,0x27ec0,0x24,0x27e54,0x275a4,0x27ec0,0x28,0x27e58,0x275a8,0x27ec0,0x2c,0x27e5c,0x275ac
.long 0x27ec0,0x30,0x27e60,0x275b0,0x27ec0,0x34,0x27e60,0x275b4,0x27ec0,0x38,0x27e60,0x275b8,0x27ec0,0x3c,0x27e60,0x275bc
.long 0x27ec0,0x40,0x27e50,0x275c0,0x27ec0,0x44,0x27e54,0x275c4,0x27ec0,0x48,0x27e58,0x275c8,0x27ec0,0x4c,0x27e5c,0x275cc
.long 0x27ec0,0x50,0x27e60,0x275d0,0x27ec0,0x54,0x27e60,0x275d4,0x27ec0,0x58,0x27e60,0x275d8,0x27ec0,0x5c,0x27e60,0x275dc
.long 0x27ec0,0x60,0x27e50,0x275e0,0x27ec0,0x64,0x27e54,0x275e4,0x27ec0,0x68,0x27e58,0x275e8,0x27ec0,0x6c,0x27e5c,0x275ec
.long 0x27ec0,0x70,0x27e60,0x275f0,0x27ec0,0x74,0x27e60,0x275f4,0x27ec0,0x78,0x27e60,0x275f8,0x27ec0,0x7c,0x27e60,0x275fc
.long 0x40,0x27ec0,0x25700,0x25700,0x50,0x27ec4,0x25728,0x25728,0x60,0x27ec8,0x25750,0x25750,0x70,0x27ecc,0x25778,0x25778
.long 0xc0,0x27ec0,0x257a0,0x257a0,0xd0,0x27ec4,0x257c8,0x257c8,0xe0,0x27ec8,0x257f0,0x257f0,0xf0,0x27ecc,0x25818,0x25818
.long 0x80,0x27ec0,0x25840,0x25840,0x90,0x27ec4,0x25868,0x25868,0xa0,0x27ec8,0x25890,0x25890,0xb0,0x27ecc,0x258b8,0x258b8
.long 0x100,0x27ec0,0x258e0,0x258e0,0x110,0x27ec4,0x25908,0x25908,0x120,0x27ec8,0x25930,0x25930,0x130,0x27ecc,0x25958,0x25958
.long 0x0,0x27ec0,0x25980,0x25980,0x10,0x27ec4,0x259a8,0x259a8,0x20,0x27ec8,0x259d0,0x259d0,0x30,0x27ecc,0x259f8,0x259f8
.long 0x40000,0x27ec0,0x25a20,0x25a20,0x40000,0x27ec4,0x25a48,0x25a48,0x40000,0x27ec8,0x25a70,0x25a70,0x40000,0x27ecc,0x25a98,0x25a98
.long 0x140,0x27ec0,0x25ac0,0x25ac0,0x40000,0x27ec4,0x25ae8,0x25ae8,0x40000,0x27ec8,0x25b10,0x25b10,0x40000,0x27ecc,0x25b38,0x25b38
.long 0x140,0x27ec0,0x25b60,0x25b60,0x40000,0x27ec4,0x25b88,0x25b88,0x40000,0x27ec8,0x25bb0,0x25bb0,0x40000,0x27ecc,0x25bd8,0x25bd8
.long 0x190,0x27ed0,0x25710,0x65700,0x1a0,0x27ed4,0x25738,0x65728,0x1b0,0x27ed8,0x25760,0x65750,0x1c0,0x27edc,0x25788,0x65778
.long 0x210,0x27ed0,0x257b0,0x657a0,0x220,0x27ed4,0x257d8,0x657c8,0x230,0x27ed8,0x25800,0x657f0,0x240,0x27edc,0x25828,0x65818
.long 0x1d0,0x27ed0,0x25850,0x65840,0x1e0,0x27ed4,0x25878,0x65868,0x1f0,0x27ed8,0x258a0,0x65890,0x200,0x27edc,0x258c8,0x658b8
.long 0x250,0x27ed0,0x258f0,0x658e0,0x260,0x27ed4,0x25918,0x65908,0x270,0x27ed8,0x25940,0x65930,0x280,0x27edc,0x25968,0x65958
.long 0x150,0x27ed0,0x25990,0x65980,0x160,0x27ed4,0x259b8,0x659a8,0x170,0x27ed8,0x259e0,0x659d0,0x180,0x27edc,0x25a08,0x659f8
.long 0x40150,0x27ed0,0x25a30,0x65a20,0x40150,0x27ed4,0x25a58,0x65a48,0x40150,0x27ed8,0x25a80,0x65a70,0x40150,0x27edc,0x25aa8,0x65a98
.long 0x290,0x27ed0,0x25ad0,0x65ac0,0x40150,0x27ed4,0x25af8,0x65ae8,0x40150,0x27ed8,0x25b20,0x65b10,0x40150,0x27edc,0x25b48,0x65b38
.long 0x290,0x27ed0,0x25b70,0x65b60,0x40150,0x27ed4,0x25b98,0x65b88,0x40150,0x27ed8,0x25bc0,0x65bb0,0x40150,0x27edc,0x25be8,0x65bd8
.long 0x27ec4,0x0,0x27e50,0x27700,0x27ec4,0x4,0x27e54,0x27704,0x27ec4,0x8,0x27e58,0x27708,0x27ec4,0xc,0x27e5c,0x2770c
.long 0x27ec4,0x10,0x27e60,0x27710,0x27ec4,0x14,0x27e60,0x27714,0x27ec4,0x18,0x27e60,0x27718,0x27ec4,0x1c,0x27e60,0x2771c
.long 0x27ec4,0x20,0x27e50,0x27720,0x27ec4,0x24,0x27e54,0x27724,0x27ec4,0x28,0x27e58,0x27728,0x27ec4,0x2c,0x27e5c,0x2772c
.long 0x27ec4,0x30,0x27e60,0x27730,0x27ec4,0x34,0x27e60,0x27734,0x27ec4,0x38,0x27e60,0x27738,0x27ec4,0x3c,0x27e60,0x2773c
.long 0x27ec4,0x40,0x27e50,0x27740,0x27ec4,0x44,0x27e54,0x27744,0x27ec4,0x48,0x27e58,0x27748,0x27ec4,0x4c,0x27e5c,0x2774c
.long 0x27ec4,0x50,0x27e60,0x27750,0x27ec4,0x54,0x27e60,0x27754,0x27ec4,0x58,0x27e60,0x27758,0x27ec4,0x5c,0x27e60,0x2775c
.long 0x27ec4,0x60,0x27e50,0x27760,0x27ec4,0x64,0x27e54,0x27764,0x27ec4,0x68,0x27e58,0x27768,0x27ec4,0x6c,0x27e5c,0x2776c
.long 0x27ec4,0x70,0x27e60,0x27770,0x27ec4,0x74,0x27e60,0x27774,0x27ec4,0x78,0x27e60,0x27778,0x27ec4,0x7c,0x27e60,0x2777c
.long 0x27ec4,0x0,0x27e50,0x27780,0x27ec4,0x4,0x27e54,0x27784,0x27ec4,0x8,0x27e58,0x27788,0x27ec4,0xc,0x27e5c,0x2778c
.long 0x27ec4,0x10,0x27e60,0x27790,0x27ec4,0x14,0x27e60,0x27794,0x27ec4,0x18,0x27e60,0x27798,0x27ec4,0x1c,0x27e60,0x2779c
.long 0x27ec4,0x20,0x27e50,0x277a0,0x27ec4,0x24,0x27e54,0x277a4,0x27ec4,0x28,0x27e58,0x277a8,0x27ec4,0x2c,0x27e5c,0x277ac
.long 0x27ec4,0x30,0x27e60,0x277b0,0x27ec4,0x34,0x27e60,0x277b4,0x27ec4,0x38,0x27e60,0x277b8,0x27ec4,0x3c,0x27e60,0x277bc
.long 0x27ec4,0x40,0x27e50,0x277c0,0x27ec4,0x44,0x27e54,0x277c4,0x27ec4,0x48,0x27e58,0x277c8,0x27ec4,0x4c,0x27e5c,0x277cc
.long 0x27ec4,0x50,0x27e60,0x277d0,0x27ec4,0x54,0x27e60,0x277d4,0x27ec4,0x58,0x27e60,0x277d8,0x27ec4,0x5c,0x27e60,0x277dc
.long 0x27ec4,0x60,0x27e50,0x277e0,0x27ec4,0x64,0x27e54,0x277e4,0x27ec4,0x68,0x27e58,0x277e8,0x27ec4,0x6c,0x27e5c,0x277ec
.long 0x27ec4,0x70,0x27e60,0x277f0,0x27ec4,0x74,0x27e60,0x277f4,0x27ec4,0x78,0x27e60,0x277f8,0x27ec4,0x7c,0x27e60,0x277fc
.long 0x0,0x27ec0,0x26100,0x26100,0x10,0x27ec4,0x26128,0x26128,0x20,0x27ec8,0x26150,0x26150,0x30,0x27ecc,0x26178,0x26178
.long 0x80,0x27ec0,0x261a0,0x261a0,0x90,0x27ec4,0x261c8,0x261c8,0xa0,0x27ec8,0x261f0,0x261f0,0xb0,0x27ecc,0x26218,0x26218
.long 0x40,0x27ec0,0x26240,0x26240,0x50,0x27ec4,0x26268,0x26268,0x60,0x27ec8,0x26290,0x26290,0x70,0x27ecc,0x262b8,0x262b8
.long 0xc0,0x27ec0,0x262e0,0x262e0,0xd0,0x27ec4,0x26308,0x26308,0xe0,0x27ec8,0x26330,0x26330,0xf0,0x27ecc,0x26358,0x26358
.long 0x100,0x27ec0,0x26380,0x26380,0x110,0x27ec4,0x263a8,0x263a8,0x120,0x27ec8,0x263d0,0x263d0,0x130,0x27ecc,0x263f8,0x263f8
.long 0x40000,0x27ec0,0x26420,0x26420,0x40000,0x27ec4,0x26448,0x26448,0x40000,0x27ec8,0x26470,0x26470,0x40000,0x27ecc,0x26498,0x26498
.long 0x140,0x27ec0,0x264c0,0x264c0,0x40000,0x27ec4,0x264e8,0x264e8,0x40000,0x27ec8,0x26510,0x26510,0x40000,0x27ecc,0x26538,0x26538
.long 0x140,0x27ec0,0x26560,0x26560,0x40000,0x27ec4,0x26588,0x26588,0x40000,0x27ec8,0x265b0,0x265b0,0x40000,0x27ecc,0x265d8,0x265d8
.long 0x150,0x27ed0,0x26110,0x66100,0x160,0x27ed4,0x26138,0x66128,0x170,0x27ed8,0x26160,0x66150,0x180,0x27edc,0x26188,0x66178
.long 0x1d0,0x27ed0,0x261b0,0x661a0,0x1e0,0x27ed4,0x261d8,0x661c8,0x1f0,0x27ed8,0x26200,0x661f0,0x200,0x27edc,0x26228,0x66218
.long 0x190,0x27ed0,0x26250,0x66240,0x1a0,0x27ed4,0x26278,0x66268,0x1b0,0x27ed8,0x262a0,0x66290,0x1c0,0x27edc,0x262c8,0x662b8
.long 0x210,0x27ed0,0x262f0,0x662e0,0x220,0x27ed4,0x26318,0x66308,0x230,0x27ed8,0x26340,0x66330,0x240,0x27edc,0x26368,0x66358
.long 0x250,0x27ed0,0x26390,0x66380,0x260,0x27ed4,0x263b8,0x663a8,0x270,0x27ed8,0x263e0,0x663d0,0x280,0x27edc,0x26408,0x663f8
.long 0x40150,0x27ed0,0x26430,0x66420,0x40150,0x27ed4,0x26458,0x66448,0x40150,0x27ed8,0x26480,0x66470,0x40150,0x27edc,0x264a8,0x66498
.long 0x290,0x27ed0,0x264d0,0x664c0,0x40150,0x27ed4,0x264f8,0x664e8,0x40150,0x27ed8,0x26520,0x66510,0x40150,0x27edc,0x26548,0x66538
.long 0x290,0x27ed0,0x26570,0x66560,0x40150,0x27ed4,0x26598,0x66588,0x40150,0x27ed8,0x265c0,0x665b0,0x40150,0x27edc,0x265e8,0x665d8
.long 0x27ec8,0x0,0x27e50,0x27900,0x27ec8,0x4,0x27e54,0x27904,0x27ec8,0x8,0x27e58,0x27908,0x27ec8,0xc,0x27e5c,0x2790c
.long 0x27ec8,0x10,0x27e60,0x27910,0x27ec8,0x14,0x27e60,0x27914,0x27ec8,0x18,0x27e60,0x27918,0x27ec8,0x1c,0x27e60,0x2791c
.long 0x27ec8,0x20,0x27e50,0x27920,0x27ec8,0x24,0x27e54,0x27924,0x27ec8,0x28,0x27e58,0x27928,0x27ec8,0x2c,0x27e5c,0x2792c
.long 0x27ec8,0x30,0x27e60,0x27930,0x27ec8,0x34,0x27e60,0x27934,0x27ec8,0x38,0x27e60,0x27938,0x27ec8,0x3c,0x27e60,0x2793c
.long 0x27ec8,0x40,0x27e50,0x27940,0x27ec8,0x44,0x27e54,0x27944,0x27ec8,0x48,0x27e58,0x27948,0x27ec8,0x4c,0x27e5c,0x2794c
.long 0x27ec8,0x50,0x27e60,0x27950,0x27ec8,0x54,0x27e60,0x27954,0x27ec8,0x58,0x27e60,0x27958,0x27ec8,0x5c,0x27e60,0x2795c
.long 0x27ec8,0x60,0x27e50,0x27960,0x27ec8,0x64,0x27e54,0x27964,0x27ec8,0x68,0x27e58,0x27968,0x27ec8,0x6c,0x27e5c,0x2796c
.long 0x27ec8,0x70,0x27e60,0x27970,0x27ec8,0x74,0x27e60,0x27974,0x27ec8,0x78,0x27e60,0x27978,0x27ec8,0x7c,0x27e60,0x2797c
.long 0x27ec8,0x0,0x27e50,0x27980,0x27ec8,0x4,0x27e54,0x27984,0x27ec8,0x8,0x27e58,0x27988,0x27ec8,0xc,0x27e5c,0x2798c
.long 0x27ec8,0x10,0x27e60,0x27990,0x27ec8,0x14,0x27e60,0x27994,0x27ec8,0x18,0x27e60,0x27998,0x27ec8,0x1c,0x27e60,0x2799c
.long 0x27ec8,0x20,0x27e50,0x279a0,0x27ec8,0x24,0x27e54,0x279a4,0x27ec8,0x28,0x27e58,0x279a8,0x27ec8,0x2c,0x27e5c,0x279ac
.long 0x27ec8,0x30,0x27e60,0x279b0,0x27ec8,0x34,0x27e60,0x279b4,0x27ec8,0x38,0x27e60,0x279b8,0x27ec8,0x3c,0x27e60,0x279bc
.long 0x27ec8,0x40,0x27e50,0x279c0,0x27ec8,0x44,0x27e54,0x279c4,0x27ec8,0x48,0x27e58,0x279c8,0x27ec8,0x4c,0x27e5c,0x279cc
.long 0x27ec8,0x50,0x27e60,0x279d0,0x27ec8,0x54,0x27e60,0x279d4,0x27ec8,0x58,0x27e60,0x279d8,0x27ec8,0x5c,0x27e60,0x279dc
.long 0x27ec8,0x60,0x27e50,0x279e0,0x27ec8,0x64,0x27e54,0x279e4,0x27ec8,0x68,0x27e58,0x279e8,0x27ec8,0x6c,0x27e5c,0x279ec
.long 0x27ec8,0x70,0x27e60,0x279f0,0x27ec8,0x74,0x27e60,0x279f4,0x27ec8,0x78,0x27e60,0x279f8,0x27ec8,0x7c,0x27e60,0x279fc
.long 0x40,0x27ec0,0x26b00,0x26b00,0x50,0x27ec4,0x26b28,0x26b28,0x60,0x27ec8,0x26b50,0x26b50,0x70,0x27ecc,0x26b78,0x26b78
.long 0xc0,0x27ec0,0x26ba0,0x26ba0,0xd0,0x27ec4,0x26bc8,0x26bc8,0xe0,0x27ec8,0x26bf0,0x26bf0,0xf0,0x27ecc,0x26c18,0x26c18
.long 0x80,0x27ec0,0x26c40,0x26c40,0x90,0x27ec4,0x26c68,0x26c68,0xa0,0x27ec8,0x26c90,0x26c90,0xb0,0x27ecc,0x26cb8,0x26cb8
.long 0x100,0x27ec0,0x26ce0,0x26ce0,0x110,0x27ec4,0x26d08,0x26d08,0x120,0x27ec8,0x26d30,0x26d30,0x130,0x27ecc,0x26d58,0x26d58
.long 0x0,0x27ec0,0x26d80,0x26d80,0x10,0x27ec4,0x26da8,0x26da8,0x20,0x27ec8,0x26dd0,0x26dd0,0x30,0x27ecc,0x26df8,0x26df8
.long 0x40000,0x27ec0,0x26e20,0x26e20,0x40000,0x27ec4,0x26e48,0x26e48,0x40000,0x27ec8,0x26e70,0x26e70,0x40000,0x27ecc,0x26e98,0x26e98
.long 0x140,0x27ec0,0x26ec0,0x26ec0,0x40000,0x27ec4,0x26ee8,0x26ee8,0x40000,0x27ec8,0x26f10,0x26f10,0x40000,0x27ecc,0x26f38,0x26f38
.long 0x140,0x27ec0,0x26f60,0x26f60,0x40000,0x27ec4,0x26f88,0x26f88,0x40000,0x27ec8,0x26fb0,0x26fb0,0x40000,0x27ecc,0x26fd8,0x26fd8
.long 0x190,0x27ed0,0x26b10,0x66b00,0x1a0,0x27ed4,0x26b38,0x66b28,0x1b0,0x27ed8,0x26b60,0x66b50,0x1c0,0x27edc,0x26b88,0x66b78
.long 0x210,0x27ed0,0x26bb0,0x66ba0,0x220,0x27ed4,0x26bd8,0x66bc8,0x230,0x27ed8,0x26c00,0x66bf0,0x240,0x27edc,0x26c28,0x66c18
.long 0x1d0,0x27ed0,0x26c50,0x66c40,0x1e0,0x27ed4,0x26c78,0x66c68,0x1f0,0x27ed8,0x26ca0,0x66c90,0x200,0x27edc,0x26cc8,0x66cb8
.long 0x250,0x27ed0,0x26cf0,0x66ce0,0x260,0x27ed4,0x26d18,0x66d08,0x270,0x27ed8,0x26d40,0x66d30,0x280,0x27edc,0x26d68,0x66d58
.long 0x150,0x27ed0,0x26d90,0x66d80,0x160,0x27ed4,0x26db8,0x66da8,0x170,0x27ed8,0x26de0,0x66dd0,0x180,0x27edc,0x26e08,0x66df8
.long 0x40150,0x27ed0,0x26e30,0x66e20,0x40150,0x27ed4,0x26e58,0x66e48,0x40150,0x27ed8,0x26e80,0x66e70,0x40150,0x27edc,0x26ea8,0x66e98
.long 0x290,0x27ed0,0x26ed0,0x66ec0,0x40150,0x27ed4,0x26ef8,0x66ee8,0x40150,0x27ed8,0x26f20,0x66f10,0x40150,0x27edc,0x26f48,0x66f38
.long 0x290,0x27ed0,0x26f70,0x66f60,0x40150,0x27ed4,0x26f98,0x66f88,0x40150,0x27ed8,0x26fc0,0x66fb0,0x40150,0x27edc,0x26fe8,0x66fd8
.long 0x27ecc,0x0,0x27e50,0x27b00,0x27ecc,0x4,0x27e54,0x27b04,0x27ecc,0x8,0x27e58,0x27b08,0x27ecc,0xc,0x27e5c,0x27b0c
.long 0x27ecc,0x10,0x27e60,0x27b10,0x27ecc,0x14,0x27e60,0x27b14,0x27ecc,0x18,0x27e60,0x27b18,0x27ecc,0x1c,0x27e60,0x27b1c
.long 0x27ecc,0x20,0x27e50,0x27b20,0x27ecc,0x24,0x27e54,0x27b24,0x27ecc,0x28,0x27e58,0x27b28,0x27ecc,0x2c,0x27e5c,0x27b2c
.long 0x27ecc,0x30,0x27e60,0x27b30,0x27ecc,0x34,0x27e60,0x27b34,0x27ecc,0x38,0x27e60,0x27b38,0x27ecc,0x3c,0x27e60,0x27b3c
.long 0x27ecc,0x40,0x27e50,0x27b40,0x27ecc,0x44,0x27e54,0x27b44,0x27ecc,0x48,0x27e58,0x27b48,0x27ecc,0x4c,0x27e5c,0x27b4c
.long 0x27ecc,0x50,0x27e60,0x27b50,0x27ecc,0x54,0x27e60,0x27b54,0x27ecc,0x58,0x27e60,0x27b58,0x27ecc,0x5c,0x27e60,0x27b5c
.long 0x27ecc,0x60,0x27e50,0x27b60,0x27ecc,0x64,0x27e54,0x27b64,0x27ecc,0x68,0x27e58,0x27b68,0x27ecc,0x6c,0x27e5c,0x27b6c
.long 0x27ecc,0x70,0x27e60,0x27b70,0x27ecc,0x74,0x27e60,0x27b74,0x27ecc,0x78,0x27e60,0x27b78,0x27ecc,0x7c,0x27e60,0x27b7c
.long 0x27ecc,0x0,0x27e50,0x27b80,0x27ecc,0x4,0x27e54,0x27b84,0x27ecc,0x8,0x27e58,0x27b88,0x27ecc,0xc,0x27e5c,0x27b8c
.long 0x27ecc,0x10,0x27e60,0x27b90,0x27ecc,0x14,0x27e60,0x27b94,0x27ecc,0x18,0x27e60,0x27b98,0x27ecc,0x1c,0x27e60,0x27b9c
.long 0x27ecc,0x20,0x27e50,0x27ba0,0x27ecc,0x24,0x27e54,0x27ba4,0x27ecc,0x28,0x27e58,0x27ba8,0x27ecc,0x2c,0x27e5c,0x27bac
.long 0x27ecc,0x30,0x27e60,0x27bb0,0x27ecc,0x34,0x27e60,0x27bb4,0x27ecc,0x38,0x27e60,0x27bb8,0x27ecc,0x3c,0x27e60,0x27bbc
.long 0x27ecc,0x40,0x27e50,0x27bc0,0x27ecc,0x44,0x27e54,0x27bc4,0x27ecc,0x48,0x27e58,0x27bc8,0x27ecc,0x4c,0x27e5c,0x27bcc
.long 0x27ecc,0x50,0x27e60,0x27bd0,0x27ecc,0x54,0x27e60,0x27bd4,0x27ecc,0x58,0x27e60,0x27bd8,0x27ecc,0x5c,0x27e60,0x27bdc
.long 0x27ecc,0x60,0x27e50,0x27be0,0x27ecc,0x64,0x27e54,0x27be4,0x27ecc,0x68,0x27e58,0x27be8,0x27ecc,0x6c,0x27e5c,0x27bec
.long 0x27ecc,0x70,0x27e60,0x27bf0,0x27ecc,0x74,0x27e60,0x27bf4,0x27ecc,0x78,0x27e60,0x27bf8,0x27ecc,0x7c,0x27e60,0x27bfc
.long 0x0,0x27ed0,0x24d00,0x24d00,0x10,0x27ed4,0x24d28,0x24d28,0x20,0x27ed8,0x24d50,0x24d50,0x30,0x27edc,0x24d78,0x24d78
.long 0x80,0x27ed0,0x24da0,0x24da0,0x90,0x27ed4,0x24dc8,0x24dc8,0xa0,0x27ed8,0x24df0,0x24df0,0xb0,0x27edc,0x24e18,0x24e18
.long 0x40,0x27ed0,0x24e40,0x24e40,0x50,0x27ed4,0x24e68,0x24e68,0x60,0x27ed8,0x24e90,0x24e90,0x70,0x27edc,0x24eb8,0x24eb8
.long 0xc0,0x27ed0,0x24ee0,0x24ee0,0xd0,0x27ed4,0x24f08,0x24f08,0xe0,0x27ed8,0x24f30,0x24f30,0xf0,0x27edc,0x24f58,0x24f58
.long 0x100,0x27ed0,0x24f80,0x24f80,0x110,0x27ed4,0x24fa8,0x24fa8,0x120,0x27ed8,0x24fd0,0x24fd0,0x130,0x27edc,0x24ff8,0x24ff8
.long 0x40000,0x27ed0,0x25020,0x25020,0x40000,0x27ed4,0x25048,0x25048,0x40000,0x27ed8,0x25070,0x25070,0x40000,0x27edc,0x25098,0x25098
.long 0x140,0x27ed0,0x250c0,0x250c0,0x40000,0x27ed4,0x250e8,0x250e8,0x40000,0x27ed8,0x25110,0x25110,0x40000,0x27edc,0x25138,0x25138
.long 0x140,0x27ed0,0x25160,0x25160,0x40000,0x27ed4,0x25188,0x25188,0x40000,0x27ed8,0x251b0,0x251b0,0x40000,0x27edc,0x251d8,0x251d8
.long 0x150,0x27ec0,0x24d10,0x64d00,0x160,0x27ec4,0x24d38,0x64d28,0x170,0x27ec8,0x24d60,0x64d50,0x180,0x27ecc,0x24d88,0x64d78
.long 0x1d0,0x27ec0,0x24db0,0x64da0,0x1e0,0x27ec4,0x24dd8,0x64dc8,0x1f0,0x27ec8,0x24e00,0x64df0,0x200,0x27ecc,0x24e28,0x64e18
.long 0x190,0x27ec0,0x24e50,0x64e40,0x1a0,0x27ec4,0x24e78,0x64e68,0x1b0,0x27ec8,0x24ea0,0x64e90,0x1c0,0x27ecc,0x24ec8,0x64eb8
.long 0x210,0x27ec0,0x24ef0,0x64ee0,0x220,0x27ec4,0x24f18,0x64f08,0x230,0x27ec8,0x24f40,0x64f30,0x240,0x27ecc,0x24f68,0x64f58
.long 0x250,0x27ec0,0x24f90,0x64f80,0x260,0x27ec4,0x24fb8,0x64fa8,0x270,0x27ec8,0x24fe0,0x64fd0,0x280,0x27ecc,0x25008,0x64ff8
.long 0x40150,0x27ec0,0x25030,0x65020,0x40150,0x27ec4,0x25058,0x65048,0x40150,0x27ec8,0x25080,0x65070,0x40150,0x27ecc,0x250a8,0x65098
.long 0x290,0x27ec0,0x250d0,0x650c0,0x40150,0x27ec4,0x250f8,0x650e8,0x40150,0x27ec8,0x25120,0x65110,0x40150,0x27ecc,0x25148,0x65138
.long 0x290,0x27ec0,0x25170,0x65160,0x40150,0x27ec4,0x25198,0x65188,0x40150,0x27ec8,0x251c0,0x651b0,0x40150,0x27ecc,0x251e8,0x651d8
.long 0x27ed0,0x80,0x27e70,0x27500,0x27ed0,0x84,0x27e74,0x27504,0x27ed0,0x88,0x27e78,0x27508,0x27ed0,0x8c,0x27e7c,0x2750c
.long 0x27ed0,0x90,0x27e70,0x27510,0x27ed0,0x94,0x27e74,0x27514,0x27ed0,0x98,0x27e78,0x27518,0x27ed0,0x9c,0x27e7c,0x2751c
.long 0x27ed0,0xa0,0x27e70,0x27520,0x27ed0,0xa4,0x27e74,0x27524,0x27ed0,0xa8,0x27e78,0x27528,0x27ed0,0xac,0x27e7c,0x2752c
.long 0x27ed0,0xb0,0x27e70,0x27530,0x27ed0,0xb4,0x27e74,0x27534,0x27ed0,0xb8,0x27e78,0x27538,0x27ed0,0xbc,0x27e7c,0x2753c
.long 0x27ed0,0xc0,0x27e70,0x27540,0x27ed0,0xc4,0x27e74,0x27544,0x27ed0,0xc8,0x27e78,0x27548,0x27ed0,0xcc,0x27e7c,0x2754c
.long 0x27ed0,0xd0,0x27e70,0x27550,0x27ed0,0xd4,0x27e74,0x27554,0x27ed0,0xd8,0x27e78,0x27558,0x27ed0,0xdc,0x27e7c,0x2755c
.long 0x27ed0,0xe0,0x27e70,0x27560,0x27ed0,0xe4,0x27e74,0x27564,0x27ed0,0xe8,0x27e78,0x27568,0x27ed0,0xec,0x27e7c,0x2756c
.long 0x27ed0,0xf0,0x27e70,0x27570,0x27ed0,0xf4,0x27e74,0x27574,0x27ed0,0xf8,0x27e78,0x27578,0x27ed0,0xfc,0x27e7c,0x2757c
.long 0x27ed0,0x80,0x27e80,0x27580,0x27ed0,0x84,0x27e80,0x27584,0x27ed0,0x88,0x27e80,0x27588,0x27ed0,0x8c,0x27e80,0x2758c
.long 0x27ed0,0x90,0x27e80,0x27590,0x27ed0,0x94,0x27e80,0x27594,0x27ed0,0x98,0x27e80,0x27598,0x27ed0,0x9c,0x27e80,0x2759c
.long 0x27ed0,0xa0,0x27e80,0x275a0,0x27ed0,0xa4,0x27e80,0x275a4,0x27ed0,0xa8,0x27e80,0x275a8,0x27ed0,0xac,0x27e80,0x275ac
.long 0x27ed0,0xb0,0x27e80,0x275b0,0x27ed0,0xb4,0x27e80,0x275b4,0x27ed0,0xb8,0x27e80,0x275b8,0x27ed0,0xbc,0x27e80,0x275bc
.long 0x27ed0,0xc0,0x27e80,0x275c0,0x27ed0,0xc4,0x27e80,0x275c4,0x27ed0,0xc8,0x27e80,0x275c8,0x27ed0,0xcc,0x27e80,0x275cc
.long 0x27ed0,0xd0,0x27e80,0x275d0,0x27ed0,0xd4,0x27e80,0x275d4,0x27ed0,0xd8,0x27e80,0x275d8,0x27ed0,0xdc,0x27e80,0x275dc
.long 0x27ed0,0xe0,0x27e80,0x275e0,0x27ed0,0xe4,0x27e80,0x275e4,0x27ed0,0xe8,0x27e80,0x275e8,0x27ed0,0xec,0x27e80,0x275ec
.long 0x27ed0,0xf0,0x27e80,0x275f0,0x27ed0,0xf4,0x27e80,0x275f4,0x27ed0,0xf8,0x27e80,0x275f8,0x27ed0,0xfc,0x27e80,0x275fc
.long 0x40,0x27ed0,0x25700,0x25700,0x50,0x27ed4,0x25728,0x25728,0x60,0x27ed8,0x25750,0x25750,0x70,0x27edc,0x25778,0x25778
.long 0xc0,0x27ed0,0x257a0,0x257a0,0xd0,0x27ed4,0x257c8,0x257c8,0xe0,0x27ed8,0x257f0,0x257f0,0xf0,0x27edc,0x25818,0x25818
.long 0x80,0x27ed0,0x25840,0x25840,0x90,0x27ed4,0x25868,0x25868,0xa0,0x27ed8,0x25890,0x25890,0xb0,0x27edc,0x258b8,0x258b8
.long 0x100,0x27ed0,0x258e0,0x258e0,0x110,0x27ed4,0x25908,0x25908,0x120,0x27ed8,0x25930,0x25930,0x130,0x27edc,0x25958,0x25958
.long 0x0,0x27ed0,0x25980,0x25980,0x10,0x27ed4,0x259a8,0x259a8,0x20,0x27ed8,0x259d0,0x259d0,0x30,0x27edc,0x259f8,0x259f8
.long 0x40000,0x27ed0,0x25a20,0x25a20,0x40000,0x27ed4,0x25a48,0x25a48,0x40000,0x27ed8,0x25a70,0x25a70,0x40000,0x27edc,0x25a98,0x25a98
.long 0x140,0x27ed0,0x25ac0,0x25ac0,0x40000,0x27ed4,0x25ae8,0x25ae8,0x40000,0x27ed8,0x25b10,0x25b10,0x40000,0x27edc,0x25b38,0x25b38
.long 0x140,0x27ed0,0x25b60,0x25b60,0x40000,0x27ed4,0x25b88,0x25b88,0x40000,0x27ed8,0x25bb0,0x25bb0,0x40000,0x27edc,0x25bd8,0x25bd8
.long 0x190,0x27ec0,0x25710,0x65700,0x1a0,0x27ec4,0x25738,0x65728,0x1b0,0x27ec8,0x25760,0x65750,0x1c0,0x27ecc,0x25788,0x65778
.long 0x210,0x27ec0,0x257b0,0x657a0,0x220,0x27ec4,0x257d8,0x657c8,0x230,0x27ec8,0x25800,0x657f0,0x240,0x27ecc,0x25828,0x65818
.long 0x1d0,0x27ec0,0x25850,0x65840,0x1e0,0x27ec4,0x25878,0x65868,0x1f0,0x27ec8,0x258a0,0x65890,0x200,0x27ecc,0x258c8,0x658b8
.long 0x250,0x27ec0,0x258f0,0x658e0,0x260,0x27ec4,0x25918,0x65908,0x270,0x27ec8,0x25940,0x65930,0x280,0x27ecc,0x25968,0x65958
.long 0x150,0x27ec0,0x25990,0x65980,0x160,0x27ec4,0x259b8,0x659a8,0x170,0x27ec8,0x259e0,0x659d0,0x180,0x27ecc,0x25a08,0x659f8
.long 0x40150,0x27ec0,0x25a30,0x65a20,0x40150,0x27ec4,0x25a58,0x65a48,0x40150,0x27ec8,0x25a80,0x65a70,0x40150,0x27ecc,0x25aa8,0x65a98
.long 0x290,0x27ec0,0x25ad0,0x65ac0,0x40150,0x27ec4,0x25af8,0x65ae8,0x40150,0x27ec8,0x25b20,0x65b10,0x40150,0x27ecc,0x25b48,0x65b38
.long 0x290,0x27ec0,0x25b70,0x65b60,0x40150,0x27ec4,0x25b98,0x65b88,0x40150,0x27ec8,0x25bc0,0x65bb0,0x40150,0x27ecc,0x25be8,0x65bd8
.long 0x27ed4,0x80,0x27e70,0x27700,0x27ed4,0x84,0x27e74,0x27704,0x27ed4,0x88,0x27e78,0x27708,0x27ed4,0x8c,0x27e7c,0x2770c
.long 0x27ed4,0x90,0x27e70,0x27710,0x27ed4,0x94,0x27e74,0x27714,0x27ed4,0x98,0x27e78,0x27718,0x27ed4,0x9c,0x27e7c,0x2771c
.long 0x27ed4,0xa0,0x27e70,0x27720,0x27ed4,0xa4,0x27e74,0x27724,0x27ed4,0xa8,0x27e78,0x27728,0x27ed4,0xac,0x27e7c,0x2772c
.long 0x27ed4,0xb0,0x27e70,0x27730,0x27ed4,0xb4,0x27e74,0x27734,0x27ed4,0xb8,0x27e78,0x27738,0x27ed4,0xbc,0x27e7c,0x2773c
.long 0x27ed4,0xc0,0x27e70,0x27740,0x27ed4,0xc4,0x27e74,0x27744,0x27ed4,0xc8,0x27e78,0x27748,0x27ed4,0xcc,0x27e7c,0x2774c
.long 0x27ed4,0xd0,0x27e70,0x27750,0x27ed4,0xd4,0x27e74,0x27754,0x27ed4,0xd8,0x27e78,0x27758,0x27ed4,0xdc,0x27e7c,0x2775c
.long 0x27ed4,0xe0,0x27e70,0x27760,0x27ed4,0xe4,0x27e74,0x27764,0x27ed4,0xe8,0x27e78,0x27768,0x27ed4,0xec,0x27e7c,0x2776c
.long 0x27ed4,0xf0,0x27e70,0x27770,0x27ed4,0xf4,0x27e74,0x27774,0x27ed4,0xf8,0x27e78,0x27778,0x27ed4,0xfc,0x27e7c,0x2777c
.long 0x27ed4,0x80,0x27e84,0x27780,0x27ed4,0x84,0x27e84,0x27784,0x27ed4,0x88,0x27e84,0x27788,0x27ed4,0x8c,0x27e84,0x2778c
.long 0x27ed4,0x90,0x27e84,0x27790,0x27ed4,0x94,0x27e84,0x27794,0x27ed4,0x98,0x27e84,0x27798,0x27ed4,0x9c,0x27e84,0x2779c
.long 0x27ed4,0xa0,0x27e84,0x277a0,0x27ed4,0xa4,0x27e84,0x277a4,0x27ed4,0xa8,0x27e84,0x277a8,0x27ed4,0xac,0x27e84,0x277ac
.long 0x27ed4,0xb0,0x27e84,0x277b0,0x27ed4,0xb4,0x27e84,0x277b4,0x27ed4,0xb8,0x27e84,0x277b8,0x27ed4,0xbc,0x27e84,0x277bc
.long 0x27ed4,0xc0,0x27e84,0x277c0,0x27ed4,0xc4,0x27e84,0x277c4,0x27ed4,0xc8,0x27e84,0x277c8,0x27ed4,0xcc,0x27e84,0x277cc
.long 0x27ed4,0xd0,0x27e84,0x277d0,0x27ed4,0xd4,0x27e84,0x277d4,0x27ed4,0xd8,0x27e84,0x277d8,0x27ed4,0xdc,0x27e84,0x277dc
.long 0x27ed4,0xe0,0x27e84,0x277e0,0x27ed4,0xe4,0x27e84,0x277e4,0x27ed4,0xe8,0x27e84,0x277e8,0x27ed4,0xec,0x27e84,0x277ec
.long 0x27ed4,0xf0,0x27e84,0x277f0,0x27ed4,0xf4,0x27e84,0x277f4,0x27ed4,0xf8,0x27e84,0x277f8,0x27ed4,0xfc,0x27e84,0x277fc
.long 0x0,0x27ed0,0x26100,0x26100,0x10,0x27ed4,0x26128,0x26128,0x20,0x27ed8,0x26150,0x26150,0x30,0x27edc,0x26178,0x26178
.long 0x80,0x27ed0,0x261a0,0x261a0,0x90,0x27ed4,0x261c8,0x261c8,0xa0,0x27ed8,0x261f0,0x261f0,0xb0,0x27edc,0x26218,0x26218
.long 0x40,0x27ed0,0x26240,0x26240,0x50,0x27ed4,0x26268,0x26268,0x60,0x27ed8,0x26290,0x26290,0x70,0x27edc,0x262b8,0x262b8
.long 0xc0,0x27ed0,0x262e0,0x262e0,0xd0,0x27ed4,0x26308,0x26308,0xe0,0x27ed8,0x26330,0x26330,0xf0,0x27edc,0x26358,0x26358
.long 0x100,0x27ed0,0x26380,0x26380,0x110,0x27ed4,0x263a8,0x263a8,0x120,0x27ed8,0x263d0,0x263d0,0x130,0x27edc,0x263f8,0x263f8
.long 0x40000,0x27ed0,0x26420,0x26420,0x40000,0x27ed4,0x26448,0x26448,0x40000,0x27ed8,0x26470,0x26470,0x40000,0x27edc,0x26498,0x26498
.long 0x140,0x27ed0,0x264c0,0x264c0,0x40000,0x27ed4,0x264e8,0x264e8,0x40000,0x27ed8,0x26510,0x26510,0x40000,0x27edc,0x26538,0x26538
.long 0x140,0x27ed0,0x26560,0x26560,0x40000,0x27ed4,0x26588,0x26588,0x40000,0x27ed8,0x265b0,0x265b0,0x40000,0x27edc,0x265d8,0x265d8
.long 0x150,0x27ec0,0x26110,0x66100,0x160,0x27ec4,0x26138,0x66128,0x170,0x27ec8,0x26160,0x66150,0x180,0x27ecc,0x26188,0x66178
.long 0x1d0,0x27ec0,0x261b0,0x661a0,0x1e0,0x27ec4,0x261d8,0x661c8,0x1f0,0x27ec8,0x26200,0x661f0,0x200,0x27ecc,0x26228,0x66218
.long 0x190,0x27ec0,0x26250,0x66240,0x1a0,0x27ec4,0x26278,0x66268,0x1b0,0x27ec8,0x262a0,0x66290,0x1c0,0x27ecc,0x262c8,0x662b8
.long 0x210,0x27ec0,0x262f0,0x662e0,0x220,0x27ec4,0x26318,0x66308,0x230,0x27ec8,0x26340,0x66330,0x240,0x27ecc,0x26368,0x66358
.long 0x250,0x27ec0,0x26390,0x66380,0x260,0x27ec4,0x263b8,0x663a8,0x270,0x27ec8,0x263e0,0x663d0,0x280,0x27ecc,0x26408,0x663f8
.long 0x40150,0x27ec0,0x26430,0x66420,0x40150,0x27ec4,0x26458,0x66448,0x40150,0x27ec8,0x26480,0x66470,0x40150,0x27ecc,0x264a8,0x66498
.long 0x290,0x27ec0,0x264d0,0x664c0,0x40150,0x27ec4,0x264f8,0x664e8,0x40150,0x27ec8,0x26520,0x66510,0x40150,0x27ecc,0x26548,0x66538
.long 0x290,0x27ec0,0x26570,0x66560,0x40150,0x27ec4,0x26598,0x66588,0x40150,0x27ec8,0x265c0,0x665b0,0x40150,0x27ecc,0x265e8,0x665d8
.long 0x27ed8,0x80,0x27e70,0x27900,0x27ed8,0x84,0x27e74,0x27904,0x27ed8,0x88,0x27e78,0x27908,0x27ed8,0x8c,0x27e7c,0x2790c
.long 0x27ed8,0x90,0x27e70,0x27910,0x27ed8,0x94,0x27e74,0x27914,0x27ed8,0x98,0x27e78,0x27918,0x27ed8,0x9c,0x27e7c,0x2791c
.long 0x27ed8,0xa0,0x27e70,0x27920,0x27ed8,0xa4,0x27e74,0x27924,0x27ed8,0xa8,0x27e78,0x27928,0x27ed8,0xac,0x27e7c,0x2792c
.long 0x27ed8,0xb0,0x27e70,0x27930,0x27ed8,0xb4,0x27e74,0x27934,0x27ed8,0xb8,0x27e78,0x27938,0x27ed8,0xbc,0x27e7c,0x2793c
.long 0x27ed8,0xc0,0x27e70,0x27940,0x27ed8,0xc4,0x27e74,0x27944,0x27ed8,0xc8,0x27e78,0x27948,0x27ed8,0xcc,0x27e7c,0x2794c
.long 0x27ed8,0xd0,0x27e70,0x27950,0x27ed8,0xd4,0x27e74,0x27954,0x27ed8,0xd8,0x27e78,0x27958,0x27ed8,0xdc,0x27e7c,0x2795c
.long 0x27ed8,0xe0,0x27e70,0x27960,0x27ed8,0xe4,0x27e74,0x27964,0x27ed8,0xe8,0x27e78,0x27968,0x27ed8,0xec,0x27e7c,0x2796c
.long 0x27ed8,0xf0,0x27e70,0x27970,0x27ed8,0xf4,0x27e74,0x27974,0x27ed8,0xf8,0x27e78,0x27978,0x27ed8,0xfc,0x27e7c,0x2797c
.long 0x27ed8,0x80,0x27e88,0x27980,0x27ed8,0x84,0x27e88,0x27984,0x27ed8,0x88,0x27e88,0x27988,0x27ed8,0x8c,0x27e88,0x2798c
.long 0x27ed8,0x90,0x27e88,0x27990,0x27ed8,0x94,0x27e88,0x27994,0x27ed8,0x98,0x27e88,0x27998,0x27ed8,0x9c,0x27e88,0x2799c
.long 0x27ed8,0xa0,0x27e88,0x279a0,0x27ed8,0xa4,0x27e88,0x279a4,0x27ed8,0xa8,0x27e88,0x279a8,0x27ed8,0xac,0x27e88,0x279ac
.long 0x27ed8,0xb0,0x27e88,0x279b0,0x27ed8,0xb4,0x27e88,0x279b4,0x27ed8,0xb8,0x27e88,0x279b8,0x27ed8,0xbc,0x27e88,0x279bc
.long 0x27ed8,0xc0,0x27e88,0x279c0,0x27ed8,0xc4,0x27e88,0x279c4,0x27ed8,0xc8,0x27e88,0x279c8,0x27ed8,0xcc,0x27e88,0x279cc
.long 0x27ed8,0xd0,0x27e88,0x279d0,0x27ed8,0xd4,0x27e88,0x279d4,0x27ed8,0xd8,0x27e88,0x279d8,0x27ed8,0xdc,0x27e88,0x279dc
.long 0x27ed8,0xe0,0x27e88,0x279e0,0x27ed8,0xe4,0x27e88,0x279e4,0x27ed8,0xe8,0x27e88,0x279e8,0x27ed8,0xec,0x27e88,0x279ec
.long 0x27ed8,0xf0,0x27e88,0x279f0,0x27ed8,0xf4,0x27e88,0x279f4,0x27ed8,0xf8,0x27e88,0x279f8,0x27ed8,0xfc,0x27e88,0x279fc
.long 0x40,0x27ed0,0x26b00,0x26b00,0x50,0x27ed4,0x26b28,0x26b28,0x60,0x27ed8,0x26b50,0x26b50,0x70,0x27edc,0x26b78,0x26b78
.long 0xc0,0x27ed0,0x26ba0,0x26ba0,0xd0,0x27ed4,0x26bc8,0x26bc8,0xe0,0x27ed8,0x26bf0,0x26bf0,0xf0,0x27edc,0x26c18,0x26c18
.long 0x80,0x27ed0,0x26c40,0x26c40,0x90,0x27ed4,0x26c68,0x26c68,0xa0,0x27ed8,0x26c90,0x26c90,0xb0,0x27edc,0x26cb8,0x26cb8
.long 0x100,0x27ed0,0x26ce0,0x26ce0,0x110,0x27ed4,0x26d08,0x26d08,0x120,0x27ed8,0x26d30,0x26d30,0x130,0x27edc,0x26d58,0x26d58
.long 0x0,0x27ed0,0x26d80,0x26d80,0x10,0x27ed4,0x26da8,0x26da8,0x20,0x27ed8,0x26dd0,0x26dd0,0x30,0x27edc,0x26df8,0x26df8
.long 0x40000,0x27ed0,0x26e20,0x26e20,0x40000,0x27ed4,0x26e48,0x26e48,0x40000,0x27ed8,0x26e70,0x26e70,0x40000,0x27edc,0x26e98,0x26e98
.long 0x140,0x27ed0,0x26ec0,0x26ec0,0x40000,0x27ed4,0x26ee8,0x26ee8,0x40000,0x27ed8,0x26f10,0x26f10,0x40000,0x27edc,0x26f38,0x26f38
.long 0x140,0x27ed0,0x26f60,0x26f60,0x40000,0x27ed4,0x26f88,0x26f88,0x40000,0x27ed8,0x26fb0,0x26fb0,0x40000,0x27edc,0x26fd8,0x26fd8
.long 0x190,0x27ec0,0x26b10,0x66b00,0x1a0,0x27ec4,0x26b38,0x66b28,0x1b0,0x27ec8,0x26b60,0x66b50,0x1c0,0x27ecc,0x26b88,0x66b78
.long 0x210,0x27ec0,0x26bb0,0x66ba0,0x220,0x27ec4,0x26bd8,0x66bc8,0x230,0x27ec8,0x26c00,0x66bf0,0x240,0x27ecc,0x26c28,0x66c18
.long 0x1d0,0x27ec0,0x26c50,0x66c40,0x1e0,0x27ec4,0x26c78,0x66c68,0x1f0,0x27ec8,0x26ca0,0x66c90,0x200,0x27ecc,0x26cc8,0x66cb8
.long 0x250,0x27ec0,0x26cf0,0x66ce0,0x260,0x27ec4,0x26d18,0x66d08,0x270,0x27ec8,0x26d40,0x66d30,0x280,0x27ecc,0x26d68,0x66d58
.long 0x150,0x27ec0,0x26d90,0x66d80,0x160,0x27ec4,0x26db8,0x66da8,0x170,0x27ec8,0x26de0,0x66dd0,0x180,0x27ecc,0x26e08,0x66df8
.long 0x40150,0x27ec0,0x26e30,0x66e20,0x40150,0x27ec4,0x26e58,0x66e48,0x40150,0x27ec8,0x26e80,0x66e70,0x40150,0x27ecc,0x26ea8,0x66e98
.long 0x290,0x27ec0,0x26ed0,0x66ec0,0x40150,0x27ec4,0x26ef8,0x66ee8,0x40150,0x27ec8,0x26f20,0x66f10,0x40150,0x27ecc,0x26f48,0x66f38
.long 0x290,0x27ec0,0x26f70,0x66f60,0x40150,0x27ec4,0x26f98,0x66f88,0x40150,0x27ec8,0x26fc0,0x66fb0,0x40150,0x27ecc,0x26fe8,0x66fd8
.long 0x27edc,0x80,0x27e70,0x27b00,0x27edc,0x84,0x27e74,0x27b04,0x27edc,0x88,0x27e78,0x27b08,0x27edc,0x8c,0x27e7c,0x27b0c
.long 0x27edc,0x90,0x27e70,0x27b10,0x27edc,0x94,0x27e74,0x27b14,0x27edc,0x98,0x27e78,0x27b18,0x27edc,0x9c,0x27e7c,0x27b1c
.long 0x27edc,0xa0,0x27e70,0x27b20,0x27edc,0xa4,0x27e74,0x27b24,0x27edc,0xa8,0x27e78,0x27b28,0x27edc,0xac,0x27e7c,0x27b2c
.long 0x27edc,0xb0,0x27e70,0x27b30,0x27edc,0xb4,0x27e74,0x27b34,0x27edc,0xb8,0x27e78,0x27b38,0x27edc,0xbc,0x27e7c,0x27b3c
.long 0x27edc,0xc0,0x27e70,0x27b40,0x27edc,0xc4,0x27e74,0x27b44,0x27edc,0xc8,0x27e78,0x27b48,0x27edc,0xcc,0x27e7c,0x27b4c
.long 0x27edc,0xd0,0x27e70,0x27b50,0x27edc,0xd4,0x27e74,0x27b54,0x27edc,0xd8,0x27e78,0x27b58,0x27edc,0xdc,0x27e7c,0x27b5c
.long 0x27edc,0xe0,0x27e70,0x27b60,0x27edc,0xe4,0x27e74,0x27b64,0x27edc,0xe8,0x27e78,0x27b68,0x27edc,0xec,0x27e7c,0x27b6c
.long 0x27edc,0xf0,0x27e70,0x27b70,0x27edc,0xf4,0x27e74,0x27b74,0x27edc,0xf8,0x27e78,0x27b78,0x27edc,0xfc,0x27e7c,0x27b7c
.long 0x27edc,0x80,0x27e8c,0x27b80,0x27edc,0x84,0x27e8c,0x27b84,0x27edc,0x88,0x27e8c,0x27b88,0x27edc,0x8c,0x27e8c,0x27b8c
.long 0x27edc,0x90,0x27e8c,0x27b90,0x27edc,0x94,0x27e8c,0x27b94,0x27edc,0x98,0x27e8c,0x27b98,0x27edc,0x9c,0x27e8c,0x27b9c
.long 0x27edc,0xa0,0x27e8c,0x27ba0,0x27edc,0xa4,0x27e8c,0x27ba4,0x27edc,0xa8,0x27e8c,0x27ba8,0x27edc,0xac,0x27e8c,0x27bac
.long 0x27edc,0xb0,0x27e8c,0x27bb0,0x27edc,0xb4,0x27e8c,0x27bb4,0x27edc,0xb8,0x27e8c,0x27bb8,0x27edc,0xbc,0x27e8c,0x27bbc
.long 0x27edc,0xc0,0x27e8c,0x27bc0,0x27edc,0xc4,0x27e8c,0x27bc4,0x27edc,0xc8,0x27e8c,0x27bc8,0x27edc,0xcc,0x27e8c,0x27bcc
.long 0x27edc,0xd0,0x27e8c,0x27bd0,0x27edc,0xd4,0x27e8c,0x27bd4,0x27edc,0xd8,0x27e8c,0x27bd8,0x27edc,0xdc,0x27e8c,0x27bdc
.long 0x27edc,0xe0,0x27e8c,0x27be0,0x27edc,0xe4,0x27e8c,0x27be4,0x27edc,0xe8,0x27e8c,0x27be8,0x27edc,0xec,0x27e8c,0x27bec
.long 0x27edc,0xf0,0x27e8c,0x27bf0,0x27edc,0xf4,0x27e8c,0x27bf4,0x27edc,0xf8,0x27e8c,0x27bf8,0x27edc,0xfc,0x27e8c,0x27bfc
.long 0x10300,0x10300,0x1fb00,0x22b00,0x10390,0x10310,0x1fb10,0x22b10,0x10420,0x10320,0x1fb20,0x22b20,0x104b0,0x10330,0x1fb30,0x22b30
.long 0x10540,0x10340,0x1fb40,0x22b40,0x105d0,0x10350,0x1fb50,0x22b50,0x10660,0x10360,0x1fb60,0x22b60,0x106f0,0x10370,0x1fb70,0x22b70
.long 0x10780,0x10390,0x1fb80,0x22b80,0x10810,0x103a0,0x1fb90,0x22b90,0x108a0,0x103b0,0x1fba0,0x22ba0,0x10930,0x103c0,0x1fbb0,0x22bb0
.long 0x109c0,0x103d0,0x1fbc0,0x22bc0,0x10a50,0x103e0,0x1fbd0,0x22bd0,0x10ae0,0x103f0,0x1fbe0,0x22be0,0x10b70,0x10400,0x1fbf0,0x22bf0
.long 0x10340,0x10420,0x1fc00,0x22c00,0x103d0,0x10430,0x1fc10,0x22c10,0x10460,0x10440,0x1fc20,0x22c20,0x104f0,0x10450,0x1fc30,0x22c30
.long 0x10580,0x10460,0x1fc40,0x22c40,0x10610,0x10470,0x1fc50,0x22c50,0x106a0,0x10480,0x1fc60,0x22c60,0x10730,0x10490,0x1fc70,0x22c70
.long 0x107c0,0x104b0,0x1fc80,0x22c80,0x10850,0x104c0,0x1fc90,0x22c90,0x108e0,0x104d0,0x1fca0,0x22ca0,0x10970,0x104e0,0x1fcb0,0x22cb0
.long 0x10a00,0x104f0,0x1fcc0,0x22cc0,0x10a90,0x10500,0x1fcd0,0x22cd0,0x10b20,0x10510,0x1fce0,0x22ce0,0x10bb0,0x10520,0x1fcf0,0x22cf0
.long 0x10308,0x10540,0x1fd00,0x22d00,0x10398,0x10550,0x1fd10,0x22d10,0x10428,0x10560,0x1fd20,0x22d20,0x104b8,0x10570,0x1fd30,0x22d30
.long 0x10548,0x10580,0x1fd40,0x22d40,0x105d8,0x10590,0x1fd50,0x22d50,0x10668,0x105a0,0x1fd60,0x22d60,0x106f8,0x105b0,0x1fd70,0x22d70
.long 0x10788,0x105d0,0x1fd80,0x22d80,0x10818,0x105e0,0x1fd90,0x22d90,0x108a8,0x105f0,0x1fda0,0x22da0,0x10938,0x10600,0x1fdb0,0x22db0
.long 0x109c8,0x10610,0x1fdc0,0x22dc0,0x10a58,0x10620,0x1fdd0,0x22dd0,0x10ae8,0x10630,0x1fde0,0x22de0,0x10b78,0x10640,0x1fdf0,0x22df0
.long 0x10348,0x10660,0x1fe00,0x22e00,0x103d8,0x10670,0x1fe10,0x22e10,0x10468,0x10680,0x1fe20,0x22e20,0x104f8,0x10690,0x1fe30,0x22e30
.long 0x10588,0x106a0,0x1fe40,0x22e40,0x10618,0x106b0,0x1fe50,0x22e50,0x106a8,0x106c0,0x1fe60,0x22e60,0x10738,0x106d0,0x1fe70,0x22e70
.long 0x107c8,0x106f0,0x1fe80,0x22e80,0x10858,0x10700,0x1fe90,0x22e90,0x108e8,0x10710,0x1fea0,0x22ea0,0x10978,0x10720,0x1feb0,0x22eb0
.long 0x10a08,0x10730,0x1fec0,0x22ec0,0x10a98,0x10740,0x1fed0,0x22ed0,0x10b28,0x10750,0x1fee0,0x22ee0,0x10bb8,0x10760,0x1fef0,0x22ef0
.long 0x26000,0x26400,0x0,0x800,0x26004,0x26404,0x10,0x810,0x26008,0x26408,0x20,0x820,0x2600c,0x2640c,0x30,0x830
.long 0x26010,0x26410,0x40,0x840,0x26014,0x26414,0x50,0x850,0x26018,0x26418,0x60,0x860,0x2601c,0x2641c,0x70,0x870
.long 0x26020,0x26420,0x80,0x880,0x26024,0x26424,0x90,0x890,0x26028,0x26428,0xa0,0x8a0,0x2602c,0x2642c,0xb0,0x8b0
.long 0x26030,0x26430,0xc0,0x8c0,0x26034,0x26434,0xd0,0x8d0,0x26038,0x26438,0xe0,0x8e0,0x2603c,0x2643c,0xf0,0x8f0
.long 0x26040,0x26440,0x100,0x900,0x26044,0x26444,0x110,0x910,0x26048,0x26448,0x120,0x920,0x2604c,0x2644c,0x130,0x930
.long 0x26050,0x26450,0x140,0x940,0x26054,0x26454,0x150,0x950,0x26058,0x26458,0x160,0x960,0x2605c,0x2645c,0x170,0x970
.long 0x26060,0x26460,0x180,0x980,0x26064,0x26464,0x190,0x990,0x26068,0x26468,0x1a0,0x9a0,0x2606c,0x2646c,0x1b0,0x9b0
.long 0x26070,0x26470,0x1c0,0x9c0,0x26074,0x26474,0x1d0,0x9d0,0x26078,0x26478,0x1e0,0x9e0,0x2607c,0x2647c,0x1f0,0x9f0
.long 0x26080,0x26480,0x400,0x40000800,0x26084,0x26484,0x410,0x40000810,0x26088,0x26488,0x420,0x40000820,0x2608c,0x2648c,0x430,0x40000830
.long 0x26090,0x26490,0x440,0x40000840,0x26094,0x26494,0x450,0x40000850,0x26098,0x26498,0x460,0x40000860,0x2609c,0x2649c,0x470,0x40000870
.long 0x260a0,0x264a0,0x480,0x40000880,0x260a4,0x264a4,0x490,0x40000890,0x260a8,0x264a8,0x4a0,0x400008a0,0x260ac,0x264ac,0x4b0,0x400008b0
.long 0x260b0,0x264b0,0x4c0,0x400008c0,0x260b4,0x264b4,0x4d0,0x400008d0,0x260b8,0x264b8,0x4e0,0x400008e0,0x260bc,0x264bc,0x4f0,0x400008f0
.long 0x260c0,0x264c0,0x500,0x40000900,0x260c4,0x264c4,0x510,0x40000910,0x260c8,0x264c8,0x520,0x40000920,0x260cc,0x264cc,0x530,0x40000930
.long 0x260d0,0x264d0,0x540,0x40000940,0x260d4,0x264d4,0x550,0x40000950,0x260d8,0x264d8,0x560,0x40000960,0x260dc,0x264dc,0x570,0x40000970
.long 0x260e0,0x264e0,0x580,0x40000980,0x260e4,0x264e4,0x590,0x40000990,0x260e8,0x264e8,0x5a0,0x400009a0,0x260ec,0x264ec,0x5b0,0x400009b0
.long 0x260f0,0x264f0,0x5c0,0x400009c0,0x260f4,0x264f4,0x5d0,0x400009d0,0x260f8,0x264f8,0x5e0,0x400009e0,0x260fc,0x264fc,0x5f0,0x400009f0
.long 0x10c00,0x10c00,0x20700,0x23700,0x10c90,0x10c10,0x20710,0x23710,0x10d20,0x10c20,0x20720,0x23720,0x10db0,0x10c30,0x20730,0x23730
.long 0x10e40,0x10c40,0x20740,0x23740,0x10ed0,0x10c50,0x20750,0x23750,0x10f60,0x10c60,0x20760,0x23760,0x10ff0,0x10c70,0x20770,0x23770
.long 0x11080,0x10c90,0x20780,0x23780,0x11110,0x10ca0,0x20790,0x23790,0x111a0,0x10cb0,0x207a0,0x237a0,0x11230,0x10cc0,0x207b0,0x237b0
.long 0x112c0,0x10cd0,0x207c0,0x237c0,0x11350,0x10ce0,0x207d0,0x237d0,0x113e0,0x10cf0,0x207e0,0x237e0,0x11470,0x10d00,0x207f0,0x237f0
.long 0x10c40,0x10d20,0x20800,0x23800,0x10cd0,0x10d30,0x20810,0x23810,0x10d60,0x10d40,0x20820,0x23820,0x10df0,0x10d50,0x20830,0x23830
.long 0x10e80,0x10d60,0x20840,0x23840,0x10f10,0x10d70,0x20850,0x23850,0x10fa0,0x10d80,0x20860,0x23860,0x11030,0x10d90,0x20870,0x23870
.long 0x110c0,0x10db0,0x20880,0x23880,0x11150,0x10dc0,0x20890,0x23890,0x111e0,0x10dd0,0x208a0,0x238a0,0x11270,0x10de0,0x208b0,0x238b0
.long 0x11300,0x10df0,0x208c0,0x238c0,0x11390,0x10e00,0x208d0,0x238d0,0x11420,0x10e10,0x208e0,0x238e0,0x114b0,0x10e20,0x208f0,0x238f0
.long 0x10c08,0x10e40,0x20900,0x23900,0x10c98,0x10e50,0x20910,0x23910,0x10d28,0x10e60,0x20920,0x23920,0x10db8,0x10e70,0x20930,0x23930
.long 0x10e48,0x10e80,0x20940,0x23940,0x10ed8,0x10e90,0x20950,0x23950,0x10f68,0x10ea0,0x20960,0x23960,0x10ff8,0x10eb0,0x20970,0x23970
.long 0x11088,0x10ed0,0x20980,0x23980,0x11118,0x10ee0,0x20990,0x23990,0x111a8,0x10ef0,0x209a0,0x239a0,0x11238,0x10f00,0x209b0,0x239b0
.long 0x112c8,0x10f10,0x209c0,0x239c0,0x11358,0x10f20,0x209d0,0x239d0,0x113e8,0x10f30,0x209e0,0x239e0,0x11478,0x10f40,0x209f0,0x239f0
.long 0x10c48,0x10f60,0x20a00,0x23a00,0x10cd8,0x10f70,0x20a10,0x23a10,0x10d68,0x10f80,0x20a20,0x23a20,0x10df8,0x10f90,0x20a30,0x23a30
.long 0x10e88,0x10fa0,0x20a40,0x23a40,0x10f18,0x10fb0,0x20a50,0x23a50,0x10fa8,0x10fc0,0x20a60,0x23a60,0x11038,0x10fd0,0x20a70,0x23a70
.long 0x110c8,0x10ff0,0x20a80,0x23a80,0x11158,0x11000,0x20a90,0x23a90,0x111e8,0x11010,0x20aa0,0x23aa0,0x11278,0x11020,0x20ab0,0x23ab0
.long 0x11308,0x11030,0x20ac0,0x23ac0,0x11398,0x11040,0x20ad0,0x23ad0,0x11428,0x11050,0x20ae0,0x23ae0,0x114b8,0x11060,0x20af0,0x23af0
.long 0x26100,0x26500,0xc00,0x808,0x26104,0x26504,0xc10,0x818,0x26108,0x26508,0xc20,0x828,0x2610c,0x2650c,0xc30,0x838
.long 0x26110,0x26510,0xc40,0x848,0x26114,0x26514,0xc50,0x858,0x26118,0x26518,0xc60,0x868,0x2611c,0x2651c,0xc70,0x878
.long 0x26120,0x26520,0xc80,0x888,0x26124,0x26524,0xc90,0x898,0x26128,0x26528,0xca0,0x8a8,0x2612c,0x2652c,0xcb0,0x8b8
.long 0x26130,0x26530,0xcc0,0x8c8,0x26134,0x26534,0xcd0,0x8d8,0x26138,0x26538,0xce0,0x8e8,0x2613c,0x2653c,0xcf0,0x8f8
.long 0x26140,0x26540,0xd00,0x908,0x26144,0x26544,0xd10,0x918,0x26148,0x26548,0xd20,0x928,0x2614c,0x2654c,0xd30,0x938
.long 0x26150,0x26550,0xd40,0x948,0x26154,0x26554,0xd50,0x958,0x26158,0x26558,0xd60,0x968,0x2615c,0x2655c,0xd70,0x978
.long 0x26160,0x26560,0xd80,0x988,0x26164,0x26564,0xd90,0x998,0x26168,0x26568,0xda0,0x9a8,0x2616c,0x2656c,0xdb0,0x9b8
.long 0x26170,0x26570,0xdc0,0x9c8,0x26174,0x26574,0xdd0,0x9d8,0x26178,0x26578,0xde0,0x9e8,0x2617c,0x2657c,0xdf0,0x9f8
.long 0x26180,0x26580,0x1000,0x40000808,0x26184,0x26584,0x1010,0x40000818,0x26188,0x26588,0x1020,0x40000828,0x2618c,0x2658c,0x1030,0x40000838
.long 0x26190,0x26590,0x1040,0x40000848,0x26194,0x26594,0x1050,0x40000858,0x26198,0x26598,0x1060,0x40000868,0x2619c,0x2659c,0x1070,0x40000878
.long 0x261a0,0x265a0,0x1080,0x40000888,0x261a4,0x265a4,0x1090,0x40000898,0x261a8,0x265a8,0x10a0,0x400008a8,0x261ac,0x265ac,0x10b0,0x400008b8
.long 0x261b0,0x265b0,0x10c0,0x400008c8,0x261b4,0x265b4,0x10d0,0x400008d8,0x261b8,0x265b8,0x10e0,0x400008e8,0x261bc,0x265bc,0x10f0,0x400008f8
.long 0x261c0,0x265c0,0x1100,0x40000908,0x261c4,0x265c4,0x1110,0x40000918,0x261c8,0x265c8,0x1120,0x40000928,0x261cc,0x265cc,0x1130,0x40000938
.long 0x261d0,0x265d0,0x1140,0x40000948,0x261d4,0x265d4,0x1150,0x40000958,0x261d8,0x265d8,0x1160,0x40000968,0x261dc,0x265dc,0x1170,0x40000978
.long 0x261e0,0x265e0,0x1180,0x40000988,0x261e4,0x265e4,0x1190,0x40000998,0x261e8,0x265e8,0x11a0,0x400009a8,0x261ec,0x265ec,0x11b0,0x400009b8
.long 0x261f0,0x265f0,0x11c0,0x400009c8,0x261f4,0x265f4,0x11d0,0x400009d8,0x261f8,0x265f8,0x11e0,0x400009e8,0x261fc,0x265fc,0x11f0,0x400009f8
.long 0x26b00,0x26b00,0x21300,0x24300,0x26b90,0x26b10,0x21310,0x24310,0x26c20,0x26b20,0x21320,0x24320,0x26cb0,0x26b30,0x21330,0x24330
.long 0x26d40,0x26b40,0x21340,0x24340,0x26dd0,0x26b50,0x21350,0x24350,0x26e60,0x26b60,0x21360,0x24360,0x26ef0,0x26b70,0x21370,0x24370
.long 0x26f80,0x26b90,0x21380,0x24380,0x27010,0x26ba0,0x21390,0x24390,0x270a0,0x26bb0,0x213a0,0x243a0,0x27130,0x26bc0,0x213b0,0x243b0
.long 0x271c0,0x26bd0,0x213c0,0x243c0,0x27250,0x26be0,0x213d0,0x243d0,0x272e0,0x26bf0,0x213e0,0x243e0,0x27370,0x26c00,0x213f0,0x243f0
.long 0x26b40,0x26c20,0x21400,0x24400,0x26bd0,0x26c30,0x21410,0x24410,0x26c60,0x26c40,0x21420,0x24420,0x26cf0,0x26c50,0x21430,0x24430
.long 0x26d80,0x26c60,0x21440,0x24440,0x26e10,0x26c70,0x21450,0x24450,0x26ea0,0x26c80,0x21460,0x24460,0x26f30,0x26c90,0x21470,0x24470
.long 0x26fc0,0x26cb0,0x21480,0x24480,0x27050,0x26cc0,0x21490,0x24490,0x270e0,0x26cd0,0x214a0,0x244a0,0x27170,0x26ce0,0x214b0,0x244b0
.long 0x27200,0x26cf0,0x214c0,0x244c0,0x27290,0x26d00,0x214d0,0x244d0,0x27320,0x26d10,0x214e0,0x244e0,0x273b0,0x26d20,0x214f0,0x244f0
.long 0x26b08,0x26d40,0x21500,0x24500,0x26b98,0x26d50,0x21510,0x24510,0x26c28,0x26d60,0x21520,0x24520,0x26cb8,0x26d70,0x21530,0x24530
.long 0x26d48,0x26d80,0x21540,0x24540,0x26dd8,0x26d90,0x21550,0x24550,0x26e68,0x26da0,0x21560,0x24560,0x26ef8,0x26db0,0x21570,0x24570
.long 0x26f88,0x26dd0,0x21580,0x24580,0x27018,0x26de0,0x21590,0x24590,0x270a8,0x26df0,0x215a0,0x245a0,0x27138,0x26e00,0x215b0,0x245b0
.long 0x271c8,0x26e10,0x215c0,0x245c0,0x27258,0x26e20,0x215d0,0x245d0,0x272e8,0x26e30,0x215e0,0x245e0,0x27378,0x26e40,0x215f0,0x245f0
.long 0x26b48,0x26e60,0x21600,0x24600,0x26bd8,0x26e70,0x21610,0x24610,0x26c68,0x26e80,0x21620,0x24620,0x26cf8,0x26e90,0x21630,0x24630
.long 0x26d88,0x26ea0,0x21640,0x24640,0x26e18,0x26eb0,0x21650,0x24650,0x26ea8,0x26ec0,0x21660,0x24660,0x26f38,0x26ed0,0x21670,0x24670
.long 0x26fc8,0x26ef0,0x21680,0x24680,0x27058,0x26f00,0x21690,0x24690,0x270e8,0x26f10,0x216a0,0x246a0,0x27178,0x26f20,0x216b0,0x246b0
.long 0x27208,0x26f30,0x216c0,0x246c0,0x27298,0x26f40,0x216d0,0x246d0,0x27328,0x26f50,0x216e0,0x246e0,0x273b8,0x26f60,0x216f0,0x246f0
.long 0x26200,0x26600,0x1400,0x1c00,0x26204,0x26604,0x1410,0x1c10,0x26208,0x26608,0x1420,0x1c20,0x2620c,0x2660c,0x1430,0x1c30
.long 0x26210,0x26610,0x1440,0x1c40,0x26214,0x26614,0x1450,0x1c50,0x26218,0x26618,0x1460,0x1c60,0x2621c,0x2661c,0x1470,0x1c70
.long 0x26220,0x26620,0x1480,0x1c80,0x26224,0x26624,0x1490,0x1c90,0x26228,0x26628,0x14a0,0x1ca0,0x2622c,0x2662c,0x14b0,0x1cb0
.long 0x26230,0x26630,0x14c0,0x1cc0,0x26234,0x26634,0x14d0,0x1cd0,0x26238,0x26638,0x14e0,0x1ce0,0x2623c,0x2663c,0x14f0,0x1cf0
.long 0x26240,0x26640,0x1500,0x1d00,0x26244,0x26644,0x1510,0x1d10,0x26248,0x26648,0x1520,0x1d20,0x2624c,0x2664c,0x1530,0x1d30
.long 0x26250,0x26650,0x1540,0x1d40,0x26254,0x26654,0x1550,0x1d50,0x26258,0x26658,0x1560,0x1d60,0x2625c,0x2665c,0x1570,0x1d70
.long 0x26260,0x26660,0x1580,0x1d80,0x26264,0x26664,0x1590,0x1d90,0x26268,0x26668,0x15a0,0x1da0,0x2626c,0x2666c,0x15b0,0x1db0
.long 0x26270,0x26670,0x15c0,0x1dc0,0x26274,0x26674,0x15d0,0x1dd0,0x26278,0x26678,0x15e0,0x1de0,0x2627c,0x2667c,0x15f0,0x1df0
.long 0x26280,0x26680,0x1800,0x40001c00,0x26284,0x26684,0x1810,0x40001c10,0x26288,0x26688,0x1820,0x40001c20,0x2628c,0x2668c,0x1830,0x40001c30
.long 0x26290,0x26690,0x1840,0x40001c40,0x26294,0x26694,0x1850,0x40001c50,0x26298,0x26698,0x1860,0x40001c60,0x2629c,0x2669c,0x1870,0x40001c70
.long 0x262a0,0x266a0,0x1880,0x40001c80,0x262a4,0x266a4,0x1890,0x40001c90,0x262a8,0x266a8,0x18a0,0x40001ca0,0x262ac,0x266ac,0x18b0,0x40001cb0
.long 0x262b0,0x266b0,0x18c0,0x40001cc0,0x262b4,0x266b4,0x18d0,0x40001cd0,0x262b8,0x266b8,0x18e0,0x40001ce0,0x262bc,0x266bc,0x18f0,0x40001cf0
.long 0x262c0,0x266c0,0x1900,0x40001d00,0x262c4,0x266c4,0x1910,0x40001d10,0x262c8,0x266c8,0x1920,0x40001d20,0x262cc,0x266cc,0x1930,0x40001d30
.long 0x262d0,0x266d0,0x1940,0x40001d40,0x262d4,0x266d4,0x1950,0x40001d50,0x262d8,0x266d8,0x1960,0x40001d60,0x262dc,0x266dc,0x1970,0x40001d70
.long 0x262e0,0x266e0,0x1980,0x40001d80,0x262e4,0x266e4,0x1990,0x40001d90,0x262e8,0x266e8,0x19a0,0x40001da0,0x262ec,0x266ec,0x19b0,0x40001db0
.long 0x262f0,0x266f0,0x19c0,0x40001dc0,0x262f4,0x266f4,0x19d0,0x40001dd0,0x262f8,0x266f8,0x19e0,0x40001de0,0x262fc,0x266fc,0x19f0,0x40001df0
.long 0x27400,0x27400,0x21f00,0x24f00,0x27490,0x27410,0x21f10,0x24f10,0x27520,0x27420,0x21f20,0x24f20,0x275b0,0x27430,0x21f30,0x24f30
.long 0x27640,0x27440,0x21f40,0x24f40,0x276d0,0x27450,0x21f50,0x24f50,0x27760,0x27460,0x21f60,0x24f60,0x277f0,0x27470,0x21f70,0x24f70
.long 0x27880,0x27490,0x21f80,0x24f80,0x27910,0x274a0,0x21f90,0x24f90,0x279a0,0x274b0,0x21fa0,0x24fa0,0x27a30,0x274c0,0x21fb0,0x24fb0
.long 0x27ac0,0x274d0,0x21fc0,0x24fc0,0x27b50,0x274e0,0x21fd0,0x24fd0,0x27be0,0x274f0,0x21fe0,0x24fe0,0x27c70,0x27500,0x21ff0,0x24ff0
.long 0x27440,0x27520,0x22000,0x25000,0x274d0,0x27530,0x22010,0x25010,0x27560,0x27540,0x22020,0x25020,0x275f0,0x27550,0x22030,0x25030
.long 0x27680,0x27560,0x22040,0x25040,0x27710,0x27570,0x22050,0x25050,0x277a0,0x27580,0x22060,0x25060,0x27830,0x27590,0x22070,0x25070
.long 0x278c0,0x275b0,0x22080,0x25080,0x27950,0x275c0,0x22090,0x25090,0x279e0,0x275d0,0x220a0,0x250a0,0x27a70,0x275e0,0x220b0,0x250b0
.long 0x27b00,0x275f0,0x220c0,0x250c0,0x27b90,0x27600,0x220d0,0x250d0,0x27c20,0x27610,0x220e0,0x250e0,0x27cb0,0x27620,0x220f0,0x250f0
.long 0x27408,0x27640,0x22100,0x25100,0x27498,0x27650,0x22110,0x25110,0x27528,0x27660,0x22120,0x25120,0x275b8,0x27670,0x22130,0x25130
.long 0x27648,0x27680,0x22140,0x25140,0x276d8,0x27690,0x22150,0x25150,0x27768,0x276a0,0x22160,0x25160,0x277f8,0x276b0,0x22170,0x25170
.long 0x27888,0x276d0,0x22180,0x25180,0x27918,0x276e0,0x22190,0x25190,0x279a8,0x276f0,0x221a0,0x251a0,0x27a38,0x27700,0x221b0,0x251b0
.long 0x27ac8,0x27710,0x221c0,0x251c0,0x27b58,0x27720,0x221d0,0x251d0,0x27be8,0x27730,0x221e0,0x251e0,0x27c78,0x27740,0x221f0,0x251f0
.long 0x27448,0x27760,0x22200,0x25200,0x274d8,0x27770,0x22210,0x25210,0x27568,0x27780,0x22220,0x25220,0x275f8,0x27790,0x22230,0x25230
.long 0x27688,0x277a0,0x22240,0x25240,0x27718,0x277b0,0x22250,0x25250,0x277a8,0x277c0,0x22260,0x25260,0x27838,0x277d0,0x22270,0x25270
.long 0x278c8,0x277f0,0x22280,0x25280,0x27958,0x27800,0x22290,0x25290,0x279e8,0x27810,0x222a0,0x252a0,0x27a78,0x27820,0x222b0,0x252b0
.long 0x27b08,0x27830,0x222c0,0x252c0,0x27b98,0x27840,0x222d0,0x252d0,0x27c28,0x27850,0x222e0,0x252e0,0x27cb8,0x27860,0x222f0,0x252f0
.long 0x26300,0x26700,0x2000,0x1c08,0x26304,0x26704,0x2010,0x1c18,0x26308,0x26708,0x2020,0x1c28,0x2630c,0x2670c,0x2030,0x1c38
.long 0x26310,0x26710,0x2040,0x1c48,0x26314,0x26714,0x2050,0x1c58,0x26318,0x26718,0x2060,0x1c68,0x2631c,0x2671c,0x2070,0x1c78
.long 0x26320,0x26720,0x2080,0x1c88,0x26324,0x26724,0x2090,0x1c98,0x26328,0x26728,0x20a0,0x1ca8,0x2632c,0x2672c,0x20b0,0x1cb8
.long 0x26330,0x26730,0x20c0,0x1cc8,0x26334,0x26734,0x20d0,0x1cd8,0x26338,0x26738,0x20e0,0x1ce8,0x2633c,0x2673c,0x20f0,0x1cf8
.long 0x26340,0x26740,0x2100,0x1d08,0x26344,0x26744,0x2110,0x1d18,0x26348,0x26748,0x2120,0x1d28,0x2634c,0x2674c,0x2130,0x1d38
.long 0x26350,0x26750,0x2140,0x1d48,0x26354,0x26754,0x2150,0x1d58,0x26358,0x26758,0x2160,0x1d68,0x2635c,0x2675c,0x2170,0x1d78
.long 0x26360,0x26760,0x2180,0x1d88,0x26364,0x26764,0x2190,0x1d98,0x26368,0x26768,0x21a0,0x1da8,0x2636c,0x2676c,0x21b0,0x1db8
.long 0x26370,0x26770,0x21c0,0x1dc8,0x26374,0x26774,0x21d0,0x1dd8,0x26378,0x26778,0x21e0,0x1de8,0x2637c,0x2677c,0x21f0,0x1df8
.long 0x26380,0x26780,0x2400,0x40001c08,0x26384,0x26784,0x2410,0x40001c18,0x26388,0x26788,0x2420,0x40001c28,0x2638c,0x2678c,0x2430,0x40001c38
.long 0x26390,0x26790,0x2440,0x40001c48,0x26394,0x26794,0x2450,0x40001c58,0x26398,0x26798,0x2460,0x40001c68,0x2639c,0x2679c,0x2470,0x40001c78
.long 0x263a0,0x267a0,0x2480,0x40001c88,0x263a4,0x267a4,0x2490,0x40001c98,0x263a8,0x267a8,0x24a0,0x40001ca8,0x263ac,0x267ac,0x24b0,0x40001cb8
.long 0x263b0,0x267b0,0x24c0,0x40001cc8,0x263b4,0x267b4,0x24d0,0x40001cd8,0x263b8,0x267b8,0x24e0,0x40001ce8,0x263bc,0x267bc,0x24f0,0x40001cf8
.long 0x263c0,0x267c0,0x2500,0x40001d08,0x263c4,0x267c4,0x2510,0x40001d18,0x263c8,0x267c8,0x2520,0x40001d28,0x263cc,0x267cc,0x2530,0x40001d38
.long 0x263d0,0x267d0,0x2540,0x40001d48,0x263d4,0x267d4,0x2550,0x40001d58,0x263d8,0x267d8,0x2560,0x40001d68,0x263dc,0x267dc,0x2570,0x40001d78
.long 0x263e0,0x267e0,0x2580,0x40001d88,0x263e4,0x267e4,0x2590,0x40001d98,0x263e8,0x267e8,0x25a0,0x40001da8,0x263ec,0x267ec,0x25b0,0x40001db8
.long 0x263f0,0x267f0,0x25c0,0x40001dc8,0x263f4,0x267f4,0x25d0,0x40001dd8,0x263f8,0x267f8,0x25e0,0x40001de8,0x263fc,0x267fc,0x25f0,0x40001df8
.long 0x10300,0x10300,0x22b00,0x1fb00,0x10390,0x10310,0x22b10,0x1fb10,0x10420,0x10320,0x22b20,0x1fb20,0x104b0,0x10330,0x22b30,0x1fb30
.long 0x10540,0x10340,0x22b40,0x1fb40,0x105d0,0x10350,0x22b50,0x1fb50,0x10660,0x10360,0x22b60,0x1fb60,0x106f0,0x10370,0x22b70,0x1fb70
.long 0x10780,0x10390,0x22b80,0x1fb80,0x10810,0x103a0,0x22b90,0x1fb90,0x108a0,0x103b0,0x22ba0,0x1fba0,0x10930,0x103c0,0x22bb0,0x1fbb0
.long 0x109c0,0x103d0,0x22bc0,0x1fbc0,0x10a50,0x103e0,0x22bd0,0x1fbd0,0x10ae0,0x103f0,0x22be0,0x1fbe0,0x10b70,0x10400,0x22bf0,0x1fbf0
.long 0x10340,0x10420,0x22c00,0x1fc00,0x103d0,0x10430,0x22c10,0x1fc10,0x10460,0x10440,0x22c20,0x1fc20,0x104f0,0x10450,0x22c30,0x1fc30
.long 0x10580,0x10460,0x22c40,0x1fc40,0x10610,0x10470,0x22c50,0x1fc50,0x106a0,0x10480,0x22c60,0x1fc60,0x10730,0x10490,0x22c70,0x1fc70
.long 0x107c0,0x104b0,0x22c80,0x1fc80,0x10850,0x104c0,0x22c90,0x1fc90,0x108e0,0x104d0,0x22ca0,0x1fca0,0x10970,0x104e0,0x22cb0,0x1fcb0
.long 0x10a00,0x104f0,0x22cc0,0x1fcc0,0x10a90,0x10500,0x22cd0,0x1fcd0,0x10b20,0x10510,0x22ce0,0x1fce0,0x10bb0,0x10520,0x22cf0,0x1fcf0
.long 0x10308,0x10540,0x22d00,0x1fd00,0x10398,0x10550,0x22d10,0x1fd10,0x10428,0x10560,0x22d20,0x1fd20,0x104b8,0x10570,0x22d30,0x1fd30
.long 0x10548,0x10580,0x22d40,0x1fd40,0x105d8,0x10590,0x22d50,0x1fd50,0x10668,0x105a0,0x22d60,0x1fd60,0x106f8,0x105b0,0x22d70,0x1fd70
.long 0x10788,0x105d0,0x22d80,0x1fd80,0x10818,0x105e0,0x22d90,0x1fd90,0x108a8,0x105f0,0x22da0,0x1fda0,0x10938,0x10600,0x22db0,0x1fdb0
.long 0x109c8,0x10610,0x22dc0,0x1fdc0,0x10a58,0x10620,0x22dd0,0x1fdd0,0x10ae8,0x10630,0x22de0,0x1fde0,0x10b78,0x10640,0x22df0,0x1fdf0
.long 0x10348,0x10660,0x22e00,0x1fe00,0x103d8,0x10670,0x22e10,0x1fe10,0x10468,0x10680,0x22e20,0x1fe20,0x104f8,0x10690,0x22e30,0x1fe30
.long 0x10588,0x106a0,0x22e40,0x1fe40,0x10618,0x106b0,0x22e50,0x1fe50,0x106a8,0x106c0,0x22e60,0x1fe60,0x10738,0x106d0,0x22e70,0x1fe70
.long 0x107c8,0x106f0,0x22e80,0x1fe80,0x10858,0x10700,0x22e90,0x1fe90,0x108e8,0x10710,0x22ea0,0x1fea0,0x10978,0x10720,0x22eb0,0x1feb0
.long 0x10a08,0x10730,0x22ec0,0x1fec0,0x10a98,0x10740,0x22ed0,0x1fed0,0x10b28,0x10750,0x22ee0,0x1fee0,0x10bb8,0x10760,0x22ef0,0x1fef0
.long 0x26400,0x26000,0x200,0xa00,0x26404,0x26004,0x210,0xa10,0x26408,0x26008,0x220,0xa20,0x2640c,0x2600c,0x230,0xa30
.long 0x26410,0x26010,0x240,0xa40,0x26414,0x26014,0x250,0xa50,0x26418,0x26018,0x260,0xa60,0x2641c,0x2601c,0x270,0xa70
.long 0x26420,0x26020,0x280,0xa80,0x26424,0x26024,0x290,0xa90,0x26428,0x26028,0x2a0,0xaa0,0x2642c,0x2602c,0x2b0,0xab0
.long 0x26430,0x26030,0x2c0,0xac0,0x26434,0x26034,0x2d0,0xad0,0x26438,0x26038,0x2e0,0xae0,0x2643c,0x2603c,0x2f0,0xaf0
.long 0x26440,0x26040,0x300,0xb00,0x26444,0x26044,0x310,0xb10,0x26448,0x26048,0x320,0xb20,0x2644c,0x2604c,0x330,0xb30
.long 0x26450,0x26050,0x340,0xb40,0x26454,0x26054,0x350,0xb50,0x26458,0x26058,0x360,0xb60,0x2645c,0x2605c,0x370,0xb70
.long 0x26460,0x26060,0x380,0xb80,0x26464,0x26064,0x390,0xb90,0x26468,0x26068,0x3a0,0xba0,0x2646c,0x2606c,0x3b0,0xbb0
.long 0x26470,0x26070,0x3c0,0xbc0,0x26474,0x26074,0x3d0,0xbd0,0x26478,0x26078,0x3e0,0xbe0,0x2647c,0x2607c,0x3f0,0xbf0
.long 0x26480,0x26080,0x600,0x40000a00,0x26484,0x26084,0x610,0x40000a10,0x26488,0x26088,0x620,0x40000a20,0x2648c,0x2608c,0x630,0x40000a30
.long 0x26490,0x26090,0x640,0x40000a40,0x26494,0x26094,0x650,0x40000a50,0x26498,0x26098,0x660,0x40000a60,0x2649c,0x2609c,0x670,0x40000a70
.long 0x264a0,0x260a0,0x680,0x40000a80,0x264a4,0x260a4,0x690,0x40000a90,0x264a8,0x260a8,0x6a0,0x40000aa0,0x264ac,0x260ac,0x6b0,0x40000ab0
.long 0x264b0,0x260b0,0x6c0,0x40000ac0,0x264b4,0x260b4,0x6d0,0x40000ad0,0x264b8,0x260b8,0x6e0,0x40000ae0,0x264bc,0x260bc,0x6f0,0x40000af0
.long 0x264c0,0x260c0,0x700,0x40000b00,0x264c4,0x260c4,0x710,0x40000b10,0x264c8,0x260c8,0x720,0x40000b20,0x264cc,0x260cc,0x730,0x40000b30
.long 0x264d0,0x260d0,0x740,0x40000b40,0x264d4,0x260d4,0x750,0x40000b50,0x264d8,0x260d8,0x760,0x40000b60,0x264dc,0x260dc,0x770,0x40000b70
.long 0x264e0,0x260e0,0x780,0x40000b80,0x264e4,0x260e4,0x790,0x40000b90,0x264e8,0x260e8,0x7a0,0x40000ba0,0x264ec,0x260ec,0x7b0,0x40000bb0
.long 0x264f0,0x260f0,0x7c0,0x40000bc0,0x264f4,0x260f4,0x7d0,0x40000bd0,0x264f8,0x260f8,0x7e0,0x40000be0,0x264fc,0x260fc,0x7f0,0x40000bf0
.long 0x10c00,0x10c00,0x23700,0x20700,0x10c90,0x10c10,0x23710,0x20710,0x10d20,0x10c20,0x23720,0x20720,0x10db0,0x10c30,0x23730,0x20730
.long 0x10e40,0x10c40,0x23740,0x20740,0x10ed0,0x10c50,0x23750,0x20750,0x10f60,0x10c60,0x23760,0x20760,0x10ff0,0x10c70,0x23770,0x20770
.long 0x11080,0x10c90,0x23780,0x20780,0x11110,0x10ca0,0x23790,0x20790,0x111a0,0x10cb0,0x237a0,0x207a0,0x11230,0x10cc0,0x237b0,0x207b0
.long 0x112c0,0x10cd0,0x237c0,0x207c0,0x11350,0x10ce0,0x237d0,0x207d0,0x113e0,0x10cf0,0x237e0,0x207e0,0x11470,0x10d00,0x237f0,0x207f0
.long 0x10c40,0x10d20,0x23800,0x20800,0x10cd0,0x10d30,0x23810,0x20810,0x10d60,0x10d40,0x23820,0x20820,0x10df0,0x10d50,0x23830,0x20830
.long 0x10e80,0x10d60,0x23840,0x20840,0x10f10,0x10d70,0x23850,0x20850,0x10fa0,0x10d80,0x23860,0x20860,0x11030,0x10d90,0x23870,0x20870
.long 0x110c0,0x10db0,0x23880,0x20880,0x11150,0x10dc0,0x23890,0x20890,0x111e0,0x10dd0,0x238a0,0x208a0,0x11270,0x10de0,0x238b0,0x208b0
.long 0x11300,0x10df0,0x238c0,0x208c0,0x11390,0x10e00,0x238d0,0x208d0,0x11420,0x10e10,0x238e0,0x208e0,0x114b0,0x10e20,0x238f0,0x208f0
.long 0x10c08,0x10e40,0x23900,0x20900,0x10c98,0x10e50,0x23910,0x20910,0x10d28,0x10e60,0x23920,0x20920,0x10db8,0x10e70,0x23930,0x20930
.long 0x10e48,0x10e80,0x23940,0x20940,0x10ed8,0x10e90,0x23950,0x20950,0x10f68,0x10ea0,0x23960,0x20960,0x10ff8,0x10eb0,0x23970,0x20970
.long 0x11088,0x10ed0,0x23980,0x20980,0x11118,0x10ee0,0x23990,0x20990,0x111a8,0x10ef0,0x239a0,0x209a0,0x11238,0x10f00,0x239b0,0x209b0
.long 0x112c8,0x10f10,0x239c0,0x209c0,0x11358,0x10f20,0x239d0,0x209d0,0x113e8,0x10f30,0x239e0,0x209e0,0x11478,0x10f40,0x239f0,0x209f0
.long 0x10c48,0x10f60,0x23a00,0x20a00,0x10cd8,0x10f70,0x23a10,0x20a10,0x10d68,0x10f80,0x23a20,0x20a20,0x10df8,0x10f90,0x23a30,0x20a30
.long 0x10e88,0x10fa0,0x23a40,0x20a40,0x10f18,0x10fb0,0x23a50,0x20a50,0x10fa8,0x10fc0,0x23a60,0x20a60,0x11038,0x10fd0,0x23a70,0x20a70
.long 0x110c8,0x10ff0,0x23a80,0x20a80,0x11158,0x11000,0x23a90,0x20a90,0x111e8,0x11010,0x23aa0,0x20aa0,0x11278,0x11020,0x23ab0,0x20ab0
.long 0x11308,0x11030,0x23ac0,0x20ac0,0x11398,0x11040,0x23ad0,0x20ad0,0x11428,0x11050,0x23ae0,0x20ae0,0x114b8,0x11060,0x23af0,0x20af0
.long 0x26500,0x26100,0xe00,0xa08,0x26504,0x26104,0xe10,0xa18,0x26508,0x26108,0xe20,0xa28,0x2650c,0x2610c,0xe30,0xa38
.long 0x26510,0x26110,0xe40,0xa48,0x26514,0x26114,0xe50,0xa58,0x26518,0x26118,0xe60,0xa68,0x2651c,0x2611c,0xe70,0xa78
.long 0x26520,0x26120,0xe80,0xa88,0x26524,0x26124,0xe90,0xa98,0x26528,0x26128,0xea0,0xaa8,0x2652c,0x2612c,0xeb0,0xab8
.long 0x26530,0x26130,0xec0,0xac8,0x26534,0x26134,0xed0,0xad8,0x26538,0x26138,0xee0,0xae8,0x2653c,0x2613c,0xef0,0xaf8
.long 0x26540,0x26140,0xf00,0xb08,0x26544,0x26144,0xf10,0xb18,0x26548,0x26148,0xf20,0xb28,0x2654c,0x2614c,0xf30,0xb38
.long 0x26550,0x26150,0xf40,0xb48,0x26554,0x26154,0xf50,0xb58,0x26558,0x26158,0xf60,0xb68,0x2655c,0x2615c,0xf70,0xb78
.long 0x26560,0x26160,0xf80,0xb88,0x26564,0x26164,0xf90,0xb98,0x26568,0x26168,0xfa0,0xba8,0x2656c,0x2616c,0xfb0,0xbb8
.long 0x26570,0x26170,0xfc0,0xbc8,0x26574,0x26174,0xfd0,0xbd8,0x26578,0x26178,0xfe0,0xbe8,0x2657c,0x2617c,0xff0,0xbf8
.long 0x26580,0x26180,0x1200,0x40000a08,0x26584,0x26184,0x1210,0x40000a18,0x26588,0x26188,0x1220,0x40000a28,0x2658c,0x2618c,0x1230,0x40000a38
.long 0x26590,0x26190,0x1240,0x40000a48,0x26594,0x26194,0x1250,0x40000a58,0x26598,0x26198,0x1260,0x40000a68,0x2659c,0x2619c,0x1270,0x40000a78
.long 0x265a0,0x261a0,0x1280,0x40000a88,0x265a4,0x261a4,0x1290,0x40000a98,0x265a8,0x261a8,0x12a0,0x40000aa8,0x265ac,0x261ac,0x12b0,0x40000ab8
.long 0x265b0,0x261b0,0x12c0,0x40000ac8,0x265b4,0x261b4,0x12d0,0x40000ad8,0x265b8,0x261b8,0x12e0,0x40000ae8,0x265bc,0x261bc,0x12f0,0x40000af8
.long 0x265c0,0x261c0,0x1300,0x40000b08,0x265c4,0x261c4,0x1310,0x40000b18,0x265c8,0x261c8,0x1320,0x40000b28,0x265cc,0x261cc,0x1330,0x40000b38
.long 0x265d0,0x261d0,0x1340,0x40000b48,0x265d4,0x261d4,0x1350,0x40000b58,0x265d8,0x261d8,0x1360,0x40000b68,0x265dc,0x261dc,0x1370,0x40000b78
.long 0x265e0,0x261e0,0x1380,0x40000b88,0x265e4,0x261e4,0x1390,0x40000b98,0x265e8,0x261e8,0x13a0,0x40000ba8,0x265ec,0x261ec,0x13b0,0x40000bb8
.long 0x265f0,0x261f0,0x13c0,0x40000bc8,0x265f4,0x261f4,0x13d0,0x40000bd8,0x265f8,0x261f8,0x13e0,0x40000be8,0x265fc,0x261fc,0x13f0,0x40000bf8
.long 0x26b00,0x26b00,0x24300,0x21300,0x26b90,0x26b10,0x24310,0x21310,0x26c20,0x26b20,0x24320,0x21320,0x26cb0,0x26b30,0x24330,0x21330
.long 0x26d40,0x26b40,0x24340,0x21340,0x26dd0,0x26b50,0x24350,0x21350,0x26e60,0x26b60,0x24360,0x21360,0x26ef0,0x26b70,0x24370,0x21370
.long 0x26f80,0x26b90,0x24380,0x21380,0x27010,0x26ba0,0x24390,0x21390,0x270a0,0x26bb0,0x243a0,0x213a0,0x27130,0x26bc0,0x243b0,0x213b0
.long 0x271c0,0x26bd0,0x243c0,0x213c0,0x27250,0x26be0,0x243d0,0x213d0,0x272e0,0x26bf0,0x243e0,0x213e0,0x27370,0x26c00,0x243f0,0x213f0
.long 0x26b40,0x26c20,0x24400,0x21400,0x26bd0,0x26c30,0x24410,0x21410,0x26c60,0x26c40,0x24420,0x21420,0x26cf0,0x26c50,0x24430,0x21430
.long 0x26d80,0x26c60,0x24440,0x21440,0x26e10,0x26c70,0x24450,0x21450,0x26ea0,0x26c80,0x24460,0x21460,0x26f30,0x26c90,0x24470,0x21470
.long 0x26fc0,0x26cb0,0x24480,0x21480,0x27050,0x26cc0,0x24490,0x21490,0x270e0,0x26cd0,0x244a0,0x214a0,0x27170,0x26ce0,0x244b0,0x214b0
.long 0x27200,0x26cf0,0x244c0,0x214c0,0x27290,0x26d00,0x244d0,0x214d0,0x27320,0x26d10,0x244e0,0x214e0,0x273b0,0x26d20,0x244f0,0x214f0
.long 0x26b08,0x26d40,0x24500,0x21500,0x26b98,0x26d50,0x24510,0x21510,0x26c28,0x26d60,0x24520,0x21520,0x26cb8,0x26d70,0x24530,0x21530
.long 0x26d48,0x26d80,0x24540,0x21540,0x26dd8,0x26d90,0x24550,0x21550,0x26e68,0x26da0,0x24560,0x21560,0x26ef8,0x26db0,0x24570,0x21570
.long 0x26f88,0x26dd0,0x24580,0x21580,0x27018,0x26de0,0x24590,0x21590,0x270a8,0x26df0,0x245a0,0x215a0,0x27138,0x26e00,0x245b0,0x215b0
.long 0x271c8,0x26e10,0x245c0,0x215c0,0x27258,0x26e20,0x245d0,0x215d0,0x272e8,0x26e30,0x245e0,0x215e0,0x27378,0x26e40,0x245f0,0x215f0
.long 0x26b48,0x26e60,0x24600,0x21600,0x26bd8,0x26e70,0x24610,0x21610,0x26c68,0x26e80,0x24620,0x21620,0x26cf8,0x26e90,0x24630,0x21630
.long 0x26d88,0x26ea0,0x24640,0x21640,0x26e18,0x26eb0,0x24650,0x21650,0x26ea8,0x26ec0,0x24660,0x21660,0x26f38,0x26ed0,0x24670,0x21670
.long 0x26fc8,0x26ef0,0x24680,0x21680,0x27058,0x26f00,0x24690,0x21690,0x270e8,0x26f10,0x246a0,0x216a0,0x27178,0x26f20,0x246b0,0x216b0
.long 0x27208,0x26f30,0x246c0,0x216c0,0x27298,0x26f40,0x246d0,0x216d0,0x27328,0x26f50,0x246e0,0x216e0,0x273b8,0x26f60,0x246f0,0x216f0
.long 0x26600,0x26200,0x1600,0x1e00,0x26604,0x26204,0x1610,0x1e10,0x26608,0x26208,0x1620,0x1e20,0x2660c,0x2620c,0x1630,0x1e30
.long 0x26610,0x26210,0x1640,0x1e40,0x26614,0x26214,0x1650,0x1e50,0x26618,0x26218,0x1660,0x1e60,0x2661c,0x2621c,0x1670,0x1e70
.long 0x26620,0x26220,0x1680,0x1e80,0x26624,0x26224,0x1690,0x1e90,0x26628,0x26228,0x16a0,0x1ea0,0x2662c,0x2622c,0x16b0,0x1eb0
.long 0x26630,0x26230,0x16c0,0x1ec0,0x26634,0x26234,0x16d0,0x1ed0,0x26638,0x26238,0x16e0,0x1ee0,0x2663c,0x2623c,0x16f0,0x1ef0
.long 0x26640,0x26240,0x1700,0x1f00,0x26644,0x26244,0x1710,0x1f10,0x26648,0x26248,0x1720,0x1f20,0x2664c,0x2624c,0x1730,0x1f30
.long 0x26650,0x26250,0x1740,0x1f40,0x26654,0x26254,0x1750,0x1f50,0x26658,0x26258,0x1760,0x1f60,0x2665c,0x2625c,0x1770,0x1f70
.long 0x26660,0x26260,0x1780,0x1f80,0x26664,0x26264,0x1790,0x1f90,0x26668,0x26268,0x17a0,0x1fa0,0x2666c,0x2626c,0x17b0,0x1fb0
.long 0x26670,0x26270,0x17c0,0x1fc0,0x26674,0x26274,0x17d0,0x1fd0,0x26678,0x26278,0x17e0,0x1fe0,0x2667c,0x2627c,0x17f0,0x1ff0
.long 0x26680,0x26280,0x1a00,0x40001e00,0x26684,0x26284,0x1a10,0x40001e10,0x26688,0x26288,0x1a20,0x40001e20,0x2668c,0x2628c,0x1a30,0x40001e30
.long 0x26690,0x26290,0x1a40,0x40001e40,0x26694,0x26294,0x1a50,0x40001e50,0x26698,0x26298,0x1a60,0x40001e60,0x2669c,0x2629c,0x1a70,0x40001e70
.long 0x266a0,0x262a0,0x1a80,0x40001e80,0x266a4,0x262a4,0x1a90,0x40001e90,0x266a8,0x262a8,0x1aa0,0x40001ea0,0x266ac,0x262ac,0x1ab0,0x40001eb0
.long 0x266b0,0x262b0,0x1ac0,0x40001ec0,0x266b4,0x262b4,0x1ad0,0x40001ed0,0x266b8,0x262b8,0x1ae0,0x40001ee0,0x266bc,0x262bc,0x1af0,0x40001ef0
.long 0x266c0,0x262c0,0x1b00,0x40001f00,0x266c4,0x262c4,0x1b10,0x40001f10,0x266c8,0x262c8,0x1b20,0x40001f20,0x266cc,0x262cc,0x1b30,0x40001f30
.long 0x266d0,0x262d0,0x1b40,0x40001f40,0x266d4,0x262d4,0x1b50,0x40001f50,0x266d8,0x262d8,0x1b60,0x40001f60,0x266dc,0x262dc,0x1b70,0x40001f70
.long 0x266e0,0x262e0,0x1b80,0x40001f80,0x266e4,0x262e4,0x1b90,0x40001f90,0x266e8,0x262e8,0x1ba0,0x40001fa0,0x266ec,0x262ec,0x1bb0,0x40001fb0
.long 0x266f0,0x262f0,0x1bc0,0x40001fc0,0x266f4,0x262f4,0x1bd0,0x40001fd0,0x266f8,0x262f8,0x1be0,0x40001fe0,0x266fc,0x262fc,0x1bf0,0x40001ff0
.long 0x27400,0x27400,0x24f00,0x21f00,0x27490,0x27410,0x24f10,0x21f10,0x27520,0x27420,0x24f20,0x21f20,0x275b0,0x27430,0x24f30,0x21f30
.long 0x27640,0x27440,0x24f40,0x21f40,0x276d0,0x27450,0x24f50,0x21f50,0x27760,0x27460,0x24f60,0x21f60,0x277f0,0x27470,0x24f70,0x21f70
.long 0x27880,0x27490,0x24f80,0x21f80,0x27910,0x274a0,0x24f90,0x21f90,0x279a0,0x274b0,0x24fa0,0x21fa0,0x27a30,0x274c0,0x24fb0,0x21fb0
.long 0x27ac0,0x274d0,0x24fc0,0x21fc0,0x27b50,0x274e0,0x24fd0,0x21fd0,0x27be0,0x274f0,0x24fe0,0x21fe0,0x27c70,0x27500,0x24ff0,0x21ff0
.long 0x27440,0x27520,0x25000,0x22000,0x274d0,0x27530,0x25010,0x22010,0x27560,0x27540,0x25020,0x22020,0x275f0,0x27550,0x25030,0x22030
.long 0x27680,0x27560,0x25040,0x22040,0x27710,0x27570,0x25050,0x22050,0x277a0,0x27580,0x25060,0x22060,0x27830,0x27590,0x25070,0x22070
.long 0x278c0,0x275b0,0x25080,0x22080,0x27950,0x275c0,0x25090,0x22090,0x279e0,0x275d0,0x250a0,0x220a0,0x27a70,0x275e0,0x250b0,0x220b0
.long 0x27b00,0x275f0,0x250c0,0x220c0,0x27b90,0x27600,0x250d0,0x220d0,0x27c20,0x27610,0x250e0,0x220e0,0x27cb0,0x27620,0x250f0,0x220f0
.long 0x27408,0x27640,0x25100,0x22100,0x27498,0x27650,0x25110,0x22110,0x27528,0x27660,0x25120,0x22120,0x275b8,0x27670,0x25130,0x22130
.long 0x27648,0x27680,0x25140,0x22140,0x276d8,0x27690,0x25150,0x22150,0x27768,0x276a0,0x25160,0x22160,0x277f8,0x276b0,0x25170,0x22170
.long 0x27888,0x276d0,0x25180,0x22180,0x27918,0x276e0,0x25190,0x22190,0x279a8,0x276f0,0x251a0,0x221a0,0x27a38,0x27700,0x251b0,0x221b0
.long 0x27ac8,0x27710,0x251c0,0x221c0,0x27b58,0x27720,0x251d0,0x221d0,0x27be8,0x27730,0x251e0,0x221e0,0x27c78,0x27740,0x251f0,0x221f0
.long 0x27448,0x27760,0x25200,0x22200,0x274d8,0x27770,0x25210,0x22210,0x27568,0x27780,0x25220,0x22220,0x275f8,0x27790,0x25230,0x22230
.long 0x27688,0x277a0,0x25240,0x22240,0x27718,0x277b0,0x25250,0x22250,0x277a8,0x277c0,0x25260,0x22260,0x27838,0x277d0,0x25270,0x22270
.long 0x278c8,0x277f0,0x25280,0x22280,0x27958,0x27800,0x25290,0x22290,0x279e8,0x27810,0x252a0,0x222a0,0x27a78,0x27820,0x252b0,0x222b0
.long 0x27b08,0x27830,0x252c0,0x222c0,0x27b98,0x27840,0x252d0,0x222d0,0x27c28,0x27850,0x252e0,0x222e0,0x27cb8,0x27860,0x252f0,0x222f0
.long 0x26700,0x26300,0x2200,0x1e08,0x26704,0x26304,0x2210,0x1e18,0x26708,0x26308,0x2220,0x1e28,0x2670c,0x2630c,0x2230,0x1e38
.long 0x26710,0x26310,0x2240,0x1e48,0x26714,0x26314,0x2250,0x1e58,0x26718,0x26318,0x2260,0x1e68,0x2671c,0x2631c,0x2270,0x1e78
.long 0x26720,0x26320,0x2280,0x1e88,0x26724,0x26324,0x2290,0x1e98,0x26728,0x26328,0x22a0,0x1ea8,0x2672c,0x2632c,0x22b0,0x1eb8
.long 0x26730,0x26330,0x22c0,0x1ec8,0x26734,0x26334,0x22d0,0x1ed8,0x26738,0x26338,0x22e0,0x1ee8,0x2673c,0x2633c,0x22f0,0x1ef8
.long 0x26740,0x26340,0x2300,0x1f08,0x26744,0x26344,0x2310,0x1f18,0x26748,0x26348,0x2320,0x1f28,0x2674c,0x2634c,0x2330,0x1f38
.long 0x26750,0x26350,0x2340,0x1f48,0x26754,0x26354,0x2350,0x1f58,0x26758,0x26358,0x2360,0x1f68,0x2675c,0x2635c,0x2370,0x1f78
.long 0x26760,0x26360,0x2380,0x1f88,0x26764,0x26364,0x2390,0x1f98,0x26768,0x26368,0x23a0,0x1fa8,0x2676c,0x2636c,0x23b0,0x1fb8
.long 0x26770,0x26370,0x23c0,0x1fc8,0x26774,0x26374,0x23d0,0x1fd8,0x26778,0x26378,0x23e0,0x1fe8,0x2677c,0x2637c,0x23f0,0x1ff8
.long 0x26780,0x26380,0x2600,0x40001e08,0x26784,0x26384,0x2610,0x40001e18,0x26788,0x26388,0x2620,0x40001e28,0x2678c,0x2638c,0x2630,0x40001e38
.long 0x26790,0x26390,0x2640,0x40001e48,0x26794,0x26394,0x2650,0x40001e58,0x26798,0x26398,0x2660,0x40001e68,0x2679c,0x2639c,0x2670,0x40001e78
.long 0x267a0,0x263a0,0x2680,0x40001e88,0x267a4,0x263a4,0x2690,0x40001e98,0x267a8,0x263a8,0x26a0,0x40001ea8,0x267ac,0x263ac,0x26b0,0x40001eb8
.long 0x267b0,0x263b0,0x26c0,0x40001ec8,0x267b4,0x263b4,0x26d0,0x40001ed8,0x267b8,0x263b8,0x26e0,0x40001ee8,0x267bc,0x263bc,0x26f0,0x40001ef8
.long 0x267c0,0x263c0,0x2700,0x40001f08,0x267c4,0x263c4,0x2710,0x40001f18,0x267c8,0x263c8,0x2720,0x40001f28,0x267cc,0x263cc,0x2730,0x40001f38
.long 0x267d0,0x263d0,0x2740,0x40001f48,0x267d4,0x263d4,0x2750,0x40001f58,0x267d8,0x263d8,0x2760,0x40001f68,0x267dc,0x263dc,0x2770,0x40001f78
.long 0x267e0,0x263e0,0x2780,0x40001f88,0x267e4,0x263e4,0x2790,0x40001f98,0x267e8,0x263e8,0x27a0,0x40001fa8,0x267ec,0x263ec,0x27b0,0x40001fb8
.long 0x267f0,0x263f0,0x27c0,0x40001fc8,0x267f4,0x263f4,0x27d0,0x40001fd8,0x267f8,0x263f8,0x27e0,0x40001fe8,0x267fc,0x263fc,0x27f0,0x40001ff8
.long 0x0,0x1e40,0x2880,0x5f20,0x10,0x1e50,0x2890,0x5f30,0x20,0x1e60,0x2d00,0x5f40,0x30,0x1e70,0x2d10,0x5f50
.long 0x40,0x1e80,0x2d20,0x5f60,0x50,0x1e90,0x2d30,0x5f70,0x60,0x2300,0x2d40,0x5f80,0x70,0x2310,0x2d50,0x5f90
.long 0x80,0x2320,0x2d60,0x6400,0x90,0x2330,0x2d70,0x6410,0x500,0x2340,0x2d80,0x6420,0x510,0x2350,0x2d90,0x6430
.long 0x520,0x2360,0x3200,0x6440,0x530,0x2370,0x3210,0x6450,0x540,0x2380,0x3220,0x6460,0x550,0x2390,0x3230,0x6470
.long 0x560,0x3c00,0x3240,0x6480,0x570,0x3c10,0x3250,0x6490,0x580,0x3c20,0x3260,0x6900,0x590,0x3c30,0x3270,0x6910
.long 0xa00,0x3c40,0x3280,0x6920,0xa10,0x3c50,0x3290,0x6930,0xa20,0x3c60,0x3700,0x6940,0xa30,0x3c70,0x3710,0x6950
.long 0xa40,0x3c80,0x3720,0x6960,0xa50,0x3c90,0x3730,0x6970,0xa60,0x4100,0x3740,0x6980,0xa70,0x4110,0x3750,0x6990
.long 0xa80,0x4120,0x3760,0x6e00,0xa90,0x4130,0x3770,0x6e10,0xf00,0x4140,0x3780,0x6e20,0xf10,0x4150,0x3790,0x6e30
.long 0xf20,0x4160,0x5000,0x6e40,0xf30,0x4170,0x5010,0x6e50,0xf40,0x4180,0x5020,0x6e60,0xf50,0x4190,0x5030,0x6e70
.long 0xf60,0x4600,0x5040,0x6e80,0xf70,0x4610,0x5050,0x6e90,0xf80,0x4620,0x5060,0x7300,0xf90,0x4630,0x5070,0x7310
.long 0x1400,0x4640,0x5080,0x7320,0x1410,0x4650,0x5090,0x7330,0x1420,0x4660,0x5500,0x7340,0x1430,0x4670,0x5510,0x7350
.long 0x1440,0x4680,0x5520,0x7360,0x1450,0x4690,0x5530,0x7370,0x1460,0x4b00,0x5540,0x7380,0x1470,0x4b10,0x5550,0x7390
.long 0x1480,0x4b20,0x5560,0x8c00,0x1490,0x4b30,0x5570,0x8c10,0x1900,0x4b40,0x5580,0x8c20,0x1910,0x4b50,0x5590,0x8c30
.long 0x1920,0x4b60,0x5a00,0x8c40,0x1930,0x4b70,0x5a10,0x8c50,0x1940,0x4b80,0x5a20,0x8c60,0x1950,0x4b90,0x5a30,0x8c70
.long 0x1960,0x2800,0x5a40,0x8c80,0x1970,0x2810,0x5a50,0x8c90,0x1980,0x2820,0x5a60,0x9100,0x1990,0x2830,0x5a70,0x9110
.long 0x1e00,0x2840,0x5a80,0x9120,0x1e10,0x2850,0x5a90,0x9130,0x1e20,0x2860,0x5f00,0x9140,0x1e30,0x2870,0x5f10,0x9150
.long 0x9160,0x0,0x0,0x0,0x9170,0x10,0x0,0x0,0x9180,0x20,0x0,0x0,0x9190,0x30,0x0,0x0
.long 0x9600,0x40,0x0,0x0,0x9610,0x50,0x0,0x0,0x9620,0x60,0x0,0x0,0x9630,0x70,0x0,0x0
.long 0x9640,0x80,0x0,0x0,0x9650,0x80,0x0,0x0,0x9660,0x90,0x0,0x0,0x9670,0xa0,0x0,0x0
.long 0x9680,0xb0,0x0,0x0,0x9690,0xc0,0x0,0x0,0x9b00,0xd0,0x0,0x0,0x9b10,0xe0,0x0,0x0
.long 0x9b20,0xf0,0x0,0x0,0x9b30,0x100,0x0,0x0,0x9b40,0x100,0x0,0x0,0x9b50,0x110,0x0,0x0
.long 0x9b60,0x120,0x0,0x0,0x9b70,0x130,0x0,0x0,0x9b80,0x140,0x0,0x0,0x9b90,0x150,0x0,0x0
.long 0x7800,0x160,0x0,0x0,0x7810,0x170,0x0,0x0,0x7820,0x180,0x0,0x0,0x7830,0x180,0x0,0x0
.long 0x7840,0x190,0x0,0x0,0x7850,0x1a0,0x0,0x0,0x7860,0x1b0,0x0,0x0,0x7870,0x1c0,0x0,0x0
.long 0x7880,0x1d0,0x0,0x0,0x7890,0x1e0,0x0,0x0,0x7d00,0x1f0,0x0,0x0,0x7d10,0x200,0x0,0x0
.long 0x7d20,0x200,0x0,0x0,0x7d30,0x210,0x0,0x0,0x7d40,0x220,0x0,0x0,0x7d50,0x230,0x0,0x0
.long 0x7d60,0x240,0x0,0x0,0x7d70,0x250,0x0,0x0,0x7d80,0x260,0x0,0x0,0x7d90,0x270,0x0,0x0
.long 0x8200,0x280,0x0,0x0,0x8210,0x280,0x0,0x0,0x8220,0x290,0x0,0x0,0x8230,0x2a0,0x0,0x0
.long 0x8240,0x2b0,0x0,0x0,0x8250,0x2c0,0x0,0x0,0x8260,0x2d0,0x0,0x0,0x8270,0x2e0,0x0,0x0
.long 0x8280,0x2f0,0x0,0x0,0x8290,0x300,0x0,0x0,0x8700,0x300,0x0,0x0,0x8710,0x310,0x0,0x0
.long 0x8720,0x320,0x0,0x0,0x8730,0x330,0x0,0x0,0x8740,0x340,0x0,0x0,0x8750,0x350,0x0,0x0
.long 0x8760,0x360,0x0,0x0,0x8770,0x370,0x0,0x0,0x8780,0x380,0x0,0x0,0x8790,0x380,0x0,0x0
.long 0x1908,0x126a0,0x1108,0x11da0,0x888,0x12730,0x88,0x11e30,0x1900,0x127c0,0x1100,0x11ec0,0x880,0x12850,0x80,0x11f50
.long 0x18f8,0x128e0,0x10f8,0x11fe0,0x878,0x12970,0x78,0x12070,0x18f0,0x12a00,0x10f0,0x12100,0x870,0x12a90,0x70,0x12190
.long 0x18e8,0x12b20,0x10e8,0x12220,0x868,0x12bb0,0x68,0x122b0,0x18e0,0x12c40,0x10e0,0x12340,0x860,0x12cd0,0x60,0x123d0
.long 0x18d8,0x12d60,0x10d8,0x12460,0x858,0x12df0,0x58,0x124f0,0x18d0,0x12e80,0x10d0,0x12580,0x850,0x12f10,0x50,0x12610
.long 0x18c8,0x143a0,0x10c8,0x13aa0,0x848,0x14430,0x48,0x13b30,0x18c0,0x144c0,0x10c0,0x13bc0,0x840,0x14550,0x40,0x13c50
.long 0x18b8,0x145e0,0x10b8,0x13ce0,0x838,0x14670,0x38,0x13d70,0x18b0,0x14700,0x10b0,0x13e00,0x830,0x14790,0x30,0x13e90
.long 0x18a8,0x14820,0x10a8,0x13f20,0x828,0x148b0,0x28,0x13fb0,0x18a0,0x14940,0x10a0,0x14040,0x820,0x149d0,0x20,0x140d0
.long 0x1898,0x14a60,0x1098,0x14160,0x818,0x14af0,0x18,0x141f0,0x1890,0x14b80,0x1090,0x14280,0x810,0x14c10,0x10,0x14310
.long 0x18f8,0x12690,0x10f8,0x11d90,0x878,0x12720,0x78,0x11e20,0x18f0,0x127b0,0x10f0,0x11eb0,0x870,0x12840,0x70,0x11f40
.long 0x18e8,0x128d0,0x10e8,0x11fd0,0x868,0x12960,0x68,0x12060,0x18e0,0x129f0,0x10e0,0x120f0,0x860,0x12a80,0x60,0x12180
.long 0x18d8,0x12b10,0x10d8,0x12210,0x858,0x12ba0,0x58,0x122a0,0x18d0,0x12c30,0x10d0,0x12330,0x850,0x12cc0,0x50,0x123c0
.long 0x18c8,0x12d50,0x10c8,0x12450,0x848,0x12de0,0x48,0x124e0,0x18c0,0x12e70,0x10c0,0x12570,0x840,0x12f00,0x40,0x12600
.long 0x18b8,0x14390,0x10b8,0x13a90,0x838,0x14420,0x38,0x13b20,0x18b0,0x144b0,0x10b0,0x13bb0,0x830,0x14540,0x30,0x13c40
.long 0x18a8,0x145d0,0x10a8,0x13cd0,0x828,0x14660,0x28,0x13d60,0x18a0,0x146f0,0x10a0,0x13df0,0x820,0x14780,0x20,0x13e80
.long 0x1898,0x14810,0x1098,0x13f10,0x818,0x148a0,0x18,0x13fa0,0x1890,0x14930,0x1090,0x14030,0x810,0x149c0,0x10,0x140c0
.long 0x1888,0x14a50,0x1088,0x14150,0x808,0x14ae0,0x8,0x141e0,0x1880,0x14b70,0x1080,0x14270,0x800,0x14c00,0x0,0x14300
.long 0x7608,0x160a0,0x6e08,0x157a0,0x6588,0x16130,0x5d88,0x15830,0x7600,0x161c0,0x6e00,0x158c0,0x6580,0x16250,0x5d80,0x15950
.long 0x75f8,0x162e0,0x6df8,0x159e0,0x6578,0x16370,0x5d78,0x15a70,0x75f0,0x16400,0x6df0,0x15b00,0x6570,0x16490,0x5d70,0x15b90
.long 0x75e8,0x16520,0x6de8,0x15c20,0x6568,0x165b0,0x5d68,0x15cb0,0x75e0,0x16640,0x6de0,0x15d40,0x6560,0x166d0,0x5d60,0x15dd0
.long 0x75d8,0x16760,0x6dd8,0x15e60,0x6558,0x167f0,0x5d58,0x15ef0,0x75d0,0x16880,0x6dd0,0x15f80,0x6550,0x16910,0x5d50,0x16010
.long 0x75c8,0x17da0,0x6dc8,0x174a0,0x6548,0x17e30,0x5d48,0x17530,0x75c0,0x17ec0,0x6dc0,0x175c0,0x6540,0x17f50,0x5d40,0x17650
.long 0x75b8,0x17fe0,0x6db8,0x176e0,0x6538,0x18070,0x5d38,0x17770,0x75b0,0x18100,0x6db0,0x17800,0x6530,0x18190,0x5d30,0x17890
.long 0x75a8,0x18220,0x6da8,0x17920,0x6528,0x182b0,0x5d28,0x179b0,0x75a0,0x18340,0x6da0,0x17a40,0x6520,0x183d0,0x5d20,0x17ad0
.long 0x7598,0x18460,0x6d98,0x17b60,0x6518,0x184f0,0x5d18,0x17bf0,0x7590,0x18580,0x6d90,0x17c80,0x6510,0x18610,0x5d10,0x17d10
.long 0x75f8,0x16090,0x6df8,0x15790,0x6578,0x16120,0x5d78,0x15820,0x75f0,0x161b0,0x6df0,0x158b0,0x6570,0x16240,0x5d70,0x15940
.long 0x75e8,0x162d0,0x6de8,0x159d0,0x6568,0x16360,0x5d68,0x15a60,0x75e0,0x163f0,0x6de0,0x15af0,0x6560,0x16480,0x5d60,0x15b80
.long 0x75d8,0x16510,0x6dd8,0x15c10,0x6558,0x165a0,0x5d58,0x15ca0,0x75d0,0x16630,0x6dd0,0x15d30,0x6550,0x166c0,0x5d50,0x15dc0
.long 0x75c8,0x16750,0x6dc8,0x15e50,0x6548,0x167e0,0x5d48,0x15ee0,0x75c0,0x16870,0x6dc0,0x15f70,0x6540,0x16900,0x5d40,0x16000
.long 0x75b8,0x17d90,0x6db8,0x17490,0x6538,0x17e20,0x5d38,0x17520,0x75b0,0x17eb0,0x6db0,0x175b0,0x6530,0x17f40,0x5d30,0x17640
.long 0x75a8,0x17fd0,0x6da8,0x176d0,0x6528,0x18060,0x5d28,0x17760,0x75a0,0x180f0,0x6da0,0x177f0,0x6520,0x18180,0x5d20,0x17880
.long 0x7598,0x18210,0x6d98,0x17910,0x6518,0x182a0,0x5d18,0x179a0,0x7590,0x18330,0x6d90,0x17a30,0x6510,0x183c0,0x5d10,0x17ac0
.long 0x7588,0x18450,0x6d88,0x17b50,0x6508,0x184e0,0x5d08,0x17be0,0x7580,0x18570,0x6d80,0x17c70,0x6500,0x18600,0x5d00,0x17d00
.long 0x9708,0x19aa0,0x8f08,0x191a0,0x8688,0x19b30,0x7e88,0x19230,0x9700,0x19bc0,0x8f00,0x192c0,0x8680,0x19c50,0x7e80,0x19350
.long 0x96f8,0x19ce0,0x8ef8,0x193e0,0x8678,0x19d70,0x7e78,0x19470,0x96f0,0x19e00,0x8ef0,0x19500,0x8670,0x19e90,0x7e70,0x19590
.long 0x96e8,0x19f20,0x8ee8,0x19620,0x8668,0x19fb0,0x7e68,0x196b0,0x96e0,0x1a040,0x8ee0,0x19740,0x8660,0x1a0d0,0x7e60,0x197d0
.long 0x96d8,0x1a160,0x8ed8,0x19860,0x8658,0x1a1f0,0x7e58,0x198f0,0x96d0,0x1a280,0x8ed0,0x19980,0x8650,0x1a310,0x7e50,0x19a10
.long 0x96c8,0x1b7a0,0x8ec8,0x1aea0,0x8648,0x1b830,0x7e48,0x1af30,0x96c0,0x1b8c0,0x8ec0,0x1afc0,0x8640,0x1b950,0x7e40,0x1b050
.long 0x96b8,0x1b9e0,0x8eb8,0x1b0e0,0x8638,0x1ba70,0x7e38,0x1b170,0x96b0,0x1bb00,0x8eb0,0x1b200,0x8630,0x1bb90,0x7e30,0x1b290
.long 0x96a8,0x1bc20,0x8ea8,0x1b320,0x8628,0x1bcb0,0x7e28,0x1b3b0,0x96a0,0x1bd40,0x8ea0,0x1b440,0x8620,0x1bdd0,0x7e20,0x1b4d0
.long 0x9698,0x1be60,0x8e98,0x1b560,0x8618,0x1bef0,0x7e18,0x1b5f0,0x9690,0x1bf80,0x8e90,0x1b680,0x8610,0x1c010,0x7e10,0x1b710
.long 0x96f8,0x19a90,0x8ef8,0x19190,0x8678,0x19b20,0x7e78,0x19220,0x96f0,0x19bb0,0x8ef0,0x192b0,0x8670,0x19c40,0x7e70,0x19340
.long 0x96e8,0x19cd0,0x8ee8,0x193d0,0x8668,0x19d60,0x7e68,0x19460,0x96e0,0x19df0,0x8ee0,0x194f0,0x8660,0x19e80,0x7e60,0x19580
.long 0x96d8,0x19f10,0x8ed8,0x19610,0x8658,0x19fa0,0x7e58,0x196a0,0x96d0,0x1a030,0x8ed0,0x19730,0x8650,0x1a0c0,0x7e50,0x197c0
.long 0x96c8,0x1a150,0x8ec8,0x19850,0x8648,0x1a1e0,0x7e48,0x198e0,0x96c0,0x1a270,0x8ec0,0x19970,0x8640,0x1a300,0x7e40,0x19a00
.long 0x96b8,0x1b790,0x8eb8,0x1ae90,0x8638,0x1b820,0x7e38,0x1af20,0x96b0,0x1b8b0,0x8eb0,0x1afb0,0x8630,0x1b940,0x7e30,0x1b040
.long 0x96a8,0x1b9d0,0x8ea8,0x1b0d0,0x8628,0x1ba60,0x7e28,0x1b160,0x96a0,0x1baf0,0x8ea0,0x1b1f0,0x8620,0x1bb80,0x7e20,0x1b280
.long 0x9698,0x1bc10,0x8e98,0x1b310,0x8618,0x1bca0,0x7e18,0x1b3a0,0x9690,0x1bd30,0x8e90,0x1b430,0x8610,0x1bdc0,0x7e10,0x1b4c0
.long 0x9688,0x1be50,0x8e88,0x1b550,0x8608,0x1bee0,0x7e08,0x1b5e0,0x9680,0x1bf70,0x8e80,0x1b670,0x8600,0x1c000,0x7e00,0x1b700
.long 0x1908,0x11da0,0x7608,0x157a0,0x888,0x11e30,0x6588,0x15830,0x1900,0x11ec0,0x7600,0x158c0,0x880,0x11f50,0x6580,0x15950
.long 0x18f8,0x11fe0,0x75f8,0x159e0,0x878,0x12070,0x6578,0x15a70,0x18f0,0x12100,0x75f0,0x15b00,0x870,0x12190,0x6570,0x15b90
.long 0x18e8,0x12220,0x75e8,0x15c20,0x868,0x122b0,0x6568,0x15cb0,0x18e0,0x12340,0x75e0,0x15d40,0x860,0x123d0,0x6560,0x15dd0
.long 0x18d8,0x12460,0x75d8,0x15e60,0x858,0x124f0,0x6558,0x15ef0,0x18d0,0x12580,0x75d0,0x15f80,0x850,0x12610,0x6550,0x16010
.long 0x18c8,0x13aa0,0x75c8,0x174a0,0x848,0x13b30,0x6548,0x17530,0x18c0,0x13bc0,0x75c0,0x175c0,0x840,0x13c50,0x6540,0x17650
.long 0x18b8,0x13ce0,0x75b8,0x176e0,0x838,0x13d70,0x6538,0x17770,0x18b0,0x13e00,0x75b0,0x17800,0x830,0x13e90,0x6530,0x17890
.long 0x18a8,0x13f20,0x75a8,0x17920,0x828,0x13fb0,0x6528,0x179b0,0x18a0,0x14040,0x75a0,0x17a40,0x820,0x140d0,0x6520,0x17ad0
.long 0x1898,0x14160,0x7598,0x17b60,0x818,0x141f0,0x6518,0x17bf0,0x1890,0x14280,0x7590,0x17c80,0x810,0x14310,0x6510,0x17d10
.long 0x18f8,0x11d90,0x75f8,0x15790,0x878,0x11e20,0x6578,0x15820,0x18f0,0x11eb0,0x75f0,0x158b0,0x870,0x11f40,0x6570,0x15940
.long 0x18e8,0x11fd0,0x75e8,0x159d0,0x868,0x12060,0x6568,0x15a60,0x18e0,0x120f0,0x75e0,0x15af0,0x860,0x12180,0x6560,0x15b80
.long 0x18d8,0x12210,0x75d8,0x15c10,0x858,0x122a0,0x6558,0x15ca0,0x18d0,0x12330,0x75d0,0x15d30,0x850,0x123c0,0x6550,0x15dc0
.long 0x18c8,0x12450,0x75c8,0x15e50,0x848,0x124e0,0x6548,0x15ee0,0x18c0,0x12570,0x75c0,0x15f70,0x840,0x12600,0x6540,0x16000
.long 0x18b8,0x13a90,0x75b8,0x17490,0x838,0x13b20,0x6538,0x17520,0x18b0,0x13bb0,0x75b0,0x175b0,0x830,0x13c40,0x6530,0x17640
.long 0x18a8,0x13cd0,0x75a8,0x176d0,0x828,0x13d60,0x6528,0x17760,0x18a0,0x13df0,0x75a0,0x177f0,0x820,0x13e80,0x6520,0x17880
.long 0x1898,0x13f10,0x7598,0x17910,0x818,0x13fa0,0x6518,0x179a0,0x1890,0x14030,0x7590,0x17a30,0x810,0x140c0,0x6510,0x17ac0
.long 0x1888,0x14150,0x7588,0x17b50,0x808,0x141e0,0x6508,0x17be0,0x1880,0x14270,0x7580,0x17c70,0x800,0x14300,0x6500,0x17d00
.long 0x7608,0x160a0,0x6e08,0x157a0,0x6588,0x16130,0x5d88,0x15830,0x7600,0x161c0,0x6e00,0x158c0,0x6580,0x16250,0x5d80,0x15950
.long 0x75f8,0x162e0,0x6df8,0x159e0,0x6578,0x16370,0x5d78,0x15a70,0x75f0,0x16400,0x6df0,0x15b00,0x6570,0x16490,0x5d70,0x15b90
.long 0x75e8,0x16520,0x6de8,0x15c20,0x6568,0x165b0,0x5d68,0x15cb0,0x75e0,0x16640,0x6de0,0x15d40,0x6560,0x166d0,0x5d60,0x15dd0
.long 0x75d8,0x16760,0x6dd8,0x15e60,0x6558,0x167f0,0x5d58,0x15ef0,0x75d0,0x16880,0x6dd0,0x15f80,0x6550,0x16910,0x5d50,0x16010
.long 0x75c8,0x17da0,0x6dc8,0x174a0,0x6548,0x17e30,0x5d48,0x17530,0x75c0,0x17ec0,0x6dc0,0x175c0,0x6540,0x17f50,0x5d40,0x17650
.long 0x75b8,0x17fe0,0x6db8,0x176e0,0x6538,0x18070,0x5d38,0x17770,0x75b0,0x18100,0x6db0,0x17800,0x6530,0x18190,0x5d30,0x17890
.long 0x75a8,0x18220,0x6da8,0x17920,0x6528,0x182b0,0x5d28,0x179b0,0x75a0,0x18340,0x6da0,0x17a40,0x6520,0x183d0,0x5d20,0x17ad0
.long 0x7598,0x18460,0x6d98,0x17b60,0x6518,0x184f0,0x5d18,0x17bf0,0x7590,0x18580,0x6d90,0x17c80,0x6510,0x18610,0x5d10,0x17d10
.long 0x75f8,0x16090,0x6df8,0x15790,0x6578,0x16120,0x5d78,0x15820,0x75f0,0x161b0,0x6df0,0x158b0,0x6570,0x16240,0x5d70,0x15940
.long 0x75e8,0x162d0,0x6de8,0x159d0,0x6568,0x16360,0x5d68,0x15a60,0x75e0,0x163f0,0x6de0,0x15af0,0x6560,0x16480,0x5d60,0x15b80
.long 0x75d8,0x16510,0x6dd8,0x15c10,0x6558,0x165a0,0x5d58,0x15ca0,0x75d0,0x16630,0x6dd0,0x15d30,0x6550,0x166c0,0x5d50,0x15dc0
.long 0x75c8,0x16750,0x6dc8,0x15e50,0x6548,0x167e0,0x5d48,0x15ee0,0x75c0,0x16870,0x6dc0,0x15f70,0x6540,0x16900,0x5d40,0x16000
.long 0x75b8,0x17d90,0x6db8,0x17490,0x6538,0x17e20,0x5d38,0x17520,0x75b0,0x17eb0,0x6db0,0x175b0,0x6530,0x17f40,0x5d30,0x17640
.long 0x75a8,0x17fd0,0x6da8,0x176d0,0x6528,0x18060,0x5d28,0x17760,0x75a0,0x180f0,0x6da0,0x177f0,0x6520,0x18180,0x5d20,0x17880
.long 0x7598,0x18210,0x6d98,0x17910,0x6518,0x182a0,0x5d18,0x179a0,0x7590,0x18330,0x6d90,0x17a30,0x6510,0x183c0,0x5d10,0x17ac0
.long 0x7588,0x18450,0x6d88,0x17b50,0x6508,0x184e0,0x5d08,0x17be0,0x7580,0x18570,0x6d80,0x17c70,0x6500,0x18600,0x5d00,0x17d00
.long 0x9708,0x19aa0,0x8f08,0x191a0,0x8688,0x19b30,0x7e88,0x19230,0x9700,0x19bc0,0x8f00,0x192c0,0x8680,0x19c50,0x7e80,0x19350
.long 0x96f8,0x19ce0,0x8ef8,0x193e0,0x8678,0x19d70,0x7e78,0x19470,0x96f0,0x19e00,0x8ef0,0x19500,0x8670,0x19e90,0x7e70,0x19590
.long 0x96e8,0x19f20,0x8ee8,0x19620,0x8668,0x19fb0,0x7e68,0x196b0,0x96e0,0x1a040,0x8ee0,0x19740,0x8660,0x1a0d0,0x7e60,0x197d0
.long 0x96d8,0x1a160,0x8ed8,0x19860,0x8658,0x1a1f0,0x7e58,0x198f0,0x96d0,0x1a280,0x8ed0,0x19980,0x8650,0x1a310,0x7e50,0x19a10
.long 0x96c8,0x1b7a0,0x8ec8,0x1aea0,0x8648,0x1b830,0x7e48,0x1af30,0x96c0,0x1b8c0,0x8ec0,0x1afc0,0x8640,0x1b950,0x7e40,0x1b050
.long 0x96b8,0x1b9e0,0x8eb8,0x1b0e0,0x8638,0x1ba70,0x7e38,0x1b170,0x96b0,0x1bb00,0x8eb0,0x1b200,0x8630,0x1bb90,0x7e30,0x1b290
.long 0x96a8,0x1bc20,0x8ea8,0x1b320,0x8628,0x1bcb0,0x7e28,0x1b3b0,0x96a0,0x1bd40,0x8ea0,0x1b440,0x8620,0x1bdd0,0x7e20,0x1b4d0
.long 0x9698,0x1be60,0x8e98,0x1b560,0x8618,0x1bef0,0x7e18,0x1b5f0,0x9690,0x1bf80,0x8e90,0x1b680,0x8610,0x1c010,0x7e10,0x1b710
.long 0x96f8,0x19a90,0x8ef8,0x19190,0x8678,0x19b20,0x7e78,0x19220,0x96f0,0x19bb0,0x8ef0,0x192b0,0x8670,0x19c40,0x7e70,0x19340
.long 0x96e8,0x19cd0,0x8ee8,0x193d0,0x8668,0x19d60,0x7e68,0x19460,0x96e0,0x19df0,0x8ee0,0x194f0,0x8660,0x19e80,0x7e60,0x19580
.long 0x96d8,0x19f10,0x8ed8,0x19610,0x8658,0x19fa0,0x7e58,0x196a0,0x96d0,0x1a030,0x8ed0,0x19730,0x8650,0x1a0c0,0x7e50,0x197c0
.long 0x96c8,0x1a150,0x8ec8,0x19850,0x8648,0x1a1e0,0x7e48,0x198e0,0x96c0,0x1a270,0x8ec0,0x19970,0x8640,0x1a300,0x7e40,0x19a00
.long 0x96b8,0x1b790,0x8eb8,0x1ae90,0x8638,0x1b820,0x7e38,0x1af20,0x96b0,0x1b8b0,0x8eb0,0x1afb0,0x8630,0x1b940,0x7e30,0x1b040
.long 0x96a8,0x1b9d0,0x8ea8,0x1b0d0,0x8628,0x1ba60,0x7e28,0x1b160,0x96a0,0x1baf0,0x8ea0,0x1b1f0,0x8620,0x1bb80,0x7e20,0x1b280
.long 0x9698,0x1bc10,0x8e98,0x1b310,0x8618,0x1bca0,0x7e18,0x1b3a0,0x9690,0x1bd30,0x8e90,0x1b430,0x8610,0x1bdc0,0x7e10,0x1b4c0
.long 0x9688,0x1be50,0x8e88,0x1b550,0x8608,0x1bee0,0x7e08,0x1b5e0,0x9680,0x1bf70,0x8e80,0x1b670,0x8600,0x1c000,0x7e00,0x1b700
.long 0x7608,0x157a0,0x9708,0x191a0,0x6588,0x15830,0x8688,0x19230,0x7600,0x158c0,0x9700,0x192c0,0x6580,0x15950,0x8680,0x19350
.long 0x75f8,0x159e0,0x96f8,0x193e0,0x6578,0x15a70,0x8678,0x19470,0x75f0,0x15b00,0x96f0,0x19500,0x6570,0x15b90,0x8670,0x19590
.long 0x75e8,0x15c20,0x96e8,0x19620,0x6568,0x15cb0,0x8668,0x196b0,0x75e0,0x15d40,0x96e0,0x19740,0x6560,0x15dd0,0x8660,0x197d0
.long 0x75d8,0x15e60,0x96d8,0x19860,0x6558,0x15ef0,0x8658,0x198f0,0x75d0,0x15f80,0x96d0,0x19980,0x6550,0x16010,0x8650,0x19a10
.long 0x75c8,0x174a0,0x96c8,0x1aea0,0x6548,0x17530,0x8648,0x1af30,0x75c0,0x175c0,0x96c0,0x1afc0,0x6540,0x17650,0x8640,0x1b050
.long 0x75b8,0x176e0,0x96b8,0x1b0e0,0x6538,0x17770,0x8638,0x1b170,0x75b0,0x17800,0x96b0,0x1b200,0x6530,0x17890,0x8630,0x1b290
.long 0x75a8,0x17920,0x96a8,0x1b320,0x6528,0x179b0,0x8628,0x1b3b0,0x75a0,0x17a40,0x96a0,0x1b440,0x6520,0x17ad0,0x8620,0x1b4d0
.long 0x7598,0x17b60,0x9698,0x1b560,0x6518,0x17bf0,0x8618,0x1b5f0,0x7590,0x17c80,0x9690,0x1b680,0x6510,0x17d10,0x8610,0x1b710
.long 0x75f8,0x15790,0x96f8,0x19190,0x6578,0x15820,0x8678,0x19220,0x75f0,0x158b0,0x96f0,0x192b0,0x6570,0x15940,0x8670,0x19340
.long 0x75e8,0x159d0,0x96e8,0x193d0,0x6568,0x15a60,0x8668,0x19460,0x75e0,0x15af0,0x96e0,0x194f0,0x6560,0x15b80,0x8660,0x19580
.long 0x75d8,0x15c10,0x96d8,0x19610,0x6558,0x15ca0,0x8658,0x196a0,0x75d0,0x15d30,0x96d0,0x19730,0x6550,0x15dc0,0x8650,0x197c0
.long 0x75c8,0x15e50,0x96c8,0x19850,0x6548,0x15ee0,0x8648,0x198e0,0x75c0,0x15f70,0x96c0,0x19970,0x6540,0x16000,0x8640,0x19a00
.long 0x75b8,0x17490,0x96b8,0x1ae90,0x6538,0x17520,0x8638,0x1af20,0x75b0,0x175b0,0x96b0,0x1afb0,0x6530,0x17640,0x8630,0x1b040
.long 0x75a8,0x176d0,0x96a8,0x1b0d0,0x6528,0x17760,0x8628,0x1b160,0x75a0,0x177f0,0x96a0,0x1b1f0,0x6520,0x17880,0x8620,0x1b280
.long 0x7598,0x17910,0x9698,0x1b310,0x6518,0x179a0,0x8618,0x1b3a0,0x7590,0x17a30,0x9690,0x1b430,0x6510,0x17ac0,0x8610,0x1b4c0
.long 0x7588,0x17b50,0x9688,0x1b550,0x6508,0x17be0,0x8608,0x1b5e0,0x7580,0x17c70,0x9680,0x1b670,0x6500,0x17d00,0x8600,0x1b700
.long 0x1908,0x11da0,0x41908,0x51da0,0x888,0x11e30,0x40888,0x51e30,0x1900,0x11ec0,0x41900,0x51ec0,0x880,0x11f50,0x40880,0x51f50
.long 0x18f8,0x11fe0,0x418f8,0x51fe0,0x878,0x12070,0x40878,0x52070,0x18f0,0x12100,0x418f0,0x52100,0x870,0x12190,0x40870,0x52190
.long 0x18e8,0x12220,0x418e8,0x52220,0x868,0x122b0,0x40868,0x522b0,0x18e0,0x12340,0x418e0,0x52340,0x860,0x123d0,0x40860,0x523d0
.long 0x18d8,0x12460,0x418d8,0x52460,0x858,0x124f0,0x40858,0x524f0,0x18d0,0x12580,0x418d0,0x52580,0x850,0x12610,0x40850,0x52610
.long 0x18c8,0x13aa0,0x418c8,0x53aa0,0x848,0x13b30,0x40848,0x53b30,0x18c0,0x13bc0,0x418c0,0x53bc0,0x840,0x13c50,0x40840,0x53c50
.long 0x18b8,0x13ce0,0x418b8,0x53ce0,0x838,0x13d70,0x40838,0x53d70,0x18b0,0x13e00,0x418b0,0x53e00,0x830,0x13e90,0x40830,0x53e90
.long 0x18a8,0x13f20,0x418a8,0x53f20,0x828,0x13fb0,0x40828,0x53fb0,0x18a0,0x14040,0x418a0,0x54040,0x820,0x140d0,0x40820,0x540d0
.long 0x1898,0x14160,0x41898,0x54160,0x818,0x141f0,0x40818,0x541f0,0x1890,0x14280,0x41890,0x54280,0x810,0x14310,0x40810,0x54310
.long 0x18f8,0x11d90,0x418f8,0x51d90,0x878,0x11e20,0x40878,0x51e20,0x18f0,0x11eb0,0x418f0,0x51eb0,0x870,0x11f40,0x40870,0x51f40
.long 0x18e8,0x11fd0,0x418e8,0x51fd0,0x868,0x12060,0x40868,0x52060,0x18e0,0x120f0,0x418e0,0x520f0,0x860,0x12180,0x40860,0x52180
.long 0x18d8,0x12210,0x418d8,0x52210,0x858,0x122a0,0x40858,0x522a0,0x18d0,0x12330,0x418d0,0x52330,0x850,0x123c0,0x40850,0x523c0
.long 0x18c8,0x12450,0x418c8,0x52450,0x848,0x124e0,0x40848,0x524e0,0x18c0,0x12570,0x418c0,0x52570,0x840,0x12600,0x40840,0x52600
.long 0x18b8,0x13a90,0x418b8,0x53a90,0x838,0x13b20,0x40838,0x53b20,0x18b0,0x13bb0,0x418b0,0x53bb0,0x830,0x13c40,0x40830,0x53c40
.long 0x18a8,0x13cd0,0x418a8,0x53cd0,0x828,0x13d60,0x40828,0x53d60,0x18a0,0x13df0,0x418a0,0x53df0,0x820,0x13e80,0x40820,0x53e80
.long 0x1898,0x13f10,0x41898,0x53f10,0x818,0x13fa0,0x40818,0x53fa0,0x1890,0x14030,0x41890,0x54030,0x810,0x140c0,0x40810,0x540c0
.long 0x1888,0x14150,0x41888,0x54150,0x808,0x141e0,0x40808,0x541e0,0x1880,0x14270,0x41880,0x54270,0x800,0x14300,0x40800,0x54300
.long 0x0,0x280,0x19000,0x19040,0x28,0x2a8,0x19090,0x190d0,0x50,0x2d0,0x19120,0x19160,0x78,0x2f8,0x191b0,0x191f0
.long 0xa0,0x320,0x19a40,0x19a00,0xc8,0x348,0x19ad0,0x19a90,0xf0,0x370,0x19b60,0x19b20,0x118,0x398,0x19bf0,0x19bb0
.long 0x140,0x3c0,0x1a400,0x1a440,0x168,0x3e8,0x1a490,0x1a4d0,0x190,0x410,0x1a520,0x1a560,0x1b8,0x438,0x1a5b0,0x1a5f0
.long 0x1e0,0x460,0x1ae40,0x1ae00,0x208,0x488,0x1aed0,0x1ae90,0x230,0x4b0,0x1af60,0x1af20,0x258,0x4d8,0x1aff0,0x1afb0
.long 0x780,0x500,0x19040,0x19000,0x7a8,0x528,0x190d0,0x19090,0x7d0,0x550,0x19160,0x19120,0x7f8,0x578,0x191f0,0x191b0
.long 0x820,0x5a0,0x19a00,0x19a40,0x848,0x5c8,0x19a90,0x19ad0,0x870,0x5f0,0x19b20,0x19b60,0x898,0x618,0x19bb0,0x19bf0
.long 0x8c0,0x640,0x1a440,0x1a400,0x8e8,0x668,0x1a4d0,0x1a490,0x910,0x690,0x1a560,0x1a520,0x938,0x6b8,0x1a5f0,0x1a5b0
.long 0x960,0x6e0,0x1ae00,0x1ae40,0x988,0x708,0x1ae90,0x1aed0,0x9b0,0x730,0x1af20,0x1af60,0x9d8,0x758,0x1afb0,0x1aff0
.long 0xa00,0xc80,0x19000,0x19040,0xa28,0xca8,0x19090,0x190d0,0xa50,0xcd0,0x19120,0x19160,0xa78,0xcf8,0x191b0,0x191f0
.long 0xaa0,0xd20,0x19a40,0x19a00,0xac8,0xd48,0x19ad0,0x19a90,0xaf0,0xd70,0x19b60,0x19b20,0xb18,0xd98,0x19bf0,0x19bb0
.long 0xb40,0xdc0,0x1a400,0x1a440,0xb68,0xde8,0x1a490,0x1a4d0,0xb90,0xe10,0x1a520,0x1a560,0xbb8,0xe38,0x1a5b0,0x1a5f0
.long 0xbe0,0xe60,0x1ae40,0x1ae00,0xc08,0xe88,0x1aed0,0x1ae90,0xc30,0xeb0,0x1af60,0x1af20,0xc58,0xed8,0x1aff0,0x1afb0
.long 0x1180,0xf00,0x19040,0x19000,0x11a8,0xf28,0x190d0,0x19090,0x11d0,0xf50,0x19160,0x19120,0x11f8,0xf78,0x191f0,0x191b0
.long 0x1220,0xfa0,0x19a00,0x19a40,0x1248,0xfc8,0x19a90,0x19ad0,0x1270,0xff0,0x19b20,0x19b60,0x1298,0x1018,0x19bb0,0x19bf0
.long 0x12c0,0x1040,0x1a440,0x1a400,0x12e8,0x1068,0x1a4d0,0x1a490,0x1310,0x1090,0x1a560,0x1a520,0x1338,0x10b8,0x1a5f0,0x1a5b0
.long 0x1360,0x10e0,0x1ae00,0x1ae40,0x1388,0x1108,0x1ae90,0x1aed0,0x13b0,0x1130,0x1af20,0x1af60,0x13d8,0x1158,0x1afb0,0x1aff0
.long 0x0,0x0,0x0,0x27ea0,0x500,0x4,0x10,0x27ea0,0xa00,0x8,0x20,0x27ea0,0xf00,0xc,0x30,0x27ea0
.long 0x1400,0x10,0x40,0x27ea0,0x1900,0x14,0x50,0x27ea0,0x1e00,0x18,0x60,0x27ea0,0x2300,0x1c,0x70,0x27ea0
.long 0x2800,0x20,0x80,0x27ea0,0x2d00,0x24,0x90,0x27ea0,0x3200,0x28,0xa0,0x27ea0,0x3700,0x2c,0xb0,0x27ea0
.long 0x3c00,0x30,0xc0,0x27ea0,0x4100,0x34,0xd0,0x27ea0,0x4600,0x38,0xe0,0x27ea0,0x4b00,0x3c,0xf0,0x27ea0
.long 0x28,0x0,0x400,0x27ea0,0x528,0x4,0x410,0x27ea0,0xa28,0x8,0x420,0x27ea0,0xf28,0xc,0x430,0x27ea0
.long 0x1428,0x10,0x440,0x27ea0,0x1928,0x14,0x450,0x27ea0,0x1e28,0x18,0x460,0x27ea0,0x2328,0x1c,0x470,0x27ea0
.long 0x2828,0x20,0x480,0x27ea0,0x2d28,0x24,0x490,0x27ea0,0x3228,0x28,0x4a0,0x27ea0,0x3728,0x2c,0x4b0,0x27ea0
.long 0x3c28,0x30,0x4c0,0x27ea0,0x4128,0x34,0x4d0,0x27ea0,0x4628,0x38,0x4e0,0x27ea0,0x4b28,0x3c,0x4f0,0x27ea0
.long 0x50,0x0,0x800,0x27ea0,0x550,0x4,0x810,0x27ea0,0xa50,0x8,0x820,0x27ea0,0xf50,0xc,0x830,0x27ea0
.long 0x1450,0x10,0x840,0x27ea0,0x1950,0x14,0x850,0x27ea0,0x1e50,0x18,0x860,0x27ea0,0x2350,0x1c,0x870,0x27ea0
.long 0x2850,0x20,0x880,0x27ea0,0x2d50,0x24,0x890,0x27ea0,0x3250,0x28,0x8a0,0x27ea0,0x3750,0x2c,0x8b0,0x27ea0
.long 0x3c50,0x30,0x8c0,0x27ea0,0x4150,0x34,0x8d0,0x27ea0,0x4650,0x38,0x8e0,0x27ea0,0x4b50,0x3c,0x8f0,0x27ea0
.long 0x78,0x0,0xc00,0x27ea0,0x578,0x4,0xc10,0x27ea0,0xa78,0x8,0xc20,0x27ea0,0xf78,0xc,0xc30,0x27ea0
.long 0x1478,0x10,0xc40,0x27ea0,0x1978,0x14,0xc50,0x27ea0,0x1e78,0x18,0xc60,0x27ea0,0x2378,0x1c,0xc70,0x27ea0
.long 0x2878,0x20,0xc80,0x27ea0,0x2d78,0x24,0xc90,0x27ea0,0x3278,0x28,0xca0,0x27ea0,0x3778,0x2c,0xcb0,0x27ea0
.long 0x3c78,0x30,0xcc0,0x27ea0,0x4178,0x34,0xcd0,0x27ea0,0x4678,0x38,0xce0,0x27ea0,0x4b78,0x3c,0xcf0,0x27ea0
.long 0xffff,0x0,0x0,0x0,0x0,0x0,0x0,0x0,0xffff0000,0x0,0x0,0x0,0x0,0x0,0x0,0x0
.long 0x0,0xffff,0x0,0x0,0x0,0x0,0x0,0x0,0x0,0xffff0000,0x0,0x0,0x0,0x0,0x0,0x0
.long 0x0,0x0,0xffff,0x0,0x0,0x0,0x0,0x0,0x0,0x0,0xffff0000,0x0,0x0,0x0,0x0,0x0
.long 0x0,0x0,0x0,0xffff,0x0,0x0,0x0,0x0,0x0,0x0,0x0,0xffff0000,0x0,0x0,0x0,0x0
.long 0x0,0x0,0x0,0x0,0xffff,0x0,0x0,0x0,0x0,0x0,0x0,0x0,0xffff0000,0x0,0x0,0x0
.long 0x0,0x0,0x0,0x0,0x0,0xffff,0x0,0x0,0x0,0x0,0x0,0x0,0x0,0xffff0000,0x0,0x0
.long 0x0,0x0,0x0,0x0,0x0,0x0,0xffff,0x0,0x0,0x0,0x0,0x0,0x0,0x0,0xffff0000,0x0
.long 0x0,0x0,0x0,0x0,0x0,0x0,0x0,0xffff,0x0,0x0,0x0,0x0,0x0,0x0,0x0,0xffff0000
.long 0x0,0x0,0x0,0x0,0x0,0x0,0x0,0x0,0x0,0x0,0x0,0x0,0x0,0x0,0x0,0x0
.long 0x0,0x0,0x0,0x0,0x0,0x0,0x0,0x0,0x0,0x0,0x0,0x0,0x0,0x0,0x0,0x0
.long 0x0,0x0,0x0,0x0,0x0,0x0,0x0,0x0,0x0,0x0,0x0,0x0,0x0,0x0,0x0,0x0
.long 0x0,0x0,0x0,0x0,0x0,0x0,0x0,0x0,0x0,0x0,0x0,0x0,0x0,0x0,0x0,0x0
.long 0x0,0x0,0x0,0x0,0x0,0x0,0x0,0x0,0x0,0x0,0x0,0x0,0x0,0x0,0x0,0x0
.long 0x0,0x0,0x0,0x0,0x0,0x0,0x0,0x0,0x0,0x0,0x0,0x0,0x0,0x0,0x0,0x0
.long 0x0,0x0,0x0,0x0,0x0,0x0,0x0,0x0,0x0,0x0,0x0,0x0,0x0,0x0,0x0,0x0
.long 0x0,0x0,0x0,0x0,0x0,0x0,0x0,0x0,0x0,0x0,0x0,0x0,0x0,0x0,0x0,0x0
.long 0x0,0x280,0x19010,0x19050,0x28,0x2a8,0x19080,0x190c0,0x50,0x2d0,0x19130,0x19170,0x78,0x2f8,0x191a0,0x191e0
.long 0xa0,0x320,0x19a50,0x19a10,0xc8,0x348,0x19ac0,0x19a80,0xf0,0x370,0x19b70,0x19b30,0x118,0x398,0x19be0,0x19ba0
.long 0x140,0x3c0,0x1a410,0x1a450,0x168,0x3e8,0x1a480,0x1a4c0,0x190,0x410,0x1a530,0x1a570,0x1b8,0x438,0x1a5a0,0x1a5e0
.long 0x1e0,0x460,0x1ae50,0x1ae10,0x208,0x488,0x1aec0,0x1ae80,0x230,0x4b0,0x1af70,0x1af30,0x258,0x4d8,0x1afe0,0x1afa0
.long 0x780,0x500,0x19050,0x19010,0x7a8,0x528,0x190c0,0x19080,0x7d0,0x550,0x19170,0x19130,0x7f8,0x578,0x191e0,0x191a0
.long 0x820,0x5a0,0x19a10,0x19a50,0x848,0x5c8,0x19a80,0x19ac0,0x870,0x5f0,0x19b30,0x19b70,0x898,0x618,0x19ba0,0x19be0
.long 0x8c0,0x640,0x1a450,0x1a410,0x8e8,0x668,0x1a4c0,0x1a480,0x910,0x690,0x1a570,0x1a530,0x938,0x6b8,0x1a5e0,0x1a5a0
.long 0x960,0x6e0,0x1ae10,0x1ae50,0x988,0x708,0x1ae80,0x1aec0,0x9b0,0x730,0x1af30,0x1af70,0x9d8,0x758,0x1afa0,0x1afe0
.long 0xa00,0xc80,0x19010,0x19050,0xa28,0xca8,0x19080,0x190c0,0xa50,0xcd0,0x19130,0x19170,0xa78,0xcf8,0x191a0,0x191e0
.long 0xaa0,0xd20,0x19a50,0x19a10,0xac8,0xd48,0x19ac0,0x19a80,0xaf0,0xd70,0x19b70,0x19b30,0xb18,0xd98,0x19be0,0x19ba0
.long 0xb40,0xdc0,0x1a410,0x1a450,0xb68,0xde8,0x1a480,0x1a4c0,0xb90,0xe10,0x1a530,0x1a570,0xbb8,0xe38,0x1a5a0,0x1a5e0
.long 0xbe0,0xe60,0x1ae50,0x1ae10,0xc08,0xe88,0x1aec0,0x1ae80,0xc30,0xeb0,0x1af70,0x1af30,0xc58,0xed8,0x1afe0,0x1afa0
.long 0x1180,0xf00,0x19050,0x19010,0x11a8,0xf28,0x190c0,0x19080,0x11d0,0xf50,0x19170,0x19130,0x11f8,0xf78,0x191e0,0x191a0
.long 0x1220,0xfa0,0x19a10,0x19a50,0x1248,0xfc8,0x19a80,0x19ac0,0x1270,0xff0,0x19b30,0x19b70,0x1298,0x1018,0x19ba0,0x19be0
.long 0x12c0,0x1040,0x1a450,0x1a410,0x12e8,0x1068,0x1a4c0,0x1a480,0x1310,0x1090,0x1a570,0x1a530,0x1338,0x10b8,0x1a5e0,0x1a5a0
.long 0x1360,0x10e0,0x1ae10,0x1ae50,0x1388,0x1108,0x1ae80,0x1aec0,0x13b0,0x1130,0x1af30,0x1af70,0x13d8,0x1158,0x1afa0,0x1afe0
.long 0x5000,0x40,0x100,0x27ea0,0x5500,0x44,0x110,0x27ea0,0x5a00,0x48,0x120,0x27ea0,0x5f00,0x4c,0x130,0x27ea0
.long 0x6400,0x50,0x140,0x27ea0,0x6900,0x54,0x150,0x27ea0,0x6e00,0x58,0x160,0x27ea0,0x7300,0x5c,0x170,0x27ea0
.long 0x7800,0x60,0x180,0x27ea0,0x7d00,0x64,0x190,0x27ea0,0x8200,0x68,0x1a0,0x27ea0,0x8700,0x6c,0x1b0,0x27ea0
.long 0x8c00,0x70,0x1c0,0x27ea0,0x9100,0x74,0x1d0,0x27ea0,0x9600,0x78,0x1e0,0x27ea0,0x9b00,0x7c,0x1f0,0x27ea0
.long 0x5028,0x40,0x500,0x27ea0,0x5528,0x44,0x510,0x27ea0,0x5a28,0x48,0x520,0x27ea0,0x5f28,0x4c,0x530,0x27ea0
.long 0x6428,0x50,0x540,0x27ea0,0x6928,0x54,0x550,0x27ea0,0x6e28,0x58,0x560,0x27ea0,0x7328,0x5c,0x570,0x27ea0
.long 0x7828,0x60,0x580,0x27ea0,0x7d28,0x64,0x590,0x27ea0,0x8228,0x68,0x5a0,0x27ea0,0x8728,0x6c,0x5b0,0x27ea0
.long 0x8c28,0x70,0x5c0,0x27ea0,0x9128,0x74,0x5d0,0x27ea0,0x9628,0x78,0x5e0,0x27ea0,0x9b28,0x7c,0x5f0,0x27ea0
.long 0x5050,0x40,0x900,0x27ea0,0x5550,0x44,0x910,0x27ea0,0x5a50,0x48,0x920,0x27ea0,0x5f50,0x4c,0x930,0x27ea0
.long 0x6450,0x50,0x940,0x27ea0,0x6950,0x54,0x950,0x27ea0,0x6e50,0x58,0x960,0x27ea0,0x7350,0x5c,0x970,0x27ea0
.long 0x7850,0x60,0x980,0x27ea0,0x7d50,0x64,0x990,0x27ea0,0x8250,0x68,0x9a0,0x27ea0,0x8750,0x6c,0x9b0,0x27ea0
.long 0x8c50,0x70,0x9c0,0x27ea0,0x9150,0x74,0x9d0,0x27ea0,0x9650,0x78,0x9e0,0x27ea0,0x9b50,0x7c,0x9f0,0x27ea0
.long 0x5078,0x40,0xd00,0x27ea0,0x5578,0x44,0xd10,0x27ea0,0x5a78,0x48,0xd20,0x27ea0,0x5f78,0x4c,0xd30,0x27ea0
.long 0x6478,0x50,0xd40,0x27ea0,0x6978,0x54,0xd50,0x27ea0,0x6e78,0x58,0xd60,0x27ea0,0x7378,0x5c,0xd70,0x27ea0
.long 0x7878,0x60,0xd80,0x27ea0,0x7d78,0x64,0xd90,0x27ea0,0x8278,0x68,0xda0,0x27ea0,0x8778,0x6c,0xdb0,0x27ea0
.long 0x8c78,0x70,0xdc0,0x27ea0,0x9178,0x74,0xdd0,0x27ea0,0x9678,0x78,0xde0,0x27ea0,0x9b78,0x7c,0xdf0,0x27ea0
.long 0xffff,0x0,0x0,0x0,0x0,0x0,0x0,0x0,0xffff0000,0x0,0x0,0x0,0x0,0x0,0x0,0x0
.long 0x0,0xffff,0x0,0x0,0x0,0x0,0x0,0x0,0x0,0xffff0000,0x0,0x0,0x0,0x0,0x0,0x0
.long 0x0,0x0,0xffff,0x0,0x0,0x0,0x0,0x0,0x0,0x0,0xffff0000,0x0,0x0,0x0,0x0,0x0
.long 0x0,0x0,0x0,0xffff,0x0,0x0,0x0,0x0,0x0,0x0,0x0,0xffff0000,0x0,0x0,0x0,0x0
.long 0x0,0x0,0x0,0x0,0xffff,0x0,0x0,0x0,0x0,0x0,0x0,0x0,0xffff0000,0x0,0x0,0x0
.long 0x0,0x0,0x0,0x0,0x0,0xffff,0x0,0x0,0x0,0x0,0x0,0x0,0x0,0xffff0000,0x0,0x0
.long 0x0,0x0,0x0,0x0,0x0,0x0,0xffff,0x0,0x0,0x0,0x0,0x0,0x0,0x0,0xffff0000,0x0
.long 0x0,0x0,0x0,0x0,0x0,0x0,0x0,0xffff,0x0,0x0,0x0,0x0,0x0,0x0,0x0,0xffff0000
.long 0x0,0x0,0x0,0x0,0x0,0x0,0x0,0x0,0x0,0x0,0x0,0x0,0x0,0x0,0x0,0x0
.long 0x0,0x0,0x0,0x0,0x0,0x0,0x0,0x0,0x0,0x0,0x0,0x0,0x0,0x0,0x0,0x0
.long 0x0,0x0,0x0,0x0,0x0,0x0,0x0,0x0,0x0,0x0,0x0,0x0,0x0,0x0,0x0,0x0
.long 0x0,0x0,0x0,0x0,0x0,0x0,0x0,0x0,0x0,0x0,0x0,0x0,0x0,0x0,0x0,0x0
.long 0x0,0x0,0x0,0x0,0x0,0x0,0x0,0x0,0x0,0x0,0x0,0x0,0x0,0x0,0x0,0x0
.long 0x0,0x0,0x0,0x0,0x0,0x0,0x0,0x0,0x0,0x0,0x0,0x0,0x0,0x0,0x0,0x0
.long 0x0,0x0,0x0,0x0,0x0,0x0,0x0,0x0,0x0,0x0,0x0,0x0,0x0,0x0,0x0,0x0
.long 0x0,0x0,0x0,0x0,0x0,0x0,0x0,0x0,0x0,0x0,0x0,0x0,0x0,0x0,0x0,0x0
.long 0x0,0x280,0x19020,0x19060,0x28,0x2a8,0x190b0,0x190f0,0x50,0x2d0,0x19100,0x19140,0x78,0x2f8,0x19190,0x191d0
.long 0xa0,0x320,0x19a60,0x19a20,0xc8,0x348,0x19af0,0x19ab0,0xf0,0x370,0x19b40,0x19b00,0x118,0x398,0x19bd0,0x19b90
.long 0x140,0x3c0,0x1a420,0x1a460,0x168,0x3e8,0x1a4b0,0x1a4f0,0x190,0x410,0x1a500,0x1a540,0x1b8,0x438,0x1a590,0x1a5d0
.long 0x1e0,0x460,0x1ae60,0x1ae20,0x208,0x488,0x1aef0,0x1aeb0,0x230,0x4b0,0x1af40,0x1af00,0x258,0x4d8,0x1afd0,0x1af90
.long 0x780,0x500,0x19060,0x19020,0x7a8,0x528,0x190f0,0x190b0,0x7d0,0x550,0x19140,0x19100,0x7f8,0x578,0x191d0,0x19190
.long 0x820,0x5a0,0x19a20,0x19a60,0x848,0x5c8,0x19ab0,0x19af0,0x870,0x5f0,0x19b00,0x19b40,0x898,0x618,0x19b90,0x19bd0
.long 0x8c0,0x640,0x1a460,0x1a420,0x8e8,0x668,0x1a4f0,0x1a4b0,0x910,0x690,0x1a540,0x1a500,0x938,0x6b8,0x1a5d0,0x1a590
.long 0x960,0x6e0,0x1ae20,0x1ae60,0x988,0x708,0x1aeb0,0x1aef0,0x9b0,0x730,0x1af00,0x1af40,0x9d8,0x758,0x1af90,0x1afd0
.long 0xa00,0xc80,0x19020,0x19060,0xa28,0xca8,0x190b0,0x190f0,0xa50,0xcd0,0x19100,0x19140,0xa78,0xcf8,0x19190,0x191d0
.long 0xaa0,0xd20,0x19a60,0x19a20,0xac8,0xd48,0x19af0,0x19ab0,0xaf0,0xd70,0x19b40,0x19b00,0xb18,0xd98,0x19bd0,0x19b90
.long 0xb40,0xdc0,0x1a420,0x1a460,0xb68,0xde8,0x1a4b0,0x1a4f0,0xb90,0xe10,0x1a500,0x1a540,0xbb8,0xe38,0x1a590,0x1a5d0
.long 0xbe0,0xe60,0x1ae60,0x1ae20,0xc08,0xe88,0x1aef0,0x1aeb0,0xc30,0xeb0,0x1af40,0x1af00,0xc58,0xed8,0x1afd0,0x1af90
.long 0x1180,0xf00,0x19060,0x19020,0x11a8,0xf28,0x190f0,0x190b0,0x11d0,0xf50,0x19140,0x19100,0x11f8,0xf78,0x191d0,0x19190
.long 0x1220,0xfa0,0x19a20,0x19a60,0x1248,0xfc8,0x19ab0,0x19af0,0x1270,0xff0,0x19b00,0x19b40,0x1298,0x1018,0x19b90,0x19bd0
.long 0x12c0,0x1040,0x1a460,0x1a420,0x12e8,0x1068,0x1a4f0,0x1a4b0,0x1310,0x1090,0x1a540,0x1a500,0x1338,0x10b8,0x1a5d0,0x1a590
.long 0x1360,0x10e0,0x1ae20,0x1ae60,0x1388,0x1108,0x1aeb0,0x1aef0,0x13b0,0x1130,0x1af00,0x1af40,0x13d8,0x1158,0x1af90,0x1afd0
.long 0xa000,0x80,0x200,0x27ea0,0xa500,0x84,0x210,0x27ea0,0xaa00,0x88,0x220,0x27ea0,0xaf00,0x8c,0x230,0x27ea0
.long 0xb400,0x90,0x240,0x27ea0,0xb900,0x94,0x250,0x27ea0,0xbe00,0x98,0x260,0x27ea0,0xc300,0x9c,0x270,0x27ea0
.long 0xc800,0xa0,0x280,0x27ea0,0xcd00,0xa4,0x290,0x27ea0,0xd200,0xa8,0x2a0,0x27ea0,0xd700,0xac,0x2b0,0x27ea0
.long 0xdc00,0xb0,0x2c0,0x27ea0,0xe100,0xb4,0x2d0,0x27ea0,0xe600,0xb8,0x2e0,0x27ea0,0xeb00,0xbc,0x2f0,0x27ea0
.long 0xa028,0x80,0x600,0x27ea0,0xa528,0x84,0x610,0x27ea0,0xaa28,0x88,0x620,0x27ea0,0xaf28,0x8c,0x630,0x27ea0
.long 0xb428,0x90,0x640,0x27ea0,0xb928,0x94,0x650,0x27ea0,0xbe28,0x98,0x660,0x27ea0,0xc328,0x9c,0x670,0x27ea0
.long 0xc828,0xa0,0x680,0x27ea0,0xcd28,0xa4,0x690,0x27ea0,0xd228,0xa8,0x6a0,0x27ea0,0xd728,0xac,0x6b0,0x27ea0
.long 0xdc28,0xb0,0x6c0,0x27ea0,0xe128,0xb4,0x6d0,0x27ea0,0xe628,0xb8,0x6e0,0x27ea0,0xeb28,0xbc,0x6f0,0x27ea0
.long 0xa050,0x80,0xa00,0x27ea0,0xa550,0x84,0xa10,0x27ea0,0xaa50,0x88,0xa20,0x27ea0,0xaf50,0x8c,0xa30,0x27ea0
.long 0xb450,0x90,0xa40,0x27ea0,0xb950,0x94,0xa50,0x27ea0,0xbe50,0x98,0xa60,0x27ea0,0xc350,0x9c,0xa70,0x27ea0
.long 0xc850,0xa0,0xa80,0x27ea0,0xcd50,0xa4,0xa90,0x27ea0,0xd250,0xa8,0xaa0,0x27ea0,0xd750,0xac,0xab0,0x27ea0
.long 0xdc50,0xb0,0xac0,0x27ea0,0xe150,0xb4,0xad0,0x27ea0,0xe650,0xb8,0xae0,0x27ea0,0xeb50,0xbc,0xaf0,0x27ea0
.long 0xa078,0x80,0xe00,0x27ea0,0xa578,0x84,0xe10,0x27ea0,0xaa78,0x88,0xe20,0x27ea0,0xaf78,0x8c,0xe30,0x27ea0
.long 0xb478,0x90,0xe40,0x27ea0,0xb978,0x94,0xe50,0x27ea0,0xbe78,0x98,0xe60,0x27ea0,0xc378,0x9c,0xe70,0x27ea0
.long 0xc878,0xa0,0xe80,0x27ea0,0xcd78,0xa4,0xe90,0x27ea0,0xd278,0xa8,0xea0,0x27ea0,0xd778,0xac,0xeb0,0x27ea0
.long 0xdc78,0xb0,0xec0,0x27ea0,0xe178,0xb4,0xed0,0x27ea0,0xe678,0xb8,0xee0,0x27ea0,0xeb78,0xbc,0xef0,0x27ea0
.long 0xffff,0x0,0x0,0x0,0x0,0x0,0x0,0x0,0xffff0000,0x0,0x0,0x0,0x0,0x0,0x0,0x0
.long 0x0,0xffff,0x0,0x0,0x0,0x0,0x0,0x0,0x0,0xffff0000,0x0,0x0,0x0,0x0,0x0,0x0
.long 0x0,0x0,0xffff,0x0,0x0,0x0,0x0,0x0,0x0,0x0,0xffff0000,0x0,0x0,0x0,0x0,0x0
.long 0x0,0x0,0x0,0xffff,0x0,0x0,0x0,0x0,0x0,0x0,0x0,0xffff0000,0x0,0x0,0x0,0x0
.long 0x0,0x0,0x0,0x0,0xffff,0x0,0x0,0x0,0x0,0x0,0x0,0x0,0xffff0000,0x0,0x0,0x0
.long 0x0,0x0,0x0,0x0,0x0,0xffff,0x0,0x0,0x0,0x0,0x0,0x0,0x0,0xffff0000,0x0,0x0
.long 0x0,0x0,0x0,0x0,0x0,0x0,0xffff,0x0,0x0,0x0,0x0,0x0,0x0,0x0,0xffff0000,0x0
.long 0x0,0x0,0x0,0x0,0x0,0x0,0x0,0xffff,0x0,0x0,0x0,0x0,0x0,0x0,0x0,0xffff0000
.long 0x0,0x0,0x0,0x0,0x0,0x0,0x0,0x0,0x0,0x0,0x0,0x0,0x0,0x0,0x0,0x0
.long 0x0,0x0,0x0,0x0,0x0,0x0,0x0,0x0,0x0,0x0,0x0,0x0,0x0,0x0,0x0,0x0
.long 0x0,0x0,0x0,0x0,0x0,0x0,0x0,0x0,0x0,0x0,0x0,0x0,0x0,0x0,0x0,0x0
.long 0x0,0x0,0x0,0x0,0x0,0x0,0x0,0x0,0x0,0x0,0x0,0x0,0x0,0x0,0x0,0x0
.long 0x0,0x0,0x0,0x0,0x0,0x0,0x0,0x0,0x0,0x0,0x0,0x0,0x0,0x0,0x0,0x0
.long 0x0,0x0,0x0,0x0,0x0,0x0,0x0,0x0,0x0,0x0,0x0,0x0,0x0,0x0,0x0,0x0
.long 0x0,0x0,0x0,0x0,0x0,0x0,0x0,0x0,0x0,0x0,0x0,0x0,0x0,0x0,0x0,0x0
.long 0x0,0x0,0x0,0x0,0x0,0x0,0x0,0x0,0x0,0x0,0x0,0x0,0x0,0x0,0x0,0x0
.long 0x0,0x280,0x19030,0x19070,0x28,0x2a8,0x190a0,0x190e0,0x50,0x2d0,0x19110,0x19150,0x78,0x2f8,0x19180,0x191c0
.long 0xa0,0x320,0x19a70,0x19a30,0xc8,0x348,0x19ae0,0x19aa0,0xf0,0x370,0x19b50,0x19b10,0x118,0x398,0x19bc0,0x19b80
.long 0x140,0x3c0,0x1a430,0x1a470,0x168,0x3e8,0x1a4a0,0x1a4e0,0x190,0x410,0x1a510,0x1a550,0x1b8,0x438,0x1a580,0x1a5c0
.long 0x1e0,0x460,0x1ae70,0x1ae30,0x208,0x488,0x1aee0,0x1aea0,0x230,0x4b0,0x1af50,0x1af10,0x258,0x4d8,0x1afc0,0x1af80
.long 0x780,0x500,0x19070,0x19030,0x7a8,0x528,0x190e0,0x190a0,0x7d0,0x550,0x19150,0x19110,0x7f8,0x578,0x191c0,0x19180
.long 0x820,0x5a0,0x19a30,0x19a70,0x848,0x5c8,0x19aa0,0x19ae0,0x870,0x5f0,0x19b10,0x19b50,0x898,0x618,0x19b80,0x19bc0
.long 0x8c0,0x640,0x1a470,0x1a430,0x8e8,0x668,0x1a4e0,0x1a4a0,0x910,0x690,0x1a550,0x1a510,0x938,0x6b8,0x1a5c0,0x1a580
.long 0x960,0x6e0,0x1ae30,0x1ae70,0x988,0x708,0x1aea0,0x1aee0,0x9b0,0x730,0x1af10,0x1af50,0x9d8,0x758,0x1af80,0x1afc0
.long 0xa00,0xc80,0x19030,0x19070,0xa28,0xca8,0x190a0,0x190e0,0xa50,0xcd0,0x19110,0x19150,0xa78,0xcf8,0x19180,0x191c0
.long 0xaa0,0xd20,0x19a70,0x19a30,0xac8,0xd48,0x19ae0,0x19aa0,0xaf0,0xd70,0x19b50,0x19b10,0xb18,0xd98,0x19bc0,0x19b80
.long 0xb40,0xdc0,0x1a430,0x1a470,0xb68,0xde8,0x1a4a0,0x1a4e0,0xb90,0xe10,0x1a510,0x1a550,0xbb8,0xe38,0x1a580,0x1a5c0
.long 0xbe0,0xe60,0x1ae70,0x1ae30,0xc08,0xe88,0x1aee0,0x1aea0,0xc30,0xeb0,0x1af50,0x1af10,0xc58,0xed8,0x1afc0,0x1af80
.long 0x1180,0xf00,0x19070,0x19030,0x11a8,0xf28,0x190e0,0x190a0,0x11d0,0xf50,0x19150,0x19110,0x11f8,0xf78,0x191c0,0x19180
.long 0x1220,0xfa0,0x19a30,0x19a70,0x1248,0xfc8,0x19aa0,0x19ae0,0x1270,0xff0,0x19b10,0x19b50,0x1298,0x1018,0x19b80,0x19bc0
.long 0x12c0,0x1040,0x1a470,0x1a430,0x12e8,0x1068,0x1a4e0,0x1a4a0,0x1310,0x1090,0x1a550,0x1a510,0x1338,0x10b8,0x1a5c0,0x1a580
.long 0x1360,0x10e0,0x1ae30,0x1ae70,0x1388,0x1108,0x1aea0,0x1aee0,0x13b0,0x1130,0x1af10,0x1af50,0x13d8,0x1158,0x1af80,0x1afc0
.long 0xf000,0xc0,0x300,0x27ea0,0xf500,0xc4,0x310,0x27ea0,0xfa00,0xc8,0x320,0x27ea0,0xff00,0xcc,0x330,0x27ea0
.long 0x10400,0xd0,0x340,0x27ea0,0x10900,0xd4,0x350,0x27ea0,0x10e00,0xd8,0x360,0x27ea0,0x11300,0xdc,0x370,0x27ea0
.long 0x11800,0xe0,0x380,0x27ea0,0x11d00,0xe4,0x390,0x27ea0,0x12200,0xe8,0x3a0,0x27ea0,0x12700,0xec,0x3b0,0x27ea0
.long 0x12c00,0xf0,0x3c0,0x27ea0,0x13100,0xf4,0x3d0,0x27ea0,0x13600,0xf8,0x3e0,0x27ea0,0x13b00,0xfc,0x3f0,0x27ea0
.long 0xf028,0xc0,0x700,0x27ea0,0xf528,0xc4,0x710,0x27ea0,0xfa28,0xc8,0x720,0x27ea0,0xff28,0xcc,0x730,0x27ea0
.long 0x10428,0xd0,0x740,0x27ea0,0x10928,0xd4,0x750,0x27ea0,0x10e28,0xd8,0x760,0x27ea0,0x11328,0xdc,0x770,0x27ea0
.long 0x11828,0xe0,0x780,0x27ea0,0x11d28,0xe4,0x790,0x27ea0,0x12228,0xe8,0x7a0,0x27ea0,0x12728,0xec,0x7b0,0x27ea0
.long 0x12c28,0xf0,0x7c0,0x27ea0,0x13128,0xf4,0x7d0,0x27ea0,0x13628,0xf8,0x7e0,0x27ea0,0x13b28,0xfc,0x7f0,0x27ea0
.long 0xf050,0xc0,0xb00,0x27ea0,0xf550,0xc4,0xb10,0x27ea0,0xfa50,0xc8,0xb20,0x27ea0,0xff50,0xcc,0xb30,0x27ea0
.long 0x10450,0xd0,0xb40,0x27ea0,0x10950,0xd4,0xb50,0x27ea0,0x10e50,0xd8,0xb60,0x27ea0,0x11350,0xdc,0xb70,0x27ea0
.long 0x11850,0xe0,0xb80,0x27ea0,0x11d50,0xe4,0xb90,0x27ea0,0x12250,0xe8,0xba0,0x27ea0,0x12750,0xec,0xbb0,0x27ea0
.long 0x12c50,0xf0,0xbc0,0x27ea0,0x13150,0xf4,0xbd0,0x27ea0,0x13650,0xf8,0xbe0,0x27ea0,0x13b50,0xfc,0xbf0,0x27ea0
.long 0xf078,0xc0,0xf00,0x27ea0,0xf578,0xc4,0xf10,0x27ea0,0xfa78,0xc8,0xf20,0x27ea0,0xff78,0xcc,0xf30,0x27ea0
.long 0x10478,0xd0,0xf40,0x27ea0,0x10978,0xd4,0xf50,0x27ea0,0x10e78,0xd8,0xf60,0x27ea0,0x11378,0xdc,0xf70,0x27ea0
.long 0x11878,0xe0,0xf80,0x27ea0,0x11d78,0xe4,0xf90,0x27ea0,0x12278,0xe8,0xfa0,0x27ea0,0x12778,0xec,0xfb0,0x27ea0
.long 0x12c78,0xf0,0xfc0,0x27ea0,0x13178,0xf4,0xfd0,0x27ea0,0x13678,0xf8,0xfe0,0x27ea0,0x13b78,0xfc,0xff0,0x27ea0
.long 0xffff,0x0,0x0,0x0,0x0,0x0,0x0,0x0,0xffff0000,0x0,0x0,0x0,0x0,0x0,0x0,0x0
.long 0x0,0xffff,0x0,0x0,0x0,0x0,0x0,0x0,0x0,0xffff0000,0x0,0x0,0x0,0x0,0x0,0x0
.long 0x0,0x0,0xffff,0x0,0x0,0x0,0x0,0x0,0x0,0x0,0xffff0000,0x0,0x0,0x0,0x0,0x0
.long 0x0,0x0,0x0,0xffff,0x0,0x0,0x0,0x0,0x0,0x0,0x0,0xffff0000,0x0,0x0,0x0,0x0
.long 0x0,0x0,0x0,0x0,0xffff,0x0,0x0,0x0,0x0,0x0,0x0,0x0,0xffff0000,0x0,0x0,0x0
.long 0x0,0x0,0x0,0x0,0x0,0xffff,0x0,0x0,0x0,0x0,0x0,0x0,0x0,0xffff0000,0x0,0x0
.long 0x0,0x0,0x0,0x0,0x0,0x0,0xffff,0x0,0x0,0x0,0x0,0x0,0x0,0x0,0xffff0000,0x0
.long 0x0,0x0,0x0,0x0,0x0,0x0,0x0,0xffff,0x0,0x0,0x0,0x0,0x0,0x0,0x0,0xffff0000
.long 0x0,0x0,0x0,0x0,0x0,0x0,0x0,0x0,0x0,0x0,0x0,0x0,0x0,0x0,0x0,0x0
.long 0x0,0x0,0x0,0x0,0x0,0x0,0x0,0x0,0x0,0x0,0x0,0x0,0x0,0x0,0x0,0x0
.long 0x0,0x0,0x0,0x0,0x0,0x0,0x0,0x0,0x0,0x0,0x0,0x0,0x0,0x0,0x0,0x0
.long 0x0,0x0,0x0,0x0,0x0,0x0,0x0,0x0,0x0,0x0,0x0,0x0,0x0,0x0,0x0,0x0
.long 0x0,0x0,0x0,0x0,0x0,0x0,0x0,0x0,0x0,0x0,0x0,0x0,0x0,0x0,0x0,0x0
.long 0x0,0x0,0x0,0x0,0x0,0x0,0x0,0x0,0x0,0x0,0x0,0x0,0x0,0x0,0x0,0x0
.long 0x0,0x0,0x0,0x0,0x0,0x0,0x0,0x0,0x0,0x0,0x0,0x0,0x0,0x0,0x0,0x0
.long 0x0,0x0,0x0,0x0,0x0,0x0,0x0,0x0,0x0,0x0,0x0,0x0,0x0,0x0,0x0,0x0
.size TABLES, 133376
.globl gated_mix__ssm_conv_s4d__grouped_kv_mqa__prompt_kernel
.p2align 8
.type gated_mix__ssm_conv_s4d__grouped_kv_mqa__prompt_kernel,@function
gated_mix__ssm_conv_s4d__grouped_kv_mqa__prompt_kernel:
    s_cmp_ge_u32 s2, 256
    s_cbranch_scc1 K_END
    s_load_dwordx16 s[40:55], s[0:1], 0
    s_load_dwordx16 s[56:71], s[0:1], 64
    s_getpc_b64 s[38:39]
PC0:
    s_mov_b64 s[72:73], s[38:39]
    s_sub_u32 s38, s38, PC0-TABLES
    s_subb_u32 s39, s39, 0
    v_lshrrev_b32 v4, 3, v0
    v_lshlrev_b32 v4, 12, v4
    s_lshr_b32 s6, s2, 3
    s_lshl_b32 s6, s6, 7
    v_add_u32 v4, s6, v4
    s_mov_b32 s7, IMG_END-TABLES-4
    v_min_u32 v4, s7, v4
    global_load_dword v252, v4, s[38:39]
    v_lshrrev_b32 v1, 6, v0
    v_lshlrev_b32 v2, 2, v0
    v_and_b32 v0, 63, v0
    v_readfirstlane_b32 s3, v1
    v_lshlrev_b32 v1, 4, v0
    v_min_u32 v2, 508, v2
    v_mov_b32 v3, 0
    v_add_u32 v2, 163328, v2
    ds_write_b32 v2, v3
    s_and_b32 s4, s2, 7
    s_lshl_b32 s4, s4, 2
    s_bfe_u32 s6, s2, 0x20003
    s_add_u32 s4, s4, s6
    s_lshr_b32 s5, s2, 5
    s_mul_i32 s6, s6, 5
    s_lshr_b32 s6, s6, 1
    s_mul_i32 s7, s5, 5
    s_lshr_b32 s7, s7, 2
    s_add_u32 s37, s6, s7
    s_sub_u32 s6, s37, 10
    s_min_u32 s37, s37, s6
    s_cmp_eq_u32 s3, 7
    s_cbranch_scc1 R_AUX
    s_cmp_ge_u32 s3, 4
    s_cbranch_scc1 R_KD
    s_setprio 2
    s_lshl_b32 s7, s3, 10
    s_add_u32 s6, s7, 256
    s_add_u32 s34, s38, s6
    s_addc_u32 s35, s39, 0
    global_load_dwordx4 v[8:11], v1, s[34:35] offset:0
    s_lshl_b32 s6, s5, 12
    s_add_u32 s7, s7, s6
    s_add_u32 s6, s7, 4352
    s_add_u32 s34, s38, s6
    s_addc_u32 s35, s39, 0
    global_load_dwordx4 v[12:15], v1, s[34:35] offset:0
    v_lshrrev_b32 v2, 3, v0
    v_lshrrev_b32 v4, 4, v0
    v_xor_b32 v4, v4, v0
    v_and_b32 v4, 7, v4
    v_mul_u32_u24 v2, 1280, v2
    v_xor_b32 v5, 4, v4
    v_lshl_add_u32 v5, v5, 4, v2
    v_lshl_add_u32 v2, v4, 4, v2
    v_add_u32 v5, 9216, v5
    s_lshl_b32 s6, s4, 2
    s_add_u32 s6, s6, s3
    s_mul_i32 s73, s6, 20480
    s_cmp_lt_u32 s5, 3
    s_cselect_b32 s75, 0, 3
    s_sub_u32 s75, s5, s75
    s_lshl_b32 s75, s75, 4
    s_cmp_lt_u32 s5, 6
    s_cselect_b32 s75, s75, 0
    s_cselect_b32 s76, 40, 2
    v_mul_u32_u24 v3, s76, v0
    s_lshl_b32 s76, s76, 6
    s_add_u32 s78, s37, s3
    s_sub_u32 s6, s78, 10
    s_min_u32 s78, s78, s6
    s_mul_i32 s74, s3, 10240
    s_lshl_b32 s6, s3, 10
    s_add_u32 m0, s6, 150784
    s_mov_b32 s10, 2621440
    s_mov_b32 s11, 0x00020000
    s_mov_b32 s19, 0x00020000
    s_lshl_b32 s72, s37, 7
    s_mul_i32 s79, s78, s76
    s_add_u32 s79, s79, s75
    s_lshl_b32 s85, s3, 2
    s_add_u32 s85, s85, 163328
    v_mov_b32 v16, 1
    s_waitcnt lgkmcnt(0)
    s_mov_b64 s[8:9], s[40:41]
    s_cmp_lt_u32 s5, 3
    s_cselect_b64 s[16:17], s[58:59], s[60:61]
    s_cmp_lt_u32 s5, 6
    s_cselect_b64 s[16:17], s[16:17], s[64:65]
    s_movk_i32 s18, 1284
    s_cselect_b32 s18, 25600, s18
    s_lshl_b32 s6, s3, 10
    s_add_u32 m0, s6, 150784
    s_nop 0
    buffer_load_dwordx4 v3, s[16:19], s79 offen lds
    s_add_u32 m0, m0, 4096
    s_add_u32 s78, s78, 4
    s_sub_u32 s6, s78, 10
    s_min_u32 s78, s78, s6
    s_mul_i32 s79, s78, s76
    s_add_u32 s79, s79, s75
    buffer_load_dwordx4 v3, s[16:19], s79 offen lds
    s_add_u32 m0, m0, 4096
    s_add_u32 s78, s78, 4
    s_sub_u32 s6, s78, 10
    s_min_u32 s78, s78, s6
    s_mul_i32 s79, s78, s76
    s_add_u32 s79, s79, s75
    buffer_load_dwordx4 v3, s[16:19], s79 offen lds
    s_add_u32 m0, s74, 0
    s_add_u32 s77, s72, s73
    buffer_load_dwordx4 v2, s[8:11], s77 offen lds
    buffer_load_dwordx4 v5, s[8:11], s77 offen offset:1024 lds
    s_add_u32 s72, s72, 128
    s_cmp_eq_u32 s72, 1280
    s_cselect_b32 s72, 0, s72
    s_add_u32 m0, s74, 2048
    s_add_u32 s77, s72, s73
    buffer_load_dwordx4 v2, s[8:11], s77 offen lds
    buffer_load_dwordx4 v5, s[8:11], s77 offen offset:1024 lds
    s_add_u32 s72, s72, 128
    s_cmp_eq_u32 s72, 1280
    s_cselect_b32 s72, 0, s72
    s_barrier
    s_add_u32 m0, s85, 0
    s_mov_b64 exec, 1
    global_load_lds_dword v1, s[38:39]
    s_mov_b64 exec, -1
    s_add_u32 m0, s74, 4096
    s_add_u32 s77, s72, s73
    buffer_load_dwordx4 v2, s[8:11], s77 offen lds
    buffer_load_dwordx4 v5, s[8:11], s77 offen offset:1024 lds
    s_add_u32 s72, s72, 128
    s_cmp_eq_u32 s72, 1280
    s_cselect_b32 s72, 0, s72
    s_add_u32 m0, s74, 6144
    s_add_u32 s77, s72, s73
    buffer_load_dwordx4 v2, s[8:11], s77 offen lds
    buffer_load_dwordx4 v5, s[8:11], s77 offen offset:1024 lds
    s_add_u32 s72, s72, 128
    s_cmp_eq_u32 s72, 1280
    s_cselect_b32 s72, 0, s72
    s_add_u32 m0, s74, 8192
    s_add_u32 s77, s72, s73
    buffer_load_dwordx4 v2, s[8:11], s77 offen lds
    buffer_load_dwordx4 v5, s[8:11], s77 offen offset:1024 lds
    s_add_u32 s72, s72, 128
    s_cmp_eq_u32 s72, 1280
    s_cselect_b32 s72, 0, s72
    s_add_u32 m0, s74, 109824
    s_add_u32 s77, s72, s73
    buffer_load_dwordx4 v2, s[8:11], s77 offen lds
    buffer_load_dwordx4 v5, s[8:11], s77 offen offset:1024 lds
    s_add_u32 s72, s72, 128
    s_cmp_eq_u32 s72, 1280
    s_cselect_b32 s72, 0, s72
    s_add_u32 m0, s74, 111872
    s_add_u32 s77, s72, s73
    buffer_load_dwordx4 v2, s[8:11], s77 offen lds
    buffer_load_dwordx4 v5, s[8:11], s77 offen offset:1024 lds
    s_add_u32 s72, s72, 128
    s_cmp_eq_u32 s72, 1280
    s_cselect_b32 s72, 0, s72
    s_add_u32 m0, s74, 113920
    s_add_u32 s77, s72, s73
    buffer_load_dwordx4 v2, s[8:11], s77 offen lds
    buffer_load_dwordx4 v5, s[8:11], s77 offen offset:1024 lds
    s_add_u32 s72, s72, 128
    s_cmp_eq_u32 s72, 1280
    s_cselect_b32 s72, 0, s72
    s_add_u32 m0, s74, 115968
    s_add_u32 s77, s72, s73
    buffer_load_dwordx4 v2, s[8:11], s77 offen lds
    buffer_load_dwordx4 v5, s[8:11], s77 offen offset:1024 lds
    s_add_u32 s72, s72, 128
    s_cmp_eq_u32 s72, 1280
    s_cselect_b32 s72, 0, s72
    s_add_u32 m0, s74, 118016
    s_add_u32 s77, s72, s73
    buffer_load_dwordx4 v2, s[8:11], s77 offen lds
    buffer_load_dwordx4 v5, s[8:11], s77 offen offset:1024 lds
    s_add_u32 s72, s72, 128
    s_cmp_eq_u32 s72, 1280
    s_cselect_b32 s72, 0, s72
    s_mov_b64 s[20:21], s[70:71]
    s_mov_b32 s22, 16777216
    s_mov_b32 s23, 0x00020000
    s_mul_i32 s80, s4, 6144
    s_add_u32 s80, s80, 9175040
    v_mov_b32 v7, 9453568
    buffer_load_dword v7, v7, s[20:23], 0 offen sc1
    s_and_b32 s7, s5, 3
    s_lshl_b32 s7, s7, 2
    s_add_u32 s7, s7, s3
    s_lshl_b32 s7, s7, 11
    s_add_u32 s6, s7, 45312
    s_add_u32 s34, s38, s6
    s_addc_u32 s35, s39, 0
    global_load_dwordx4 v[108:111], v1, s[34:35] offset:0
    global_load_dwordx4 v[112:115], v1, s[34:35] offset:1024
    s_waitcnt vmcnt(19)
    v_xor_b32 v18, 64, v8
    v_add_u32 v19, 109824, v8
    v_add_u32 v105, 109824, v18
    ds_read_b128 v[24:27], v8 offset:0
    ds_read_b128 v[28:31], v18 offset:0
    ds_read_b128 v[32:35], v8 offset:2048
    ds_read_b128 v[36:39], v18 offset:2048
    ds_read_b32 v17, v12
    s_cmp_lt_u32 s5, 3
    s_cbranch_scc1 G_PK
    s_cmp_ge_u32 s5, 6
    s_cbranch_scc1 G_PK
    s_waitcnt lgkmcnt(0)
    v_cmp_gt_u32 vcc, 1, v17
    s_nop 0
    s_cbranch_vccz CK_1
    s_mov_b32 s7, 0x40000
LP_2:
    ds_read_b32 v17, v12 offset:0
    s_sub_u32 s7, s7, 1
    s_waitcnt lgkmcnt(0)
    v_cmp_gt_u32 vcc, 1, v17
    s_cbranch_scc1 LPD_3
    s_cbranch_vccnz LP_2
LPD_3:
CK_1:
    ds_read_b64_tr_b16 v[160:161], v11 offset:0
    ds_read_b64_tr_b16 v[162:163], v11 offset:64
    ds_read_b64_tr_b16 v[164:165], v11 offset:512
    ds_read_b64_tr_b16 v[166:167], v11 offset:576
    ds_read_b64_tr_b16 v[168:169], v11 offset:1024
    ds_read_b64_tr_b16 v[170:171], v11 offset:1088
    ds_read_b64_tr_b16 v[172:173], v11 offset:1536
    ds_read_b64_tr_b16 v[174:175], v11 offset:1600
    s_waitcnt vmcnt(15)
    ds_read_b128 v[40:43], v8 offset:4096
    ds_read_b128 v[44:47], v18 offset:4096
    ds_read_b128 v[48:51], v8 offset:6144
    ds_read_b128 v[52:55], v18 offset:6144
    s_waitcnt lgkmcnt(4)
    v_mfma_f32_16x16x32_bf16 v[20:23], v[24:27], v[160:163], 0
    ds_read_b64_tr_b16 v[224:225], v11 offset:2048
    ds_read_b64_tr_b16 v[226:227], v11 offset:2112
    v_mfma_f32_16x16x32_bf16 v[20:23], v[28:31], v[164:167], v[20:23]
    ds_read_b64_tr_b16 v[228:229], v11 offset:2560
    ds_read_b64_tr_b16 v[230:231], v11 offset:2624
    v_mfma_f32_16x16x32_bf16 v[20:23], v[32:35], v[168:171], v[20:23]
    ds_read_b64_tr_b16 v[232:233], v11 offset:3072
    ds_read_b64_tr_b16 v[234:235], v11 offset:3136
    v_mfma_f32_16x16x32_bf16 v[20:23], v[36:39], v[172:175], v[20:23]
    ds_read_b64_tr_b16 v[236:237], v11 offset:3584
    ds_read_b64_tr_b16 v[238:239], v11 offset:3648
    s_waitcnt vmcnt(11)
    ds_read_b128 v[56:59], v8 offset:8192
    ds_read_b128 v[60:63], v18 offset:8192
    ds_read_b128 v[64:67], v19 offset:0
    ds_read_b128 v[68:71], v105 offset:0
    s_waitcnt lgkmcnt(4)
    v_mfma_f32_16x16x32_bf16 v[20:23], v[40:43], v[224:227], v[20:23]
    ds_read_b64_tr_b16 v[160:161], v11 offset:4096
    ds_read_b64_tr_b16 v[162:163], v11 offset:4160
    v_mfma_f32_16x16x32_bf16 v[20:23], v[44:47], v[228:231], v[20:23]
    ds_read_b64_tr_b16 v[164:165], v11 offset:4608
    ds_read_b64_tr_b16 v[166:167], v11 offset:4672
    v_mfma_f32_16x16x32_bf16 v[20:23], v[48:51], v[232:235], v[20:23]
    ds_read_b64_tr_b16 v[168:169], v11 offset:5120
    ds_read_b64_tr_b16 v[170:171], v11 offset:5184
    v_mfma_f32_16x16x32_bf16 v[20:23], v[52:55], v[236:239], v[20:23]
    ds_read_b64_tr_b16 v[172:173], v11 offset:5632
    ds_read_b64_tr_b16 v[174:175], v11 offset:5696
    s_waitcnt vmcnt(7)
    ds_read_b128 v[72:75], v19 offset:2048
    ds_read_b128 v[76:79], v105 offset:2048
    ds_read_b128 v[80:83], v19 offset:4096
    ds_read_b128 v[84:87], v105 offset:4096
    s_waitcnt lgkmcnt(4)
    v_mfma_f32_16x16x32_bf16 v[20:23], v[56:59], v[160:163], v[20:23]
    ds_read_b64_tr_b16 v[224:225], v11 offset:6144
    ds_read_b64_tr_b16 v[226:227], v11 offset:6208
    v_mfma_f32_16x16x32_bf16 v[20:23], v[60:63], v[164:167], v[20:23]
    ds_read_b64_tr_b16 v[228:229], v11 offset:6656
    ds_read_b64_tr_b16 v[230:231], v11 offset:6720
    v_mfma_f32_16x16x32_bf16 v[20:23], v[64:67], v[168:171], v[20:23]
    ds_read_b64_tr_b16 v[232:233], v11 offset:7168
    ds_read_b64_tr_b16 v[234:235], v11 offset:7232
    v_mfma_f32_16x16x32_bf16 v[20:23], v[68:71], v[172:175], v[20:23]
    ds_read_b64_tr_b16 v[236:237], v11 offset:7680
    ds_read_b64_tr_b16 v[238:239], v11 offset:7744
    s_waitcnt vmcnt(3)
    ds_read_b128 v[88:91], v19 offset:6144
    ds_read_b128 v[92:95], v105 offset:6144
    ds_read_b128 v[96:99], v19 offset:8192
    ds_read_b128 v[100:103], v105 offset:8192
    s_waitcnt lgkmcnt(4)
    v_mfma_f32_16x16x32_bf16 v[20:23], v[72:75], v[224:227], v[20:23]
    ds_read_b64_tr_b16 v[160:161], v11 offset:8192
    ds_read_b64_tr_b16 v[162:163], v11 offset:8256
    v_mfma_f32_16x16x32_bf16 v[20:23], v[76:79], v[228:231], v[20:23]
    ds_read_b64_tr_b16 v[164:165], v11 offset:8704
    ds_read_b64_tr_b16 v[166:167], v11 offset:8768
    v_mfma_f32_16x16x32_bf16 v[20:23], v[80:83], v[232:235], v[20:23]
    ds_read_b64_tr_b16 v[168:169], v11 offset:9216
    ds_read_b64_tr_b16 v[170:171], v11 offset:9280
    v_mfma_f32_16x16x32_bf16 v[20:23], v[84:87], v[236:239], v[20:23]
    ds_read_b64_tr_b16 v[172:173], v11 offset:9728
    ds_read_b64_tr_b16 v[174:175], v11 offset:9792
    s_waitcnt lgkmcnt(0)
    v_mfma_f32_16x16x32_bf16 v[20:23], v[88:91], v[160:163], v[20:23]
    v_mfma_f32_16x16x32_bf16 v[20:23], v[92:95], v[164:167], v[20:23]
    v_mfma_f32_16x16x32_bf16 v[20:23], v[96:99], v[168:171], v[20:23]
    v_mfma_f32_16x16x32_bf16 v[20:23], v[100:103], v[172:175], v[20:23]
    v_add_u32 v19, 51200, v10
    v_mov_b32 v104, 163552
    s_nop 5
    s_branch G_ST2
G_PK:
    s_waitcnt lgkmcnt(0)
    v_cmp_gt_u32 vcc, 1, v17
    s_nop 0
    s_cbranch_vccz CK_4
    s_mov_b32 s7, 0x40000
LP_5:
    ds_read_b32 v17, v12 offset:0
    s_sub_u32 s7, s7, 1
    s_waitcnt lgkmcnt(0)
    v_cmp_gt_u32 vcc, 1, v17
    s_cbranch_scc1 LPD_6
    s_cbranch_vccnz LP_5
LPD_6:
CK_4:
    ds_read_b64_tr_b16 v[160:161], v11 offset:0
    ds_read_b64_tr_b16 v[162:163], v11 offset:64
    ds_read_b64_tr_b16 v[164:165], v11 offset:512
    ds_read_b64_tr_b16 v[166:167], v11 offset:576
    ds_read_b64_tr_b16 v[168:169], v11 offset:1024
    ds_read_b64_tr_b16 v[170:171], v11 offset:1088
    ds_read_b64_tr_b16 v[172:173], v11 offset:1536
    ds_read_b64_tr_b16 v[174:175], v11 offset:1600
    s_waitcnt vmcnt(15)
    ds_read_b128 v[40:43], v8 offset:4096
    ds_read_b128 v[44:47], v18 offset:4096
    ds_read_b128 v[48:51], v8 offset:6144
    ds_read_b128 v[52:55], v18 offset:6144
    s_waitcnt lgkmcnt(4)
    v_mfma_f32_16x16x32_bf16 v[20:23], v[160:163], v[24:27], 0
    ds_read_b64_tr_b16 v[224:225], v11 offset:2048
    ds_read_b64_tr_b16 v[226:227], v11 offset:2112
    v_mfma_f32_16x16x32_bf16 v[20:23], v[164:167], v[28:31], v[20:23]
    ds_read_b64_tr_b16 v[228:229], v11 offset:2560
    ds_read_b64_tr_b16 v[230:231], v11 offset:2624
    v_mfma_f32_16x16x32_bf16 v[20:23], v[168:171], v[32:35], v[20:23]
    ds_read_b64_tr_b16 v[232:233], v11 offset:3072
    ds_read_b64_tr_b16 v[234:235], v11 offset:3136
    v_mfma_f32_16x16x32_bf16 v[20:23], v[172:175], v[36:39], v[20:23]
    ds_read_b64_tr_b16 v[236:237], v11 offset:3584
    ds_read_b64_tr_b16 v[238:239], v11 offset:3648
    s_waitcnt vmcnt(11)
    ds_read_b128 v[56:59], v8 offset:8192
    ds_read_b128 v[60:63], v18 offset:8192
    ds_read_b128 v[64:67], v19 offset:0
    ds_read_b128 v[68:71], v105 offset:0
    s_waitcnt lgkmcnt(4)
    v_mfma_f32_16x16x32_bf16 v[20:23], v[224:227], v[40:43], v[20:23]
    ds_read_b64_tr_b16 v[160:161], v11 offset:4096
    ds_read_b64_tr_b16 v[162:163], v11 offset:4160
    v_mfma_f32_16x16x32_bf16 v[20:23], v[228:231], v[44:47], v[20:23]
    ds_read_b64_tr_b16 v[164:165], v11 offset:4608
    ds_read_b64_tr_b16 v[166:167], v11 offset:4672
    v_mfma_f32_16x16x32_bf16 v[20:23], v[232:235], v[48:51], v[20:23]
    ds_read_b64_tr_b16 v[168:169], v11 offset:5120
    ds_read_b64_tr_b16 v[170:171], v11 offset:5184
    v_mfma_f32_16x16x32_bf16 v[20:23], v[236:239], v[52:55], v[20:23]
    ds_read_b64_tr_b16 v[172:173], v11 offset:5632
    ds_read_b64_tr_b16 v[174:175], v11 offset:5696
    s_waitcnt vmcnt(7)
    ds_read_b128 v[72:75], v19 offset:2048
    ds_read_b128 v[76:79], v105 offset:2048
    ds_read_b128 v[80:83], v19 offset:4096
    ds_read_b128 v[84:87], v105 offset:4096
    s_waitcnt lgkmcnt(4)
    v_mfma_f32_16x16x32_bf16 v[20:23], v[160:163], v[56:59], v[20:23]
    ds_read_b64_tr_b16 v[224:225], v11 offset:6144
    ds_read_b64_tr_b16 v[226:227], v11 offset:6208
    v_mfma_f32_16x16x32_bf16 v[20:23], v[164:167], v[60:63], v[20:23]
    ds_read_b64_tr_b16 v[228:229], v11 offset:6656
    ds_read_b64_tr_b16 v[230:231], v11 offset:6720
    v_mfma_f32_16x16x32_bf16 v[20:23], v[168:171], v[64:67], v[20:23]
    ds_read_b64_tr_b16 v[232:233], v11 offset:7168
    ds_read_b64_tr_b16 v[234:235], v11 offset:7232
    v_mfma_f32_16x16x32_bf16 v[20:23], v[172:175], v[68:71], v[20:23]
    ds_read_b64_tr_b16 v[236:237], v11 offset:7680
    ds_read_b64_tr_b16 v[238:239], v11 offset:7744
    s_waitcnt vmcnt(3)
    ds_read_b128 v[88:91], v19 offset:6144
    ds_read_b128 v[92:95], v105 offset:6144
    ds_read_b128 v[96:99], v19 offset:8192
    ds_read_b128 v[100:103], v105 offset:8192
    s_waitcnt lgkmcnt(4)
    v_mfma_f32_16x16x32_bf16 v[20:23], v[224:227], v[72:75], v[20:23]
    ds_read_b64_tr_b16 v[160:161], v11 offset:8192
    ds_read_b64_tr_b16 v[162:163], v11 offset:8256
    v_mfma_f32_16x16x32_bf16 v[20:23], v[228:231], v[76:79], v[20:23]
    ds_read_b64_tr_b16 v[164:165], v11 offset:8704
    ds_read_b64_tr_b16 v[166:167], v11 offset:8768
    v_mfma_f32_16x16x32_bf16 v[20:23], v[232:235], v[80:83], v[20:23]
    ds_read_b64_tr_b16 v[168:169], v11 offset:9216
    ds_read_b64_tr_b16 v[170:171], v11 offset:9280
    v_mfma_f32_16x16x32_bf16 v[20:23], v[236:239], v[84:87], v[20:23]
    ds_read_b64_tr_b16 v[172:173], v11 offset:9728
    ds_read_b64_tr_b16 v[174:175], v11 offset:9792
    s_waitcnt lgkmcnt(0)
    v_mfma_f32_16x16x32_bf16 v[20:23], v[160:163], v[88:91], v[20:23]
    v_mfma_f32_16x16x32_bf16 v[20:23], v[164:167], v[92:95], v[20:23]
    v_mfma_f32_16x16x32_bf16 v[20:23], v[168:171], v[96:99], v[20:23]
    v_mfma_f32_16x16x32_bf16 v[20:23], v[172:175], v[100:103], v[20:23]
    v_add_u32 v19, 51200, v10
    v_mov_b32 v104, 163552
    s_nop 5
    s_cmp_eq_u32 s5, 6
    s_cbranch_scc1 G_STG
    s_cmp_lt_u32 s5, 2
    s_cbranch_scc1 G_ST2
    s_cmp_eq_u32 s5, 7
    s_cselect_b32 s82, -1, 0
    s_mov_b32 s83, -1
    s_cselect_b32 s6, 1.0, 0
    v_mov_b32 v18, s6
    v_cndmask_b32 v20, v20, 1.0, s[82:83]
    v_cndmask_b32 v21, v21, 1.0, s[82:83]
    v_cndmask_b32 v22, v22, 1.0, s[82:83]
    v_cndmask_b32 v23, v23, v18, s[82:83]
G_ST2:
    v_cvt_pk_bf16_f32 v20, v20, v21
    v_cvt_pk_bf16_f32 v21, v22, v23
    buffer_store_dwordx2 v[20:21], v13, s[20:23], s80 offen sc1
    s_branch G_GEMM
G_STG:
    v_cvt_pk_bf16_f32 v20, v20, v20
    v_lshlrev_b32 v20, 16, v20
    v_mul_f32 v20, 0xbfb8aa3b, v20
    v_exp_f32 v20, v20
    s_mov_b32 s82, 0
    s_mov_b32 s83, -1
    v_add_f32 v20, 1.0, v20
    v_rcp_f32 v20, v20
    s_lshl_b32 s6, s4, 8
    v_cvt_pk_bf16_f32 v20, v20, v20
    v_lshlrev_b32 v20, 16, v20
    v_sub_f32 v21, 1.0, v20
    v_cvt_pk_bf16_f32 v21, v21, v21
    v_lshlrev_b32 v21, 16, v21
    v_cndmask_b32 v20, v20, v21, s[82:83]
    s_add_u32 s6, s6, 9371648
    buffer_store_dword v20, v13, s[20:23], s6 offen sc1
G_GEMM:
    s_setprio 2
    v_add_u32 v18, 51200, v9
    s_waitcnt vmcnt(1)
    ds_read_b64_tr_b16 v[160:161], v108 offset:0
    ds_read_b64_tr_b16 v[162:163], v109 offset:0
    ds_read_b64_tr_b16 v[164:165], v108 offset:20480
    ds_read_b64_tr_b16 v[166:167], v109 offset:20480
    s_waitcnt lgkmcnt(0)
    ds_write_b128 v112, v[160:163]
    ds_write_b128 v112, v[164:167] offset:64
    ds_read_b128 v[124:127], v113
    ds_read_b128 v[128:131], v113 offset:1152
    s_cmp_lg_u32 s3, 3
    s_cbranch_scc1 G_UT1
    ds_read_b64_tr_b16 v[160:161], v110 offset:0
    ds_read_b64_tr_b16 v[162:163], v111 offset:0
    ds_read_b64_tr_b16 v[164:165], v110 offset:20480
    ds_read_b64_tr_b16 v[166:167], v111 offset:20480
    s_waitcnt lgkmcnt(0)
    ds_write_b128 v112, v[160:163]
    ds_write_b128 v112, v[164:167] offset:64
    ds_read_b128 v[132:135], v113
    ds_read_b128 v[136:139], v113 offset:1152
G_UT1:
    v_readfirstlane_b32 s36, v7
    s_lshr_b32 s89, s2, 2
    s_lshl_b32 s89, s89, 6
    s_and_b32 s7, s2, 3
    s_lshl_b32 s7, s7, 2
    s_add_u32 s89, s89, s7
    s_mul_i32 s36, s36, 1664525
    s_add_u32 s36, s36, 1013904223
    v_mov_b32 v4, s36
    ds_write_b32 v104, v4 offset:44
    ds_write_b32 v15, v16 offset:48
    s_lshl_b32 s74, s37, 2
    s_and_b32 s6, s5, 3
    s_add_u32 s74, s74, s6
    s_add_u32 s75, s74, 4
    s_add_u32 s74, s74, s3
    s_lshl_b32 s7, s4, 7
    s_add_u32 s7, s7, 2621568
    s_sub_u32 s6, s74, 40
    s_min_u32 s74, s74, s6
    s_mul_i32 s74, s74, 67584
    s_add_u32 s76, s74, s7
    s_sub_u32 s6, s75, 40
    s_min_u32 s75, s75, s6
    s_mul_i32 s75, s75, 67584
    s_add_u32 s77, s75, s7
    s_lshr_b32 s88, s3, 2
    s_and_b32 s6, s3, 3
    s_mul_i32 s94, s6, 3072
    s_mov_b32 s90, s6
    s_mul_i32 s93, s88, 98304
    s_add_u32 s93, s93, s94
    s_add_u32 s93, s93, 9175040
    s_mul_i32 s32, s4, 81920
    s_mov_b32 s33, 0
    s_mul_i32 s6, s5, 160
    s_add_u32 s24, s62, s6
    s_addc_u32 s25, s63, 0
    s_sub_u32 s26, 819200, s6
    s_mov_b32 s27, 0x00020000
    s_mov_b64 s[28:29], s[66:67]
    s_mov_b32 s30, 2621440
    s_mov_b32 s31, 0x00020000
    s_lshl_b32 s69, s3, 2
    s_add_u32 s69, s69, 163520
    s_mov_b32 s86, 0
    s_mov_b32 s87, -1
    s_lshl_b32 s78, s37, 1
    s_add_u32 s78, s78, s3
    s_mul_i32 s78, s78, 40960
    s_sub_u32 s6, s78, 819200
    s_cmp_lt_u32 s78, 819200
    s_cselect_b32 s78, s78, s6
    s_mov_b32 s82, 0x3ea52b5c
    s_mov_b32 s83, s82
    s_waitcnt vmcnt(0)
    v_mov_b32 v4, 163472
    v_mov_b32 v5, 1
    s_mov_b64 exec, 1
    ds_add_rtn_u32 v6, v4, v5
    v_mov_b32 v4, 9437184
    v_mov_b32 v5, s36
    s_waitcnt lgkmcnt(0)
    v_cmp_eq_u32 vcc, 3, v6
    s_nop 0
    s_cbranch_vccz PUB_7
    buffer_store_dword v5, v4, s[20:23], s89 offen sc1
PUB_7:
    s_mov_b64 exec, -1
    s_mov_b32 s7, 0x40000
LP_8:
    ds_read_b32 v17, v104 offset:0
    s_sub_u32 s7, s7, 1
    s_waitcnt lgkmcnt(0)
    v_cmp_gt_u32 vcc, 1, v17
    s_cbranch_scc1 LPD_9
    s_cbranch_vccnz LP_8
LPD_9:
    ds_read_b32 v17, v104 offset:4
    ds_read_b64_tr_b16 v[160:161], v9 offset:0
    ds_read_b64_tr_b16 v[162:163], v10 offset:0
    ds_read_b64_tr_b16 v[164:165], v9 offset:8
    ds_read_b64_tr_b16 v[166:167], v10 offset:8
    ds_read_b64_tr_b16 v[168:169], v9 offset:16
    ds_read_b64_tr_b16 v[170:171], v10 offset:16
    ds_read_b64_tr_b16 v[172:173], v9 offset:24
    ds_read_b64_tr_b16 v[174:175], v10 offset:24
    ds_read_b64_tr_b16 v[176:177], v9 offset:32
    ds_read_b64_tr_b16 v[178:179], v10 offset:32
    ds_read_b64_tr_b16 v[224:225], v9 offset:5120
    ds_read_b64_tr_b16 v[226:227], v10 offset:5120
    ds_read_b64_tr_b16 v[228:229], v9 offset:5128
    ds_read_b64_tr_b16 v[230:231], v10 offset:5128
    ds_read_b64_tr_b16 v[232:233], v9 offset:5136
    ds_read_b64_tr_b16 v[234:235], v10 offset:5136
    ds_read_b64_tr_b16 v[236:237], v9 offset:5144
    ds_read_b64_tr_b16 v[238:239], v10 offset:5144
    ds_read_b64_tr_b16 v[240:241], v9 offset:5152
    ds_read_b64_tr_b16 v[242:243], v10 offset:5152
    s_waitcnt lgkmcnt(10)
    v_cmp_gt_u32 vcc, 1, v17
    s_nop 0
    s_cbranch_vccz CK_10
    s_mov_b32 s7, 0x40000
LP_11:
    ds_read_b32 v17, v104 offset:4
    s_sub_u32 s7, s7, 1
    s_waitcnt lgkmcnt(0)
    v_cmp_gt_u32 vcc, 1, v17
    s_cbranch_scc1 LPD_12
    s_cbranch_vccnz LP_11
LPD_12:
CK_10:
    v_mfma_f32_16x16x32_bf16 v[140:143], v[160:163], v[24:27], 0
    ds_read_b64_tr_b16 v[180:181], v9 offset:10240
    ds_read_b64_tr_b16 v[182:183], v10 offset:10240
    v_mfma_f32_16x16x32_bf16 v[144:147], v[164:167], v[24:27], 0
    ds_read_b64_tr_b16 v[184:185], v9 offset:10248
    ds_read_b64_tr_b16 v[186:187], v10 offset:10248
    v_mfma_f32_16x16x32_bf16 v[148:151], v[168:171], v[24:27], 0
    ds_read_b64_tr_b16 v[188:189], v9 offset:10256
    ds_read_b64_tr_b16 v[190:191], v10 offset:10256
    v_mfma_f32_16x16x32_bf16 v[152:155], v[172:175], v[24:27], 0
    ds_read_b64_tr_b16 v[244:245], v9 offset:10264
    ds_read_b64_tr_b16 v[246:247], v10 offset:10264
    v_mfma_f32_16x16x32_bf16 v[156:159], v[176:179], v[24:27], 0
    ds_read_b64_tr_b16 v[248:249], v9 offset:10272
    ds_read_b64_tr_b16 v[250:251], v10 offset:10272
    s_waitcnt lgkmcnt(10)
    ds_read_b32 v17, v104 offset:8
    v_mfma_f32_16x16x32_bf16 v[140:143], v[224:227], v[28:31], v[140:143]
    ds_read_b64_tr_b16 v[160:161], v9 offset:15360
    ds_read_b64_tr_b16 v[162:163], v10 offset:15360
    v_mfma_f32_16x16x32_bf16 v[144:147], v[228:231], v[28:31], v[144:147]
    ds_read_b64_tr_b16 v[164:165], v9 offset:15368
    ds_read_b64_tr_b16 v[166:167], v10 offset:15368
    v_mfma_f32_16x16x32_bf16 v[148:151], v[232:235], v[28:31], v[148:151]
    ds_read_b64_tr_b16 v[168:169], v9 offset:15376
    ds_read_b64_tr_b16 v[170:171], v10 offset:15376
    v_mfma_f32_16x16x32_bf16 v[152:155], v[236:239], v[28:31], v[152:155]
    ds_read_b64_tr_b16 v[172:173], v9 offset:15384
    ds_read_b64_tr_b16 v[174:175], v10 offset:15384
    v_mfma_f32_16x16x32_bf16 v[156:159], v[240:243], v[28:31], v[156:159]
    ds_read_b64_tr_b16 v[176:177], v9 offset:15392
    ds_read_b64_tr_b16 v[178:179], v10 offset:15392
    s_waitcnt lgkmcnt(10)
    v_cmp_gt_u32 vcc, 1, v17
    s_nop 0
    s_cbranch_vccz CK_13
    s_mov_b32 s7, 0x40000
LP_14:
    ds_read_b32 v17, v104 offset:8
    s_sub_u32 s7, s7, 1
    s_waitcnt lgkmcnt(0)
    v_cmp_gt_u32 vcc, 1, v17
    s_cbranch_scc1 LPD_15
    s_cbranch_vccnz LP_14
LPD_15:
CK_13:
    v_mfma_f32_16x16x32_bf16 v[140:143], v[180:183], v[32:35], v[140:143]
    ds_read_b64_tr_b16 v[224:225], v9 offset:20480
    ds_read_b64_tr_b16 v[226:227], v10 offset:20480
    v_mfma_f32_16x16x32_bf16 v[144:147], v[184:187], v[32:35], v[144:147]
    ds_read_b64_tr_b16 v[228:229], v9 offset:20488
    ds_read_b64_tr_b16 v[230:231], v10 offset:20488
    v_mfma_f32_16x16x32_bf16 v[148:151], v[188:191], v[32:35], v[148:151]
    ds_read_b64_tr_b16 v[232:233], v9 offset:20496
    ds_read_b64_tr_b16 v[234:235], v10 offset:20496
    v_mfma_f32_16x16x32_bf16 v[152:155], v[244:247], v[32:35], v[152:155]
    ds_read_b64_tr_b16 v[236:237], v9 offset:20504
    ds_read_b64_tr_b16 v[238:239], v10 offset:20504
    v_mfma_f32_16x16x32_bf16 v[156:159], v[248:251], v[32:35], v[156:159]
    ds_read_b64_tr_b16 v[240:241], v9 offset:20512
    ds_read_b64_tr_b16 v[242:243], v10 offset:20512
    s_waitcnt lgkmcnt(10)
    ds_read_b32 v17, v104 offset:12
    v_mfma_f32_16x16x32_bf16 v[140:143], v[160:163], v[36:39], v[140:143]
    ds_read_b64_tr_b16 v[180:181], v9 offset:25600
    ds_read_b64_tr_b16 v[182:183], v10 offset:25600
    v_mfma_f32_16x16x32_bf16 v[144:147], v[164:167], v[36:39], v[144:147]
    ds_read_b64_tr_b16 v[184:185], v9 offset:25608
    ds_read_b64_tr_b16 v[186:187], v10 offset:25608
    v_mfma_f32_16x16x32_bf16 v[148:151], v[168:171], v[36:39], v[148:151]
    ds_read_b64_tr_b16 v[188:189], v9 offset:25616
    ds_read_b64_tr_b16 v[190:191], v10 offset:25616
    v_mfma_f32_16x16x32_bf16 v[152:155], v[172:175], v[36:39], v[152:155]
    ds_read_b64_tr_b16 v[244:245], v9 offset:25624
    ds_read_b64_tr_b16 v[246:247], v10 offset:25624
    v_mfma_f32_16x16x32_bf16 v[156:159], v[176:179], v[36:39], v[156:159]
    ds_read_b64_tr_b16 v[248:249], v9 offset:25632
    ds_read_b64_tr_b16 v[250:251], v10 offset:25632
    s_waitcnt lgkmcnt(10)
    v_cmp_gt_u32 vcc, 1, v17
    s_nop 0
    s_cbranch_vccz CK_16
    s_mov_b32 s7, 0x40000
LP_17:
    ds_read_b32 v17, v104 offset:12
    s_sub_u32 s7, s7, 1
    s_waitcnt lgkmcnt(0)
    v_cmp_gt_u32 vcc, 1, v17
    s_cbranch_scc1 LPD_18
    s_cbranch_vccnz LP_17
LPD_18:
CK_16:
    ds_write_b32 v15, v16 offset:32
    v_mfma_f32_16x16x32_bf16 v[140:143], v[224:227], v[40:43], v[140:143]
    ds_read_b64_tr_b16 v[160:161], v9 offset:30720
    ds_read_b64_tr_b16 v[162:163], v10 offset:30720
    v_mfma_f32_16x16x32_bf16 v[144:147], v[228:231], v[40:43], v[144:147]
    ds_read_b64_tr_b16 v[164:165], v9 offset:30728
    ds_read_b64_tr_b16 v[166:167], v10 offset:30728
    v_mfma_f32_16x16x32_bf16 v[148:151], v[232:235], v[40:43], v[148:151]
    ds_read_b64_tr_b16 v[168:169], v9 offset:30736
    ds_read_b64_tr_b16 v[170:171], v10 offset:30736
    v_mfma_f32_16x16x32_bf16 v[152:155], v[236:239], v[40:43], v[152:155]
    ds_read_b64_tr_b16 v[172:173], v9 offset:30744
    ds_read_b64_tr_b16 v[174:175], v10 offset:30744
    v_mfma_f32_16x16x32_bf16 v[156:159], v[240:243], v[40:43], v[156:159]
    ds_read_b64_tr_b16 v[176:177], v9 offset:30752
    ds_read_b64_tr_b16 v[178:179], v10 offset:30752
    s_waitcnt lgkmcnt(10)
    ds_read_b32 v17, v104 offset:16
    v_mfma_f32_16x16x32_bf16 v[140:143], v[180:183], v[44:47], v[140:143]
    ds_read_b64_tr_b16 v[224:225], v9 offset:35840
    ds_read_b64_tr_b16 v[226:227], v10 offset:35840
    v_mfma_f32_16x16x32_bf16 v[144:147], v[184:187], v[44:47], v[144:147]
    ds_read_b64_tr_b16 v[228:229], v9 offset:35848
    ds_read_b64_tr_b16 v[230:231], v10 offset:35848
    v_mfma_f32_16x16x32_bf16 v[148:151], v[188:191], v[44:47], v[148:151]
    ds_read_b64_tr_b16 v[232:233], v9 offset:35856
    ds_read_b64_tr_b16 v[234:235], v10 offset:35856
    v_mfma_f32_16x16x32_bf16 v[152:155], v[244:247], v[44:47], v[152:155]
    ds_read_b64_tr_b16 v[236:237], v9 offset:35864
    ds_read_b64_tr_b16 v[238:239], v10 offset:35864
    v_mfma_f32_16x16x32_bf16 v[156:159], v[248:251], v[44:47], v[156:159]
    ds_read_b64_tr_b16 v[240:241], v9 offset:35872
    ds_read_b64_tr_b16 v[242:243], v10 offset:35872
    s_waitcnt lgkmcnt(10)
    v_cmp_gt_u32 vcc, 1, v17
    s_nop 0
    s_cbranch_vccz CK_19
    s_mov_b32 s7, 0x40000
LP_20:
    ds_read_b32 v17, v104 offset:16
    s_sub_u32 s7, s7, 1
    s_waitcnt lgkmcnt(0)
    v_cmp_gt_u32 vcc, 1, v17
    s_cbranch_scc1 LPD_21
    s_cbranch_vccnz LP_20
LPD_21:
CK_19:
    v_mfma_f32_16x16x32_bf16 v[140:143], v[160:163], v[48:51], v[140:143]
    ds_read_b64_tr_b16 v[180:181], v9 offset:40960
    ds_read_b64_tr_b16 v[182:183], v10 offset:40960
    v_mfma_f32_16x16x32_bf16 v[144:147], v[164:167], v[48:51], v[144:147]
    ds_read_b64_tr_b16 v[184:185], v9 offset:40968
    ds_read_b64_tr_b16 v[186:187], v10 offset:40968
    v_mfma_f32_16x16x32_bf16 v[148:151], v[168:171], v[48:51], v[148:151]
    ds_read_b64_tr_b16 v[188:189], v9 offset:40976
    ds_read_b64_tr_b16 v[190:191], v10 offset:40976
    v_mfma_f32_16x16x32_bf16 v[152:155], v[172:175], v[48:51], v[152:155]
    ds_read_b64_tr_b16 v[244:245], v9 offset:40984
    ds_read_b64_tr_b16 v[246:247], v10 offset:40984
    v_mfma_f32_16x16x32_bf16 v[156:159], v[176:179], v[48:51], v[156:159]
    ds_read_b64_tr_b16 v[248:249], v9 offset:40992
    ds_read_b64_tr_b16 v[250:251], v10 offset:40992
    s_waitcnt lgkmcnt(10)
    ds_read_b32 v17, v104 offset:20
    v_mfma_f32_16x16x32_bf16 v[140:143], v[224:227], v[52:55], v[140:143]
    ds_read_b64_tr_b16 v[160:161], v9 offset:46080
    ds_read_b64_tr_b16 v[162:163], v10 offset:46080
    v_mfma_f32_16x16x32_bf16 v[144:147], v[228:231], v[52:55], v[144:147]
    ds_read_b64_tr_b16 v[164:165], v9 offset:46088
    ds_read_b64_tr_b16 v[166:167], v10 offset:46088
    v_mfma_f32_16x16x32_bf16 v[148:151], v[232:235], v[52:55], v[148:151]
    ds_read_b64_tr_b16 v[168:169], v9 offset:46096
    ds_read_b64_tr_b16 v[170:171], v10 offset:46096
    v_mfma_f32_16x16x32_bf16 v[152:155], v[236:239], v[52:55], v[152:155]
    ds_read_b64_tr_b16 v[172:173], v9 offset:46104
    ds_read_b64_tr_b16 v[174:175], v10 offset:46104
    v_mfma_f32_16x16x32_bf16 v[156:159], v[240:243], v[52:55], v[156:159]
    ds_read_b64_tr_b16 v[176:177], v9 offset:46112
    ds_read_b64_tr_b16 v[178:179], v10 offset:46112
    s_waitcnt lgkmcnt(10)
    v_cmp_gt_u32 vcc, 1, v17
    s_nop 0
    s_cbranch_vccz CK_22
    s_mov_b32 s7, 0x40000
LP_23:
    ds_read_b32 v17, v104 offset:20
    s_sub_u32 s7, s7, 1
    s_waitcnt lgkmcnt(0)
    v_cmp_gt_u32 vcc, 1, v17
    s_cbranch_scc1 LPD_24
    s_cbranch_vccnz LP_23
LPD_24:
CK_22:
    v_mfma_f32_16x16x32_bf16 v[140:143], v[180:183], v[56:59], v[140:143]
    ds_read_b64_tr_b16 v[224:225], v18 offset:0
    ds_read_b64_tr_b16 v[226:227], v19 offset:0
    v_mfma_f32_16x16x32_bf16 v[144:147], v[184:187], v[56:59], v[144:147]
    ds_read_b64_tr_b16 v[228:229], v18 offset:8
    ds_read_b64_tr_b16 v[230:231], v19 offset:8
    v_mfma_f32_16x16x32_bf16 v[148:151], v[188:191], v[56:59], v[148:151]
    ds_read_b64_tr_b16 v[232:233], v18 offset:16
    ds_read_b64_tr_b16 v[234:235], v19 offset:16
    v_mfma_f32_16x16x32_bf16 v[152:155], v[244:247], v[56:59], v[152:155]
    ds_read_b64_tr_b16 v[236:237], v18 offset:24
    ds_read_b64_tr_b16 v[238:239], v19 offset:24
    v_mfma_f32_16x16x32_bf16 v[156:159], v[248:251], v[56:59], v[156:159]
    ds_read_b64_tr_b16 v[240:241], v18 offset:32
    ds_read_b64_tr_b16 v[242:243], v19 offset:32
    s_waitcnt lgkmcnt(10)
    ds_read_b32 v17, v104 offset:24
    v_mfma_f32_16x16x32_bf16 v[140:143], v[160:163], v[60:63], v[140:143]
    ds_read_b64_tr_b16 v[180:181], v18 offset:5120
    ds_read_b64_tr_b16 v[182:183], v19 offset:5120
    v_mfma_f32_16x16x32_bf16 v[144:147], v[164:167], v[60:63], v[144:147]
    ds_read_b64_tr_b16 v[184:185], v18 offset:5128
    ds_read_b64_tr_b16 v[186:187], v19 offset:5128
    v_mfma_f32_16x16x32_bf16 v[148:151], v[168:171], v[60:63], v[148:151]
    ds_read_b64_tr_b16 v[188:189], v18 offset:5136
    ds_read_b64_tr_b16 v[190:191], v19 offset:5136
    v_mfma_f32_16x16x32_bf16 v[152:155], v[172:175], v[60:63], v[152:155]
    ds_read_b64_tr_b16 v[244:245], v18 offset:5144
    ds_read_b64_tr_b16 v[246:247], v19 offset:5144
    v_mfma_f32_16x16x32_bf16 v[156:159], v[176:179], v[60:63], v[156:159]
    ds_read_b64_tr_b16 v[248:249], v18 offset:5152
    ds_read_b64_tr_b16 v[250:251], v19 offset:5152
    s_waitcnt lgkmcnt(10)
    v_cmp_gt_u32 vcc, 1, v17
    s_nop 0
    s_cbranch_vccz CK_25
    s_mov_b32 s7, 0x40000
LP_26:
    ds_read_b32 v17, v104 offset:24
    s_sub_u32 s7, s7, 1
    s_waitcnt lgkmcnt(0)
    v_cmp_gt_u32 vcc, 1, v17
    s_cbranch_scc1 LPD_27
    s_cbranch_vccnz LP_26
LPD_27:
CK_25:
    v_mfma_f32_16x16x32_bf16 v[140:143], v[224:227], v[64:67], v[140:143]
    ds_read_b64_tr_b16 v[160:161], v18 offset:10240
    ds_read_b64_tr_b16 v[162:163], v19 offset:10240
    v_mfma_f32_16x16x32_bf16 v[144:147], v[228:231], v[64:67], v[144:147]
    ds_read_b64_tr_b16 v[164:165], v18 offset:10248
    ds_read_b64_tr_b16 v[166:167], v19 offset:10248
    v_mfma_f32_16x16x32_bf16 v[148:151], v[232:235], v[64:67], v[148:151]
    ds_read_b64_tr_b16 v[168:169], v18 offset:10256
    ds_read_b64_tr_b16 v[170:171], v19 offset:10256
    v_mfma_f32_16x16x32_bf16 v[152:155], v[236:239], v[64:67], v[152:155]
    ds_read_b64_tr_b16 v[172:173], v18 offset:10264
    ds_read_b64_tr_b16 v[174:175], v19 offset:10264
    v_mfma_f32_16x16x32_bf16 v[156:159], v[240:243], v[64:67], v[156:159]
    ds_read_b64_tr_b16 v[176:177], v18 offset:10272
    ds_read_b64_tr_b16 v[178:179], v19 offset:10272
    s_waitcnt lgkmcnt(10)
    ds_read_b32 v17, v104 offset:28
    v_mfma_f32_16x16x32_bf16 v[140:143], v[180:183], v[68:71], v[140:143]
    ds_read_b64_tr_b16 v[224:225], v18 offset:15360
    ds_read_b64_tr_b16 v[226:227], v19 offset:15360
    v_mfma_f32_16x16x32_bf16 v[144:147], v[184:187], v[68:71], v[144:147]
    ds_read_b64_tr_b16 v[228:229], v18 offset:15368
    ds_read_b64_tr_b16 v[230:231], v19 offset:15368
    v_mfma_f32_16x16x32_bf16 v[148:151], v[188:191], v[68:71], v[148:151]
    ds_read_b64_tr_b16 v[232:233], v18 offset:15376
    ds_read_b64_tr_b16 v[234:235], v19 offset:15376
    v_mfma_f32_16x16x32_bf16 v[152:155], v[244:247], v[68:71], v[152:155]
    ds_read_b64_tr_b16 v[236:237], v18 offset:15384
    ds_read_b64_tr_b16 v[238:239], v19 offset:15384
    v_mfma_f32_16x16x32_bf16 v[156:159], v[248:251], v[68:71], v[156:159]
    ds_read_b64_tr_b16 v[240:241], v18 offset:15392
    ds_read_b64_tr_b16 v[242:243], v19 offset:15392
    s_waitcnt lgkmcnt(10)
    v_cmp_gt_u32 vcc, 1, v17
    s_nop 0
    s_cbranch_vccz CK_28
    s_mov_b32 s7, 0x40000
LP_29:
    ds_read_b32 v17, v104 offset:28
    s_sub_u32 s7, s7, 1
    s_waitcnt lgkmcnt(0)
    v_cmp_gt_u32 vcc, 1, v17
    s_cbranch_scc1 LPD_30
    s_cbranch_vccnz LP_29
LPD_30:
CK_28:
    s_lshl_b32 s7, s3, 11
    s_add_u32 s6, s7, 78080
    s_add_u32 s34, s38, s6
    s_addc_u32 s35, s39, 0
    global_load_dwordx4 v[116:119], v1, s[34:35] offset:0
    global_load_dwordx4 v[120:123], v1, s[34:35] offset:1024
    v_mfma_f32_16x16x32_bf16 v[140:143], v[160:163], v[72:75], v[140:143]
    ds_read_b64_tr_b16 v[180:181], v18 offset:20480
    ds_read_b64_tr_b16 v[182:183], v19 offset:20480
    v_mfma_f32_16x16x32_bf16 v[144:147], v[164:167], v[72:75], v[144:147]
    ds_read_b64_tr_b16 v[184:185], v18 offset:20488
    ds_read_b64_tr_b16 v[186:187], v19 offset:20488
    v_mfma_f32_16x16x32_bf16 v[148:151], v[168:171], v[72:75], v[148:151]
    ds_read_b64_tr_b16 v[188:189], v18 offset:20496
    ds_read_b64_tr_b16 v[190:191], v19 offset:20496
    v_mfma_f32_16x16x32_bf16 v[152:155], v[172:175], v[72:75], v[152:155]
    ds_read_b64_tr_b16 v[244:245], v18 offset:20504
    ds_read_b64_tr_b16 v[246:247], v19 offset:20504
    v_mfma_f32_16x16x32_bf16 v[156:159], v[176:179], v[72:75], v[156:159]
    ds_read_b64_tr_b16 v[248:249], v18 offset:20512
    ds_read_b64_tr_b16 v[250:251], v19 offset:20512
    s_waitcnt lgkmcnt(10)
    ds_read_b32 v17, v104 offset:32
    ds_write_b32 v15, v16 offset:176
    v_mfma_f32_16x16x32_bf16 v[140:143], v[224:227], v[76:79], v[140:143]
    ds_read_b64_tr_b16 v[160:161], v18 offset:25600
    ds_read_b64_tr_b16 v[162:163], v19 offset:25600
    v_mfma_f32_16x16x32_bf16 v[144:147], v[228:231], v[76:79], v[144:147]
    ds_read_b64_tr_b16 v[164:165], v18 offset:25608
    ds_read_b64_tr_b16 v[166:167], v19 offset:25608
    v_mfma_f32_16x16x32_bf16 v[148:151], v[232:235], v[76:79], v[148:151]
    ds_read_b64_tr_b16 v[168:169], v18 offset:25616
    ds_read_b64_tr_b16 v[170:171], v19 offset:25616
    v_mfma_f32_16x16x32_bf16 v[152:155], v[236:239], v[76:79], v[152:155]
    ds_read_b64_tr_b16 v[172:173], v18 offset:25624
    ds_read_b64_tr_b16 v[174:175], v19 offset:25624
    v_mfma_f32_16x16x32_bf16 v[156:159], v[240:243], v[76:79], v[156:159]
    ds_read_b64_tr_b16 v[176:177], v18 offset:25632
    ds_read_b64_tr_b16 v[178:179], v19 offset:25632
    s_waitcnt lgkmcnt(10)
    v_cmp_gt_u32 vcc, 1, v17
    s_nop 0
    s_cbranch_vccz CK_31
    s_mov_b32 s7, 0x40000
LP_32:
    ds_read_b32 v17, v104 offset:32
    s_sub_u32 s7, s7, 1
    s_waitcnt lgkmcnt(0)
    v_cmp_gt_u32 vcc, 1, v17
    s_cbranch_scc1 LPD_33
    s_cbranch_vccnz LP_32
LPD_33:
CK_31:
    v_mfma_f32_16x16x32_bf16 v[140:143], v[180:183], v[80:83], v[140:143]
    ds_read_b64_tr_b16 v[224:225], v18 offset:30720
    ds_read_b64_tr_b16 v[226:227], v19 offset:30720
    v_mfma_f32_16x16x32_bf16 v[144:147], v[184:187], v[80:83], v[144:147]
    ds_read_b64_tr_b16 v[228:229], v18 offset:30728
    ds_read_b64_tr_b16 v[230:231], v19 offset:30728
    v_mfma_f32_16x16x32_bf16 v[148:151], v[188:191], v[80:83], v[148:151]
    ds_read_b64_tr_b16 v[232:233], v18 offset:30736
    ds_read_b64_tr_b16 v[234:235], v19 offset:30736
    v_mfma_f32_16x16x32_bf16 v[152:155], v[244:247], v[80:83], v[152:155]
    ds_read_b64_tr_b16 v[236:237], v18 offset:30744
    ds_read_b64_tr_b16 v[238:239], v19 offset:30744
    v_mfma_f32_16x16x32_bf16 v[156:159], v[248:251], v[80:83], v[156:159]
    ds_read_b64_tr_b16 v[240:241], v18 offset:30752
    ds_read_b64_tr_b16 v[242:243], v19 offset:30752
    s_waitcnt lgkmcnt(10)
    ds_read_b32 v17, v104 offset:36
    v_mfma_f32_16x16x32_bf16 v[140:143], v[160:163], v[84:87], v[140:143]
    ds_read_b64_tr_b16 v[180:181], v18 offset:35840
    ds_read_b64_tr_b16 v[182:183], v19 offset:35840
    v_mfma_f32_16x16x32_bf16 v[144:147], v[164:167], v[84:87], v[144:147]
    ds_read_b64_tr_b16 v[184:185], v18 offset:35848
    ds_read_b64_tr_b16 v[186:187], v19 offset:35848
    v_mfma_f32_16x16x32_bf16 v[148:151], v[168:171], v[84:87], v[148:151]
    ds_read_b64_tr_b16 v[188:189], v18 offset:35856
    ds_read_b64_tr_b16 v[190:191], v19 offset:35856
    v_mfma_f32_16x16x32_bf16 v[152:155], v[172:175], v[84:87], v[152:155]
    ds_read_b64_tr_b16 v[244:245], v18 offset:35864
    ds_read_b64_tr_b16 v[246:247], v19 offset:35864
    v_mfma_f32_16x16x32_bf16 v[156:159], v[176:179], v[84:87], v[156:159]
    ds_read_b64_tr_b16 v[248:249], v18 offset:35872
    ds_read_b64_tr_b16 v[250:251], v19 offset:35872
    s_waitcnt lgkmcnt(10)
    v_cmp_gt_u32 vcc, 1, v17
    s_nop 0
    s_cbranch_vccz CK_34
    s_mov_b32 s7, 0x40000
LP_35:
    ds_read_b32 v17, v104 offset:36
    s_sub_u32 s7, s7, 1
    s_waitcnt lgkmcnt(0)
    v_cmp_gt_u32 vcc, 1, v17
    s_cbranch_scc1 LPD_36
    s_cbranch_vccnz LP_35
LPD_36:
CK_34:
    v_mfma_f32_16x16x32_bf16 v[140:143], v[224:227], v[88:91], v[140:143]
    ds_read_b64_tr_b16 v[160:161], v18 offset:40960
    ds_read_b64_tr_b16 v[162:163], v19 offset:40960
    v_mfma_f32_16x16x32_bf16 v[144:147], v[228:231], v[88:91], v[144:147]
    ds_read_b64_tr_b16 v[164:165], v18 offset:40968
    ds_read_b64_tr_b16 v[166:167], v19 offset:40968
    v_mfma_f32_16x16x32_bf16 v[148:151], v[232:235], v[88:91], v[148:151]
    ds_read_b64_tr_b16 v[168:169], v18 offset:40976
    ds_read_b64_tr_b16 v[170:171], v19 offset:40976
    v_mfma_f32_16x16x32_bf16 v[152:155], v[236:239], v[88:91], v[152:155]
    ds_read_b64_tr_b16 v[172:173], v18 offset:40984
    ds_read_b64_tr_b16 v[174:175], v19 offset:40984
    v_mfma_f32_16x16x32_bf16 v[156:159], v[240:243], v[88:91], v[156:159]
    ds_read_b64_tr_b16 v[176:177], v18 offset:40992
    ds_read_b64_tr_b16 v[178:179], v19 offset:40992
    s_waitcnt lgkmcnt(10)
    v_mfma_f32_16x16x32_bf16 v[140:143], v[180:183], v[92:95], v[140:143]
    ds_read_b64_tr_b16 v[224:225], v18 offset:46080
    ds_read_b64_tr_b16 v[226:227], v19 offset:46080
    v_mfma_f32_16x16x32_bf16 v[144:147], v[184:187], v[92:95], v[144:147]
    ds_read_b64_tr_b16 v[228:229], v18 offset:46088
    ds_read_b64_tr_b16 v[230:231], v19 offset:46088
    v_mfma_f32_16x16x32_bf16 v[148:151], v[188:191], v[92:95], v[148:151]
    ds_read_b64_tr_b16 v[232:233], v18 offset:46096
    ds_read_b64_tr_b16 v[234:235], v19 offset:46096
    v_mfma_f32_16x16x32_bf16 v[152:155], v[244:247], v[92:95], v[152:155]
    ds_read_b64_tr_b16 v[236:237], v18 offset:46104
    ds_read_b64_tr_b16 v[238:239], v19 offset:46104
    v_mfma_f32_16x16x32_bf16 v[156:159], v[248:251], v[92:95], v[156:159]
    ds_read_b64_tr_b16 v[240:241], v18 offset:46112
    ds_read_b64_tr_b16 v[242:243], v19 offset:46112
    s_waitcnt lgkmcnt(10)
    v_mfma_f32_16x16x32_bf16 v[140:143], v[160:163], v[96:99], v[140:143]
    v_mfma_f32_16x16x32_bf16 v[144:147], v[164:167], v[96:99], v[144:147]
    v_mfma_f32_16x16x32_bf16 v[148:151], v[168:171], v[96:99], v[148:151]
    v_mfma_f32_16x16x32_bf16 v[152:155], v[172:175], v[96:99], v[152:155]
    v_mfma_f32_16x16x32_bf16 v[156:159], v[176:179], v[96:99], v[156:159]
    s_waitcnt lgkmcnt(0)
    v_mfma_f32_16x16x32_bf16 v[140:143], v[224:227], v[100:103], v[140:143]
    v_mfma_f32_16x16x32_bf16 v[144:147], v[228:231], v[100:103], v[144:147]
    v_mfma_f32_16x16x32_bf16 v[148:151], v[232:235], v[100:103], v[148:151]
    v_mfma_f32_16x16x32_bf16 v[152:155], v[236:239], v[100:103], v[152:155]
    v_mfma_f32_16x16x32_bf16 v[156:159], v[240:243], v[100:103], v[156:159]
    s_waitcnt vmcnt(0)
    v_add_u32 v2, 48384, v1
    v_add_u32 v3, 48384, v116
    v_add_u32 v4, 117504, v1
    v_add_u32 v5, 117504, v116
    v_add_u32 v6, 129792, v1
    v_add_u32 v7, 129792, v116
    v_pk_mul_f32 v[140:141], v[140:141], s[82:83]
    v_pk_mul_f32 v[142:143], v[142:143], s[82:83]
    v_pk_mul_f32 v[144:145], v[144:145], s[82:83]
    v_pk_mul_f32 v[146:147], v[146:147], s[82:83]
    v_pk_mul_f32 v[148:149], v[148:149], s[82:83]
    v_pk_mul_f32 v[150:151], v[150:151], s[82:83]
    v_pk_mul_f32 v[152:153], v[152:153], s[82:83]
    v_pk_mul_f32 v[154:155], v[154:155], s[82:83]
    v_pk_mul_f32 v[156:157], v[156:157], s[82:83]
    v_pk_mul_f32 v[158:159], v[158:159], s[82:83]
    v_cvt_pk_bf16_f32 v24, v140, v141
    v_cvt_pk_bf16_f32 v25, v142, v143
    v_cvt_pk_bf16_f32 v26, v144, v145
    v_cvt_pk_bf16_f32 v27, v146, v147
    v_cvt_pk_bf16_f32 v28, v148, v149
    v_cvt_pk_bf16_f32 v29, v150, v151
    v_cvt_pk_bf16_f32 v30, v152, v153
    v_cvt_pk_bf16_f32 v31, v154, v155
    v_cvt_pk_bf16_f32 v32, v156, v157
    v_cvt_pk_bf16_f32 v33, v158, v159
    ds_write_b64 v14, v[24:25] offset:0
    ds_write_b64 v14, v[26:27] offset:8
    ds_write_b64 v14, v[28:29] offset:16
    ds_write_b64 v14, v[30:31] offset:24
    ds_write_b64 v14, v[32:33] offset:32
    ds_write_b32 v15, v16 offset:80
    s_mov_b32 s7, 0x40000
LP_37:
    ds_read_b32 v10, v122 offset:0
    s_sub_u32 s7, s7, 1
    s_waitcnt lgkmcnt(0)
    v_cmp_gt_u32 vcc, 1, v10
    s_cbranch_scc1 LPD_38
    s_cbranch_vccnz LP_37
LPD_38:
    ds_read_b128 v[68:71], v2
    ds_read_b128 v[76:79], v2 offset:2048
    ds_read2_b64 v[56:59], v118 offset0:0 offset1:1
    ds_read_b64 v[64:65], v119 offset:32
    ds_read2_b64 v[60:63], v118 offset0:160 offset1:161
    ds_read_b64 v[66:67], v119 offset:1312
    ds_read_b128 v[84:87], v3 offset:3072
    ds_read_b128 v[88:91], v3 offset:3744
    s_waitcnt lgkmcnt(2)
    v_mfma_f32_32x32x16_bf16 v[16:31], v[68:71], v[56:59], 0
    v_mfma_f32_32x32x8_bf16 v[16:31], v[76:77], v[64:65], v[16:31]
    v_mfma_f32_32x32x16_bf16 v[32:47], v[68:71], v[60:63], 0
    v_mfma_f32_32x32x8_bf16 v[32:47], v[76:77], v[66:67], v[32:47]
    s_add_u32 m0, s94, 117504
    s_add_u32 s70, s93, 12288
    buffer_load_dwordx4 v1, s[20:23], s70 offen sc1 lds
    buffer_load_dwordx4 v1, s[20:23], s70 offen offset:1024 sc1 lds
    buffer_load_dwordx4 v1, s[20:23], s70 offen offset:2048 sc1 lds
    s_sub_u32 m0, s69, 0
    s_mov_b64 exec, 1
    global_load_lds_dword v1, s[38:39] offset:0
    s_mov_b64 exec, -1
    v_mov_b32 v11, 1
    v_max3_f32 v16, v16, v17, v18
    v_max3_f32 v16, v16, v19, v20
    v_max3_f32 v16, v16, v21, v22
    v_max3_f32 v16, v16, v23, v24
    v_max3_f32 v16, v16, v25, v26
    v_max3_f32 v16, v16, v27, v28
    v_max3_f32 v16, v16, v29, v30
    v_max_f32 v16, v16, v31
    v_mov_b32 v17, v16
    s_nop 1
    v_permlane32_swap_b32 v16, v17
    s_nop 0
    v_max_f32 v16, v16, v17
    v_cvt_pk_bf16_f32 v16, -v16, 0
    v_cndmask_b32 v64, v64, v16, s[86:87]
    ds_write_b32 v123, v64 offset:0
    v_mfma_f32_32x32x16_bf16 v[16:31], v[68:71], v[56:59], 0
    v_mfma_f32_32x32x8_bf16 v[16:31], v[76:77], v[64:65], v[16:31]
    v_max3_f32 v32, v32, v33, v34
    v_max3_f32 v32, v32, v35, v36
    v_max3_f32 v32, v32, v37, v38
    v_max3_f32 v32, v32, v39, v40
    v_max3_f32 v32, v32, v41, v42
    v_max3_f32 v32, v32, v43, v44
    v_max3_f32 v32, v32, v45, v46
    v_max_f32 v32, v32, v47
    v_mov_b32 v33, v32
    s_nop 1
    v_permlane32_swap_b32 v32, v33
    s_nop 0
    v_max_f32 v32, v32, v33
    v_cvt_pk_bf16_f32 v32, -v32, 0
    v_cndmask_b32 v66, v66, v32, s[86:87]
    ds_write_b32 v123, v66 offset:256
    v_subrev_u32 v8, 64, v120
    ds_write_b32 v8, v11
    s_setprio 0
    s_branch A_ENTRY0
R_AUX:
    v_lshlrev_b32 v2, 7, v0
    s_bfe_u32 s6, s2, 0x30003
    s_lshl_b32 s6, s6, 13
    v_add_u32 v2, s6, v2
    s_mov_b32 s6, 43264
    s_add_u32 s34, s38, s6
    s_addc_u32 s35, s39, 0
    global_load_dwordx4 v[8:11], v1, s[34:35] offset:0
    global_load_dwordx4 v[12:15], v1, s[34:35] offset:1024
    s_waitcnt lgkmcnt(0)
    s_barrier
    s_mov_b64 s[20:21], s[70:71]
    s_mov_b32 s22, 16777216
    s_mov_b32 s23, 0x00020000
    s_mul_i32 s6, s5, 160
    s_add_u32 s12, s56, s6
    s_addc_u32 s13, s57, 0
    s_sub_u32 s14, 819200, s6
    s_mov_b32 s15, 0x00020000
    v_min_u32 v5, 24, v0
    v_lshlrev_b32 v5, 7, v5
    s_mul_i32 s6, s2, 3200
    s_setprio 3
    buffer_load_dword v5, v5, s[12:15], s6 offen
    v_min_u32 v6, 4, v0
    v_lshlrev_b32 v6, 21, v6
    v_sub_u32 v6, 0x8c0000, v6
    buffer_load_dword v6, v6, s[20:23], 0 offen sc1
    s_setprio 0
    s_lshr_b32 s88, s3, 2
    s_and_b32 s6, s3, 3
    s_mul_i32 s94, s6, 3072
    s_mov_b32 s90, s6
    s_mul_i32 s93, s88, 98304
    s_add_u32 s93, s93, s94
    s_add_u32 s93, s93, 9175040
    s_and_b32 s7, s2, 1
    s_lshl_b32 s85, s7, 2
    s_add_u32 s6, s6, s85
    s_lshl_b32 s6, s6, 2
    s_lshr_b32 s95, 0x2530531, s6
    s_and_b32 s95, s95, 15
    s_lshr_b32 s100, 0x4532531, s6
    s_and_b32 s100, s100, 15
    s_lshr_b32 s6, s2, 1
    s_mul_i32 s6, s6, 10
    s_add_u32 s6, s6, s85
    s_and_b32 s101, s95, 1
    s_add_u32 s95, s95, s6
    s_mul_i32 s95, s95, 2112
    s_lshl_b32 s7, s101, 6
    s_sub_u32 s95, s95, s7
    s_add_u32 s95, s95, 5767168
    s_add_u32 s100, s100, s6
    s_mul_i32 s100, s100, 2112
    s_add_u32 s100, s100, 5767168
    s_cmp_eq_u32 s100, s95
    s_cselect_b32 s100, 16777216, s100
    s_mul_i32 s32, s4, 81920
    s_mov_b32 s33, 0
    s_mul_i32 s6, s5, 160
    s_add_u32 s24, s62, s6
    s_addc_u32 s25, s63, 0
    s_sub_u32 s26, 819200, s6
    s_mov_b32 s27, 0x00020000
    s_mov_b64 s[28:29], s[66:67]
    s_mov_b32 s30, 2621440
    s_mov_b32 s31, 0x00020000
    s_and_b32 s80, s2, 1
    s_lshr_b32 s81, s2, 1
    s_mul_i32 s81, s81, 5
    s_lshl_b32 s80, s80, 1
    s_add_u32 s81, s81, s80
    s_mul_i32 s81, s81, 4224
    s_add_u32 s81, s81, 2621566
    v_mov_b32 v26, 163392
    v_mov_b32 v27, 1
    v_mov_b32 v28, 0
    v_mov_b32 v29, 0
    v_mov_b32 v30, 0
    v_mov_b32 v31, 0
    v_add_u32 v25, 72960, v1
    v_lshlrev_b32 v24, 6, v0
    s_mov_b32 s79, 9437184
    s_mul_i32 s82, s37, 81920
    s_mov_b32 s83, 163552
    v_mov_b32 v4, 9453568
    buffer_load_dword v4, v4, s[20:23], 0 offen sc1
    s_waitcnt vmcnt(1)
    s_mov_b32 m0, 48384
    s_add_u32 s84, s82, 40960
    buffer_load_dwordx4 v8, s[12:15], s82 offen offset:0 lds
    buffer_load_dwordx4 v9, s[12:15], s82 offen offset:1024 lds
    buffer_load_dwordx4 v10, s[12:15], s82 offen offset:2048 lds
    buffer_load_dwordx4 v11, s[12:15], s82 offen offset:3072 lds
    s_mov_b32 m0, 52480
    s_cmp_eq_u32 s84, 819200
    buffer_load_dwordx4 v12, s[12:15], s82 offen lds
    s_cselect_b32 s82, 0, s84
    s_waitcnt vmcnt(12)
    s_mov_b32 m0, 53504
    s_add_u32 s84, s82, 40960
    buffer_load_dwordx4 v8, s[12:15], s82 offen offset:0 lds
    buffer_load_dwordx4 v9, s[12:15], s82 offen offset:1024 lds
    buffer_load_dwordx4 v10, s[12:15], s82 offen offset:2048 lds
    buffer_load_dwordx4 v11, s[12:15], s82 offen offset:3072 lds
    s_mov_b32 m0, 57600
    s_cmp_eq_u32 s84, 819200
    buffer_load_dwordx4 v12, s[12:15], s82 offen lds
    s_cselect_b32 s82, 0, s84
    s_add_u32 m0, s83, 0
    s_mov_b64 exec, 1
    global_load_lds_dword v1, s[38:39]
    s_mov_b64 exec, -1
    s_waitcnt vmcnt(12)
    s_mov_b32 m0, 58624
    s_add_u32 s84, s82, 40960
    buffer_load_dwordx4 v8, s[12:15], s82 offen offset:0 lds
    buffer_load_dwordx4 v9, s[12:15], s82 offen offset:1024 lds
    buffer_load_dwordx4 v10, s[12:15], s82 offen offset:2048 lds
    buffer_load_dwordx4 v11, s[12:15], s82 offen offset:3072 lds
    s_mov_b32 m0, 62720
    s_cmp_eq_u32 s84, 819200
    buffer_load_dwordx4 v12, s[12:15], s82 offen lds
    s_cselect_b32 s82, 0, s84
    s_waitcnt vmcnt(12)
    s_mov_b32 m0, 63744
    s_add_u32 s84, s82, 40960
    buffer_load_dwordx4 v8, s[12:15], s82 offen offset:0 lds
    buffer_load_dwordx4 v9, s[12:15], s82 offen offset:1024 lds
    buffer_load_dwordx4 v10, s[12:15], s82 offen offset:2048 lds
    buffer_load_dwordx4 v11, s[12:15], s82 offen offset:3072 lds
    s_mov_b32 m0, 67840
    s_cmp_eq_u32 s84, 819200
    buffer_load_dwordx4 v12, s[12:15], s82 offen lds
    s_cselect_b32 s82, 0, s84
    s_add_u32 m0, s83, 4
    s_mov_b64 exec, 1
    global_load_lds_dword v1, s[38:39]
    s_mov_b64 exec, -1
    s_setprio 3
    s_waitcnt vmcnt(12)
    s_mov_b32 m0, 68864
    s_add_u32 s84, s82, 40960
    buffer_load_dwordx4 v8, s[12:15], s82 offen offset:0 lds
    buffer_load_dwordx4 v9, s[12:15], s82 offen offset:1024 lds
    buffer_load_dwordx4 v10, s[12:15], s82 offen offset:2048 lds
    buffer_load_dwordx4 v11, s[12:15], s82 offen offset:3072 lds
    s_mov_b32 m0, 72960
    s_cmp_eq_u32 s84, 819200
    buffer_load_dwordx4 v12, s[12:15], s82 offen lds
    s_cselect_b32 s82, 0, s84
    s_waitcnt vmcnt(12)
    s_mov_b32 m0, 73984
    s_add_u32 s84, s82, 40960
    buffer_load_dwordx4 v8, s[12:15], s82 offen offset:0 lds
    buffer_load_dwordx4 v9, s[12:15], s82 offen offset:1024 lds
    buffer_load_dwordx4 v10, s[12:15], s82 offen offset:2048 lds
    buffer_load_dwordx4 v11, s[12:15], s82 offen offset:3072 lds
    s_mov_b32 m0, 78080
    s_cmp_eq_u32 s84, 819200
    buffer_load_dwordx4 v12, s[12:15], s82 offen lds
    s_cselect_b32 s82, 0, s84
    s_add_u32 m0, s83, 8
    s_mov_b64 exec, 1
    global_load_lds_dword v1, s[38:39]
    s_mov_b64 exec, -1
    s_waitcnt vmcnt(12)
    s_mov_b32 m0, 79104
    s_add_u32 s84, s82, 40960
    buffer_load_dwordx4 v8, s[12:15], s82 offen offset:0 lds
    buffer_load_dwordx4 v9, s[12:15], s82 offen offset:1024 lds
    buffer_load_dwordx4 v10, s[12:15], s82 offen offset:2048 lds
    buffer_load_dwordx4 v11, s[12:15], s82 offen offset:3072 lds
    s_mov_b32 m0, 83200
    s_cmp_eq_u32 s84, 819200
    buffer_load_dwordx4 v12, s[12:15], s82 offen lds
    s_cselect_b32 s82, 0, s84
    s_waitcnt vmcnt(12)
    s_mov_b32 m0, 84224
    s_add_u32 s84, s82, 40960
    buffer_load_dwordx4 v8, s[12:15], s82 offen offset:0 lds
    buffer_load_dwordx4 v9, s[12:15], s82 offen offset:1024 lds
    buffer_load_dwordx4 v10, s[12:15], s82 offen offset:2048 lds
    buffer_load_dwordx4 v11, s[12:15], s82 offen offset:3072 lds
    s_mov_b32 m0, 88320
    s_cmp_eq_u32 s84, 819200
    buffer_load_dwordx4 v12, s[12:15], s82 offen lds
    s_cselect_b32 s82, 0, s84
    s_add_u32 m0, s83, 12
    s_mov_b64 exec, 1
    global_load_lds_dword v1, s[38:39]
    s_mov_b64 exec, -1
    s_waitcnt vmcnt(12)
    s_mov_b32 m0, 89344
    s_add_u32 s84, s82, 40960
    buffer_load_dwordx4 v8, s[12:15], s82 offen offset:0 lds
    buffer_load_dwordx4 v9, s[12:15], s82 offen offset:1024 lds
    buffer_load_dwordx4 v10, s[12:15], s82 offen offset:2048 lds
    buffer_load_dwordx4 v11, s[12:15], s82 offen offset:3072 lds
    s_mov_b32 m0, 93440
    s_cmp_eq_u32 s84, 819200
    buffer_load_dwordx4 v12, s[12:15], s82 offen lds
    s_cselect_b32 s82, 0, s84
    s_waitcnt vmcnt(12)
    s_mov_b32 m0, 94464
    s_add_u32 s84, s82, 40960
    buffer_load_dwordx4 v8, s[12:15], s82 offen offset:0 lds
    buffer_load_dwordx4 v9, s[12:15], s82 offen offset:1024 lds
    buffer_load_dwordx4 v10, s[12:15], s82 offen offset:2048 lds
    buffer_load_dwordx4 v11, s[12:15], s82 offen offset:3072 lds
    s_mov_b32 m0, 98560
    s_cmp_eq_u32 s84, 819200
    buffer_load_dwordx4 v12, s[12:15], s82 offen lds
    s_cselect_b32 s82, 0, s84
    s_add_u32 m0, s83, 16
    s_mov_b64 exec, 1
    global_load_lds_dword v1, s[38:39]
    s_mov_b64 exec, -1
    s_waitcnt vmcnt(12)
    s_mov_b32 m0, 99584
    s_add_u32 s84, s82, 40960
    buffer_load_dwordx4 v8, s[12:15], s82 offen offset:0 lds
    buffer_load_dwordx4 v9, s[12:15], s82 offen offset:1024 lds
    buffer_load_dwordx4 v10, s[12:15], s82 offen offset:2048 lds
    buffer_load_dwordx4 v11, s[12:15], s82 offen offset:3072 lds
    s_mov_b32 m0, 103680
    s_cmp_eq_u32 s84, 819200
    buffer_load_dwordx4 v12, s[12:15], s82 offen lds
    s_cselect_b32 s82, 0, s84
    s_waitcnt vmcnt(12)
    s_mov_b32 m0, 104704
    s_add_u32 s84, s82, 40960
    buffer_load_dwordx4 v8, s[12:15], s82 offen offset:0 lds
    buffer_load_dwordx4 v9, s[12:15], s82 offen offset:1024 lds
    buffer_load_dwordx4 v10, s[12:15], s82 offen offset:2048 lds
    buffer_load_dwordx4 v11, s[12:15], s82 offen offset:3072 lds
    s_mov_b32 m0, 108800
    s_cmp_eq_u32 s84, 819200
    buffer_load_dwordx4 v12, s[12:15], s82 offen lds
    s_cselect_b32 s82, 0, s84
    s_add_u32 m0, s83, 20
    s_mov_b64 exec, 1
    global_load_lds_dword v1, s[38:39]
    s_mov_b64 exec, -1
    v_readfirstlane_b32 s36, v4
    s_lshr_b32 s89, s2, 2
    s_lshl_b32 s89, s89, 6
    s_and_b32 s7, s2, 3
    s_lshl_b32 s7, s7, 2
    s_add_u32 s89, s89, s7
    s_mul_i32 s36, s36, 1664525
    s_add_u32 s36, s36, 1013904223
    s_mov_b32 s7, 0x40000
LP_39:
    ds_read_b32 v5, v14 offset:48
    s_sub_u32 s7, s7, 1
    s_waitcnt lgkmcnt(0)
    v_cmp_gt_u32 vcc, 1, v5
    s_cbranch_scc1 LPD_40
    s_cbranch_vccnz LP_39
LPD_40:
    s_waitcnt vmcnt(12)
    s_mov_b32 m0, 109824
    s_add_u32 s84, s82, 40960
    buffer_load_dwordx4 v8, s[12:15], s82 offen offset:0 lds
    buffer_load_dwordx4 v9, s[12:15], s82 offen offset:1024 lds
    buffer_load_dwordx4 v10, s[12:15], s82 offen offset:2048 lds
    buffer_load_dwordx4 v11, s[12:15], s82 offen offset:3072 lds
    s_mov_b32 m0, 113920
    s_cmp_eq_u32 s84, 819200
    buffer_load_dwordx4 v12, s[12:15], s82 offen lds
    s_cselect_b32 s82, 0, s84
    s_waitcnt vmcnt(12)
    s_mov_b32 m0, 114944
    s_add_u32 s84, s82, 40960
    buffer_load_dwordx4 v8, s[12:15], s82 offen offset:0 lds
    buffer_load_dwordx4 v9, s[12:15], s82 offen offset:1024 lds
    buffer_load_dwordx4 v10, s[12:15], s82 offen offset:2048 lds
    buffer_load_dwordx4 v11, s[12:15], s82 offen offset:3072 lds
    s_mov_b32 m0, 119040
    s_cmp_eq_u32 s84, 819200
    buffer_load_dwordx4 v12, s[12:15], s82 offen lds
    s_cselect_b32 s82, 0, s84
    s_add_u32 m0, s83, 24
    s_mov_b64 exec, 1
    global_load_lds_dword v1, s[38:39]
    s_mov_b64 exec, -1
    s_waitcnt vmcnt(12)
    s_mov_b32 m0, 120064
    s_add_u32 s84, s82, 40960
    buffer_load_dwordx4 v8, s[12:15], s82 offen offset:0 lds
    buffer_load_dwordx4 v9, s[12:15], s82 offen offset:1024 lds
    buffer_load_dwordx4 v10, s[12:15], s82 offen offset:2048 lds
    buffer_load_dwordx4 v11, s[12:15], s82 offen offset:3072 lds
    s_mov_b32 m0, 124160
    s_cmp_eq_u32 s84, 819200
    buffer_load_dwordx4 v12, s[12:15], s82 offen lds
    s_cselect_b32 s82, 0, s84
    s_waitcnt vmcnt(12)
    s_mov_b32 m0, 125184
    s_add_u32 s84, s82, 40960
    buffer_load_dwordx4 v8, s[12:15], s82 offen offset:0 lds
    buffer_load_dwordx4 v9, s[12:15], s82 offen offset:1024 lds
    buffer_load_dwordx4 v10, s[12:15], s82 offen offset:2048 lds
    buffer_load_dwordx4 v11, s[12:15], s82 offen offset:3072 lds
    s_mov_b32 m0, 129280
    s_cmp_eq_u32 s84, 819200
    buffer_load_dwordx4 v12, s[12:15], s82 offen lds
    s_cselect_b32 s82, 0, s84
    s_add_u32 m0, s83, 28
    s_mov_b64 exec, 1
    global_load_lds_dword v1, s[38:39]
    s_mov_b64 exec, -1
    s_waitcnt vmcnt(12)
    s_mov_b32 m0, 130304
    s_add_u32 s84, s82, 40960
    buffer_load_dwordx4 v8, s[12:15], s82 offen offset:0 lds
    buffer_load_dwordx4 v9, s[12:15], s82 offen offset:1024 lds
    buffer_load_dwordx4 v10, s[12:15], s82 offen offset:2048 lds
    buffer_load_dwordx4 v11, s[12:15], s82 offen offset:3072 lds
    s_mov_b32 m0, 134400
    s_cmp_eq_u32 s84, 819200
    buffer_load_dwordx4 v12, s[12:15], s82 offen lds
    s_cselect_b32 s82, 0, s84
    s_waitcnt vmcnt(12)
    s_mov_b32 m0, 135424
    s_add_u32 s84, s82, 40960
    buffer_load_dwordx4 v8, s[12:15], s82 offen offset:0 lds
    buffer_load_dwordx4 v9, s[12:15], s82 offen offset:1024 lds
    buffer_load_dwordx4 v10, s[12:15], s82 offen offset:2048 lds
    buffer_load_dwordx4 v11, s[12:15], s82 offen offset:3072 lds
    s_mov_b32 m0, 139520
    s_cmp_eq_u32 s84, 819200
    buffer_load_dwordx4 v12, s[12:15], s82 offen lds
    s_cselect_b32 s82, 0, s84
    s_add_u32 m0, s83, 32
    s_mov_b64 exec, 1
    global_load_lds_dword v1, s[38:39]
    s_mov_b64 exec, -1
    s_waitcnt vmcnt(12)
    s_mov_b32 m0, 140544
    s_add_u32 s84, s82, 40960
    buffer_load_dwordx4 v8, s[12:15], s82 offen offset:0 lds
    buffer_load_dwordx4 v9, s[12:15], s82 offen offset:1024 lds
    buffer_load_dwordx4 v10, s[12:15], s82 offen offset:2048 lds
    buffer_load_dwordx4 v11, s[12:15], s82 offen offset:3072 lds
    s_mov_b32 m0, 144640
    s_cmp_eq_u32 s84, 819200
    buffer_load_dwordx4 v12, s[12:15], s82 offen lds
    s_cselect_b32 s82, 0, s84
    s_waitcnt vmcnt(12)
    s_mov_b32 m0, 145664
    s_add_u32 s84, s82, 40960
    buffer_load_dwordx4 v8, s[12:15], s82 offen offset:0 lds
    buffer_load_dwordx4 v9, s[12:15], s82 offen offset:1024 lds
    buffer_load_dwordx4 v10, s[12:15], s82 offen offset:2048 lds
    buffer_load_dwordx4 v11, s[12:15], s82 offen offset:3072 lds
    s_mov_b32 m0, 149760
    s_cmp_eq_u32 s84, 819200
    buffer_load_dwordx4 v12, s[12:15], s82 offen lds
    s_cselect_b32 s82, 0, s84
    s_add_u32 m0, s83, 36
    s_mov_b64 exec, 1
    global_load_lds_dword v1, s[38:39]
    s_mov_b64 exec, -1
    buffer_load_dwordx4 v[32:35], v24, s[20:23], s79 offen sc1
    s_setprio 3
    s_mov_b32 s7, 0x40000
LP_41:
    ds_read_b32 v5, v14 offset:32
    s_sub_u32 s7, s7, 1
    s_waitcnt lgkmcnt(0)
    v_cmp_gt_u32 vcc, 1, v5
    s_cbranch_scc1 LPD_42
    s_cbranch_vccnz LP_41
LPD_42:
    s_mov_b32 s7, 0x4000
    s_waitcnt vmcnt(0)
L_GP:
    v_xor_b32 v32, s36, v32
    v_xor_b32 v33, s36, v33
    v_xor_b32 v34, s36, v34
    v_xor_b32 v35, s36, v35
    v_or3_b32 v32, v32, v33, v34
    v_or_b32 v32, v32, v35
    v_cmp_ne_u32 vcc, 0, v32
    s_sub_u32 s7, s7, 1
    s_cbranch_scc1 L_GPD
    s_cbranch_vccz L_GPD
    s_mov_b64 exec, vcc
    s_sleep 6
    buffer_load_dwordx4 v[32:35], v24, s[20:23], s79 offen sc1
    s_waitcnt vmcnt(0)
    s_branch L_GP
L_GPD:
    s_mov_b64 exec, -1
    s_mov_b32 s79, 9461760
    s_mov_b32 m0, 48384
    s_mov_b32 s6, 9175040
    buffer_load_dwordx4 v1, s[20:23], s6 offen offset:0 sc1 lds
    buffer_load_dwordx4 v1, s[20:23], s6 offen offset:1024 sc1 lds
    buffer_load_dwordx4 v1, s[20:23], s6 offen offset:2048 sc1 lds
    buffer_load_dwordx4 v1, s[20:23], s6 offen offset:3072 sc1 lds
    s_mov_b32 m0, 52480
    s_mov_b32 s6, 9179136
    buffer_load_dwordx4 v1, s[20:23], s6 offen offset:0 sc1 lds
    buffer_load_dwordx4 v1, s[20:23], s6 offen offset:1024 sc1 lds
    buffer_load_dwordx4 v1, s[20:23], s6 offen offset:2048 sc1 lds
    buffer_load_dwordx4 v1, s[20:23], s6 offen offset:3072 sc1 lds
    s_mov_b32 m0, 56576
    s_mov_b32 s6, 9183232
    buffer_load_dwordx4 v1, s[20:23], s6 offen offset:0 sc1 lds
    buffer_load_dwordx4 v1, s[20:23], s6 offen offset:1024 sc1 lds
    buffer_load_dwordx4 v1, s[20:23], s6 offen offset:2048 sc1 lds
    buffer_load_dwordx4 v1, s[20:23], s6 offen offset:3072 sc1 lds
    s_add_u32 m0, s83, -128
    s_mov_b64 exec, 1
    global_load_lds_dword v1, s[38:39]
    s_mov_b64 exec, -1
    v_min_u32 v23, 47, v0
    v_lshlrev_b32 v23, 7, v23
    s_lshr_b32 s6, s2, 3
    s_mul_i32 s6, s6, 6144
    s_add_u32 s6, s6, 9175040
    buffer_load_dword v23, v23, s[20:23], s6 offen sc1
    s_mov_b32 m0, 60672
    s_mov_b32 s6, 9273344
    buffer_load_dwordx4 v1, s[20:23], s6 offen offset:0 sc1 lds
    buffer_load_dwordx4 v1, s[20:23], s6 offen offset:1024 sc1 lds
    buffer_load_dwordx4 v1, s[20:23], s6 offen offset:2048 sc1 lds
    buffer_load_dwordx4 v1, s[20:23], s6 offen offset:3072 sc1 lds
    s_mov_b32 m0, 64768
    s_mov_b32 s6, 9277440
    buffer_load_dwordx4 v1, s[20:23], s6 offen offset:0 sc1 lds
    buffer_load_dwordx4 v1, s[20:23], s6 offen offset:1024 sc1 lds
    buffer_load_dwordx4 v1, s[20:23], s6 offen offset:2048 sc1 lds
    buffer_load_dwordx4 v1, s[20:23], s6 offen offset:3072 sc1 lds
    s_mov_b32 m0, 68864
    s_mov_b32 s6, 9281536
    buffer_load_dwordx4 v1, s[20:23], s6 offen offset:0 sc1 lds
    buffer_load_dwordx4 v1, s[20:23], s6 offen offset:1024 sc1 lds
    buffer_load_dwordx4 v1, s[20:23], s6 offen offset:2048 sc1 lds
    buffer_load_dwordx4 v1, s[20:23], s6 offen offset:3072 sc1 lds
    s_add_u32 m0, s83, -100
    s_mov_b64 exec, 1
    global_load_lds_dword v1, s[38:39]
    s_mov_b64 exec, -1
    s_lshl_b32 s7, s3, 11
    s_add_u32 s6, s7, 78080
    s_add_u32 s34, s38, s6
    s_addc_u32 s35, s39, 0
    global_load_dwordx4 v[116:119], v1, s[34:35] offset:0
    global_load_dwordx4 v[120:123], v1, s[34:35] offset:1024
    s_and_b32 s7, s2, 1
    s_lshl_b32 s7, s7, 2
    s_add_u32 s7, s7, s3
    s_lshl_b32 s7, s7, 10
    s_add_u32 s6, s7, 108800
    s_add_u32 s34, s38, s6
    s_addc_u32 s35, s39, 0
    global_load_dwordx4 v[244:247], v1, s[34:35] offset:0
    s_waitcnt vmcnt(0)
    s_branch PRO1
R_KD:
    s_setprio 3
    s_sub_u32 s72, s3, 4
    s_and_b32 s6, s2, 1
    s_lshr_b32 s73, s2, 1
    s_mul_i32 s73, s73, 5
    s_lshl_b32 s6, s6, 1
    s_add_u32 s73, s73, s6
    s_add_u32 s73, s73, s72
    v_lshlrev_b32 v2, 2, v0
    s_lshl_b32 s74, s73, 8
    s_and_b32 s75, s73, 0xfffffffe
    s_lshl_b32 s75, s75, 1
    s_mov_b32 s10, 163840
    s_mov_b32 s11, 0x00020000
    s_mov_b32 s14, 163840
    s_mov_b32 s15, 0x00020000
    s_mov_b32 s18, 163840
    s_mov_b32 s19, 0x00020000
    s_mov_b32 s78, 163840
    s_mov_b32 s79, 0x00020000
    s_waitcnt lgkmcnt(0)
    s_load_dword s80, s[50:51], s75
    s_load_dword s81, s[52:53], s75
    s_mov_b64 s[8:9], s[42:43]
    buffer_load_dword v12, v2, s[8:11], s74 offen
    s_mov_b64 s[12:13], s[44:45]
    buffer_load_dword v13, v2, s[12:15], s74 offen
    s_mov_b64 s[16:17], s[46:47]
    buffer_load_dword v14, v2, s[16:19], s74 offen
    s_mov_b64 s[76:77], s[48:49]
    buffer_load_dword v15, v2, s[76:79], s74 offen
    s_barrier
    s_setprio 0
    s_mov_b64 s[20:21], s[70:71]
    s_mov_b32 s22, 16777216
    s_mov_b32 s23, 0x00020000
    s_mov_b32 s82, 0x3fb8aa3b
    s_mov_b32 s83, 0x32a57060
    s_mov_b32 s84, 0x3f317218
    s_mul_i32 m0, s72, 16128
    s_lshr_b32 s88, s3, 2
    s_and_b32 s6, s3, 3
    s_mul_i32 s94, s6, 3072
    s_mov_b32 s90, s6
    s_mul_i32 s93, s88, 98304
    s_add_u32 s93, s93, s94
    s_add_u32 s93, s93, 9175040
    s_and_b32 s7, s2, 1
    s_lshl_b32 s85, s7, 2
    s_add_u32 s6, s6, s85
    s_lshl_b32 s6, s6, 2
    s_lshr_b32 s95, 0x2530531, s6
    s_and_b32 s95, s95, 15
    s_lshr_b32 s100, 0x4532531, s6
    s_and_b32 s100, s100, 15
    s_lshr_b32 s6, s2, 1
    s_mul_i32 s6, s6, 10
    s_add_u32 s6, s6, s85
    s_and_b32 s101, s95, 1
    s_add_u32 s95, s95, s6
    s_mul_i32 s95, s95, 2112
    s_lshl_b32 s7, s101, 6
    s_sub_u32 s95, s95, s7
    s_add_u32 s95, s95, 5767168
    s_add_u32 s100, s100, s6
    s_mul_i32 s100, s100, 2112
    s_add_u32 s100, s100, 5767168
    s_cmp_eq_u32 s100, s95
    s_cselect_b32 s100, 16777216, s100
    s_mul_i32 s32, s4, 81920
    s_mov_b32 s33, 0
    s_mul_i32 s6, s5, 160
    s_add_u32 s24, s62, s6
    s_addc_u32 s25, s63, 0
    s_sub_u32 s26, 819200, s6
    s_mov_b32 s27, 0x00020000
    s_mov_b64 s[28:29], s[66:67]
    s_mov_b32 s30, 2621440
    s_mov_b32 s31, 0x00020000
    s_waitcnt lgkmcnt(0)
    s_and_b32 s6, s73, 1
    s_xor_b32 s6, s6, 1
    s_lshl_b32 s6, s6, 4
    s_lshl_b32 s80, s80, s6
    s_and_b32 s80, s80, 0xffff0000
    s_lshl_b32 s81, s81, s6
    s_and_b32 s81, s81, 0xffff0000
    v_mov_b32 v5, s80
    v_mul_f32 v6, s82, v5
    v_fma_f32 v7, v5, s82, -v6
    v_fma_f32 v7, v5, s83, v7
    v_exp_f32 v6, v6
    v_mul_f32 v7, s84, v7
    v_fma_f32 v6, v6, v7, v6
    v_cvt_pk_bf16_f32 v6, v6, v6
    v_lshlrev_b32 v6, 16, v6
    v_add_f32 v7, v6, v6
    s_waitcnt vmcnt(0)
    v_and_b32 v16, 0xffff0000, v12
    v_mul_f32 v17, s82, v16
    v_fma_f32 v18, v16, s82, -v17
    v_fma_f32 v18, v16, s83, v18
    v_exp_f32 v17, v17
    v_mul_f32 v18, s84, v18
    v_fma_f32 v17, v17, v18, v17
    v_cvt_pk_bf16_f32 v17, v17, v17
    v_lshlrev_b32 v17, 16, v17
    v_mul_f32 v17, v17, v6
    v_mul_f32 v17, 0xbfb8aa3b, v17
    v_and_b32 v16, 0xffff0000, v13
    v_mul_f32 v16, v16, v6
    v_mul_f32 v16, 0.15915494, v16
    v_mul_f32 v18, 0x41000000, v17
    v_mul_f32 v19, 0x41000000, v16
    v_exp_f32 v18, v18
    v_fract_f32 v19, v19
    v_cos_f32 v26, v19
    v_sin_f32 v27, v19
    v_and_b32 v32, 0xffff0000, v14
    v_pk_mul_f32 v[26:27], v[26:27], v[18:19] op_sel_hi:[1,0]
    v_mul_f32 v18, 0x3f800000, v17
    v_mul_f32 v19, 0x3f800000, v16
    v_exp_f32 v18, v18
    v_fract_f32 v19, v19
    v_cos_f32 v20, v19
    v_sin_f32 v21, v19
    v_and_b32 v33, 0xffff0000, v15
    v_pk_mul_f32 v[20:21], v[20:21], v[18:19] op_sel_hi:[1,0]
    v_mul_f32 v18, 0x43800000, v17
    v_mul_f32 v19, 0x43800000, v16
    v_exp_f32 v18, v18
    v_fract_f32 v19, v19
    v_cos_f32 v30, v19
    v_sin_f32 v31, v19
    v_mul_f32 v32, v32, v7
    v_pk_mul_f32 v[30:31], v[30:31], v[18:19] op_sel_hi:[1,0]
    v_mul_f32 v33, v33, v7
    v_pk_mul_f32 v[56:57], v[20:21], v[20:21] op_sel:[0,0] op_sel_hi:[1,0]
    v_pk_mul_f32 v[58:59], v[26:27], v[26:27] op_sel:[0,0] op_sel_hi:[1,0]
    v_pk_fma_f32 v[22:23], v[20:21], v[20:21], v[56:57] op_sel:[1,1,0] op_sel_hi:[0,1,1] neg_lo:[1,0,0]
    v_pk_fma_f32 v[28:29], v[26:27], v[26:27], v[58:59] op_sel:[1,1,0] op_sel_hi:[0,1,1] neg_lo:[1,0,0]
    v_cvt_pk_bf16_f32 v64, v26, v27
    v_pk_mul_f32 v[56:57], v[22:23], v[22:23] op_sel:[0,0] op_sel_hi:[1,0]
    v_cvt_pk_bf16_f32 v65, v28, v29
    v_pk_fma_f32 v[24:25], v[22:23], v[22:23], v[56:57] op_sel:[1,1,0] op_sel_hi:[0,1,1] neg_lo:[1,0,0]
    v_cvt_pk_bf16_f32 v95, v32, -v33
    v_pk_mul_f32 v[56:57], v[26:27], v[28:29] op_sel:[0,0] op_sel_hi:[1,0]
    v_pk_mul_f32 v[58:59], v[28:29], v[28:29] op_sel:[0,0] op_sel_hi:[1,0]
    v_pk_mul_f32 v[60:61], v[32:33], v[20:21] op_sel:[0,0] op_sel_hi:[1,0]
    v_pk_mul_f32 v[8:9], v[32:33], v[30:31] op_sel:[0,0] op_sel_hi:[1,0]
    v_pk_fma_f32 v[48:49], v[26:27], v[28:29], v[56:57] op_sel:[1,1,0] op_sel_hi:[0,1,1] neg_lo:[1,0,0]
    v_pk_fma_f32 v[50:51], v[28:29], v[28:29], v[58:59] op_sel:[1,1,0] op_sel_hi:[0,1,1] neg_lo:[1,0,0]
    v_pk_fma_f32 v[52:53], v[32:33], v[20:21], v[60:61] op_sel:[1,1,0] op_sel_hi:[0,1,1] neg_lo:[1,0,0]
    v_pk_fma_f32 v[34:35], v[32:33], v[30:31], v[8:9] op_sel:[1,1,0] op_sel_hi:[0,1,1] neg_lo:[1,0,0]
    v_cvt_pk_bf16_f32 v66, v48, v49
    v_cvt_pk_bf16_f32 v67, v50, v51
    v_cvt_pk_bf16_f32 v96, v52, -v53
    v_cvt_pk_bf16_f32 v103, v34, -v35
    v_pk_mul_f32 v[56:57], v[48:49], v[28:29] op_sel:[0,0] op_sel_hi:[1,0]
    v_pk_mul_f32 v[58:59], v[50:51], v[28:29] op_sel:[0,0] op_sel_hi:[1,0]
    v_pk_mul_f32 v[60:61], v[52:53], v[20:21] op_sel:[0,0] op_sel_hi:[1,0]
    v_pk_mul_f32 v[8:9], v[34:35], v[30:31] op_sel:[0,0] op_sel_hi:[1,0]
    v_pk_fma_f32 v[48:49], v[48:49], v[28:29], v[56:57] op_sel:[1,1,0] op_sel_hi:[0,1,1] neg_lo:[1,0,0]
    v_pk_fma_f32 v[50:51], v[50:51], v[28:29], v[58:59] op_sel:[1,1,0] op_sel_hi:[0,1,1] neg_lo:[1,0,0]
    v_pk_fma_f32 v[52:53], v[52:53], v[20:21], v[60:61] op_sel:[1,1,0] op_sel_hi:[0,1,1] neg_lo:[1,0,0]
    v_pk_fma_f32 v[36:37], v[34:35], v[30:31], v[8:9] op_sel:[1,1,0] op_sel_hi:[0,1,1] neg_lo:[1,0,0]
    v_cvt_pk_bf16_f32 v68, v48, v49
    v_cvt_pk_bf16_f32 v69, v50, v51
    v_cvt_pk_bf16_f32 v97, v52, -v53
    v_cvt_pk_bf16_f32 v108, v36, -v37
    v_pk_mul_f32 v[56:57], v[48:49], v[28:29] op_sel:[0,0] op_sel_hi:[1,0]
    v_pk_mul_f32 v[58:59], v[50:51], v[28:29] op_sel:[0,0] op_sel_hi:[1,0]
    v_pk_mul_f32 v[60:61], v[52:53], v[20:21] op_sel:[0,0] op_sel_hi:[1,0]
    v_pk_mul_f32 v[8:9], v[36:37], v[30:31] op_sel:[0,0] op_sel_hi:[1,0]
    v_pk_fma_f32 v[48:49], v[48:49], v[28:29], v[56:57] op_sel:[1,1,0] op_sel_hi:[0,1,1] neg_lo:[1,0,0]
    v_pk_fma_f32 v[50:51], v[50:51], v[28:29], v[58:59] op_sel:[1,1,0] op_sel_hi:[0,1,1] neg_lo:[1,0,0]
    v_pk_fma_f32 v[52:53], v[52:53], v[20:21], v[60:61] op_sel:[1,1,0] op_sel_hi:[0,1,1] neg_lo:[1,0,0]
    v_pk_fma_f32 v[38:39], v[36:37], v[30:31], v[8:9] op_sel:[1,1,0] op_sel_hi:[0,1,1] neg_lo:[1,0,0]
    v_cvt_pk_bf16_f32 v70, v48, v49
    v_cvt_pk_bf16_f32 v71, v50, v51
    v_cvt_pk_bf16_f32 v98, v52, -v53
    v_cvt_pk_bf16_f32 v111, v38, -v39
    v_pk_mul_f32 v[56:57], v[48:49], v[28:29] op_sel:[0,0] op_sel_hi:[1,0]
    v_pk_mul_f32 v[58:59], v[50:51], v[28:29] op_sel:[0,0] op_sel_hi:[1,0]
    v_pk_mul_f32 v[60:61], v[52:53], v[20:21] op_sel:[0,0] op_sel_hi:[1,0]
    v_pk_mul_f32 v[8:9], v[38:39], v[30:31] op_sel:[0,0] op_sel_hi:[1,0]
    v_pk_fma_f32 v[48:49], v[48:49], v[28:29], v[56:57] op_sel:[1,1,0] op_sel_hi:[0,1,1] neg_lo:[1,0,0]
    v_pk_fma_f32 v[50:51], v[50:51], v[28:29], v[58:59] op_sel:[1,1,0] op_sel_hi:[0,1,1] neg_lo:[1,0,0]
    v_pk_fma_f32 v[52:53], v[52:53], v[20:21], v[60:61] op_sel:[1,1,0] op_sel_hi:[0,1,1] neg_lo:[1,0,0]
    v_pk_fma_f32 v[40:41], v[38:39], v[30:31], v[8:9] op_sel:[1,1,0] op_sel_hi:[0,1,1] neg_lo:[1,0,0]
    v_cvt_pk_bf16_f32 v72, v48, v49
    v_cvt_pk_bf16_f32 v73, v50, v51
    v_cvt_pk_bf16_f32 v99, v52, -v53
    v_cvt_pk_bf16_f32 v114, v40, -v41
    v_pk_mul_f32 v[56:57], v[48:49], v[28:29] op_sel:[0,0] op_sel_hi:[1,0]
    v_pk_mul_f32 v[58:59], v[50:51], v[28:29] op_sel:[0,0] op_sel_hi:[1,0]
    v_pk_mul_f32 v[60:61], v[52:53], v[20:21] op_sel:[0,0] op_sel_hi:[1,0]
    v_pk_mul_f32 v[8:9], v[40:41], v[30:31] op_sel:[0,0] op_sel_hi:[1,0]
    v_pk_fma_f32 v[48:49], v[48:49], v[28:29], v[56:57] op_sel:[1,1,0] op_sel_hi:[0,1,1] neg_lo:[1,0,0]
    v_pk_fma_f32 v[50:51], v[50:51], v[28:29], v[58:59] op_sel:[1,1,0] op_sel_hi:[0,1,1] neg_lo:[1,0,0]
    v_pk_fma_f32 v[52:53], v[52:53], v[20:21], v[60:61] op_sel:[1,1,0] op_sel_hi:[0,1,1] neg_lo:[1,0,0]
    v_pk_fma_f32 v[42:43], v[40:41], v[30:31], v[8:9] op_sel:[1,1,0] op_sel_hi:[0,1,1] neg_lo:[1,0,0]
    v_cvt_pk_bf16_f32 v74, v48, v49
    v_cvt_pk_bf16_f32 v75, v50, v51
    v_cvt_pk_bf16_f32 v100, v52, -v53
    v_cvt_pk_bf16_f32 v116, v42, -v43
    v_pk_mul_f32 v[56:57], v[48:49], v[28:29] op_sel:[0,0] op_sel_hi:[1,0]
    v_pk_mul_f32 v[58:59], v[50:51], v[28:29] op_sel:[0,0] op_sel_hi:[1,0]
    v_pk_mul_f32 v[60:61], v[52:53], v[20:21] op_sel:[0,0] op_sel_hi:[1,0]
    v_pk_mul_f32 v[8:9], v[42:43], v[30:31] op_sel:[0,0] op_sel_hi:[1,0]
    v_pk_fma_f32 v[48:49], v[48:49], v[28:29], v[56:57] op_sel:[1,1,0] op_sel_hi:[0,1,1] neg_lo:[1,0,0]
    v_pk_fma_f32 v[50:51], v[50:51], v[28:29], v[58:59] op_sel:[1,1,0] op_sel_hi:[0,1,1] neg_lo:[1,0,0]
    v_pk_fma_f32 v[52:53], v[52:53], v[20:21], v[60:61] op_sel:[1,1,0] op_sel_hi:[0,1,1] neg_lo:[1,0,0]
    v_pk_fma_f32 v[44:45], v[42:43], v[30:31], v[8:9] op_sel:[1,1,0] op_sel_hi:[0,1,1] neg_lo:[1,0,0]
    v_cvt_pk_bf16_f32 v76, v48, v49
    v_cvt_pk_bf16_f32 v77, v50, v51
    v_cvt_pk_bf16_f32 v101, v52, -v53
    v_cvt_pk_bf16_f32 v118, v44, -v45
    v_pk_mul_f32 v[56:57], v[48:49], v[28:29] op_sel:[0,0] op_sel_hi:[1,0]
    v_pk_mul_f32 v[58:59], v[50:51], v[28:29] op_sel:[0,0] op_sel_hi:[1,0]
    v_pk_mul_f32 v[60:61], v[52:53], v[20:21] op_sel:[0,0] op_sel_hi:[1,0]
    v_pk_mul_f32 v[8:9], v[44:45], v[30:31] op_sel:[0,0] op_sel_hi:[1,0]
    v_pk_fma_f32 v[48:49], v[48:49], v[28:29], v[56:57] op_sel:[1,1,0] op_sel_hi:[0,1,1] neg_lo:[1,0,0]
    v_pk_fma_f32 v[50:51], v[50:51], v[28:29], v[58:59] op_sel:[1,1,0] op_sel_hi:[0,1,1] neg_lo:[1,0,0]
    v_pk_fma_f32 v[52:53], v[52:53], v[20:21], v[60:61] op_sel:[1,1,0] op_sel_hi:[0,1,1] neg_lo:[1,0,0]
    v_pk_fma_f32 v[46:47], v[44:45], v[30:31], v[8:9] op_sel:[1,1,0] op_sel_hi:[0,1,1] neg_lo:[1,0,0]
    v_cvt_pk_bf16_f32 v78, v48, v49
    v_cvt_pk_bf16_f32 v79, v50, v51
    v_cvt_pk_bf16_f32 v102, v52, -v53
    v_cvt_pk_bf16_f32 v120, v46, -v47
    v_pk_mul_f32 v[56:57], v[48:49], v[28:29] op_sel:[0,0] op_sel_hi:[1,0]
    v_pk_mul_f32 v[58:59], v[50:51], v[28:29] op_sel:[0,0] op_sel_hi:[1,0]
    v_pk_mul_f32 v[60:61], v[34:35], v[22:23] op_sel:[0,0] op_sel_hi:[1,0]
    v_pk_mul_f32 v[8:9], v[40:41], v[26:27] op_sel:[0,0] op_sel_hi:[1,0]
    v_pk_fma_f32 v[48:49], v[48:49], v[28:29], v[56:57] op_sel:[1,1,0] op_sel_hi:[0,1,1] neg_lo:[1,0,0]
    v_pk_fma_f32 v[50:51], v[50:51], v[28:29], v[58:59] op_sel:[1,1,0] op_sel_hi:[0,1,1] neg_lo:[1,0,0]
    v_pk_fma_f32 v[52:53], v[34:35], v[22:23], v[60:61] op_sel:[1,1,0] op_sel_hi:[0,1,1] neg_lo:[1,0,0]
    v_pk_fma_f32 v[54:55], v[40:41], v[26:27], v[8:9] op_sel:[1,1,0] op_sel_hi:[0,1,1] neg_lo:[1,0,0]
    v_cvt_pk_bf16_f32 v80, v48, v49
    v_cvt_pk_bf16_f32 v81, v50, v51
    v_cvt_pk_bf16_f32 v104, v52, -v53
    v_cvt_pk_bf16_f32 v115, v54, -v55
    v_pk_mul_f32 v[56:57], v[48:49], v[28:29] op_sel:[0,0] op_sel_hi:[1,0]
    v_pk_mul_f32 v[58:59], v[50:51], v[28:29] op_sel:[0,0] op_sel_hi:[1,0]
    v_pk_mul_f32 v[60:61], v[52:53], v[22:23] op_sel:[0,0] op_sel_hi:[1,0]
    v_pk_mul_f32 v[8:9], v[42:43], v[26:27] op_sel:[0,0] op_sel_hi:[1,0]
    v_pk_fma_f32 v[48:49], v[48:49], v[28:29], v[56:57] op_sel:[1,1,0] op_sel_hi:[0,1,1] neg_lo:[1,0,0]
    v_pk_fma_f32 v[50:51], v[50:51], v[28:29], v[58:59] op_sel:[1,1,0] op_sel_hi:[0,1,1] neg_lo:[1,0,0]
    v_pk_fma_f32 v[52:53], v[52:53], v[22:23], v[60:61] op_sel:[1,1,0] op_sel_hi:[0,1,1] neg_lo:[1,0,0]
    v_pk_fma_f32 v[54:55], v[42:43], v[26:27], v[8:9] op_sel:[1,1,0] op_sel_hi:[0,1,1] neg_lo:[1,0,0]
    v_cvt_pk_bf16_f32 v82, v48, v49
    v_cvt_pk_bf16_f32 v83, v50, v51
    v_cvt_pk_bf16_f32 v105, v52, -v53
    v_cvt_pk_bf16_f32 v117, v54, -v55
    v_pk_mul_f32 v[56:57], v[48:49], v[28:29] op_sel:[0,0] op_sel_hi:[1,0]
    v_pk_mul_f32 v[58:59], v[50:51], v[28:29] op_sel:[0,0] op_sel_hi:[1,0]
    v_pk_mul_f32 v[60:61], v[52:53], v[22:23] op_sel:[0,0] op_sel_hi:[1,0]
    v_pk_mul_f32 v[8:9], v[44:45], v[26:27] op_sel:[0,0] op_sel_hi:[1,0]
    v_pk_fma_f32 v[48:49], v[48:49], v[28:29], v[56:57] op_sel:[1,1,0] op_sel_hi:[0,1,1] neg_lo:[1,0,0]
    v_pk_fma_f32 v[50:51], v[50:51], v[28:29], v[58:59] op_sel:[1,1,0] op_sel_hi:[0,1,1] neg_lo:[1,0,0]
    v_pk_fma_f32 v[52:53], v[52:53], v[22:23], v[60:61] op_sel:[1,1,0] op_sel_hi:[0,1,1] neg_lo:[1,0,0]
    v_pk_fma_f32 v[54:55], v[44:45], v[26:27], v[8:9] op_sel:[1,1,0] op_sel_hi:[0,1,1] neg_lo:[1,0,0]
    v_cvt_pk_bf16_f32 v84, v48, v49
    v_cvt_pk_bf16_f32 v85, v50, v51
    v_cvt_pk_bf16_f32 v106, v52, -v53
    v_cvt_pk_bf16_f32 v119, v54, -v55
    v_pk_mul_f32 v[56:57], v[48:49], v[28:29] op_sel:[0,0] op_sel_hi:[1,0]
    v_pk_mul_f32 v[58:59], v[50:51], v[28:29] op_sel:[0,0] op_sel_hi:[1,0]
    v_pk_mul_f32 v[60:61], v[52:53], v[22:23] op_sel:[0,0] op_sel_hi:[1,0]
    v_pk_mul_f32 v[8:9], v[46:47], v[26:27] op_sel:[0,0] op_sel_hi:[1,0]
    v_pk_fma_f32 v[48:49], v[48:49], v[28:29], v[56:57] op_sel:[1,1,0] op_sel_hi:[0,1,1] neg_lo:[1,0,0]
    v_pk_fma_f32 v[50:51], v[50:51], v[28:29], v[58:59] op_sel:[1,1,0] op_sel_hi:[0,1,1] neg_lo:[1,0,0]
    v_pk_fma_f32 v[52:53], v[52:53], v[22:23], v[60:61] op_sel:[1,1,0] op_sel_hi:[0,1,1] neg_lo:[1,0,0]
    v_pk_fma_f32 v[54:55], v[46:47], v[26:27], v[8:9] op_sel:[1,1,0] op_sel_hi:[0,1,1] neg_lo:[1,0,0]
    v_cvt_pk_bf16_f32 v86, v48, v49
    v_cvt_pk_bf16_f32 v87, v50, v51
    v_cvt_pk_bf16_f32 v107, v52, -v53
    v_cvt_pk_bf16_f32 v121, v54, -v55
    v_pk_mul_f32 v[56:57], v[48:49], v[28:29] op_sel:[0,0] op_sel_hi:[1,0]
    v_pk_mul_f32 v[58:59], v[50:51], v[28:29] op_sel:[0,0] op_sel_hi:[1,0]
    v_pk_mul_f32 v[60:61], v[36:37], v[24:25] op_sel:[0,0] op_sel_hi:[1,0]
    v_pk_mul_f32 v[8:9], v[38:39], v[24:25] op_sel:[0,0] op_sel_hi:[1,0]
    v_pk_fma_f32 v[48:49], v[48:49], v[28:29], v[56:57] op_sel:[1,1,0] op_sel_hi:[0,1,1] neg_lo:[1,0,0]
    v_pk_fma_f32 v[50:51], v[50:51], v[28:29], v[58:59] op_sel:[1,1,0] op_sel_hi:[0,1,1] neg_lo:[1,0,0]
    v_pk_fma_f32 v[52:53], v[36:37], v[24:25], v[60:61] op_sel:[1,1,0] op_sel_hi:[0,1,1] neg_lo:[1,0,0]
    v_pk_fma_f32 v[54:55], v[38:39], v[24:25], v[8:9] op_sel:[1,1,0] op_sel_hi:[0,1,1] neg_lo:[1,0,0]
    v_cvt_pk_bf16_f32 v88, v48, v49
    v_cvt_pk_bf16_f32 v89, v50, v51
    v_cvt_pk_bf16_f32 v109, v52, -v53
    v_cvt_pk_bf16_f32 v112, v54, -v55
    v_pk_mul_f32 v[56:57], v[48:49], v[28:29] op_sel:[0,0] op_sel_hi:[1,0]
    v_pk_mul_f32 v[58:59], v[50:51], v[28:29] op_sel:[0,0] op_sel_hi:[1,0]
    v_pk_mul_f32 v[60:61], v[52:53], v[24:25] op_sel:[0,0] op_sel_hi:[1,0]
    v_pk_mul_f32 v[8:9], v[54:55], v[24:25] op_sel:[0,0] op_sel_hi:[1,0]
    v_pk_fma_f32 v[48:49], v[48:49], v[28:29], v[56:57] op_sel:[1,1,0] op_sel_hi:[0,1,1] neg_lo:[1,0,0]
    v_pk_fma_f32 v[50:51], v[50:51], v[28:29], v[58:59] op_sel:[1,1,0] op_sel_hi:[0,1,1] neg_lo:[1,0,0]
    v_pk_fma_f32 v[52:53], v[52:53], v[24:25], v[60:61] op_sel:[1,1,0] op_sel_hi:[0,1,1] neg_lo:[1,0,0]
    v_pk_fma_f32 v[54:55], v[54:55], v[24:25], v[8:9] op_sel:[1,1,0] op_sel_hi:[0,1,1] neg_lo:[1,0,0]
    v_cvt_pk_bf16_f32 v90, v48, v49
    v_cvt_pk_bf16_f32 v91, v50, v51
    v_cvt_pk_bf16_f32 v110, v52, -v53
    v_cvt_pk_bf16_f32 v113, v54, -v55
    v_pk_mul_f32 v[56:57], v[48:49], v[28:29] op_sel:[0,0] op_sel_hi:[1,0]
    v_pk_mul_f32 v[58:59], v[50:51], v[28:29] op_sel:[0,0] op_sel_hi:[1,0]
    v_pk_fma_f32 v[48:49], v[48:49], v[28:29], v[56:57] op_sel:[1,1,0] op_sel_hi:[0,1,1] neg_lo:[1,0,0]
    v_pk_fma_f32 v[50:51], v[50:51], v[28:29], v[58:59] op_sel:[1,1,0] op_sel_hi:[0,1,1] neg_lo:[1,0,0]
    v_cvt_pk_bf16_f32 v92, v48, v49
    v_cvt_pk_bf16_f32 v93, v50, v51
    v_pk_mul_f32 v[56:57], v[48:49], v[28:29] op_sel:[0,0] op_sel_hi:[1,0]
    v_pk_fma_f32 v[48:49], v[48:49], v[28:29], v[56:57] op_sel:[1,1,0] op_sel_hi:[0,1,1] neg_lo:[1,0,0]
    v_cvt_pk_bf16_f32 v94, v48, v49
    s_lshl_b32 s7, s72, 11
    s_add_u32 s6, s7, 37120
    s_add_u32 s34, s38, s6
    s_addc_u32 s35, s39, 0
    global_load_dwordx4 v[180:183], v1, s[34:35] offset:0
    global_load_dwordx4 v[184:187], v1, s[34:35] offset:1024
    v_lshlrev_b32 v16, 16, v12
    v_mul_f32 v17, s82, v16
    v_fma_f32 v18, v16, s82, -v17
    v_fma_f32 v18, v16, s83, v18
    v_exp_f32 v17, v17
    v_mul_f32 v18, s84, v18
    v_fma_f32 v17, v17, v18, v17
    v_cvt_pk_bf16_f32 v17, v17, v17
    v_lshlrev_b32 v17, 16, v17
    v_mul_f32 v17, v17, v6
    v_mul_f32 v17, 0xbfb8aa3b, v17
    v_lshlrev_b32 v16, 16, v13
    v_mul_f32 v16, v16, v6
    v_mul_f32 v16, 0.15915494, v16
    v_mul_f32 v18, 0x41000000, v17
    v_mul_f32 v19, 0x41000000, v16
    v_exp_f32 v18, v18
    v_fract_f32 v19, v19
    v_cos_f32 v26, v19
    v_sin_f32 v27, v19
    v_lshlrev_b32 v32, 16, v14
    v_pk_mul_f32 v[26:27], v[26:27], v[18:19] op_sel_hi:[1,0]
    v_mul_f32 v18, 0x3f800000, v17
    v_mul_f32 v19, 0x3f800000, v16
    v_exp_f32 v18, v18
    v_fract_f32 v19, v19
    v_cos_f32 v20, v19
    v_sin_f32 v21, v19
    v_lshlrev_b32 v33, 16, v15
    v_pk_mul_f32 v[20:21], v[20:21], v[18:19] op_sel_hi:[1,0]
    v_mul_f32 v18, 0x43800000, v17
    v_mul_f32 v19, 0x43800000, v16
    v_exp_f32 v18, v18
    v_fract_f32 v19, v19
    v_cos_f32 v30, v19
    v_sin_f32 v31, v19
    v_mul_f32 v32, v32, v7
    v_pk_mul_f32 v[30:31], v[30:31], v[18:19] op_sel_hi:[1,0]
    v_mul_f32 v33, v33, v7
    v_pk_mul_f32 v[56:57], v[20:21], v[20:21] op_sel:[0,0] op_sel_hi:[1,0]
    v_pk_mul_f32 v[58:59], v[26:27], v[26:27] op_sel:[0,0] op_sel_hi:[1,0]
    v_pk_fma_f32 v[22:23], v[20:21], v[20:21], v[56:57] op_sel:[1,1,0] op_sel_hi:[0,1,1] neg_lo:[1,0,0]
    v_pk_fma_f32 v[28:29], v[26:27], v[26:27], v[58:59] op_sel:[1,1,0] op_sel_hi:[0,1,1] neg_lo:[1,0,0]
    v_cvt_pk_bf16_f32 v122, v26, v27
    v_pk_mul_f32 v[56:57], v[22:23], v[22:23] op_sel:[0,0] op_sel_hi:[1,0]
    v_cvt_pk_bf16_f32 v123, v28, v29
    v_pk_fma_f32 v[24:25], v[22:23], v[22:23], v[56:57] op_sel:[1,1,0] op_sel_hi:[0,1,1] neg_lo:[1,0,0]
    v_cvt_pk_bf16_f32 v153, v32, -v33
    v_pk_mul_f32 v[56:57], v[26:27], v[28:29] op_sel:[0,0] op_sel_hi:[1,0]
    v_pk_mul_f32 v[58:59], v[28:29], v[28:29] op_sel:[0,0] op_sel_hi:[1,0]
    v_pk_mul_f32 v[60:61], v[32:33], v[20:21] op_sel:[0,0] op_sel_hi:[1,0]
    v_pk_mul_f32 v[8:9], v[32:33], v[30:31] op_sel:[0,0] op_sel_hi:[1,0]
    v_pk_fma_f32 v[48:49], v[26:27], v[28:29], v[56:57] op_sel:[1,1,0] op_sel_hi:[0,1,1] neg_lo:[1,0,0]
    v_pk_fma_f32 v[50:51], v[28:29], v[28:29], v[58:59] op_sel:[1,1,0] op_sel_hi:[0,1,1] neg_lo:[1,0,0]
    v_pk_fma_f32 v[52:53], v[32:33], v[20:21], v[60:61] op_sel:[1,1,0] op_sel_hi:[0,1,1] neg_lo:[1,0,0]
    v_pk_fma_f32 v[34:35], v[32:33], v[30:31], v[8:9] op_sel:[1,1,0] op_sel_hi:[0,1,1] neg_lo:[1,0,0]
    v_cvt_pk_bf16_f32 v124, v48, v49
    v_cvt_pk_bf16_f32 v125, v50, v51
    v_cvt_pk_bf16_f32 v154, v52, -v53
    v_cvt_pk_bf16_f32 v161, v34, -v35
    v_pk_mul_f32 v[56:57], v[48:49], v[28:29] op_sel:[0,0] op_sel_hi:[1,0]
    v_pk_mul_f32 v[58:59], v[50:51], v[28:29] op_sel:[0,0] op_sel_hi:[1,0]
    v_pk_mul_f32 v[60:61], v[52:53], v[20:21] op_sel:[0,0] op_sel_hi:[1,0]
    v_pk_mul_f32 v[8:9], v[34:35], v[30:31] op_sel:[0,0] op_sel_hi:[1,0]
    v_pk_fma_f32 v[48:49], v[48:49], v[28:29], v[56:57] op_sel:[1,1,0] op_sel_hi:[0,1,1] neg_lo:[1,0,0]
    v_pk_fma_f32 v[50:51], v[50:51], v[28:29], v[58:59] op_sel:[1,1,0] op_sel_hi:[0,1,1] neg_lo:[1,0,0]
    v_pk_fma_f32 v[52:53], v[52:53], v[20:21], v[60:61] op_sel:[1,1,0] op_sel_hi:[0,1,1] neg_lo:[1,0,0]
    v_pk_fma_f32 v[36:37], v[34:35], v[30:31], v[8:9] op_sel:[1,1,0] op_sel_hi:[0,1,1] neg_lo:[1,0,0]
    v_cvt_pk_bf16_f32 v126, v48, v49
    v_cvt_pk_bf16_f32 v127, v50, v51
    v_cvt_pk_bf16_f32 v155, v52, -v53
    v_cvt_pk_bf16_f32 v166, v36, -v37
    v_pk_mul_f32 v[56:57], v[48:49], v[28:29] op_sel:[0,0] op_sel_hi:[1,0]
    v_pk_mul_f32 v[58:59], v[50:51], v[28:29] op_sel:[0,0] op_sel_hi:[1,0]
    v_pk_mul_f32 v[60:61], v[52:53], v[20:21] op_sel:[0,0] op_sel_hi:[1,0]
    v_pk_mul_f32 v[8:9], v[36:37], v[30:31] op_sel:[0,0] op_sel_hi:[1,0]
    v_pk_fma_f32 v[48:49], v[48:49], v[28:29], v[56:57] op_sel:[1,1,0] op_sel_hi:[0,1,1] neg_lo:[1,0,0]
    v_pk_fma_f32 v[50:51], v[50:51], v[28:29], v[58:59] op_sel:[1,1,0] op_sel_hi:[0,1,1] neg_lo:[1,0,0]
    v_pk_fma_f32 v[52:53], v[52:53], v[20:21], v[60:61] op_sel:[1,1,0] op_sel_hi:[0,1,1] neg_lo:[1,0,0]
    v_pk_fma_f32 v[38:39], v[36:37], v[30:31], v[8:9] op_sel:[1,1,0] op_sel_hi:[0,1,1] neg_lo:[1,0,0]
    v_cvt_pk_bf16_f32 v128, v48, v49
    v_cvt_pk_bf16_f32 v129, v50, v51
    v_cvt_pk_bf16_f32 v156, v52, -v53
    v_cvt_pk_bf16_f32 v169, v38, -v39
    v_pk_mul_f32 v[56:57], v[48:49], v[28:29] op_sel:[0,0] op_sel_hi:[1,0]
    v_pk_mul_f32 v[58:59], v[50:51], v[28:29] op_sel:[0,0] op_sel_hi:[1,0]
    v_pk_mul_f32 v[60:61], v[52:53], v[20:21] op_sel:[0,0] op_sel_hi:[1,0]
    v_pk_mul_f32 v[8:9], v[38:39], v[30:31] op_sel:[0,0] op_sel_hi:[1,0]
    v_pk_fma_f32 v[48:49], v[48:49], v[28:29], v[56:57] op_sel:[1,1,0] op_sel_hi:[0,1,1] neg_lo:[1,0,0]
    v_pk_fma_f32 v[50:51], v[50:51], v[28:29], v[58:59] op_sel:[1,1,0] op_sel_hi:[0,1,1] neg_lo:[1,0,0]
    v_pk_fma_f32 v[52:53], v[52:53], v[20:21], v[60:61] op_sel:[1,1,0] op_sel_hi:[0,1,1] neg_lo:[1,0,0]
    v_pk_fma_f32 v[40:41], v[38:39], v[30:31], v[8:9] op_sel:[1,1,0] op_sel_hi:[0,1,1] neg_lo:[1,0,0]
    v_cvt_pk_bf16_f32 v130, v48, v49
    v_cvt_pk_bf16_f32 v131, v50, v51
    v_cvt_pk_bf16_f32 v157, v52, -v53
    v_cvt_pk_bf16_f32 v172, v40, -v41
    v_pk_mul_f32 v[56:57], v[48:49], v[28:29] op_sel:[0,0] op_sel_hi:[1,0]
    v_pk_mul_f32 v[58:59], v[50:51], v[28:29] op_sel:[0,0] op_sel_hi:[1,0]
    v_pk_mul_f32 v[60:61], v[52:53], v[20:21] op_sel:[0,0] op_sel_hi:[1,0]
    v_pk_mul_f32 v[8:9], v[40:41], v[30:31] op_sel:[0,0] op_sel_hi:[1,0]
    v_pk_fma_f32 v[48:49], v[48:49], v[28:29], v[56:57] op_sel:[1,1,0] op_sel_hi:[0,1,1] neg_lo:[1,0,0]
    v_pk_fma_f32 v[50:51], v[50:51], v[28:29], v[58:59] op_sel:[1,1,0] op_sel_hi:[0,1,1] neg_lo:[1,0,0]
    v_pk_fma_f32 v[52:53], v[52:53], v[20:21], v[60:61] op_sel:[1,1,0] op_sel_hi:[0,1,1] neg_lo:[1,0,0]
    v_pk_fma_f32 v[42:43], v[40:41], v[30:31], v[8:9] op_sel:[1,1,0] op_sel_hi:[0,1,1] neg_lo:[1,0,0]
    v_cvt_pk_bf16_f32 v132, v48, v49
    v_cvt_pk_bf16_f32 v133, v50, v51
    v_cvt_pk_bf16_f32 v158, v52, -v53
    v_cvt_pk_bf16_f32 v174, v42, -v43
    v_pk_mul_f32 v[56:57], v[48:49], v[28:29] op_sel:[0,0] op_sel_hi:[1,0]
    v_pk_mul_f32 v[58:59], v[50:51], v[28:29] op_sel:[0,0] op_sel_hi:[1,0]
    v_pk_mul_f32 v[60:61], v[52:53], v[20:21] op_sel:[0,0] op_sel_hi:[1,0]
    v_pk_mul_f32 v[8:9], v[42:43], v[30:31] op_sel:[0,0] op_sel_hi:[1,0]
    v_pk_fma_f32 v[48:49], v[48:49], v[28:29], v[56:57] op_sel:[1,1,0] op_sel_hi:[0,1,1] neg_lo:[1,0,0]
    v_pk_fma_f32 v[50:51], v[50:51], v[28:29], v[58:59] op_sel:[1,1,0] op_sel_hi:[0,1,1] neg_lo:[1,0,0]
    v_pk_fma_f32 v[52:53], v[52:53], v[20:21], v[60:61] op_sel:[1,1,0] op_sel_hi:[0,1,1] neg_lo:[1,0,0]
    v_pk_fma_f32 v[44:45], v[42:43], v[30:31], v[8:9] op_sel:[1,1,0] op_sel_hi:[0,1,1] neg_lo:[1,0,0]
    v_cvt_pk_bf16_f32 v134, v48, v49
    v_cvt_pk_bf16_f32 v135, v50, v51
    v_cvt_pk_bf16_f32 v159, v52, -v53
    v_cvt_pk_bf16_f32 v176, v44, -v45
    v_pk_mul_f32 v[56:57], v[48:49], v[28:29] op_sel:[0,0] op_sel_hi:[1,0]
    v_pk_mul_f32 v[58:59], v[50:51], v[28:29] op_sel:[0,0] op_sel_hi:[1,0]
    v_pk_mul_f32 v[60:61], v[52:53], v[20:21] op_sel:[0,0] op_sel_hi:[1,0]
    v_pk_mul_f32 v[8:9], v[44:45], v[30:31] op_sel:[0,0] op_sel_hi:[1,0]
    v_pk_fma_f32 v[48:49], v[48:49], v[28:29], v[56:57] op_sel:[1,1,0] op_sel_hi:[0,1,1] neg_lo:[1,0,0]
    v_pk_fma_f32 v[50:51], v[50:51], v[28:29], v[58:59] op_sel:[1,1,0] op_sel_hi:[0,1,1] neg_lo:[1,0,0]
    v_pk_fma_f32 v[52:53], v[52:53], v[20:21], v[60:61] op_sel:[1,1,0] op_sel_hi:[0,1,1] neg_lo:[1,0,0]
    v_pk_fma_f32 v[46:47], v[44:45], v[30:31], v[8:9] op_sel:[1,1,0] op_sel_hi:[0,1,1] neg_lo:[1,0,0]
    v_cvt_pk_bf16_f32 v136, v48, v49
    v_cvt_pk_bf16_f32 v137, v50, v51
    v_cvt_pk_bf16_f32 v160, v52, -v53
    v_cvt_pk_bf16_f32 v178, v46, -v47
    v_pk_mul_f32 v[56:57], v[48:49], v[28:29] op_sel:[0,0] op_sel_hi:[1,0]
    v_pk_mul_f32 v[58:59], v[50:51], v[28:29] op_sel:[0,0] op_sel_hi:[1,0]
    v_pk_mul_f32 v[60:61], v[34:35], v[22:23] op_sel:[0,0] op_sel_hi:[1,0]
    v_pk_mul_f32 v[8:9], v[40:41], v[26:27] op_sel:[0,0] op_sel_hi:[1,0]
    v_pk_fma_f32 v[48:49], v[48:49], v[28:29], v[56:57] op_sel:[1,1,0] op_sel_hi:[0,1,1] neg_lo:[1,0,0]
    v_pk_fma_f32 v[50:51], v[50:51], v[28:29], v[58:59] op_sel:[1,1,0] op_sel_hi:[0,1,1] neg_lo:[1,0,0]
    v_pk_fma_f32 v[52:53], v[34:35], v[22:23], v[60:61] op_sel:[1,1,0] op_sel_hi:[0,1,1] neg_lo:[1,0,0]
    v_pk_fma_f32 v[54:55], v[40:41], v[26:27], v[8:9] op_sel:[1,1,0] op_sel_hi:[0,1,1] neg_lo:[1,0,0]
    v_cvt_pk_bf16_f32 v138, v48, v49
    v_cvt_pk_bf16_f32 v139, v50, v51
    v_cvt_pk_bf16_f32 v162, v52, -v53
    v_cvt_pk_bf16_f32 v173, v54, -v55
    v_pk_mul_f32 v[56:57], v[48:49], v[28:29] op_sel:[0,0] op_sel_hi:[1,0]
    v_pk_mul_f32 v[58:59], v[50:51], v[28:29] op_sel:[0,0] op_sel_hi:[1,0]
    v_pk_mul_f32 v[60:61], v[52:53], v[22:23] op_sel:[0,0] op_sel_hi:[1,0]
    v_pk_mul_f32 v[8:9], v[42:43], v[26:27] op_sel:[0,0] op_sel_hi:[1,0]
    v_pk_fma_f32 v[48:49], v[48:49], v[28:29], v[56:57] op_sel:[1,1,0] op_sel_hi:[0,1,1] neg_lo:[1,0,0]
    v_pk_fma_f32 v[50:51], v[50:51], v[28:29], v[58:59] op_sel:[1,1,0] op_sel_hi:[0,1,1] neg_lo:[1,0,0]
    v_pk_fma_f32 v[52:53], v[52:53], v[22:23], v[60:61] op_sel:[1,1,0] op_sel_hi:[0,1,1] neg_lo:[1,0,0]
    v_pk_fma_f32 v[54:55], v[42:43], v[26:27], v[8:9] op_sel:[1,1,0] op_sel_hi:[0,1,1] neg_lo:[1,0,0]
    v_cvt_pk_bf16_f32 v140, v48, v49
    v_cvt_pk_bf16_f32 v141, v50, v51
    v_cvt_pk_bf16_f32 v163, v52, -v53
    v_cvt_pk_bf16_f32 v175, v54, -v55
    v_pk_mul_f32 v[56:57], v[48:49], v[28:29] op_sel:[0,0] op_sel_hi:[1,0]
    v_pk_mul_f32 v[58:59], v[50:51], v[28:29] op_sel:[0,0] op_sel_hi:[1,0]
    v_pk_mul_f32 v[60:61], v[52:53], v[22:23] op_sel:[0,0] op_sel_hi:[1,0]
    v_pk_mul_f32 v[8:9], v[44:45], v[26:27] op_sel:[0,0] op_sel_hi:[1,0]
    v_pk_fma_f32 v[48:49], v[48:49], v[28:29], v[56:57] op_sel:[1,1,0] op_sel_hi:[0,1,1] neg_lo:[1,0,0]
    v_pk_fma_f32 v[50:51], v[50:51], v[28:29], v[58:59] op_sel:[1,1,0] op_sel_hi:[0,1,1] neg_lo:[1,0,0]
    v_pk_fma_f32 v[52:53], v[52:53], v[22:23], v[60:61] op_sel:[1,1,0] op_sel_hi:[0,1,1] neg_lo:[1,0,0]
    v_pk_fma_f32 v[54:55], v[44:45], v[26:27], v[8:9] op_sel:[1,1,0] op_sel_hi:[0,1,1] neg_lo:[1,0,0]
    v_cvt_pk_bf16_f32 v142, v48, v49
    v_cvt_pk_bf16_f32 v143, v50, v51
    v_cvt_pk_bf16_f32 v164, v52, -v53
    v_cvt_pk_bf16_f32 v177, v54, -v55
    v_pk_mul_f32 v[56:57], v[48:49], v[28:29] op_sel:[0,0] op_sel_hi:[1,0]
    v_pk_mul_f32 v[58:59], v[50:51], v[28:29] op_sel:[0,0] op_sel_hi:[1,0]
    v_pk_mul_f32 v[60:61], v[52:53], v[22:23] op_sel:[0,0] op_sel_hi:[1,0]
    v_pk_mul_f32 v[8:9], v[46:47], v[26:27] op_sel:[0,0] op_sel_hi:[1,0]
    v_pk_fma_f32 v[48:49], v[48:49], v[28:29], v[56:57] op_sel:[1,1,0] op_sel_hi:[0,1,1] neg_lo:[1,0,0]
    v_pk_fma_f32 v[50:51], v[50:51], v[28:29], v[58:59] op_sel:[1,1,0] op_sel_hi:[0,1,1] neg_lo:[1,0,0]
    v_pk_fma_f32 v[52:53], v[52:53], v[22:23], v[60:61] op_sel:[1,1,0] op_sel_hi:[0,1,1] neg_lo:[1,0,0]
    v_pk_fma_f32 v[54:55], v[46:47], v[26:27], v[8:9] op_sel:[1,1,0] op_sel_hi:[0,1,1] neg_lo:[1,0,0]
    v_cvt_pk_bf16_f32 v144, v48, v49
    v_cvt_pk_bf16_f32 v145, v50, v51
    v_cvt_pk_bf16_f32 v165, v52, -v53
    v_cvt_pk_bf16_f32 v179, v54, -v55
    v_pk_mul_f32 v[56:57], v[48:49], v[28:29] op_sel:[0,0] op_sel_hi:[1,0]
    v_pk_mul_f32 v[58:59], v[50:51], v[28:29] op_sel:[0,0] op_sel_hi:[1,0]
    v_pk_mul_f32 v[60:61], v[36:37], v[24:25] op_sel:[0,0] op_sel_hi:[1,0]
    v_pk_mul_f32 v[8:9], v[38:39], v[24:25] op_sel:[0,0] op_sel_hi:[1,0]
    v_pk_fma_f32 v[48:49], v[48:49], v[28:29], v[56:57] op_sel:[1,1,0] op_sel_hi:[0,1,1] neg_lo:[1,0,0]
    v_pk_fma_f32 v[50:51], v[50:51], v[28:29], v[58:59] op_sel:[1,1,0] op_sel_hi:[0,1,1] neg_lo:[1,0,0]
    v_pk_fma_f32 v[52:53], v[36:37], v[24:25], v[60:61] op_sel:[1,1,0] op_sel_hi:[0,1,1] neg_lo:[1,0,0]
    v_pk_fma_f32 v[54:55], v[38:39], v[24:25], v[8:9] op_sel:[1,1,0] op_sel_hi:[0,1,1] neg_lo:[1,0,0]
    v_cvt_pk_bf16_f32 v146, v48, v49
    v_cvt_pk_bf16_f32 v147, v50, v51
    v_cvt_pk_bf16_f32 v167, v52, -v53
    v_cvt_pk_bf16_f32 v170, v54, -v55
    v_pk_mul_f32 v[56:57], v[48:49], v[28:29] op_sel:[0,0] op_sel_hi:[1,0]
    v_pk_mul_f32 v[58:59], v[50:51], v[28:29] op_sel:[0,0] op_sel_hi:[1,0]
    v_pk_mul_f32 v[60:61], v[52:53], v[24:25] op_sel:[0,0] op_sel_hi:[1,0]
    v_pk_mul_f32 v[8:9], v[54:55], v[24:25] op_sel:[0,0] op_sel_hi:[1,0]
    v_pk_fma_f32 v[48:49], v[48:49], v[28:29], v[56:57] op_sel:[1,1,0] op_sel_hi:[0,1,1] neg_lo:[1,0,0]
    v_pk_fma_f32 v[50:51], v[50:51], v[28:29], v[58:59] op_sel:[1,1,0] op_sel_hi:[0,1,1] neg_lo:[1,0,0]
    v_pk_fma_f32 v[52:53], v[52:53], v[24:25], v[60:61] op_sel:[1,1,0] op_sel_hi:[0,1,1] neg_lo:[1,0,0]
    v_pk_fma_f32 v[54:55], v[54:55], v[24:25], v[8:9] op_sel:[1,1,0] op_sel_hi:[0,1,1] neg_lo:[1,0,0]
    v_cvt_pk_bf16_f32 v148, v48, v49
    v_cvt_pk_bf16_f32 v149, v50, v51
    v_cvt_pk_bf16_f32 v168, v52, -v53
    v_cvt_pk_bf16_f32 v171, v54, -v55
    v_pk_mul_f32 v[56:57], v[48:49], v[28:29] op_sel:[0,0] op_sel_hi:[1,0]
    v_pk_mul_f32 v[58:59], v[50:51], v[28:29] op_sel:[0,0] op_sel_hi:[1,0]
    v_pk_fma_f32 v[48:49], v[48:49], v[28:29], v[56:57] op_sel:[1,1,0] op_sel_hi:[0,1,1] neg_lo:[1,0,0]
    v_pk_fma_f32 v[50:51], v[50:51], v[28:29], v[58:59] op_sel:[1,1,0] op_sel_hi:[0,1,1] neg_lo:[1,0,0]
    v_cvt_pk_bf16_f32 v150, v48, v49
    v_cvt_pk_bf16_f32 v151, v50, v51
    v_pk_mul_f32 v[56:57], v[48:49], v[28:29] op_sel:[0,0] op_sel_hi:[1,0]
    v_pk_fma_f32 v[48:49], v[48:49], v[28:29], v[56:57] op_sel:[1,1,0] op_sel_hi:[0,1,1] neg_lo:[1,0,0]
    v_cvt_pk_bf16_f32 v152, v48, v49
    v_mov_b32 v63, 0x3f80
    v_mov_b32 v2, 0
    v_mov_b32 v3, 0
    v_mov_b32 v4, 1
    v_writelane_b32 v3, s81, 0
    s_waitcnt vmcnt(0)
    s_setprio 1
    s_mov_b32 s7, 0x40000
LP_43:
    s_sleep 1
    ds_read_b32 v5, v186 offset:0
    s_sub_u32 s7, s7, 1
    s_waitcnt lgkmcnt(0)
    v_cmp_gt_u32 vcc, 1, v5
    s_cbranch_scc1 LPD_44
    s_cbranch_vccnz LP_43
LPD_44:
    v_mov_b32 v248, 163596
    ds_read_b32 v248, v248
    ds_write_addtid_b32 v63 offset:0
    ds_write_addtid_b32 v64 offset:272
    ds_write_addtid_b32 v65 offset:544
    ds_write_addtid_b32 v66 offset:816
    ds_write_addtid_b32 v67 offset:1088
    ds_write_addtid_b32 v68 offset:1360
    ds_write_addtid_b32 v69 offset:1632
    ds_write_addtid_b32 v70 offset:1904
    ds_write_addtid_b32 v71 offset:2176
    ds_write_addtid_b32 v72 offset:2448
    ds_write_addtid_b32 v73 offset:2720
    ds_write_addtid_b32 v74 offset:2992
    ds_write_addtid_b32 v75 offset:3264
    ds_write_addtid_b32 v76 offset:3536
    ds_write_addtid_b32 v77 offset:3808
    ds_write_addtid_b32 v78 offset:4080
    ds_write_addtid_b32 v79 offset:4352
    ds_write_addtid_b32 v80 offset:4624
    ds_write_addtid_b32 v81 offset:4896
    ds_write_addtid_b32 v82 offset:5168
    ds_write_addtid_b32 v83 offset:5440
    ds_write_addtid_b32 v84 offset:5712
    ds_write_addtid_b32 v85 offset:5984
    ds_write_addtid_b32 v86 offset:6256
    ds_write_addtid_b32 v87 offset:6528
    ds_write_addtid_b32 v88 offset:6800
    ds_write_addtid_b32 v89 offset:7072
    ds_write_addtid_b32 v90 offset:7344
    ds_write_addtid_b32 v91 offset:7616
    ds_write_addtid_b32 v92 offset:7888
    ds_write_addtid_b32 v93 offset:8160
    ds_write_addtid_b32 v94 offset:8432
    ds_write_addtid_b32 v95 offset:8704
    ds_write_addtid_b32 v96 offset:8976
    ds_write_addtid_b32 v97 offset:9248
    ds_write_addtid_b32 v98 offset:9520
    ds_write_addtid_b32 v99 offset:9792
    ds_write_addtid_b32 v100 offset:10064
    ds_write_addtid_b32 v101 offset:10336
    ds_write_addtid_b32 v102 offset:10608
    ds_write_addtid_b32 v103 offset:10880
    ds_write_addtid_b32 v104 offset:11152
    ds_write_addtid_b32 v105 offset:11424
    ds_write_addtid_b32 v106 offset:11696
    ds_write_addtid_b32 v107 offset:11968
    ds_write_addtid_b32 v108 offset:12240
    ds_write_addtid_b32 v109 offset:12512
    ds_write_addtid_b32 v110 offset:12784
    ds_write_addtid_b32 v111 offset:13056
    ds_write_addtid_b32 v112 offset:13328
    ds_write_addtid_b32 v113 offset:13600
    ds_write_addtid_b32 v114 offset:13872
    ds_write_addtid_b32 v115 offset:14144
    ds_write_addtid_b32 v116 offset:14416
    ds_write_addtid_b32 v117 offset:14688
    ds_write_addtid_b32 v118 offset:14960
    ds_write_addtid_b32 v119 offset:15232
    ds_write_addtid_b32 v120 offset:15504
    ds_write_addtid_b32 v121 offset:15776
    ds_read_b128 v[16:19], v180 offset:0
    ds_read_b128 v[20:23], v181 offset:0
    ds_read_b128 v[24:27], v180 offset:32
    ds_read_b128 v[28:31], v181 offset:32
    ds_read_b128 v[32:35], v180 offset:64
    ds_read_b128 v[36:39], v181 offset:64
    ds_read_b128 v[40:43], v180 offset:96
    ds_read_b128 v[44:47], v181 offset:96
    ds_read_b128 v[48:51], v180 offset:128
    ds_read_b128 v[52:55], v181 offset:128
    ds_read_b128 v[56:59], v180 offset:160
    ds_read_b128 v[60:63], v181 offset:160
    ds_read_b128 v[64:67], v180 offset:192
    ds_read_b128 v[68:71], v181 offset:192
    ds_read_b128 v[72:75], v180 offset:224
    ds_read_b128 v[76:79], v181 offset:224
    s_waitcnt lgkmcnt(0)
    v_readfirstlane_b32 s36, v248
    v_mfma_f32_32x32x16_bf16 v[208:223], v[20:23], v[16:19], 0
    ds_write_addtid_b32 v122 offset:272
    ds_write_addtid_b32 v123 offset:544
    ds_write_addtid_b32 v124 offset:816
    ds_write_addtid_b32 v125 offset:1088
    ds_write_addtid_b32 v126 offset:1360
    ds_write_addtid_b32 v127 offset:1632
    ds_write_addtid_b32 v128 offset:1904
    ds_write_addtid_b32 v129 offset:2176
    v_mfma_f32_32x32x16_bf16 v[208:223], v[28:31], v[24:27], v[208:223]
    ds_write_addtid_b32 v130 offset:2448
    ds_write_addtid_b32 v131 offset:2720
    ds_write_addtid_b32 v132 offset:2992
    ds_write_addtid_b32 v133 offset:3264
    ds_write_addtid_b32 v134 offset:3536
    ds_write_addtid_b32 v135 offset:3808
    ds_write_addtid_b32 v136 offset:4080
    v_mfma_f32_32x32x16_bf16 v[208:223], v[36:39], v[32:35], v[208:223]
    ds_write_addtid_b32 v137 offset:4352
    ds_write_addtid_b32 v138 offset:4624
    ds_write_addtid_b32 v139 offset:4896
    ds_write_addtid_b32 v140 offset:5168
    ds_write_addtid_b32 v141 offset:5440
    ds_write_addtid_b32 v142 offset:5712
    ds_write_addtid_b32 v143 offset:5984
    v_mfma_f32_32x32x16_bf16 v[208:223], v[44:47], v[40:43], v[208:223]
    ds_write_addtid_b32 v144 offset:6256
    ds_write_addtid_b32 v145 offset:6528
    ds_write_addtid_b32 v146 offset:6800
    ds_write_addtid_b32 v147 offset:7072
    ds_write_addtid_b32 v148 offset:7344
    ds_write_addtid_b32 v149 offset:7616
    ds_write_addtid_b32 v150 offset:7888
    v_mfma_f32_32x32x16_bf16 v[208:223], v[52:55], v[48:51], v[208:223]
    ds_write_addtid_b32 v151 offset:8160
    ds_write_addtid_b32 v152 offset:8432
    ds_write_addtid_b32 v153 offset:8704
    ds_write_addtid_b32 v154 offset:8976
    ds_write_addtid_b32 v155 offset:9248
    ds_write_addtid_b32 v156 offset:9520
    ds_write_addtid_b32 v157 offset:9792
    ds_write_addtid_b32 v158 offset:10064
    v_mfma_f32_32x32x16_bf16 v[208:223], v[60:63], v[56:59], v[208:223]
    ds_write_addtid_b32 v159 offset:10336
    ds_write_addtid_b32 v160 offset:10608
    ds_write_addtid_b32 v161 offset:10880
    ds_write_addtid_b32 v162 offset:11152
    ds_write_addtid_b32 v163 offset:11424
    ds_write_addtid_b32 v164 offset:11696
    ds_write_addtid_b32 v165 offset:11968
    v_mfma_f32_32x32x16_bf16 v[208:223], v[68:71], v[64:67], v[208:223]
    ds_write_addtid_b32 v166 offset:12240
    ds_write_addtid_b32 v167 offset:12512
    ds_write_addtid_b32 v168 offset:12784
    ds_write_addtid_b32 v169 offset:13056
    ds_write_addtid_b32 v170 offset:13328
    ds_write_addtid_b32 v171 offset:13600
    ds_write_addtid_b32 v172 offset:13872
    v_mfma_f32_32x32x16_bf16 v[208:223], v[76:79], v[72:75], v[208:223]
    ds_write_addtid_b32 v173 offset:14144
    ds_write_addtid_b32 v174 offset:14416
    ds_write_addtid_b32 v175 offset:14688
    ds_write_addtid_b32 v176 offset:14960
    ds_write_addtid_b32 v177 offset:15232
    ds_write_addtid_b32 v178 offset:15504
    ds_write_addtid_b32 v179 offset:15776
    ds_read_b128 v[16:19], v180 offset:0
    ds_read_b128 v[20:23], v181 offset:0
    ds_read_b128 v[24:27], v180 offset:32
    ds_read_b128 v[28:31], v181 offset:32
    ds_read_b128 v[32:35], v180 offset:64
    ds_read_b128 v[36:39], v181 offset:64
    ds_read_b128 v[40:43], v180 offset:96
    ds_read_b128 v[44:47], v181 offset:96
    ds_read_b128 v[48:51], v180 offset:128
    ds_read_b128 v[52:55], v181 offset:128
    ds_read_b128 v[56:59], v180 offset:160
    ds_read_b128 v[60:63], v181 offset:160
    ds_read_b128 v[64:67], v180 offset:192
    ds_read_b128 v[68:71], v181 offset:192
    ds_read_b128 v[72:75], v180 offset:224
    ds_read_b128 v[76:79], v181 offset:224
    s_mov_b32 s86, 0xaaaaaaaa
    s_mov_b32 s87, 0xaaaaaaaa
    s_waitcnt lgkmcnt(15)
    s_lshl_b32 s7, s3, 11
    s_add_u32 s6, s7, 78080
    s_add_u32 s34, s38, s6
    s_addc_u32 s35, s39, 0
    global_load_dwordx4 v[116:119], v1, s[34:35] offset:0
    global_load_dwordx4 v[120:123], v1, s[34:35] offset:1024
    s_and_b32 s7, s2, 1
    s_lshl_b32 s7, s7, 2
    s_add_u32 s7, s7, s3
    s_lshl_b32 s7, s7, 10
    s_add_u32 s6, s7, 108800
    s_add_u32 s34, s38, s6
    s_addc_u32 s35, s39, 0
    global_load_dwordx4 v[244:247], v1, s[34:35] offset:0
    s_waitcnt lgkmcnt(14)
    v_mfma_f32_32x32x16_bf16 v[208:223], v[20:23], v[16:19], v[208:223]
    s_waitcnt lgkmcnt(12)
    v_mfma_f32_32x32x16_bf16 v[208:223], v[28:31], v[24:27], v[208:223]
    s_waitcnt lgkmcnt(10)
    v_mfma_f32_32x32x16_bf16 v[208:223], v[36:39], v[32:35], v[208:223]
    s_waitcnt lgkmcnt(8)
    v_mfma_f32_32x32x16_bf16 v[208:223], v[44:47], v[40:43], v[208:223]
    s_waitcnt lgkmcnt(6)
    v_mfma_f32_32x32x16_bf16 v[208:223], v[52:55], v[48:51], v[208:223]
    s_waitcnt lgkmcnt(4)
    v_mfma_f32_32x32x16_bf16 v[208:223], v[60:63], v[56:59], v[208:223]
    s_waitcnt lgkmcnt(2)
    v_mfma_f32_32x32x16_bf16 v[208:223], v[68:71], v[64:67], v[208:223]
    s_waitcnt lgkmcnt(0)
    v_mfma_f32_32x32x16_bf16 v[208:223], v[76:79], v[72:75], v[208:223]
    ds_write_b32 v185, v2
    v_add_u32 v96, 3072, v184
    v_add_u32 v97, 2048, v184
    v_add_u32 v98, 1024, v184
    s_nop 7
    v_add_f32 v215, v215, v3
    v_cndmask_b32 v100, v220, v221, s[86:87]
    v_cndmask_b32 v101, v222, v223, s[86:87]
    v_cvt_pk_bf16_f32 v80, v208, v209
    v_cvt_pk_bf16_f32 v81, v210, v211
    v_cvt_pk_bf16_f32 v82, v212, v213
    v_cvt_pk_bf16_f32 v83, v214, v215
    ds_write_b128 v183, v[80:83] offset:3072
    ds_write2_b32 v96, v80, v81 offset0:0 offset1:1
    ds_write2_b32 v96, v82, v83 offset0:2 offset1:3
    v_cvt_pk_bf16_f32 v84, v218, v218
    v_cvt_pk_bf16_f32 v85, v217, v217
    v_cvt_pk_bf16_f32 v86, v217, v216
    v_cvt_pk_bf16_f32 v87, v216, v216
    ds_write_b128 v183, v[84:87] offset:2048
    ds_write2_b32 v97, v84, v85 offset0:0 offset1:1
    ds_write2_b32 v97, v86, v87 offset0:2 offset1:3
    v_cvt_pk_bf16_f32 v88, v221, v221
    v_cvt_pk_bf16_f32 v89, v221, v100
    v_cvt_pk_bf16_f32 v90, v220, v220
    v_cvt_pk_bf16_f32 v91, v220, v220
    ds_write_b128 v183, v[88:91] offset:1024
    ds_write2_b32 v98, v88, v89 offset0:0 offset1:1
    ds_write2_b32 v98, v90, v91 offset0:2 offset1:3
    v_cvt_pk_bf16_f32 v92, v223, v223
    v_cvt_pk_bf16_f32 v93, v223, v101
    v_cvt_pk_bf16_f32 v94, v222, v222
    v_cvt_pk_bf16_f32 v95, v222, v222
    ds_write_b128 v183, v[92:95] offset:0
    ds_write2_b32 v184, v92, v93 offset0:0 offset1:1
    ds_write2_b32 v184, v94, v95 offset0:2 offset1:3
    ds_write_b32 v187, v4
    s_waitcnt vmcnt(0)
PRO1:
    s_setprio 1
    s_lshl_b32 s69, s3, 2
    s_add_u32 s69, s69, 163520
    s_mov_b32 s86, 0
    s_mov_b32 s87, -1
    s_lshl_b32 s78, s37, 1
    s_add_u32 s78, s78, s3
    s_add_u32 s78, s78, 12
    s_mul_i32 s78, s78, 40960
    s_sub_u32 s6, s78, 819200
    s_cmp_lt_u32 s78, 819200
    s_cselect_b32 s78, s78, s6
    v_add_u32 v2, 60672, v1
    v_add_u32 v3, 60672, v116
    v_add_u32 v4, 8448, v1
    v_add_u32 v5, 8448, v116
    v_add_u32 v6, 142080, v1
    v_add_u32 v7, 142080, v116
    s_mov_b32 s7, 0x40000
LP_45:
    ds_read_b32 v10, v122 offset:0
    s_sub_u32 s7, s7, 1
    s_waitcnt lgkmcnt(0)
    v_cmp_gt_u32 vcc, 1, v10
    s_cbranch_scc1 LPD_46
    s_cbranch_vccnz LP_45
LPD_46:
    ds_read_b128 v[68:71], v2
    ds_read_b128 v[76:79], v2 offset:2048
    ds_read2_b64 v[56:59], v118 offset0:0 offset1:1
    ds_read_b32 v65, v119 offset:36
    ds_read_b32 v64, v123 offset:0
    ds_read2_b64 v[60:63], v118 offset0:160 offset1:161
    ds_read_b32 v67, v119 offset:1316
    ds_read_b32 v66, v123 offset:256
    ds_read_b128 v[84:87], v3 offset:3072
    ds_read_b128 v[88:91], v3 offset:3744
    s_waitcnt lgkmcnt(5)
    v_mfma_f32_32x32x16_bf16 v[16:31], v[68:71], v[56:59], 0
    v_mfma_f32_32x32x8_bf16 v[16:31], v[76:77], v[64:65], v[16:31]
    s_waitcnt lgkmcnt(0)
    s_add_u32 m0, s94, 8448
    s_add_u32 s70, s93, 12288
    buffer_load_dwordx4 v1, s[20:23], s70 offen sc1 lds
    buffer_load_dwordx4 v1, s[20:23], s70 offen offset:1024 sc1 lds
    buffer_load_dwordx4 v1, s[20:23], s70 offen offset:2048 sc1 lds
    s_sub_u32 m0, s69, 0
    s_mov_b64 exec, 1
    global_load_lds_dword v1, s[38:39] offset:0
    s_mov_b64 exec, -1
    s_nop 1
    s_branch A_ENTRY1
.p2align 6
A_ENTRY0:
    s_mov_b32 s33, 0x40000
    s_waitcnt lgkmcnt(0)
    v_mfma_f32_32x32x16_bf16 v[32:47], v[68:71], v[60:63], 0
    v_exp_f32 v16, v16
    v_exp_f32 v17, v17
    v_exp_f32 v18, v18
    v_exp_f32 v19, v19
    v_exp_f32 v20, v20
    s_add_u32 s6, s76, 33792
    buffer_store_dwordx4 v[124:127], v114, s[20:23], s76 offen sc1
    buffer_store_dwordx4 v[128:131], v114, s[20:23], s6 offen sc1
    v_exp_f32 v21, v21
    v_exp_f32 v22, v22
    v_exp_f32 v23, v23
    v_cvt_pk_bf16_f32 v48, v16, v17
    v_cvt_pk_bf16_f32 v49, v18, v19
    v_cvt_pk_bf16_f32 v50, v20, v21
    v_cvt_pk_bf16_f32 v51, v22, v23
    ds_read_b128 v[72:75], v2 offset:1024
    v_mfma_f32_32x32x8_bf16 v[32:47], v[76:77], v[66:67], v[32:47]
    v_exp_f32 v24, v24
    v_exp_f32 v25, v25
    v_exp_f32 v26, v26
    v_exp_f32 v27, v27
    v_exp_f32 v28, v28
    s_cmp_eq_u32 s3, 3
    s_cbranch_scc1 A_U2
A_U2R:
    s_cmp_eq_u32 s4, 0
    s_cbranch_scc1 A_U3
A_U3R:
    v_mfma_f32_32x32x16_bf16 v[192:207], v[84:87], v[48:51], 0
    v_exp_f32 v29, v29
    v_exp_f32 v30, v30
    v_exp_f32 v31, v31
    v_cvt_pk_bf16_f32 v52, v24, v25
    v_cvt_pk_bf16_f32 v53, v26, v27
    v_cvt_pk_bf16_f32 v54, v28, v29
    v_cvt_pk_bf16_f32 v55, v30, v31
    s_waitcnt lgkmcnt(0)
    v_mfma_f32_32x32x16_bf16 v[16:31], v[72:75], v[56:59], 0
    v_exp_f32 v32, v32
    v_exp_f32 v33, v33
    v_exp_f32 v34, v34
    v_exp_f32 v35, v35
    v_exp_f32 v36, v36
    v_mfma_f32_32x32x16_bf16 v[192:207], v[88:91], v[52:55], v[192:207]
    v_exp_f32 v37, v37
    v_exp_f32 v38, v38
    v_exp_f32 v39, v39
    v_cvt_pk_bf16_f32 v48, v32, v33
    v_cvt_pk_bf16_f32 v49, v34, v35
    v_cvt_pk_bf16_f32 v50, v36, v37
    v_cvt_pk_bf16_f32 v51, v38, v39
    ds_read_b128 v[92:95], v3 offset:4416
    ds_read_b128 v[96:99], v3 offset:5088
    v_mfma_f32_32x32x8_bf16 v[16:31], v[78:79], v[64:65], v[16:31]
    v_exp_f32 v40, v40
    v_exp_f32 v41, v41
    v_exp_f32 v42, v42
    v_exp_f32 v43, v43
    v_exp_f32 v44, v44
    v_mfma_f32_32x32x16_bf16 v[208:223], v[84:87], v[48:51], 0
    v_exp_f32 v45, v45
    v_exp_f32 v46, v46
    v_exp_f32 v47, v47
    v_cvt_pk_bf16_f32 v52, v40, v41
    v_cvt_pk_bf16_f32 v53, v42, v43
    v_cvt_pk_bf16_f32 v54, v44, v45
    v_cvt_pk_bf16_f32 v55, v46, v47
    s_waitcnt lgkmcnt(0)
    v_mfma_f32_32x32x16_bf16 v[32:47], v[72:75], v[60:63], 0
    v_exp_f32 v16, v16
    v_exp_f32 v17, v17
    v_exp_f32 v18, v18
    v_exp_f32 v19, v19
    v_exp_f32 v20, v20
    s_and_b32 s73, s2, 0xf8
    s_add_u32 s73, s73, s3
    s_mul_i32 s73, s73, 3200
    v_min_u32 v8, 24, v0
    v_lshlrev_b32 v8, 7, v8
    buffer_load_dword v9, v8, s[24:27], s73 offen
    v_mfma_f32_32x32x16_bf16 v[208:223], v[88:91], v[52:55], v[208:223]
    v_exp_f32 v21, v21
    v_exp_f32 v22, v22
    v_exp_f32 v23, v23
    v_cvt_pk_bf16_f32 v48, v16, v17
    v_cvt_pk_bf16_f32 v49, v18, v19
    v_cvt_pk_bf16_f32 v50, v20, v21
    v_cvt_pk_bf16_f32 v51, v22, v23
    ds_read_b128 v[68:71], v2 offset:6144
    ds_read_b128 v[80:83], v2 offset:8192
    v_mfma_f32_32x32x8_bf16 v[32:47], v[78:79], v[66:67], v[32:47]
    v_exp_f32 v24, v24
    v_exp_f32 v25, v25
    v_exp_f32 v26, v26
    v_exp_f32 v27, v27
    v_exp_f32 v28, v28
    v_mfma_f32_32x32x16_bf16 v[192:207], v[92:95], v[48:51], v[192:207]
    v_exp_f32 v29, v29
    v_exp_f32 v30, v30
    v_exp_f32 v31, v31
    v_cvt_pk_bf16_f32 v52, v24, v25
    v_cvt_pk_bf16_f32 v53, v26, v27
    v_cvt_pk_bf16_f32 v54, v28, v29
    v_cvt_pk_bf16_f32 v55, v30, v31
    s_waitcnt lgkmcnt(0)
    v_mfma_f32_32x32x16_bf16 v[16:31], v[68:71], v[56:59], 0
    v_exp_f32 v32, v32
    v_exp_f32 v33, v33
    v_exp_f32 v34, v34
    v_exp_f32 v35, v35
    v_exp_f32 v36, v36
    s_lshl_b32 s72, s4, 8
    s_add_u32 s72, s72, 9379840
    buffer_load_dword v12, v121, s[20:23], s72 offen sc1
    v_mfma_f32_32x32x16_bf16 v[192:207], v[96:99], v[52:55], v[192:207]
    v_exp_f32 v37, v37
    v_exp_f32 v38, v38
    v_exp_f32 v39, v39
    v_cvt_pk_bf16_f32 v48, v32, v33
    v_cvt_pk_bf16_f32 v49, v34, v35
    v_cvt_pk_bf16_f32 v50, v36, v37
    v_cvt_pk_bf16_f32 v51, v38, v39
    ds_read_b128 v[84:87], v3 offset:9216
    ds_read_b128 v[88:91], v3 offset:9888
    v_mfma_f32_32x32x8_bf16 v[16:31], v[80:81], v[64:65], v[16:31]
    v_exp_f32 v40, v40
    v_exp_f32 v41, v41
    v_exp_f32 v42, v42
    v_exp_f32 v43, v43
    v_exp_f32 v44, v44
    v_mfma_f32_32x32x16_bf16 v[208:223], v[92:95], v[48:51], v[208:223]
    v_exp_f32 v45, v45
    v_exp_f32 v46, v46
    v_exp_f32 v47, v47
    v_cvt_pk_bf16_f32 v52, v40, v41
    v_cvt_pk_bf16_f32 v53, v42, v43
    v_cvt_pk_bf16_f32 v54, v44, v45
    v_cvt_pk_bf16_f32 v55, v46, v47
    s_waitcnt lgkmcnt(0)
    v_mfma_f32_32x32x16_bf16 v[32:47], v[68:71], v[60:63], 0
    v_exp_f32 v16, v16
    v_exp_f32 v17, v17
    v_exp_f32 v18, v18
    v_exp_f32 v19, v19
    v_exp_f32 v20, v20
    v_mfma_f32_32x32x16_bf16 v[208:223], v[96:99], v[52:55], v[208:223]
    v_exp_f32 v21, v21
    v_exp_f32 v22, v22
    v_exp_f32 v23, v23
    v_cvt_pk_bf16_f32 v48, v16, v17
    v_cvt_pk_bf16_f32 v49, v18, v19
    v_cvt_pk_bf16_f32 v50, v20, v21
    v_cvt_pk_bf16_f32 v51, v22, v23
    ds_read_b128 v[72:75], v2 offset:7168
    v_mfma_f32_32x32x8_bf16 v[32:47], v[80:81], v[66:67], v[32:47]
    v_exp_f32 v24, v24
    v_exp_f32 v25, v25
    v_exp_f32 v26, v26
    v_exp_f32 v27, v27
    v_exp_f32 v28, v28
    v_mfma_f32_32x32x16_bf16 v[192:207], v[84:87], v[48:51], v[192:207]
    v_exp_f32 v29, v29
    v_exp_f32 v30, v30
    v_exp_f32 v31, v31
    v_cvt_pk_bf16_f32 v52, v24, v25
    v_cvt_pk_bf16_f32 v53, v26, v27
    v_cvt_pk_bf16_f32 v54, v28, v29
    v_cvt_pk_bf16_f32 v55, v30, v31
    s_waitcnt lgkmcnt(0)
    v_mfma_f32_32x32x16_bf16 v[16:31], v[72:75], v[56:59], 0
    v_exp_f32 v32, v32
    v_exp_f32 v33, v33
    v_exp_f32 v34, v34
    v_exp_f32 v35, v35
    v_exp_f32 v36, v36
    s_waitcnt vmcnt(2)
    v_mov_b32 v104, 163480
    v_mov_b32 v105, 1
    s_mov_b64 exec, 1
    ds_add_rtn_u32 v106, v104, v105
    v_mov_b32 v104, 9461760
    v_mov_b32 v105, s36
    s_waitcnt lgkmcnt(0)
    v_cmp_eq_u32 vcc, 3, v106
    s_nop 0
    s_cbranch_vccz PUB_47
    buffer_store_dword v105, v104, s[20:23], s89 offen sc1
PUB_47:
    s_mov_b64 exec, -1
    v_mfma_f32_32x32x16_bf16 v[192:207], v[88:91], v[52:55], v[192:207]
    v_exp_f32 v37, v37
    v_exp_f32 v38, v38
    v_exp_f32 v39, v39
    v_cvt_pk_bf16_f32 v48, v32, v33
    v_cvt_pk_bf16_f32 v49, v34, v35
    v_cvt_pk_bf16_f32 v50, v36, v37
    v_cvt_pk_bf16_f32 v51, v38, v39
    ds_read_b128 v[92:95], v3 offset:10560
    ds_read_b128 v[96:99], v3 offset:11232
    ds_read_b32 v10, v117
    v_mfma_f32_32x32x8_bf16 v[16:31], v[82:83], v[64:65], v[16:31]
    v_exp_f32 v40, v40
    v_exp_f32 v41, v41
    v_exp_f32 v42, v42
    v_exp_f32 v43, v43
    v_exp_f32 v44, v44
    v_mfma_f32_32x32x16_bf16 v[208:223], v[84:87], v[48:51], v[208:223]
    v_exp_f32 v45, v45
    v_exp_f32 v46, v46
    v_exp_f32 v47, v47
    v_cvt_pk_bf16_f32 v52, v40, v41
    v_cvt_pk_bf16_f32 v53, v42, v43
    v_cvt_pk_bf16_f32 v54, v44, v45
    v_cvt_pk_bf16_f32 v55, v46, v47
    s_waitcnt lgkmcnt(0)
A_T0_1:
    v_cmp_gt_u32 vcc, 1, v10
    v_cmp_ge_u32 s[74:75], 1, v10
    s_setprio 2
    s_cmp_lg_u32 vcc_lo, 0
    s_cbranch_scc1 A_T0_1S
A_T0_1R:
    s_cmp_eq_u32 s75, 0
    s_cbranch_scc1 A_T0_1H
    s_setprio 0
A_T0_1H:
    v_mfma_f32_32x32x16_bf16 v[32:47], v[72:75], v[60:63], 0
    v_exp_f32 v16, v16
    v_exp_f32 v17, v17
    v_exp_f32 v18, v18
    v_exp_f32 v19, v19
    v_exp_f32 v20, v20
    s_add_u32 m0, s94, 129792
    s_add_u32 s70, s93, 24576
    buffer_load_dwordx4 v1, s[20:23], s70 offen sc1 lds
    buffer_load_dwordx4 v1, s[20:23], s70 offen offset:1024 sc1 lds
    v_mfma_f32_32x32x16_bf16 v[208:223], v[88:91], v[52:55], v[208:223]
    v_exp_f32 v21, v21
    v_exp_f32 v22, v22
    v_exp_f32 v23, v23
    v_cvt_pk_bf16_f32 v48, v16, v17
    v_cvt_pk_bf16_f32 v49, v18, v19
    v_cvt_pk_bf16_f32 v50, v20, v21
    v_cvt_pk_bf16_f32 v51, v22, v23
    ds_read_b128 v[68:71], v4 offset:0
    ds_read_b128 v[76:79], v4 offset:2048
    v_mfma_f32_32x32x8_bf16 v[32:47], v[82:83], v[66:67], v[32:47]
    v_exp_f32 v24, v24
    v_exp_f32 v25, v25
    v_exp_f32 v26, v26
    v_exp_f32 v27, v27
    v_exp_f32 v28, v28
    buffer_load_dwordx4 v1, s[20:23], s70 offen offset:2048 sc1 lds
    s_sub_u32 m0, s69, 4
    s_mov_b64 exec, 1
    global_load_lds_dword v1, s[38:39] offset:4
    s_mov_b64 exec, -1
    v_mfma_f32_32x32x16_bf16 v[192:207], v[92:95], v[48:51], v[192:207]
    v_exp_f32 v29, v29
    v_exp_f32 v30, v30
    v_exp_f32 v31, v31
    v_cvt_pk_bf16_f32 v52, v24, v25
    v_cvt_pk_bf16_f32 v53, v26, v27
    v_cvt_pk_bf16_f32 v54, v28, v29
    v_cvt_pk_bf16_f32 v55, v30, v31
    s_waitcnt lgkmcnt(0)
    v_mfma_f32_32x32x16_bf16 v[16:31], v[68:71], v[56:59], 0
    v_exp_f32 v32, v32
    v_exp_f32 v33, v33
    v_exp_f32 v34, v34
    v_exp_f32 v35, v35
    v_exp_f32 v36, v36
    s_mov_b32 s6, 110848
    s_add_u32 s34, s38, s6
    s_addc_u32 s35, s39, 0
    global_load_dwordx4 v[132:135], v1, s[34:35] offset:0
    global_load_dwordx4 v[136:139], v1, s[34:35] offset:1024
    v_mfma_f32_32x32x16_bf16 v[192:207], v[96:99], v[52:55], v[192:207]
    v_exp_f32 v37, v37
    v_exp_f32 v38, v38
    v_exp_f32 v39, v39
    v_cvt_pk_bf16_f32 v48, v32, v33
    v_cvt_pk_bf16_f32 v49, v34, v35
    v_cvt_pk_bf16_f32 v50, v36, v37
    v_cvt_pk_bf16_f32 v51, v38, v39
    ds_read_b128 v[84:87], v5 offset:3072
    ds_read_b128 v[88:91], v5 offset:3744
    v_mfma_f32_32x32x8_bf16 v[16:31], v[76:77], v[64:65], v[16:31]
    v_exp_f32 v40, v40
    v_exp_f32 v41, v41
    v_exp_f32 v42, v42
    v_exp_f32 v43, v43
    v_exp_f32 v44, v44
    s_lshl_b32 s7, s3, 11
    s_add_u32 s6, s7, 94464
    s_add_u32 s34, s38, s6
    s_addc_u32 s35, s39, 0
    global_load_dwordx4 v[124:127], v1, s[34:35] offset:0
    global_load_dwordx4 v[128:131], v1, s[34:35] offset:1024
    v_mfma_f32_32x32x16_bf16 v[208:223], v[92:95], v[48:51], v[208:223]
    v_exp_f32 v45, v45
    v_exp_f32 v46, v46
    v_exp_f32 v47, v47
    v_cvt_pk_bf16_f32 v52, v40, v41
    v_cvt_pk_bf16_f32 v53, v42, v43
    v_cvt_pk_bf16_f32 v54, v44, v45
    v_cvt_pk_bf16_f32 v55, v46, v47
    s_waitcnt lgkmcnt(0)
    v_mfma_f32_32x32x16_bf16 v[32:47], v[68:71], v[60:63], 0
    v_exp_f32 v16, v16
    v_exp_f32 v17, v17
    v_exp_f32 v18, v18
    v_exp_f32 v19, v19
    v_exp_f32 v20, v20
    s_mul_i32 s7, s3, 3072
    s_add_u32 s6, s7, 121088
    s_add_u32 s34, s38, s6
    s_addc_u32 s35, s39, 0
    global_load_dwordx4 v[224:227], v1, s[34:35] offset:0
    global_load_dwordx4 v[228:231], v1, s[34:35] offset:1024
    global_load_dwordx4 v[232:235], v1, s[34:35] offset:2048
    v_mfma_f32_32x32x16_bf16 v[208:223], v[96:99], v[52:55], v[208:223]
    v_exp_f32 v21, v21
    v_exp_f32 v22, v22
    v_exp_f32 v23, v23
    v_cvt_pk_bf16_f32 v48, v16, v17
    v_cvt_pk_bf16_f32 v49, v18, v19
    v_cvt_pk_bf16_f32 v50, v20, v21
    v_cvt_pk_bf16_f32 v51, v22, v23
    ds_read_b128 v[72:75], v4 offset:1024
    v_mfma_f32_32x32x8_bf16 v[32:47], v[76:77], v[66:67], v[32:47]
    v_exp_f32 v24, v24
    v_exp_f32 v25, v25
    v_exp_f32 v26, v26
    v_exp_f32 v27, v27
    v_exp_f32 v28, v28
    v_mfma_f32_32x32x16_bf16 v[192:207], v[84:87], v[48:51], v[192:207]
    v_exp_f32 v29, v29
    v_exp_f32 v30, v30
    v_exp_f32 v31, v31
    v_cvt_pk_bf16_f32 v52, v24, v25
    v_cvt_pk_bf16_f32 v53, v26, v27
    v_cvt_pk_bf16_f32 v54, v28, v29
    v_cvt_pk_bf16_f32 v55, v30, v31
    s_waitcnt lgkmcnt(0)
    v_mfma_f32_32x32x16_bf16 v[16:31], v[72:75], v[56:59], 0
    v_exp_f32 v32, v32
    v_exp_f32 v33, v33
    v_exp_f32 v34, v34
    v_exp_f32 v35, v35
    v_exp_f32 v36, v36
    s_lshl_b32 s6, s4, 8
    s_lshl_b32 s7, s3, 6
    s_add_u32 s6, s6, s7
    s_add_u32 s6, s6, 9371648
    v_and_b32 v236, 15, v0
    v_lshlrev_b32 v236, 2, v236
    buffer_load_dword v236, v236, s[20:23], s6 offen sc1
    v_mfma_f32_32x32x16_bf16 v[192:207], v[88:91], v[52:55], v[192:207]
    v_exp_f32 v37, v37
    v_exp_f32 v38, v38
    v_exp_f32 v39, v39
    v_cvt_pk_bf16_f32 v48, v32, v33
    v_cvt_pk_bf16_f32 v49, v34, v35
    v_cvt_pk_bf16_f32 v50, v36, v37
    v_cvt_pk_bf16_f32 v51, v38, v39
    ds_read_b128 v[92:95], v5 offset:4416
    ds_read_b128 v[96:99], v5 offset:5088
    v_mfma_f32_32x32x8_bf16 v[16:31], v[78:79], v[64:65], v[16:31]
    v_exp_f32 v40, v40
    v_exp_f32 v41, v41
    v_exp_f32 v42, v42
    v_exp_f32 v43, v43
    v_exp_f32 v44, v44
    v_mfma_f32_32x32x16_bf16 v[208:223], v[84:87], v[48:51], v[208:223]
    v_exp_f32 v45, v45
    v_exp_f32 v46, v46
    v_exp_f32 v47, v47
    v_cvt_pk_bf16_f32 v52, v40, v41
    v_cvt_pk_bf16_f32 v53, v42, v43
    v_cvt_pk_bf16_f32 v54, v44, v45
    v_cvt_pk_bf16_f32 v55, v46, v47
    s_waitcnt lgkmcnt(0)
    v_mfma_f32_32x32x16_bf16 v[32:47], v[72:75], v[60:63], 0
    v_exp_f32 v16, v16
    v_exp_f32 v17, v17
    v_exp_f32 v18, v18
    v_exp_f32 v19, v19
    v_exp_f32 v20, v20
    v_mfma_f32_32x32x16_bf16 v[208:223], v[88:91], v[52:55], v[208:223]
    v_exp_f32 v21, v21
    v_exp_f32 v22, v22
    v_exp_f32 v23, v23
    v_cvt_pk_bf16_f32 v48, v16, v17
    v_cvt_pk_bf16_f32 v49, v18, v19
    v_cvt_pk_bf16_f32 v50, v20, v21
    v_cvt_pk_bf16_f32 v51, v22, v23
    ds_read_b128 v[68:71], v4 offset:6144
    ds_read_b128 v[80:83], v4 offset:8192
    v_mfma_f32_32x32x8_bf16 v[32:47], v[78:79], v[66:67], v[32:47]
    v_exp_f32 v24, v24
    v_exp_f32 v25, v25
    v_exp_f32 v26, v26
    v_exp_f32 v27, v27
    v_exp_f32 v28, v28
    v_mfma_f32_32x32x16_bf16 v[192:207], v[92:95], v[48:51], v[192:207]
    v_exp_f32 v29, v29
    v_exp_f32 v30, v30
    v_exp_f32 v31, v31
    v_cvt_pk_bf16_f32 v52, v24, v25
    v_cvt_pk_bf16_f32 v53, v26, v27
    v_cvt_pk_bf16_f32 v54, v28, v29
    v_cvt_pk_bf16_f32 v55, v30, v31
    s_waitcnt lgkmcnt(0)
    v_mfma_f32_32x32x16_bf16 v[16:31], v[68:71], v[56:59], 0
    v_exp_f32 v32, v32
    v_exp_f32 v33, v33
    v_exp_f32 v34, v34
    v_exp_f32 v35, v35
    v_exp_f32 v36, v36
    v_mfma_f32_32x32x16_bf16 v[192:207], v[96:99], v[52:55], v[192:207]
    v_exp_f32 v37, v37
    v_exp_f32 v38, v38
    v_exp_f32 v39, v39
    v_cvt_pk_bf16_f32 v48, v32, v33
    v_cvt_pk_bf16_f32 v49, v34, v35
    v_cvt_pk_bf16_f32 v50, v36, v37
    v_cvt_pk_bf16_f32 v51, v38, v39
    ds_read_b128 v[84:87], v5 offset:9216
    ds_read_b128 v[88:91], v5 offset:9888
    v_mfma_f32_32x32x8_bf16 v[16:31], v[80:81], v[64:65], v[16:31]
    v_exp_f32 v40, v40
    v_exp_f32 v41, v41
    v_exp_f32 v42, v42
    v_exp_f32 v43, v43
    v_exp_f32 v44, v44
    v_mfma_f32_32x32x16_bf16 v[208:223], v[92:95], v[48:51], v[208:223]
    v_exp_f32 v45, v45
    v_exp_f32 v46, v46
    v_exp_f32 v47, v47
    v_cvt_pk_bf16_f32 v52, v40, v41
    v_cvt_pk_bf16_f32 v53, v42, v43
    v_cvt_pk_bf16_f32 v54, v44, v45
    v_cvt_pk_bf16_f32 v55, v46, v47
    s_waitcnt lgkmcnt(0)
    v_mfma_f32_32x32x16_bf16 v[32:47], v[68:71], v[60:63], 0
    v_exp_f32 v16, v16
    v_exp_f32 v17, v17
    v_exp_f32 v18, v18
    v_exp_f32 v19, v19
    v_exp_f32 v20, v20
    s_waitcnt vmcnt(6)
    buffer_load_dwordx4 v[140:143], v132, s[24:27], s78 offen
    v_mfma_f32_32x32x16_bf16 v[208:223], v[96:99], v[52:55], v[208:223]
    v_exp_f32 v21, v21
    v_exp_f32 v22, v22
    v_exp_f32 v23, v23
    v_cvt_pk_bf16_f32 v48, v16, v17
    v_cvt_pk_bf16_f32 v49, v18, v19
    v_cvt_pk_bf16_f32 v50, v20, v21
    v_cvt_pk_bf16_f32 v51, v22, v23
    ds_read_b128 v[72:75], v4 offset:7168
    v_mfma_f32_32x32x8_bf16 v[32:47], v[80:81], v[66:67], v[32:47]
    v_exp_f32 v24, v24
    v_exp_f32 v25, v25
    v_exp_f32 v26, v26
    v_exp_f32 v27, v27
    v_exp_f32 v28, v28
    v_mfma_f32_32x32x16_bf16 v[192:207], v[84:87], v[48:51], v[192:207]
    v_exp_f32 v29, v29
    v_exp_f32 v30, v30
    v_exp_f32 v31, v31
    v_cvt_pk_bf16_f32 v52, v24, v25
    v_cvt_pk_bf16_f32 v53, v26, v27
    v_cvt_pk_bf16_f32 v54, v28, v29
    v_cvt_pk_bf16_f32 v55, v30, v31
    s_waitcnt lgkmcnt(0)
    v_mfma_f32_32x32x16_bf16 v[16:31], v[72:75], v[56:59], 0
    v_exp_f32 v32, v32
    v_exp_f32 v33, v33
    v_exp_f32 v34, v34
    v_exp_f32 v35, v35
    v_exp_f32 v36, v36
    v_mfma_f32_32x32x16_bf16 v[192:207], v[88:91], v[52:55], v[192:207]
    v_exp_f32 v37, v37
    v_exp_f32 v38, v38
    v_exp_f32 v39, v39
    v_cvt_pk_bf16_f32 v48, v32, v33
    v_cvt_pk_bf16_f32 v49, v34, v35
    v_cvt_pk_bf16_f32 v50, v36, v37
    v_cvt_pk_bf16_f32 v51, v38, v39
    ds_read_b128 v[92:95], v5 offset:10560
    ds_read_b128 v[96:99], v5 offset:11232
    ds_read_b32 v10, v117
    v_mfma_f32_32x32x8_bf16 v[16:31], v[82:83], v[64:65], v[16:31]
    v_exp_f32 v40, v40
    v_exp_f32 v41, v41
    v_exp_f32 v42, v42
    v_exp_f32 v43, v43
    v_exp_f32 v44, v44
    v_mfma_f32_32x32x16_bf16 v[208:223], v[84:87], v[48:51], v[208:223]
    v_exp_f32 v45, v45
    v_exp_f32 v46, v46
    v_exp_f32 v47, v47
    v_cvt_pk_bf16_f32 v52, v40, v41
    v_cvt_pk_bf16_f32 v53, v42, v43
    v_cvt_pk_bf16_f32 v54, v44, v45
    v_cvt_pk_bf16_f32 v55, v46, v47
    s_waitcnt lgkmcnt(0)
A_T0_2:
    v_cmp_gt_u32 vcc, 2, v10
    v_cmp_ge_u32 s[74:75], 2, v10
    s_setprio 2
    s_cmp_lg_u32 vcc_lo, 0
    s_cbranch_scc1 A_T0_2S
A_T0_2R:
    s_cmp_eq_u32 s75, 0
    s_cbranch_scc1 A_T0_2H
    s_setprio 0
A_T0_2H:
    v_mfma_f32_32x32x16_bf16 v[32:47], v[72:75], v[60:63], 0
    v_exp_f32 v16, v16
    v_exp_f32 v17, v17
    v_exp_f32 v18, v18
    v_exp_f32 v19, v19
    v_exp_f32 v20, v20
    s_add_u32 m0, s94, 48384
    s_add_u32 s70, s93, 36864
    buffer_load_dwordx4 v1, s[20:23], s70 offen sc1 lds
    buffer_load_dwordx4 v1, s[20:23], s70 offen offset:1024 sc1 lds
    v_mfma_f32_32x32x16_bf16 v[208:223], v[88:91], v[52:55], v[208:223]
    v_exp_f32 v21, v21
    v_exp_f32 v22, v22
    v_exp_f32 v23, v23
    v_cvt_pk_bf16_f32 v48, v16, v17
    v_cvt_pk_bf16_f32 v49, v18, v19
    v_cvt_pk_bf16_f32 v50, v20, v21
    v_cvt_pk_bf16_f32 v51, v22, v23
    ds_read_b128 v[68:71], v6 offset:0
    ds_read_b128 v[76:79], v6 offset:2048
    v_mfma_f32_32x32x8_bf16 v[32:47], v[82:83], v[66:67], v[32:47]
    v_exp_f32 v24, v24
    v_exp_f32 v25, v25
    v_exp_f32 v26, v26
    v_exp_f32 v27, v27
    v_exp_f32 v28, v28
    buffer_load_dwordx4 v1, s[20:23], s70 offen offset:2048 sc1 lds
    s_sub_u32 m0, s69, 8
    s_mov_b64 exec, 1
    global_load_lds_dword v1, s[38:39] offset:8
    s_mov_b64 exec, -1
    v_mfma_f32_32x32x16_bf16 v[192:207], v[92:95], v[48:51], v[192:207]
    v_exp_f32 v29, v29
    v_exp_f32 v30, v30
    v_exp_f32 v31, v31
    v_cvt_pk_bf16_f32 v52, v24, v25
    v_cvt_pk_bf16_f32 v53, v26, v27
    v_cvt_pk_bf16_f32 v54, v28, v29
    v_cvt_pk_bf16_f32 v55, v30, v31
    s_waitcnt lgkmcnt(0)
    v_mfma_f32_32x32x16_bf16 v[16:31], v[68:71], v[56:59], 0
    v_exp_f32 v32, v32
    v_exp_f32 v33, v33
    v_exp_f32 v34, v34
    v_exp_f32 v35, v35
    v_exp_f32 v36, v36
    buffer_load_dwordx4 v[144:147], v133, s[24:27], s78 offen
    v_mfma_f32_32x32x16_bf16 v[192:207], v[96:99], v[52:55], v[192:207]
    v_exp_f32 v37, v37
    v_exp_f32 v38, v38
    v_exp_f32 v39, v39
    v_cvt_pk_bf16_f32 v48, v32, v33
    v_cvt_pk_bf16_f32 v49, v34, v35
    v_cvt_pk_bf16_f32 v50, v36, v37
    v_cvt_pk_bf16_f32 v51, v38, v39
    ds_read_b128 v[84:87], v7 offset:3072
    ds_read_b128 v[88:91], v7 offset:3744
    v_mfma_f32_32x32x8_bf16 v[16:31], v[76:77], v[64:65], v[16:31]
    v_exp_f32 v40, v40
    v_exp_f32 v41, v41
    v_exp_f32 v42, v42
    v_exp_f32 v43, v43
    v_exp_f32 v44, v44
    v_mfma_f32_32x32x16_bf16 v[208:223], v[92:95], v[48:51], v[208:223]
    v_exp_f32 v45, v45
    v_exp_f32 v46, v46
    v_exp_f32 v47, v47
    v_cvt_pk_bf16_f32 v52, v40, v41
    v_cvt_pk_bf16_f32 v53, v42, v43
    v_cvt_pk_bf16_f32 v54, v44, v45
    v_cvt_pk_bf16_f32 v55, v46, v47
    s_waitcnt lgkmcnt(0)
    v_mfma_f32_32x32x16_bf16 v[32:47], v[68:71], v[60:63], 0
    v_exp_f32 v16, v16
    v_exp_f32 v17, v17
    v_exp_f32 v18, v18
    v_exp_f32 v19, v19
    v_exp_f32 v20, v20
    v_mfma_f32_32x32x16_bf16 v[208:223], v[96:99], v[52:55], v[208:223]
    v_exp_f32 v21, v21
    v_exp_f32 v22, v22
    v_exp_f32 v23, v23
    v_cvt_pk_bf16_f32 v48, v16, v17
    v_cvt_pk_bf16_f32 v49, v18, v19
    v_cvt_pk_bf16_f32 v50, v20, v21
    v_cvt_pk_bf16_f32 v51, v22, v23
    ds_read_b128 v[72:75], v6 offset:1024
    v_mfma_f32_32x32x8_bf16 v[32:47], v[76:77], v[66:67], v[32:47]
    v_exp_f32 v24, v24
    v_exp_f32 v25, v25
    v_exp_f32 v26, v26
    v_exp_f32 v27, v27
    v_exp_f32 v28, v28
    v_mfma_f32_32x32x16_bf16 v[192:207], v[84:87], v[48:51], v[192:207]
    v_exp_f32 v29, v29
    v_exp_f32 v30, v30
    v_exp_f32 v31, v31
    v_cvt_pk_bf16_f32 v52, v24, v25
    v_cvt_pk_bf16_f32 v53, v26, v27
    v_cvt_pk_bf16_f32 v54, v28, v29
    v_cvt_pk_bf16_f32 v55, v30, v31
    s_waitcnt lgkmcnt(0)
    v_mfma_f32_32x32x16_bf16 v[16:31], v[72:75], v[56:59], 0
    v_exp_f32 v32, v32
    v_exp_f32 v33, v33
    v_exp_f32 v34, v34
    v_exp_f32 v35, v35
    v_exp_f32 v36, v36
    buffer_load_dwordx4 v[148:151], v134, s[24:27], s78 offen
    v_mfma_f32_32x32x16_bf16 v[192:207], v[88:91], v[52:55], v[192:207]
    v_exp_f32 v37, v37
    v_exp_f32 v38, v38
    v_exp_f32 v39, v39
    v_cvt_pk_bf16_f32 v48, v32, v33
    v_cvt_pk_bf16_f32 v49, v34, v35
    v_cvt_pk_bf16_f32 v50, v36, v37
    v_cvt_pk_bf16_f32 v51, v38, v39
    ds_read_b128 v[92:95], v7 offset:4416
    ds_read_b128 v[96:99], v7 offset:5088
    v_mfma_f32_32x32x8_bf16 v[16:31], v[78:79], v[64:65], v[16:31]
    v_exp_f32 v40, v40
    v_exp_f32 v41, v41
    v_exp_f32 v42, v42
    v_exp_f32 v43, v43
    v_exp_f32 v44, v44
    v_mfma_f32_32x32x16_bf16 v[208:223], v[84:87], v[48:51], v[208:223]
    v_exp_f32 v45, v45
    v_exp_f32 v46, v46
    v_exp_f32 v47, v47
    v_cvt_pk_bf16_f32 v52, v40, v41
    v_cvt_pk_bf16_f32 v53, v42, v43
    v_cvt_pk_bf16_f32 v54, v44, v45
    v_cvt_pk_bf16_f32 v55, v46, v47
    s_waitcnt lgkmcnt(0)
    v_mfma_f32_32x32x16_bf16 v[32:47], v[72:75], v[60:63], 0
    v_exp_f32 v16, v16
    v_exp_f32 v17, v17
    v_exp_f32 v18, v18
    v_exp_f32 v19, v19
    v_exp_f32 v20, v20
    v_mfma_f32_32x32x16_bf16 v[208:223], v[88:91], v[52:55], v[208:223]
    v_exp_f32 v21, v21
    v_exp_f32 v22, v22
    v_exp_f32 v23, v23
    v_cvt_pk_bf16_f32 v48, v16, v17
    v_cvt_pk_bf16_f32 v49, v18, v19
    v_cvt_pk_bf16_f32 v50, v20, v21
    v_cvt_pk_bf16_f32 v51, v22, v23
    ds_read_b128 v[68:71], v6 offset:6144
    ds_read_b128 v[80:83], v6 offset:8192
    v_mfma_f32_32x32x8_bf16 v[32:47], v[78:79], v[66:67], v[32:47]
    v_exp_f32 v24, v24
    v_exp_f32 v25, v25
    v_exp_f32 v26, v26
    v_exp_f32 v27, v27
    v_exp_f32 v28, v28
    v_mfma_f32_32x32x16_bf16 v[192:207], v[92:95], v[48:51], v[192:207]
    v_exp_f32 v29, v29
    v_exp_f32 v30, v30
    v_exp_f32 v31, v31
    v_cvt_pk_bf16_f32 v52, v24, v25
    v_cvt_pk_bf16_f32 v53, v26, v27
    v_cvt_pk_bf16_f32 v54, v28, v29
    v_cvt_pk_bf16_f32 v55, v30, v31
    s_waitcnt lgkmcnt(0)
    v_mfma_f32_32x32x16_bf16 v[16:31], v[68:71], v[56:59], 0
    v_exp_f32 v32, v32
    v_exp_f32 v33, v33
    v_exp_f32 v34, v34
    v_exp_f32 v35, v35
    v_exp_f32 v36, v36
    buffer_load_dwordx4 v[152:155], v135, s[24:27], s78 offen
    v_mfma_f32_32x32x16_bf16 v[192:207], v[96:99], v[52:55], v[192:207]
    v_exp_f32 v37, v37
    v_exp_f32 v38, v38
    v_exp_f32 v39, v39
    v_cvt_pk_bf16_f32 v48, v32, v33
    v_cvt_pk_bf16_f32 v49, v34, v35
    v_cvt_pk_bf16_f32 v50, v36, v37
    v_cvt_pk_bf16_f32 v51, v38, v39
    ds_read_b128 v[84:87], v7 offset:9216
    ds_read_b128 v[88:91], v7 offset:9888
    v_mfma_f32_32x32x8_bf16 v[16:31], v[80:81], v[64:65], v[16:31]
    v_exp_f32 v40, v40
    v_exp_f32 v41, v41
    v_exp_f32 v42, v42
    v_exp_f32 v43, v43
    v_exp_f32 v44, v44
    v_mfma_f32_32x32x16_bf16 v[208:223], v[92:95], v[48:51], v[208:223]
    v_exp_f32 v45, v45
    v_exp_f32 v46, v46
    v_exp_f32 v47, v47
    v_cvt_pk_bf16_f32 v52, v40, v41
    v_cvt_pk_bf16_f32 v53, v42, v43
    v_cvt_pk_bf16_f32 v54, v44, v45
    v_cvt_pk_bf16_f32 v55, v46, v47
    s_waitcnt lgkmcnt(0)
    v_mfma_f32_32x32x16_bf16 v[32:47], v[68:71], v[60:63], 0
    v_exp_f32 v16, v16
    v_exp_f32 v17, v17
    v_exp_f32 v18, v18
    v_exp_f32 v19, v19
    v_exp_f32 v20, v20
    v_mfma_f32_32x32x16_bf16 v[208:223], v[96:99], v[52:55], v[208:223]
    v_exp_f32 v21, v21
    v_exp_f32 v22, v22
    v_exp_f32 v23, v23
    v_cvt_pk_bf16_f32 v48, v16, v17
    v_cvt_pk_bf16_f32 v49, v18, v19
    v_cvt_pk_bf16_f32 v50, v20, v21
    v_cvt_pk_bf16_f32 v51, v22, v23
    ds_read_b128 v[72:75], v6 offset:7168
    v_mfma_f32_32x32x8_bf16 v[32:47], v[80:81], v[66:67], v[32:47]
    v_exp_f32 v24, v24
    v_exp_f32 v25, v25
    v_exp_f32 v26, v26
    v_exp_f32 v27, v27
    v_exp_f32 v28, v28
    v_mfma_f32_32x32x16_bf16 v[192:207], v[84:87], v[48:51], v[192:207]
    v_exp_f32 v29, v29
    v_exp_f32 v30, v30
    v_exp_f32 v31, v31
    v_cvt_pk_bf16_f32 v52, v24, v25
    v_cvt_pk_bf16_f32 v53, v26, v27
    v_cvt_pk_bf16_f32 v54, v28, v29
    v_cvt_pk_bf16_f32 v55, v30, v31
    s_waitcnt lgkmcnt(0)
    v_mfma_f32_32x32x16_bf16 v[16:31], v[72:75], v[56:59], 0
    v_exp_f32 v32, v32
    v_exp_f32 v33, v33
    v_exp_f32 v34, v34
    v_exp_f32 v35, v35
    v_exp_f32 v36, v36
    buffer_load_dwordx4 v[156:159], v136, s[24:27], s78 offen
    s_add_u32 s78, s78, 163840
    s_sub_u32 s6, s78, 819200
    s_cmp_lt_u32 s78, 819200
    s_cselect_b32 s78, s78, s6
    v_mfma_f32_32x32x16_bf16 v[192:207], v[88:91], v[52:55], v[192:207]
    v_exp_f32 v37, v37
    v_exp_f32 v38, v38
    v_exp_f32 v39, v39
    v_cvt_pk_bf16_f32 v48, v32, v33
    v_cvt_pk_bf16_f32 v49, v34, v35
    v_cvt_pk_bf16_f32 v50, v36, v37
    v_cvt_pk_bf16_f32 v51, v38, v39
    ds_read_b128 v[92:95], v7 offset:10560
    ds_read_b128 v[96:99], v7 offset:11232
    ds_read_b32 v10, v117
    v_mfma_f32_32x32x8_bf16 v[16:31], v[82:83], v[64:65], v[16:31]
    v_exp_f32 v40, v40
    v_exp_f32 v41, v41
    v_exp_f32 v42, v42
    v_exp_f32 v43, v43
    v_exp_f32 v44, v44
    v_mfma_f32_32x32x16_bf16 v[208:223], v[84:87], v[48:51], v[208:223]
    v_exp_f32 v45, v45
    v_exp_f32 v46, v46
    v_exp_f32 v47, v47
    v_cvt_pk_bf16_f32 v52, v40, v41
    v_cvt_pk_bf16_f32 v53, v42, v43
    v_cvt_pk_bf16_f32 v54, v44, v45
    v_cvt_pk_bf16_f32 v55, v46, v47
    s_waitcnt lgkmcnt(0)
A_T0_3:
    v_cmp_gt_u32 vcc, 3, v10
    v_cmp_ge_u32 s[74:75], 3, v10
    s_setprio 2
    s_cmp_lg_u32 vcc_lo, 0
    s_cbranch_scc1 A_T0_3S
A_T0_3R:
    s_cmp_eq_u32 s75, 0
    s_cbranch_scc1 A_T0_3H
    s_setprio 0
A_T0_3H:
    v_mfma_f32_32x32x16_bf16 v[32:47], v[72:75], v[60:63], 0
    v_exp_f32 v16, v16
    v_exp_f32 v17, v17
    v_exp_f32 v18, v18
    v_exp_f32 v19, v19
    v_exp_f32 v20, v20
    s_add_u32 m0, s94, 117504
    s_add_u32 s70, s93, 49152
    buffer_load_dwordx4 v1, s[20:23], s70 offen sc1 lds
    buffer_load_dwordx4 v1, s[20:23], s70 offen offset:1024 sc1 lds
    v_mfma_f32_32x32x16_bf16 v[208:223], v[88:91], v[52:55], v[208:223]
    v_exp_f32 v21, v21
    v_exp_f32 v22, v22
    v_exp_f32 v23, v23
    v_cvt_pk_bf16_f32 v48, v16, v17
    v_cvt_pk_bf16_f32 v49, v18, v19
    v_cvt_pk_bf16_f32 v50, v20, v21
    v_cvt_pk_bf16_f32 v51, v22, v23
    ds_read_b128 v[68:71], v2 offset:0
    ds_read_b128 v[76:79], v2 offset:2048
    v_mfma_f32_32x32x8_bf16 v[32:47], v[82:83], v[66:67], v[32:47]
    v_exp_f32 v24, v24
    v_exp_f32 v25, v25
    v_exp_f32 v26, v26
    v_exp_f32 v27, v27
    v_exp_f32 v28, v28
    buffer_load_dwordx4 v1, s[20:23], s70 offen offset:2048 sc1 lds
    s_sub_u32 m0, s69, 12
    s_mov_b64 exec, 1
    global_load_lds_dword v1, s[38:39] offset:12
    s_mov_b64 exec, -1
    v_mfma_f32_32x32x16_bf16 v[192:207], v[92:95], v[48:51], v[192:207]
    v_exp_f32 v29, v29
    v_exp_f32 v30, v30
    v_exp_f32 v31, v31
    v_cvt_pk_bf16_f32 v52, v24, v25
    v_cvt_pk_bf16_f32 v53, v26, v27
    v_cvt_pk_bf16_f32 v54, v28, v29
    v_cvt_pk_bf16_f32 v55, v30, v31
    s_waitcnt lgkmcnt(0)
    v_mfma_f32_32x32x16_bf16 v[16:31], v[68:71], v[56:59], 0
    v_exp_f32 v32, v32
    v_exp_f32 v33, v33
    v_exp_f32 v34, v34
    v_exp_f32 v35, v35
    v_exp_f32 v36, v36
    v_mfma_f32_32x32x16_bf16 v[192:207], v[96:99], v[52:55], v[192:207]
    v_exp_f32 v37, v37
    v_exp_f32 v38, v38
    v_exp_f32 v39, v39
    v_cvt_pk_bf16_f32 v48, v32, v33
    v_cvt_pk_bf16_f32 v49, v34, v35
    v_cvt_pk_bf16_f32 v50, v36, v37
    v_cvt_pk_bf16_f32 v51, v38, v39
    ds_read_b128 v[84:87], v3 offset:3072
    ds_read_b128 v[88:91], v3 offset:3744
    v_mfma_f32_32x32x8_bf16 v[16:31], v[76:77], v[64:65], v[16:31]
    v_exp_f32 v40, v40
    v_exp_f32 v41, v41
    v_exp_f32 v42, v42
    v_exp_f32 v43, v43
    v_exp_f32 v44, v44
    v_mfma_f32_32x32x16_bf16 v[208:223], v[92:95], v[48:51], v[208:223]
    v_exp_f32 v45, v45
    v_exp_f32 v46, v46
    v_exp_f32 v47, v47
    v_cvt_pk_bf16_f32 v52, v40, v41
    v_cvt_pk_bf16_f32 v53, v42, v43
    v_cvt_pk_bf16_f32 v54, v44, v45
    v_cvt_pk_bf16_f32 v55, v46, v47
    s_waitcnt lgkmcnt(0)
    v_mfma_f32_32x32x16_bf16 v[32:47], v[68:71], v[60:63], 0
    v_exp_f32 v16, v16
    v_exp_f32 v17, v17
    v_exp_f32 v18, v18
    v_exp_f32 v19, v19
    v_exp_f32 v20, v20
    buffer_load_dwordx4 v[160:163], v132, s[24:27], s78 offen
    v_mfma_f32_32x32x16_bf16 v[208:223], v[96:99], v[52:55], v[208:223]
    v_exp_f32 v21, v21
    v_exp_f32 v22, v22
    v_exp_f32 v23, v23
    v_cvt_pk_bf16_f32 v48, v16, v17
    v_cvt_pk_bf16_f32 v49, v18, v19
    v_cvt_pk_bf16_f32 v50, v20, v21
    v_cvt_pk_bf16_f32 v51, v22, v23
    ds_read_b128 v[72:75], v2 offset:1024
    v_mfma_f32_32x32x8_bf16 v[32:47], v[76:77], v[66:67], v[32:47]
    v_exp_f32 v24, v24
    v_exp_f32 v25, v25
    v_exp_f32 v26, v26
    v_exp_f32 v27, v27
    v_exp_f32 v28, v28
    v_mfma_f32_32x32x16_bf16 v[192:207], v[84:87], v[48:51], v[192:207]
    v_exp_f32 v29, v29
    v_exp_f32 v30, v30
    v_exp_f32 v31, v31
    v_cvt_pk_bf16_f32 v52, v24, v25
    v_cvt_pk_bf16_f32 v53, v26, v27
    v_cvt_pk_bf16_f32 v54, v28, v29
    v_cvt_pk_bf16_f32 v55, v30, v31
    s_waitcnt lgkmcnt(0)
    v_mfma_f32_32x32x16_bf16 v[16:31], v[72:75], v[56:59], 0
    v_exp_f32 v32, v32
    v_exp_f32 v33, v33
    v_exp_f32 v34, v34
    v_exp_f32 v35, v35
    v_exp_f32 v36, v36
    v_mfma_f32_32x32x16_bf16 v[192:207], v[88:91], v[52:55], v[192:207]
    v_exp_f32 v37, v37
    v_exp_f32 v38, v38
    v_exp_f32 v39, v39
    v_cvt_pk_bf16_f32 v48, v32, v33
    v_cvt_pk_bf16_f32 v49, v34, v35
    v_cvt_pk_bf16_f32 v50, v36, v37
    v_cvt_pk_bf16_f32 v51, v38, v39
    ds_read_b128 v[92:95], v3 offset:4416
    ds_read_b128 v[96:99], v3 offset:5088
    v_mfma_f32_32x32x8_bf16 v[16:31], v[78:79], v[64:65], v[16:31]
    v_exp_f32 v40, v40
    v_exp_f32 v41, v41
    v_exp_f32 v42, v42
    v_exp_f32 v43, v43
    v_exp_f32 v44, v44
    v_mfma_f32_32x32x16_bf16 v[208:223], v[84:87], v[48:51], v[208:223]
    v_exp_f32 v45, v45
    v_exp_f32 v46, v46
    v_exp_f32 v47, v47
    v_cvt_pk_bf16_f32 v52, v40, v41
    v_cvt_pk_bf16_f32 v53, v42, v43
    v_cvt_pk_bf16_f32 v54, v44, v45
    v_cvt_pk_bf16_f32 v55, v46, v47
    s_waitcnt lgkmcnt(0)
    v_mfma_f32_32x32x16_bf16 v[32:47], v[72:75], v[60:63], 0
    v_exp_f32 v16, v16
    v_exp_f32 v17, v17
    v_exp_f32 v18, v18
    v_exp_f32 v19, v19
    v_exp_f32 v20, v20
    buffer_load_dwordx4 v[164:167], v133, s[24:27], s78 offen
    v_mfma_f32_32x32x16_bf16 v[208:223], v[88:91], v[52:55], v[208:223]
    v_exp_f32 v21, v21
    v_exp_f32 v22, v22
    v_exp_f32 v23, v23
    v_cvt_pk_bf16_f32 v48, v16, v17
    v_cvt_pk_bf16_f32 v49, v18, v19
    v_cvt_pk_bf16_f32 v50, v20, v21
    v_cvt_pk_bf16_f32 v51, v22, v23
    ds_read_b128 v[68:71], v2 offset:6144
    ds_read_b128 v[80:83], v2 offset:8192
    v_mfma_f32_32x32x8_bf16 v[32:47], v[78:79], v[66:67], v[32:47]
    v_exp_f32 v24, v24
    v_exp_f32 v25, v25
    v_exp_f32 v26, v26
    v_exp_f32 v27, v27
    v_exp_f32 v28, v28
    v_mfma_f32_32x32x16_bf16 v[192:207], v[92:95], v[48:51], v[192:207]
    v_exp_f32 v29, v29
    v_exp_f32 v30, v30
    v_exp_f32 v31, v31
    v_cvt_pk_bf16_f32 v52, v24, v25
    v_cvt_pk_bf16_f32 v53, v26, v27
    v_cvt_pk_bf16_f32 v54, v28, v29
    v_cvt_pk_bf16_f32 v55, v30, v31
    s_waitcnt lgkmcnt(0)
    v_mfma_f32_32x32x16_bf16 v[16:31], v[68:71], v[56:59], 0
    v_exp_f32 v32, v32
    v_exp_f32 v33, v33
    v_exp_f32 v34, v34
    v_exp_f32 v35, v35
    v_exp_f32 v36, v36
    v_mfma_f32_32x32x16_bf16 v[192:207], v[96:99], v[52:55], v[192:207]
    v_exp_f32 v37, v37
    v_exp_f32 v38, v38
    v_exp_f32 v39, v39
    v_cvt_pk_bf16_f32 v48, v32, v33
    v_cvt_pk_bf16_f32 v49, v34, v35
    v_cvt_pk_bf16_f32 v50, v36, v37
    v_cvt_pk_bf16_f32 v51, v38, v39
    ds_read_b128 v[84:87], v3 offset:9216
    ds_read_b128 v[88:91], v3 offset:9888
    v_mfma_f32_32x32x8_bf16 v[16:31], v[80:81], v[64:65], v[16:31]
    v_exp_f32 v40, v40
    v_exp_f32 v41, v41
    v_exp_f32 v42, v42
    v_exp_f32 v43, v43
    v_exp_f32 v44, v44
    v_mfma_f32_32x32x16_bf16 v[208:223], v[92:95], v[48:51], v[208:223]
    v_exp_f32 v45, v45
    v_exp_f32 v46, v46
    v_exp_f32 v47, v47
    v_cvt_pk_bf16_f32 v52, v40, v41
    v_cvt_pk_bf16_f32 v53, v42, v43
    v_cvt_pk_bf16_f32 v54, v44, v45
    v_cvt_pk_bf16_f32 v55, v46, v47
    s_waitcnt lgkmcnt(0)
    v_mfma_f32_32x32x16_bf16 v[32:47], v[68:71], v[60:63], 0
    v_exp_f32 v16, v16
    v_exp_f32 v17, v17
    v_exp_f32 v18, v18
    v_exp_f32 v19, v19
    v_exp_f32 v20, v20
    buffer_load_dwordx4 v[168:171], v134, s[24:27], s78 offen
    v_mfma_f32_32x32x16_bf16 v[208:223], v[96:99], v[52:55], v[208:223]
    v_exp_f32 v21, v21
    v_exp_f32 v22, v22
    v_exp_f32 v23, v23
    v_cvt_pk_bf16_f32 v48, v16, v17
    v_cvt_pk_bf16_f32 v49, v18, v19
    v_cvt_pk_bf16_f32 v50, v20, v21
    v_cvt_pk_bf16_f32 v51, v22, v23
    ds_read_b128 v[72:75], v2 offset:7168
    v_mfma_f32_32x32x8_bf16 v[32:47], v[80:81], v[66:67], v[32:47]
    v_exp_f32 v24, v24
    v_exp_f32 v25, v25
    v_exp_f32 v26, v26
    v_exp_f32 v27, v27
    v_exp_f32 v28, v28
    v_mfma_f32_32x32x16_bf16 v[192:207], v[84:87], v[48:51], v[192:207]
    v_exp_f32 v29, v29
    v_exp_f32 v30, v30
    v_exp_f32 v31, v31
    v_cvt_pk_bf16_f32 v52, v24, v25
    v_cvt_pk_bf16_f32 v53, v26, v27
    v_cvt_pk_bf16_f32 v54, v28, v29
    v_cvt_pk_bf16_f32 v55, v30, v31
    s_waitcnt lgkmcnt(0)
    v_mfma_f32_32x32x16_bf16 v[16:31], v[72:75], v[56:59], 0
    v_exp_f32 v32, v32
    v_exp_f32 v33, v33
    v_exp_f32 v34, v34
    v_exp_f32 v35, v35
    v_exp_f32 v36, v36
    v_mfma_f32_32x32x16_bf16 v[192:207], v[88:91], v[52:55], v[192:207]
    v_exp_f32 v37, v37
    v_exp_f32 v38, v38
    v_exp_f32 v39, v39
    v_cvt_pk_bf16_f32 v48, v32, v33
    v_cvt_pk_bf16_f32 v49, v34, v35
    v_cvt_pk_bf16_f32 v50, v36, v37
    v_cvt_pk_bf16_f32 v51, v38, v39
    ds_read_b128 v[92:95], v3 offset:10560
    ds_read_b128 v[96:99], v3 offset:11232
    ds_read_b32 v10, v117
    v_mfma_f32_32x32x8_bf16 v[16:31], v[82:83], v[64:65], v[16:31]
    v_exp_f32 v40, v40
    v_exp_f32 v41, v41
    v_exp_f32 v42, v42
    v_exp_f32 v43, v43
    v_exp_f32 v44, v44
    v_mfma_f32_32x32x16_bf16 v[208:223], v[84:87], v[48:51], v[208:223]
    v_exp_f32 v45, v45
    v_exp_f32 v46, v46
    v_exp_f32 v47, v47
    v_cvt_pk_bf16_f32 v52, v40, v41
    v_cvt_pk_bf16_f32 v53, v42, v43
    v_cvt_pk_bf16_f32 v54, v44, v45
    v_cvt_pk_bf16_f32 v55, v46, v47
    s_waitcnt lgkmcnt(0)
A_T0_4:
    v_cmp_gt_u32 vcc, 4, v10
    v_cmp_ge_u32 s[74:75], 4, v10
    s_setprio 2
    s_cmp_lg_u32 vcc_lo, 0
    s_cbranch_scc1 A_T0_4S
A_T0_4R:
    s_cmp_eq_u32 s75, 0
    s_cbranch_scc1 A_T0_4H
    s_setprio 0
A_T0_4H:
    v_mfma_f32_32x32x16_bf16 v[32:47], v[72:75], v[60:63], 0
    v_exp_f32 v16, v16
    v_exp_f32 v17, v17
    v_exp_f32 v18, v18
    v_exp_f32 v19, v19
    v_exp_f32 v20, v20
    s_add_u32 m0, s94, 129792
    s_add_u32 s70, s93, 61440
    buffer_load_dwordx4 v1, s[20:23], s70 offen sc1 lds
    buffer_load_dwordx4 v1, s[20:23], s70 offen offset:1024 sc1 lds
    v_mfma_f32_32x32x16_bf16 v[208:223], v[88:91], v[52:55], v[208:223]
    v_exp_f32 v21, v21
    v_exp_f32 v22, v22
    v_exp_f32 v23, v23
    v_cvt_pk_bf16_f32 v48, v16, v17
    v_cvt_pk_bf16_f32 v49, v18, v19
    v_cvt_pk_bf16_f32 v50, v20, v21
    v_cvt_pk_bf16_f32 v51, v22, v23
    ds_read_b128 v[68:71], v4 offset:0
    ds_read_b128 v[76:79], v4 offset:2048
    v_mfma_f32_32x32x8_bf16 v[32:47], v[82:83], v[66:67], v[32:47]
    v_exp_f32 v24, v24
    v_exp_f32 v25, v25
    v_exp_f32 v26, v26
    v_exp_f32 v27, v27
    v_exp_f32 v28, v28
    buffer_load_dwordx4 v1, s[20:23], s70 offen offset:2048 sc1 lds
    s_sub_u32 m0, s69, 16
    s_mov_b64 exec, 1
    global_load_lds_dword v1, s[38:39] offset:16
    s_mov_b64 exec, -1
    v_mfma_f32_32x32x16_bf16 v[192:207], v[92:95], v[48:51], v[192:207]
    v_exp_f32 v29, v29
    v_exp_f32 v30, v30
    v_exp_f32 v31, v31
    v_cvt_pk_bf16_f32 v52, v24, v25
    v_cvt_pk_bf16_f32 v53, v26, v27
    v_cvt_pk_bf16_f32 v54, v28, v29
    v_cvt_pk_bf16_f32 v55, v30, v31
    s_waitcnt lgkmcnt(0)
    v_mfma_f32_32x32x16_bf16 v[16:31], v[68:71], v[56:59], 0
    v_exp_f32 v32, v32
    v_exp_f32 v33, v33
    v_exp_f32 v34, v34
    v_exp_f32 v35, v35
    v_exp_f32 v36, v36
    buffer_load_dwordx4 v[172:175], v135, s[24:27], s78 offen
    v_mfma_f32_32x32x16_bf16 v[192:207], v[96:99], v[52:55], v[192:207]
    v_exp_f32 v37, v37
    v_exp_f32 v38, v38
    v_exp_f32 v39, v39
    v_cvt_pk_bf16_f32 v48, v32, v33
    v_cvt_pk_bf16_f32 v49, v34, v35
    v_cvt_pk_bf16_f32 v50, v36, v37
    v_cvt_pk_bf16_f32 v51, v38, v39
    ds_read_b128 v[84:87], v5 offset:3072
    ds_read_b128 v[88:91], v5 offset:3744
    v_mfma_f32_32x32x8_bf16 v[16:31], v[76:77], v[64:65], v[16:31]
    v_exp_f32 v40, v40
    v_exp_f32 v41, v41
    v_exp_f32 v42, v42
    v_exp_f32 v43, v43
    v_exp_f32 v44, v44
    v_mfma_f32_32x32x16_bf16 v[208:223], v[92:95], v[48:51], v[208:223]
    v_exp_f32 v45, v45
    v_exp_f32 v46, v46
    v_exp_f32 v47, v47
    v_cvt_pk_bf16_f32 v52, v40, v41
    v_cvt_pk_bf16_f32 v53, v42, v43
    v_cvt_pk_bf16_f32 v54, v44, v45
    v_cvt_pk_bf16_f32 v55, v46, v47
    s_waitcnt lgkmcnt(0)
    v_mfma_f32_32x32x16_bf16 v[32:47], v[68:71], v[60:63], 0
    v_exp_f32 v16, v16
    v_exp_f32 v17, v17
    v_exp_f32 v18, v18
    v_exp_f32 v19, v19
    v_exp_f32 v20, v20
    v_mfma_f32_32x32x16_bf16 v[208:223], v[96:99], v[52:55], v[208:223]
    v_exp_f32 v21, v21
    v_exp_f32 v22, v22
    v_exp_f32 v23, v23
    v_cvt_pk_bf16_f32 v48, v16, v17
    v_cvt_pk_bf16_f32 v49, v18, v19
    v_cvt_pk_bf16_f32 v50, v20, v21
    v_cvt_pk_bf16_f32 v51, v22, v23
    ds_read_b128 v[72:75], v4 offset:1024
    v_mfma_f32_32x32x8_bf16 v[32:47], v[76:77], v[66:67], v[32:47]
    v_exp_f32 v24, v24
    v_exp_f32 v25, v25
    v_exp_f32 v26, v26
    v_exp_f32 v27, v27
    v_exp_f32 v28, v28
    v_mfma_f32_32x32x16_bf16 v[192:207], v[84:87], v[48:51], v[192:207]
    v_exp_f32 v29, v29
    v_exp_f32 v30, v30
    v_exp_f32 v31, v31
    v_cvt_pk_bf16_f32 v52, v24, v25
    v_cvt_pk_bf16_f32 v53, v26, v27
    v_cvt_pk_bf16_f32 v54, v28, v29
    v_cvt_pk_bf16_f32 v55, v30, v31
    s_waitcnt lgkmcnt(0)
    v_mfma_f32_32x32x16_bf16 v[16:31], v[72:75], v[56:59], 0
    v_exp_f32 v32, v32
    v_exp_f32 v33, v33
    v_exp_f32 v34, v34
    v_exp_f32 v35, v35
    v_exp_f32 v36, v36
    buffer_load_dwordx4 v[176:179], v136, s[24:27], s78 offen
    s_add_u32 s78, s78, 163840
    s_sub_u32 s6, s78, 819200
    s_cmp_lt_u32 s78, 819200
    s_cselect_b32 s78, s78, s6
    v_mfma_f32_32x32x16_bf16 v[192:207], v[88:91], v[52:55], v[192:207]
    v_exp_f32 v37, v37
    v_exp_f32 v38, v38
    v_exp_f32 v39, v39
    v_cvt_pk_bf16_f32 v48, v32, v33
    v_cvt_pk_bf16_f32 v49, v34, v35
    v_cvt_pk_bf16_f32 v50, v36, v37
    v_cvt_pk_bf16_f32 v51, v38, v39
    ds_read_b128 v[92:95], v5 offset:4416
    ds_read_b128 v[96:99], v5 offset:5088
    v_mfma_f32_32x32x8_bf16 v[16:31], v[78:79], v[64:65], v[16:31]
    v_exp_f32 v40, v40
    v_exp_f32 v41, v41
    v_exp_f32 v42, v42
    v_exp_f32 v43, v43
    v_exp_f32 v44, v44
    v_mfma_f32_32x32x16_bf16 v[208:223], v[84:87], v[48:51], v[208:223]
    v_exp_f32 v45, v45
    v_exp_f32 v46, v46
    v_exp_f32 v47, v47
    v_cvt_pk_bf16_f32 v52, v40, v41
    v_cvt_pk_bf16_f32 v53, v42, v43
    v_cvt_pk_bf16_f32 v54, v44, v45
    v_cvt_pk_bf16_f32 v55, v46, v47
    s_waitcnt lgkmcnt(0)
    v_mfma_f32_32x32x16_bf16 v[32:47], v[72:75], v[60:63], 0
    v_exp_f32 v16, v16
    v_exp_f32 v17, v17
    v_exp_f32 v18, v18
    v_exp_f32 v19, v19
    v_exp_f32 v20, v20
    v_mfma_f32_32x32x16_bf16 v[208:223], v[88:91], v[52:55], v[208:223]
    v_exp_f32 v21, v21
    v_exp_f32 v22, v22
    v_exp_f32 v23, v23
    v_cvt_pk_bf16_f32 v48, v16, v17
    v_cvt_pk_bf16_f32 v49, v18, v19
    v_cvt_pk_bf16_f32 v50, v20, v21
    v_cvt_pk_bf16_f32 v51, v22, v23
    ds_read_b128 v[68:71], v4 offset:6144
    ds_read_b128 v[80:83], v4 offset:8192
    v_mfma_f32_32x32x8_bf16 v[32:47], v[78:79], v[66:67], v[32:47]
    v_exp_f32 v24, v24
    v_exp_f32 v25, v25
    v_exp_f32 v26, v26
    v_exp_f32 v27, v27
    v_exp_f32 v28, v28
    v_mfma_f32_32x32x16_bf16 v[192:207], v[92:95], v[48:51], v[192:207]
    v_exp_f32 v29, v29
    v_exp_f32 v30, v30
    v_exp_f32 v31, v31
    v_cvt_pk_bf16_f32 v52, v24, v25
    v_cvt_pk_bf16_f32 v53, v26, v27
    v_cvt_pk_bf16_f32 v54, v28, v29
    v_cvt_pk_bf16_f32 v55, v30, v31
    s_waitcnt lgkmcnt(0)
    v_mfma_f32_32x32x16_bf16 v[16:31], v[68:71], v[56:59], 0
    v_exp_f32 v32, v32
    v_exp_f32 v33, v33
    v_exp_f32 v34, v34
    v_exp_f32 v35, v35
    v_exp_f32 v36, v36
    buffer_load_dwordx4 v[180:183], v132, s[24:27], s78 offen
    v_mfma_f32_32x32x16_bf16 v[192:207], v[96:99], v[52:55], v[192:207]
    v_exp_f32 v37, v37
    v_exp_f32 v38, v38
    v_exp_f32 v39, v39
    v_cvt_pk_bf16_f32 v48, v32, v33
    v_cvt_pk_bf16_f32 v49, v34, v35
    v_cvt_pk_bf16_f32 v50, v36, v37
    v_cvt_pk_bf16_f32 v51, v38, v39
    ds_read_b128 v[84:87], v5 offset:9216
    ds_read_b128 v[88:91], v5 offset:9888
    v_mfma_f32_32x32x8_bf16 v[16:31], v[80:81], v[64:65], v[16:31]
    v_exp_f32 v40, v40
    v_exp_f32 v41, v41
    v_exp_f32 v42, v42
    v_exp_f32 v43, v43
    v_exp_f32 v44, v44
    v_mfma_f32_32x32x16_bf16 v[208:223], v[92:95], v[48:51], v[208:223]
    v_exp_f32 v45, v45
    v_exp_f32 v46, v46
    v_exp_f32 v47, v47
    v_cvt_pk_bf16_f32 v52, v40, v41
    v_cvt_pk_bf16_f32 v53, v42, v43
    v_cvt_pk_bf16_f32 v54, v44, v45
    v_cvt_pk_bf16_f32 v55, v46, v47
    s_waitcnt lgkmcnt(0)
    v_mfma_f32_32x32x16_bf16 v[32:47], v[68:71], v[60:63], 0
    v_exp_f32 v16, v16
    v_exp_f32 v17, v17
    v_exp_f32 v18, v18
    v_exp_f32 v19, v19
    v_exp_f32 v20, v20
    v_mfma_f32_32x32x16_bf16 v[208:223], v[96:99], v[52:55], v[208:223]
    v_exp_f32 v21, v21
    v_exp_f32 v22, v22
    v_exp_f32 v23, v23
    v_cvt_pk_bf16_f32 v48, v16, v17
    v_cvt_pk_bf16_f32 v49, v18, v19
    v_cvt_pk_bf16_f32 v50, v20, v21
    v_cvt_pk_bf16_f32 v51, v22, v23
    ds_read_b128 v[72:75], v4 offset:7168
    v_mfma_f32_32x32x8_bf16 v[32:47], v[80:81], v[66:67], v[32:47]
    v_exp_f32 v24, v24
    v_exp_f32 v25, v25
    v_exp_f32 v26, v26
    v_exp_f32 v27, v27
    v_exp_f32 v28, v28
    v_mfma_f32_32x32x16_bf16 v[192:207], v[84:87], v[48:51], v[192:207]
    v_exp_f32 v29, v29
    v_exp_f32 v30, v30
    v_exp_f32 v31, v31
    v_cvt_pk_bf16_f32 v52, v24, v25
    v_cvt_pk_bf16_f32 v53, v26, v27
    v_cvt_pk_bf16_f32 v54, v28, v29
    v_cvt_pk_bf16_f32 v55, v30, v31
    s_waitcnt lgkmcnt(0)
    v_mfma_f32_32x32x16_bf16 v[16:31], v[72:75], v[56:59], 0
    v_exp_f32 v32, v32
    v_exp_f32 v33, v33
    v_exp_f32 v34, v34
    v_exp_f32 v35, v35
    v_exp_f32 v36, v36
    buffer_load_dwordx4 v[184:187], v133, s[24:27], s78 offen
    v_mfma_f32_32x32x16_bf16 v[192:207], v[88:91], v[52:55], v[192:207]
    v_exp_f32 v37, v37
    v_exp_f32 v38, v38
    v_exp_f32 v39, v39
    v_cvt_pk_bf16_f32 v48, v32, v33
    v_cvt_pk_bf16_f32 v49, v34, v35
    v_cvt_pk_bf16_f32 v50, v36, v37
    v_cvt_pk_bf16_f32 v51, v38, v39
    ds_read_b128 v[92:95], v5 offset:10560
    ds_read_b128 v[96:99], v5 offset:11232
    ds_read_b32 v10, v117
    v_mfma_f32_32x32x8_bf16 v[16:31], v[82:83], v[64:65], v[16:31]
    v_exp_f32 v40, v40
    v_exp_f32 v41, v41
    v_exp_f32 v42, v42
    v_exp_f32 v43, v43
    v_exp_f32 v44, v44
    v_mfma_f32_32x32x16_bf16 v[208:223], v[84:87], v[48:51], v[208:223]
    v_exp_f32 v45, v45
    v_exp_f32 v46, v46
    v_exp_f32 v47, v47
    v_cvt_pk_bf16_f32 v52, v40, v41
    v_cvt_pk_bf16_f32 v53, v42, v43
    v_cvt_pk_bf16_f32 v54, v44, v45
    v_cvt_pk_bf16_f32 v55, v46, v47
    s_waitcnt lgkmcnt(0)
A_T0_5:
    v_cmp_gt_u32 vcc, 5, v10
    v_cmp_ge_u32 s[74:75], 5, v10
    s_setprio 2
    s_cmp_lg_u32 vcc_lo, 0
    s_cbranch_scc1 A_T0_5S
A_T0_5R:
    s_cmp_eq_u32 s75, 0
    s_cbranch_scc1 A_T0_5H
    s_setprio 0
A_T0_5H:
    v_mfma_f32_32x32x16_bf16 v[32:47], v[72:75], v[60:63], 0
    v_exp_f32 v16, v16
    v_exp_f32 v17, v17
    v_exp_f32 v18, v18
    v_exp_f32 v19, v19
    v_exp_f32 v20, v20
    s_add_u32 m0, s94, 48384
    s_add_u32 s70, s93, 73728
    buffer_load_dwordx4 v1, s[20:23], s70 offen sc1 lds
    buffer_load_dwordx4 v1, s[20:23], s70 offen offset:1024 sc1 lds
    v_mfma_f32_32x32x16_bf16 v[208:223], v[88:91], v[52:55], v[208:223]
    v_exp_f32 v21, v21
    v_exp_f32 v22, v22
    v_exp_f32 v23, v23
    v_cvt_pk_bf16_f32 v48, v16, v17
    v_cvt_pk_bf16_f32 v49, v18, v19
    v_cvt_pk_bf16_f32 v50, v20, v21
    v_cvt_pk_bf16_f32 v51, v22, v23
    ds_read_b128 v[68:71], v6 offset:0
    ds_read_b128 v[76:79], v6 offset:2048
    v_mfma_f32_32x32x8_bf16 v[32:47], v[82:83], v[66:67], v[32:47]
    v_exp_f32 v24, v24
    v_exp_f32 v25, v25
    v_exp_f32 v26, v26
    v_exp_f32 v27, v27
    v_exp_f32 v28, v28
    buffer_load_dwordx4 v1, s[20:23], s70 offen offset:2048 sc1 lds
    s_sub_u32 m0, s69, 20
    s_mov_b64 exec, 1
    global_load_lds_dword v1, s[38:39] offset:20
    s_mov_b64 exec, -1
    v_mfma_f32_32x32x16_bf16 v[192:207], v[92:95], v[48:51], v[192:207]
    v_exp_f32 v29, v29
    v_exp_f32 v30, v30
    v_exp_f32 v31, v31
    v_cvt_pk_bf16_f32 v52, v24, v25
    v_cvt_pk_bf16_f32 v53, v26, v27
    v_cvt_pk_bf16_f32 v54, v28, v29
    v_cvt_pk_bf16_f32 v55, v30, v31
    s_waitcnt lgkmcnt(0)
    v_mfma_f32_32x32x16_bf16 v[16:31], v[68:71], v[56:59], 0
    v_exp_f32 v32, v32
    v_exp_f32 v33, v33
    v_exp_f32 v34, v34
    v_exp_f32 v35, v35
    v_exp_f32 v36, v36
    v_mfma_f32_32x32x16_bf16 v[192:207], v[96:99], v[52:55], v[192:207]
    v_exp_f32 v37, v37
    v_exp_f32 v38, v38
    v_exp_f32 v39, v39
    v_cvt_pk_bf16_f32 v48, v32, v33
    v_cvt_pk_bf16_f32 v49, v34, v35
    v_cvt_pk_bf16_f32 v50, v36, v37
    v_cvt_pk_bf16_f32 v51, v38, v39
    ds_read_b128 v[84:87], v7 offset:3072
    ds_read_b128 v[88:91], v7 offset:3744
    v_mfma_f32_32x32x8_bf16 v[16:31], v[76:77], v[64:65], v[16:31]
    v_exp_f32 v40, v40
    v_exp_f32 v41, v41
    v_exp_f32 v42, v42
    v_exp_f32 v43, v43
    v_exp_f32 v44, v44
    v_mfma_f32_32x32x16_bf16 v[208:223], v[92:95], v[48:51], v[208:223]
    v_exp_f32 v45, v45
    v_exp_f32 v46, v46
    v_exp_f32 v47, v47
    v_cvt_pk_bf16_f32 v52, v40, v41
    v_cvt_pk_bf16_f32 v53, v42, v43
    v_cvt_pk_bf16_f32 v54, v44, v45
    v_cvt_pk_bf16_f32 v55, v46, v47
    s_waitcnt lgkmcnt(0)
    v_mfma_f32_32x32x16_bf16 v[32:47], v[68:71], v[60:63], 0
    v_exp_f32 v16, v16
    v_exp_f32 v17, v17
    v_exp_f32 v18, v18
    v_exp_f32 v19, v19
    v_exp_f32 v20, v20
    buffer_load_dwordx4 v[188:191], v134, s[24:27], s78 offen
    v_mfma_f32_32x32x16_bf16 v[208:223], v[96:99], v[52:55], v[208:223]
    v_exp_f32 v21, v21
    v_exp_f32 v22, v22
    v_exp_f32 v23, v23
    v_cvt_pk_bf16_f32 v48, v16, v17
    v_cvt_pk_bf16_f32 v49, v18, v19
    v_cvt_pk_bf16_f32 v50, v20, v21
    v_cvt_pk_bf16_f32 v51, v22, v23
    ds_read_b128 v[72:75], v6 offset:1024
    v_mfma_f32_32x32x8_bf16 v[32:47], v[76:77], v[66:67], v[32:47]
    v_exp_f32 v24, v24
    v_exp_f32 v25, v25
    v_exp_f32 v26, v26
    v_exp_f32 v27, v27
    v_exp_f32 v28, v28
    v_mfma_f32_32x32x16_bf16 v[192:207], v[84:87], v[48:51], v[192:207]
    v_exp_f32 v29, v29
    v_exp_f32 v30, v30
    v_exp_f32 v31, v31
    v_cvt_pk_bf16_f32 v52, v24, v25
    v_cvt_pk_bf16_f32 v53, v26, v27
    v_cvt_pk_bf16_f32 v54, v28, v29
    v_cvt_pk_bf16_f32 v55, v30, v31
    s_waitcnt lgkmcnt(0)
    v_mfma_f32_32x32x16_bf16 v[16:31], v[72:75], v[56:59], 0
    v_exp_f32 v32, v32
    v_exp_f32 v33, v33
    v_exp_f32 v34, v34
    v_exp_f32 v35, v35
    v_exp_f32 v36, v36
    v_mfma_f32_32x32x16_bf16 v[192:207], v[88:91], v[52:55], v[192:207]
    v_exp_f32 v37, v37
    v_exp_f32 v38, v38
    v_exp_f32 v39, v39
    v_cvt_pk_bf16_f32 v48, v32, v33
    v_cvt_pk_bf16_f32 v49, v34, v35
    v_cvt_pk_bf16_f32 v50, v36, v37
    v_cvt_pk_bf16_f32 v51, v38, v39
    ds_read_b128 v[92:95], v7 offset:4416
    ds_read_b128 v[96:99], v7 offset:5088
    v_mfma_f32_32x32x8_bf16 v[16:31], v[78:79], v[64:65], v[16:31]
    v_exp_f32 v40, v40
    v_exp_f32 v41, v41
    v_exp_f32 v42, v42
    v_exp_f32 v43, v43
    v_exp_f32 v44, v44
    v_mfma_f32_32x32x16_bf16 v[208:223], v[84:87], v[48:51], v[208:223]
    v_exp_f32 v45, v45
    v_exp_f32 v46, v46
    v_exp_f32 v47, v47
    v_cvt_pk_bf16_f32 v52, v40, v41
    v_cvt_pk_bf16_f32 v53, v42, v43
    v_cvt_pk_bf16_f32 v54, v44, v45
    v_cvt_pk_bf16_f32 v55, v46, v47
    s_waitcnt lgkmcnt(0)
    v_mfma_f32_32x32x16_bf16 v[32:47], v[72:75], v[60:63], 0
    v_exp_f32 v16, v16
    v_exp_f32 v17, v17
    v_exp_f32 v18, v18
    v_exp_f32 v19, v19
    v_exp_f32 v20, v20
    buffer_load_dwordx4 v[100:103], v135, s[24:27], s78 offen
    v_mfma_f32_32x32x16_bf16 v[208:223], v[88:91], v[52:55], v[208:223]
    v_exp_f32 v21, v21
    v_exp_f32 v22, v22
    v_exp_f32 v23, v23
    v_cvt_pk_bf16_f32 v48, v16, v17
    v_cvt_pk_bf16_f32 v49, v18, v19
    v_cvt_pk_bf16_f32 v50, v20, v21
    v_cvt_pk_bf16_f32 v51, v22, v23
    ds_read_b128 v[68:71], v6 offset:6144
    ds_read_b128 v[80:83], v6 offset:8192
    v_mfma_f32_32x32x8_bf16 v[32:47], v[78:79], v[66:67], v[32:47]
    v_exp_f32 v24, v24
    v_exp_f32 v25, v25
    v_exp_f32 v26, v26
    v_exp_f32 v27, v27
    v_exp_f32 v28, v28
    v_mfma_f32_32x32x16_bf16 v[192:207], v[92:95], v[48:51], v[192:207]
    v_exp_f32 v29, v29
    v_exp_f32 v30, v30
    v_exp_f32 v31, v31
    v_cvt_pk_bf16_f32 v52, v24, v25
    v_cvt_pk_bf16_f32 v53, v26, v27
    v_cvt_pk_bf16_f32 v54, v28, v29
    v_cvt_pk_bf16_f32 v55, v30, v31
    s_waitcnt lgkmcnt(0)
    v_mfma_f32_32x32x16_bf16 v[16:31], v[68:71], v[56:59], 0
    v_exp_f32 v32, v32
    v_exp_f32 v33, v33
    v_exp_f32 v34, v34
    v_exp_f32 v35, v35
    v_exp_f32 v36, v36
    v_mfma_f32_32x32x16_bf16 v[192:207], v[96:99], v[52:55], v[192:207]
    v_exp_f32 v37, v37
    v_exp_f32 v38, v38
    v_exp_f32 v39, v39
    v_cvt_pk_bf16_f32 v48, v32, v33
    v_cvt_pk_bf16_f32 v49, v34, v35
    v_cvt_pk_bf16_f32 v50, v36, v37
    v_cvt_pk_bf16_f32 v51, v38, v39
    ds_read_b128 v[84:87], v7 offset:9216
    ds_read_b128 v[88:91], v7 offset:9888
    v_mfma_f32_32x32x8_bf16 v[16:31], v[80:81], v[64:65], v[16:31]
    v_exp_f32 v40, v40
    v_exp_f32 v41, v41
    v_exp_f32 v42, v42
    v_exp_f32 v43, v43
    v_exp_f32 v44, v44
    v_mfma_f32_32x32x16_bf16 v[208:223], v[92:95], v[48:51], v[208:223]
    v_exp_f32 v45, v45
    v_exp_f32 v46, v46
    v_exp_f32 v47, v47
    v_cvt_pk_bf16_f32 v52, v40, v41
    v_cvt_pk_bf16_f32 v53, v42, v43
    v_cvt_pk_bf16_f32 v54, v44, v45
    v_cvt_pk_bf16_f32 v55, v46, v47
    s_waitcnt lgkmcnt(0)
    v_mfma_f32_32x32x16_bf16 v[32:47], v[68:71], v[60:63], 0
    v_exp_f32 v16, v16
    v_exp_f32 v17, v17
    v_exp_f32 v18, v18
    v_exp_f32 v19, v19
    v_exp_f32 v20, v20
    buffer_load_dwordx4 v[104:107], v136, s[24:27], s78 offen
    s_add_u32 s78, s78, 163840
    s_sub_u32 s6, s78, 819200
    s_cmp_lt_u32 s78, 819200
    s_cselect_b32 s78, s78, s6
    v_mfma_f32_32x32x16_bf16 v[208:223], v[96:99], v[52:55], v[208:223]
    v_exp_f32 v21, v21
    v_exp_f32 v22, v22
    v_exp_f32 v23, v23
    v_cvt_pk_bf16_f32 v48, v16, v17
    v_cvt_pk_bf16_f32 v49, v18, v19
    v_cvt_pk_bf16_f32 v50, v20, v21
    v_cvt_pk_bf16_f32 v51, v22, v23
    ds_read_b128 v[72:75], v6 offset:7168
    v_mfma_f32_32x32x8_bf16 v[32:47], v[80:81], v[66:67], v[32:47]
    v_exp_f32 v24, v24
    v_exp_f32 v25, v25
    v_exp_f32 v26, v26
    v_exp_f32 v27, v27
    v_exp_f32 v28, v28
    v_mfma_f32_32x32x16_bf16 v[192:207], v[84:87], v[48:51], v[192:207]
    v_exp_f32 v29, v29
    v_exp_f32 v30, v30
    v_exp_f32 v31, v31
    v_cvt_pk_bf16_f32 v52, v24, v25
    v_cvt_pk_bf16_f32 v53, v26, v27
    v_cvt_pk_bf16_f32 v54, v28, v29
    v_cvt_pk_bf16_f32 v55, v30, v31
    s_waitcnt lgkmcnt(0)
    v_mfma_f32_32x32x16_bf16 v[16:31], v[72:75], v[56:59], 0
    v_exp_f32 v32, v32
    v_exp_f32 v33, v33
    v_exp_f32 v34, v34
    v_exp_f32 v35, v35
    v_exp_f32 v36, v36
    v_mfma_f32_32x32x16_bf16 v[192:207], v[88:91], v[52:55], v[192:207]
    v_exp_f32 v37, v37
    v_exp_f32 v38, v38
    v_exp_f32 v39, v39
    v_cvt_pk_bf16_f32 v48, v32, v33
    v_cvt_pk_bf16_f32 v49, v34, v35
    v_cvt_pk_bf16_f32 v50, v36, v37
    v_cvt_pk_bf16_f32 v51, v38, v39
    ds_read_b128 v[92:95], v7 offset:10560
    ds_read_b128 v[96:99], v7 offset:11232
    ds_read_b32 v10, v117
    v_mfma_f32_32x32x8_bf16 v[16:31], v[82:83], v[64:65], v[16:31]
    v_exp_f32 v40, v40
    v_exp_f32 v41, v41
    v_exp_f32 v42, v42
    v_exp_f32 v43, v43
    v_exp_f32 v44, v44
    v_mfma_f32_32x32x16_bf16 v[208:223], v[84:87], v[48:51], v[208:223]
    v_exp_f32 v45, v45
    v_exp_f32 v46, v46
    v_exp_f32 v47, v47
    v_cvt_pk_bf16_f32 v52, v40, v41
    v_cvt_pk_bf16_f32 v53, v42, v43
    v_cvt_pk_bf16_f32 v54, v44, v45
    v_cvt_pk_bf16_f32 v55, v46, v47
    s_waitcnt lgkmcnt(0)
A_T0_6:
    v_cmp_gt_u32 vcc, 6, v10
    v_cmp_ge_u32 s[74:75], 6, v10
    s_setprio 2
    s_cmp_lg_u32 vcc_lo, 0
    s_cbranch_scc1 A_T0_6S
A_T0_6R:
    s_cmp_eq_u32 s75, 0
    s_cbranch_scc1 A_T0_6H
    s_setprio 0
A_T0_6H:
    v_mfma_f32_32x32x16_bf16 v[32:47], v[72:75], v[60:63], 0
    v_exp_f32 v16, v16
    v_exp_f32 v17, v17
    v_exp_f32 v18, v18
    v_exp_f32 v19, v19
    v_exp_f32 v20, v20
    s_add_u32 m0, s94, 117504
    s_add_u32 s70, s93, 86016
    buffer_load_dwordx4 v1, s[20:23], s70 offen sc1 lds
    buffer_load_dwordx4 v1, s[20:23], s70 offen offset:1024 sc1 lds
    v_mfma_f32_32x32x16_bf16 v[208:223], v[88:91], v[52:55], v[208:223]
    v_exp_f32 v21, v21
    v_exp_f32 v22, v22
    v_exp_f32 v23, v23
    v_cvt_pk_bf16_f32 v48, v16, v17
    v_cvt_pk_bf16_f32 v49, v18, v19
    v_cvt_pk_bf16_f32 v50, v20, v21
    v_cvt_pk_bf16_f32 v51, v22, v23
    ds_read_b128 v[68:71], v2 offset:0
    ds_read_b128 v[76:79], v2 offset:2048
    v_mfma_f32_32x32x8_bf16 v[32:47], v[82:83], v[66:67], v[32:47]
    v_exp_f32 v24, v24
    v_exp_f32 v25, v25
    v_exp_f32 v26, v26
    v_exp_f32 v27, v27
    v_exp_f32 v28, v28
    buffer_load_dwordx4 v1, s[20:23], s70 offen offset:2048 sc1 lds
    s_sub_u32 m0, s69, 24
    s_mov_b64 exec, 1
    global_load_lds_dword v1, s[38:39] offset:24
    s_mov_b64 exec, -1
    v_mfma_f32_32x32x16_bf16 v[192:207], v[92:95], v[48:51], v[192:207]
    v_exp_f32 v29, v29
    v_exp_f32 v30, v30
    v_exp_f32 v31, v31
    v_cvt_pk_bf16_f32 v52, v24, v25
    v_cvt_pk_bf16_f32 v53, v26, v27
    v_cvt_pk_bf16_f32 v54, v28, v29
    v_cvt_pk_bf16_f32 v55, v30, v31
    s_waitcnt lgkmcnt(0)
    v_mfma_f32_32x32x16_bf16 v[16:31], v[68:71], v[56:59], 0
    v_exp_f32 v32, v32
    v_exp_f32 v33, v33
    v_exp_f32 v34, v34
    v_exp_f32 v35, v35
    v_exp_f32 v36, v36
    buffer_load_dwordx4 v[108:111], v132, s[24:27], s78 offen
    v_mfma_f32_32x32x16_bf16 v[192:207], v[96:99], v[52:55], v[192:207]
    v_exp_f32 v37, v37
    v_exp_f32 v38, v38
    v_exp_f32 v39, v39
    v_cvt_pk_bf16_f32 v48, v32, v33
    v_cvt_pk_bf16_f32 v49, v34, v35
    v_cvt_pk_bf16_f32 v50, v36, v37
    v_cvt_pk_bf16_f32 v51, v38, v39
    ds_read_b128 v[84:87], v3 offset:3072
    ds_read_b128 v[88:91], v3 offset:3744
    v_mfma_f32_32x32x8_bf16 v[16:31], v[76:77], v[64:65], v[16:31]
    v_exp_f32 v40, v40
    v_exp_f32 v41, v41
    v_exp_f32 v42, v42
    v_exp_f32 v43, v43
    v_exp_f32 v44, v44
    v_mfma_f32_32x32x16_bf16 v[208:223], v[92:95], v[48:51], v[208:223]
    v_exp_f32 v45, v45
    v_exp_f32 v46, v46
    v_exp_f32 v47, v47
    v_cvt_pk_bf16_f32 v52, v40, v41
    v_cvt_pk_bf16_f32 v53, v42, v43
    v_cvt_pk_bf16_f32 v54, v44, v45
    v_cvt_pk_bf16_f32 v55, v46, v47
    s_waitcnt lgkmcnt(0)
    v_mfma_f32_32x32x16_bf16 v[32:47], v[68:71], v[60:63], 0
    v_exp_f32 v16, v16
    v_exp_f32 v17, v17
    v_exp_f32 v18, v18
    v_exp_f32 v19, v19
    v_exp_f32 v20, v20
    v_mfma_f32_32x32x16_bf16 v[208:223], v[96:99], v[52:55], v[208:223]
    v_exp_f32 v21, v21
    v_exp_f32 v22, v22
    v_exp_f32 v23, v23
    v_cvt_pk_bf16_f32 v48, v16, v17
    v_cvt_pk_bf16_f32 v49, v18, v19
    v_cvt_pk_bf16_f32 v50, v20, v21
    v_cvt_pk_bf16_f32 v51, v22, v23
    ds_read_b128 v[72:75], v2 offset:1024
    v_mfma_f32_32x32x8_bf16 v[32:47], v[76:77], v[66:67], v[32:47]
    v_exp_f32 v24, v24
    v_exp_f32 v25, v25
    v_exp_f32 v26, v26
    v_exp_f32 v27, v27
    v_exp_f32 v28, v28
    v_mfma_f32_32x32x16_bf16 v[192:207], v[84:87], v[48:51], v[192:207]
    v_exp_f32 v29, v29
    v_exp_f32 v30, v30
    v_exp_f32 v31, v31
    v_cvt_pk_bf16_f32 v52, v24, v25
    v_cvt_pk_bf16_f32 v53, v26, v27
    v_cvt_pk_bf16_f32 v54, v28, v29
    v_cvt_pk_bf16_f32 v55, v30, v31
    s_waitcnt lgkmcnt(0)
    v_mfma_f32_32x32x16_bf16 v[16:31], v[72:75], v[56:59], 0
    v_exp_f32 v32, v32
    v_exp_f32 v33, v33
    v_exp_f32 v34, v34
    v_exp_f32 v35, v35
    v_exp_f32 v36, v36
    buffer_load_dwordx4 v[112:115], v133, s[24:27], s78 offen
    v_mfma_f32_32x32x16_bf16 v[192:207], v[88:91], v[52:55], v[192:207]
    v_exp_f32 v37, v37
    v_exp_f32 v38, v38
    v_exp_f32 v39, v39
    v_cvt_pk_bf16_f32 v48, v32, v33
    v_cvt_pk_bf16_f32 v49, v34, v35
    v_cvt_pk_bf16_f32 v50, v36, v37
    v_cvt_pk_bf16_f32 v51, v38, v39
    ds_read_b128 v[92:95], v3 offset:4416
    ds_read_b128 v[96:99], v3 offset:5088
    v_mfma_f32_32x32x8_bf16 v[16:31], v[78:79], v[64:65], v[16:31]
    v_exp_f32 v40, v40
    v_exp_f32 v41, v41
    v_exp_f32 v42, v42
    v_exp_f32 v43, v43
    v_exp_f32 v44, v44
    v_mfma_f32_32x32x16_bf16 v[208:223], v[84:87], v[48:51], v[208:223]
    v_exp_f32 v45, v45
    v_exp_f32 v46, v46
    v_exp_f32 v47, v47
    v_cvt_pk_bf16_f32 v52, v40, v41
    v_cvt_pk_bf16_f32 v53, v42, v43
    v_cvt_pk_bf16_f32 v54, v44, v45
    v_cvt_pk_bf16_f32 v55, v46, v47
    s_waitcnt lgkmcnt(0)
    v_mfma_f32_32x32x16_bf16 v[32:47], v[72:75], v[60:63], 0
    v_exp_f32 v16, v16
    v_exp_f32 v17, v17
    v_exp_f32 v18, v18
    v_exp_f32 v19, v19
    v_exp_f32 v20, v20
    v_mfma_f32_32x32x16_bf16 v[208:223], v[88:91], v[52:55], v[208:223]
    v_exp_f32 v21, v21
    v_exp_f32 v22, v22
    v_exp_f32 v23, v23
    v_cvt_pk_bf16_f32 v48, v16, v17
    v_cvt_pk_bf16_f32 v49, v18, v19
    v_cvt_pk_bf16_f32 v50, v20, v21
    v_cvt_pk_bf16_f32 v51, v22, v23
    ds_read_b128 v[68:71], v2 offset:6144
    ds_read_b128 v[80:83], v2 offset:8192
    v_mfma_f32_32x32x8_bf16 v[32:47], v[78:79], v[66:67], v[32:47]
    v_exp_f32 v24, v24
    v_exp_f32 v25, v25
    v_exp_f32 v26, v26
    v_exp_f32 v27, v27
    v_exp_f32 v28, v28
    v_mfma_f32_32x32x16_bf16 v[192:207], v[92:95], v[48:51], v[192:207]
    v_exp_f32 v29, v29
    v_exp_f32 v30, v30
    v_exp_f32 v31, v31
    v_cvt_pk_bf16_f32 v52, v24, v25
    v_cvt_pk_bf16_f32 v53, v26, v27
    v_cvt_pk_bf16_f32 v54, v28, v29
    v_cvt_pk_bf16_f32 v55, v30, v31
    s_waitcnt lgkmcnt(0)
    v_mfma_f32_32x32x16_bf16 v[16:31], v[68:71], v[56:59], 0
    v_exp_f32 v32, v32
    v_exp_f32 v33, v33
    v_exp_f32 v34, v34
    v_exp_f32 v35, v35
    v_exp_f32 v36, v36
    buffer_load_dwordx4 v[240:243], v134, s[24:27], s78 offen
    v_mfma_f32_32x32x16_bf16 v[192:207], v[96:99], v[52:55], v[192:207]
    v_exp_f32 v37, v37
    v_exp_f32 v38, v38
    v_exp_f32 v39, v39
    v_cvt_pk_bf16_f32 v48, v32, v33
    v_cvt_pk_bf16_f32 v49, v34, v35
    v_cvt_pk_bf16_f32 v50, v36, v37
    v_cvt_pk_bf16_f32 v51, v38, v39
    ds_read_b128 v[84:87], v3 offset:9216
    ds_read_b128 v[88:91], v3 offset:9888
    v_mfma_f32_32x32x8_bf16 v[16:31], v[80:81], v[64:65], v[16:31]
    v_exp_f32 v40, v40
    v_exp_f32 v41, v41
    v_exp_f32 v42, v42
    v_exp_f32 v43, v43
    v_exp_f32 v44, v44
    v_mfma_f32_32x32x16_bf16 v[208:223], v[92:95], v[48:51], v[208:223]
    v_exp_f32 v45, v45
    v_exp_f32 v46, v46
    v_exp_f32 v47, v47
    v_cvt_pk_bf16_f32 v52, v40, v41
    v_cvt_pk_bf16_f32 v53, v42, v43
    v_cvt_pk_bf16_f32 v54, v44, v45
    v_cvt_pk_bf16_f32 v55, v46, v47
    s_waitcnt lgkmcnt(0)
    v_mfma_f32_32x32x16_bf16 v[32:47], v[68:71], v[60:63], 0
    v_exp_f32 v16, v16
    v_exp_f32 v17, v17
    v_exp_f32 v18, v18
    v_exp_f32 v19, v19
    v_exp_f32 v20, v20
    v_mfma_f32_32x32x16_bf16 v[208:223], v[96:99], v[52:55], v[208:223]
    v_exp_f32 v21, v21
    v_exp_f32 v22, v22
    v_exp_f32 v23, v23
    v_cvt_pk_bf16_f32 v48, v16, v17
    v_cvt_pk_bf16_f32 v49, v18, v19
    v_cvt_pk_bf16_f32 v50, v20, v21
    v_cvt_pk_bf16_f32 v51, v22, v23
    ds_read_b128 v[72:75], v2 offset:7168
    v_mfma_f32_32x32x8_bf16 v[32:47], v[80:81], v[66:67], v[32:47]
    v_exp_f32 v24, v24
    v_exp_f32 v25, v25
    v_exp_f32 v26, v26
    v_exp_f32 v27, v27
    v_exp_f32 v28, v28
    v_mfma_f32_32x32x16_bf16 v[192:207], v[84:87], v[48:51], v[192:207]
    v_exp_f32 v29, v29
    v_exp_f32 v30, v30
    v_exp_f32 v31, v31
    v_cvt_pk_bf16_f32 v52, v24, v25
    v_cvt_pk_bf16_f32 v53, v26, v27
    v_cvt_pk_bf16_f32 v54, v28, v29
    v_cvt_pk_bf16_f32 v55, v30, v31
    s_waitcnt lgkmcnt(0)
    v_mfma_f32_32x32x16_bf16 v[16:31], v[72:75], v[56:59], 0
    v_exp_f32 v32, v32
    v_exp_f32 v33, v33
    v_exp_f32 v34, v34
    v_exp_f32 v35, v35
    v_exp_f32 v36, v36
    buffer_load_dwordx4 v[244:247], v135, s[24:27], s78 offen
    v_mfma_f32_32x32x16_bf16 v[192:207], v[88:91], v[52:55], v[192:207]
    v_exp_f32 v37, v37
    v_exp_f32 v38, v38
    v_exp_f32 v39, v39
    v_cvt_pk_bf16_f32 v48, v32, v33
    v_cvt_pk_bf16_f32 v49, v34, v35
    v_cvt_pk_bf16_f32 v50, v36, v37
    v_cvt_pk_bf16_f32 v51, v38, v39
    ds_read_b128 v[92:95], v3 offset:10560
    ds_read_b128 v[96:99], v3 offset:11232
    ds_read_b32 v10, v117
    v_mfma_f32_32x32x8_bf16 v[16:31], v[82:83], v[64:65], v[16:31]
    v_exp_f32 v40, v40
    v_exp_f32 v41, v41
    v_exp_f32 v42, v42
    v_exp_f32 v43, v43
    v_exp_f32 v44, v44
    v_mfma_f32_32x32x16_bf16 v[208:223], v[84:87], v[48:51], v[208:223]
    v_exp_f32 v45, v45
    v_exp_f32 v46, v46
    v_exp_f32 v47, v47
    v_cvt_pk_bf16_f32 v52, v40, v41
    v_cvt_pk_bf16_f32 v53, v42, v43
    v_cvt_pk_bf16_f32 v54, v44, v45
    v_cvt_pk_bf16_f32 v55, v46, v47
    s_waitcnt lgkmcnt(0)
A_T0_7:
    v_cmp_gt_u32 vcc, 7, v10
    v_cmp_ge_u32 s[74:75], 7, v10
    s_setprio 2
    s_cmp_lg_u32 vcc_lo, 0
    s_cbranch_scc1 A_T0_7S
A_T0_7R:
    s_cmp_eq_u32 s75, 0
    s_cbranch_scc1 A_T0_7H
    s_setprio 0
A_T0_7H:
    v_mfma_f32_32x32x16_bf16 v[32:47], v[72:75], v[60:63], 0
    v_exp_f32 v16, v16
    v_exp_f32 v17, v17
    v_exp_f32 v18, v18
    v_exp_f32 v19, v19
    v_exp_f32 v20, v20
    s_sub_u32 m0, s69, 28
    s_mov_b64 exec, 1
    global_load_lds_dword v1, s[38:39] offset:28
    s_mov_b64 exec, -1
    v_mfma_f32_32x32x16_bf16 v[208:223], v[88:91], v[52:55], v[208:223]
    v_exp_f32 v21, v21
    v_exp_f32 v22, v22
    v_exp_f32 v23, v23
    v_cvt_pk_bf16_f32 v48, v16, v17
    v_cvt_pk_bf16_f32 v49, v18, v19
    v_cvt_pk_bf16_f32 v50, v20, v21
    v_cvt_pk_bf16_f32 v51, v22, v23
    ds_read_b128 v[68:71], v4 offset:0
    ds_read_b128 v[76:79], v4 offset:2048
    v_mfma_f32_32x32x8_bf16 v[32:47], v[82:83], v[66:67], v[32:47]
    v_exp_f32 v24, v24
    v_exp_f32 v25, v25
    v_exp_f32 v26, v26
    v_exp_f32 v27, v27
    v_exp_f32 v28, v28
    v_mfma_f32_32x32x16_bf16 v[192:207], v[92:95], v[48:51], v[192:207]
    v_exp_f32 v29, v29
    v_exp_f32 v30, v30
    v_exp_f32 v31, v31
    v_cvt_pk_bf16_f32 v52, v24, v25
    v_cvt_pk_bf16_f32 v53, v26, v27
    v_cvt_pk_bf16_f32 v54, v28, v29
    v_cvt_pk_bf16_f32 v55, v30, v31
    s_waitcnt lgkmcnt(0)
    v_mfma_f32_32x32x16_bf16 v[16:31], v[68:71], v[56:59], 0
    v_exp_f32 v32, v32
    v_exp_f32 v33, v33
    v_exp_f32 v34, v34
    v_exp_f32 v35, v35
    v_exp_f32 v36, v36
    v_mfma_f32_32x32x16_bf16 v[192:207], v[96:99], v[52:55], v[192:207]
    v_exp_f32 v37, v37
    v_exp_f32 v38, v38
    v_exp_f32 v39, v39
    v_cvt_pk_bf16_f32 v48, v32, v33
    v_cvt_pk_bf16_f32 v49, v34, v35
    v_cvt_pk_bf16_f32 v50, v36, v37
    v_cvt_pk_bf16_f32 v51, v38, v39
    ds_read_b128 v[84:87], v5 offset:3072
    ds_read_b128 v[88:91], v5 offset:3744
    v_mfma_f32_32x32x8_bf16 v[16:31], v[76:77], v[64:65], v[16:31]
    v_exp_f32 v40, v40
    v_exp_f32 v41, v41
    v_exp_f32 v42, v42
    v_exp_f32 v43, v43
    v_exp_f32 v44, v44
    v_mfma_f32_32x32x16_bf16 v[208:223], v[92:95], v[48:51], v[208:223]
    v_exp_f32 v45, v45
    v_exp_f32 v46, v46
    v_exp_f32 v47, v47
    v_cvt_pk_bf16_f32 v52, v40, v41
    v_cvt_pk_bf16_f32 v53, v42, v43
    v_cvt_pk_bf16_f32 v54, v44, v45
    v_cvt_pk_bf16_f32 v55, v46, v47
    s_waitcnt lgkmcnt(0)
    v_mfma_f32_32x32x16_bf16 v[32:47], v[68:71], v[60:63], 0
    v_exp_f32 v16, v16
    v_exp_f32 v17, v17
    v_exp_f32 v18, v18
    v_exp_f32 v19, v19
    v_exp_f32 v20, v20
    buffer_load_dwordx4 v[248:251], v136, s[24:27], s78 offen
    v_mfma_f32_32x32x16_bf16 v[208:223], v[96:99], v[52:55], v[208:223]
    v_exp_f32 v21, v21
    v_exp_f32 v22, v22
    v_exp_f32 v23, v23
    v_cvt_pk_bf16_f32 v48, v16, v17
    v_cvt_pk_bf16_f32 v49, v18, v19
    v_cvt_pk_bf16_f32 v50, v20, v21
    v_cvt_pk_bf16_f32 v51, v22, v23
    ds_read_b128 v[72:75], v4 offset:1024
    v_mfma_f32_32x32x8_bf16 v[32:47], v[76:77], v[66:67], v[32:47]
    v_exp_f32 v24, v24
    v_exp_f32 v25, v25
    v_exp_f32 v26, v26
    v_exp_f32 v27, v27
    v_exp_f32 v28, v28
    v_mfma_f32_32x32x16_bf16 v[192:207], v[84:87], v[48:51], v[192:207]
    v_exp_f32 v29, v29
    v_exp_f32 v30, v30
    v_exp_f32 v31, v31
    v_cvt_pk_bf16_f32 v52, v24, v25
    v_cvt_pk_bf16_f32 v53, v26, v27
    v_cvt_pk_bf16_f32 v54, v28, v29
    v_cvt_pk_bf16_f32 v55, v30, v31
    s_waitcnt lgkmcnt(0)
    v_mfma_f32_32x32x16_bf16 v[16:31], v[72:75], v[56:59], 0
    v_exp_f32 v32, v32
    v_exp_f32 v33, v33
    v_exp_f32 v34, v34
    v_exp_f32 v35, v35
    v_exp_f32 v36, v36
    v_mfma_f32_32x32x16_bf16 v[192:207], v[88:91], v[52:55], v[192:207]
    v_exp_f32 v37, v37
    v_exp_f32 v38, v38
    v_exp_f32 v39, v39
    v_cvt_pk_bf16_f32 v48, v32, v33
    v_cvt_pk_bf16_f32 v49, v34, v35
    v_cvt_pk_bf16_f32 v50, v36, v37
    v_cvt_pk_bf16_f32 v51, v38, v39
    ds_read_b128 v[92:95], v5 offset:4416
    ds_read_b128 v[96:99], v5 offset:5088
    v_mfma_f32_32x32x8_bf16 v[16:31], v[78:79], v[64:65], v[16:31]
    v_exp_f32 v40, v40
    v_exp_f32 v41, v41
    v_exp_f32 v42, v42
    v_exp_f32 v43, v43
    v_exp_f32 v44, v44
    v_mfma_f32_32x32x16_bf16 v[208:223], v[84:87], v[48:51], v[208:223]
    v_exp_f32 v45, v45
    v_exp_f32 v46, v46
    v_exp_f32 v47, v47
    v_cvt_pk_bf16_f32 v52, v40, v41
    v_cvt_pk_bf16_f32 v53, v42, v43
    v_cvt_pk_bf16_f32 v54, v44, v45
    v_cvt_pk_bf16_f32 v55, v46, v47
    s_waitcnt lgkmcnt(0)
    v_mfma_f32_32x32x16_bf16 v[32:47], v[72:75], v[60:63], 0
    v_exp_f32 v16, v16
    v_exp_f32 v17, v17
    v_exp_f32 v18, v18
    v_exp_f32 v19, v19
    v_exp_f32 v20, v20
    v_mfma_f32_32x32x16_bf16 v[208:223], v[88:91], v[52:55], v[208:223]
    v_exp_f32 v21, v21
    v_exp_f32 v22, v22
    v_exp_f32 v23, v23
    v_cvt_pk_bf16_f32 v48, v16, v17
    v_cvt_pk_bf16_f32 v49, v18, v19
    v_cvt_pk_bf16_f32 v50, v20, v21
    v_cvt_pk_bf16_f32 v51, v22, v23
    ds_read_b128 v[68:71], v4 offset:6144
    ds_read_b128 v[80:83], v4 offset:8192
    v_mfma_f32_32x32x8_bf16 v[32:47], v[78:79], v[66:67], v[32:47]
    v_exp_f32 v24, v24
    v_exp_f32 v25, v25
    v_exp_f32 v26, v26
    v_exp_f32 v27, v27
    v_exp_f32 v28, v28
    v_mfma_f32_32x32x16_bf16 v[192:207], v[92:95], v[48:51], v[192:207]
    v_exp_f32 v29, v29
    v_exp_f32 v30, v30
    v_exp_f32 v31, v31
    v_cvt_pk_bf16_f32 v52, v24, v25
    v_cvt_pk_bf16_f32 v53, v26, v27
    v_cvt_pk_bf16_f32 v54, v28, v29
    v_cvt_pk_bf16_f32 v55, v30, v31
    s_waitcnt lgkmcnt(0)
    v_mfma_f32_32x32x16_bf16 v[16:31], v[68:71], v[56:59], 0
    v_exp_f32 v32, v32
    v_exp_f32 v33, v33
    v_exp_f32 v34, v34
    v_exp_f32 v35, v35
    v_exp_f32 v36, v36
    v_mfma_f32_32x32x16_bf16 v[192:207], v[96:99], v[52:55], v[192:207]
    v_exp_f32 v37, v37
    v_exp_f32 v38, v38
    v_exp_f32 v39, v39
    v_cvt_pk_bf16_f32 v48, v32, v33
    v_cvt_pk_bf16_f32 v49, v34, v35
    v_cvt_pk_bf16_f32 v50, v36, v37
    v_cvt_pk_bf16_f32 v51, v38, v39
    ds_read_b128 v[84:87], v5 offset:9216
    ds_read_b128 v[88:91], v5 offset:9888
    v_mfma_f32_32x32x8_bf16 v[16:31], v[80:81], v[64:65], v[16:31]
    v_exp_f32 v40, v40
    v_exp_f32 v41, v41
    v_exp_f32 v42, v42
    v_exp_f32 v43, v43
    v_exp_f32 v44, v44
    v_mfma_f32_32x32x16_bf16 v[208:223], v[92:95], v[48:51], v[208:223]
    v_exp_f32 v45, v45
    v_exp_f32 v46, v46
    v_exp_f32 v47, v47
    v_cvt_pk_bf16_f32 v52, v40, v41
    v_cvt_pk_bf16_f32 v53, v42, v43
    v_cvt_pk_bf16_f32 v54, v44, v45
    v_cvt_pk_bf16_f32 v55, v46, v47
    s_waitcnt lgkmcnt(0)
    v_mfma_f32_32x32x16_bf16 v[32:47], v[68:71], v[60:63], 0
    v_exp_f32 v16, v16
    v_exp_f32 v17, v17
    v_exp_f32 v18, v18
    v_exp_f32 v19, v19
    v_exp_f32 v20, v20
    v_mfma_f32_32x32x16_bf16 v[208:223], v[96:99], v[52:55], v[208:223]
    v_exp_f32 v21, v21
    v_exp_f32 v22, v22
    v_exp_f32 v23, v23
    v_cvt_pk_bf16_f32 v48, v16, v17
    v_cvt_pk_bf16_f32 v49, v18, v19
    v_cvt_pk_bf16_f32 v50, v20, v21
    v_cvt_pk_bf16_f32 v51, v22, v23
    ds_read_b128 v[72:75], v4 offset:7168
    v_mfma_f32_32x32x8_bf16 v[32:47], v[80:81], v[66:67], v[32:47]
    v_exp_f32 v24, v24
    v_exp_f32 v25, v25
    v_exp_f32 v26, v26
    v_exp_f32 v27, v27
    v_exp_f32 v28, v28
    v_mfma_f32_32x32x16_bf16 v[192:207], v[84:87], v[48:51], v[192:207]
    v_exp_f32 v29, v29
    v_exp_f32 v30, v30
    v_exp_f32 v31, v31
    v_cvt_pk_bf16_f32 v52, v24, v25
    v_cvt_pk_bf16_f32 v53, v26, v27
    v_cvt_pk_bf16_f32 v54, v28, v29
    v_cvt_pk_bf16_f32 v55, v30, v31
    s_waitcnt lgkmcnt(0)
    v_mfma_f32_32x32x16_bf16 v[16:31], v[72:75], v[56:59], 0
    v_exp_f32 v32, v32
    v_exp_f32 v33, v33
    v_exp_f32 v34, v34
    v_exp_f32 v35, v35
    v_exp_f32 v36, v36
    v_mfma_f32_32x32x16_bf16 v[192:207], v[88:91], v[52:55], v[192:207]
    v_exp_f32 v37, v37
    v_exp_f32 v38, v38
    v_exp_f32 v39, v39
    v_cvt_pk_bf16_f32 v48, v32, v33
    v_cvt_pk_bf16_f32 v49, v34, v35
    v_cvt_pk_bf16_f32 v50, v36, v37
    v_cvt_pk_bf16_f32 v51, v38, v39
    ds_read_b128 v[92:95], v5 offset:10560
    ds_read_b128 v[96:99], v5 offset:11232
    ds_read_b32 v10, v117
    v_mfma_f32_32x32x8_bf16 v[16:31], v[82:83], v[64:65], v[16:31]
    v_exp_f32 v40, v40
    v_exp_f32 v41, v41
    v_exp_f32 v42, v42
    v_exp_f32 v43, v43
    v_exp_f32 v44, v44
    v_mfma_f32_32x32x16_bf16 v[208:223], v[84:87], v[48:51], v[208:223]
    v_exp_f32 v45, v45
    v_exp_f32 v46, v46
    v_exp_f32 v47, v47
    v_cvt_pk_bf16_f32 v52, v40, v41
    v_cvt_pk_bf16_f32 v53, v42, v43
    v_cvt_pk_bf16_f32 v54, v44, v45
    v_cvt_pk_bf16_f32 v55, v46, v47
    s_waitcnt lgkmcnt(0)
A_T0_8:
    v_cmp_gt_u32 vcc, 8, v10
    v_cmp_ge_u32 s[74:75], 8, v10
    s_setprio 2
    s_cmp_lg_u32 vcc_lo, 0
    s_cbranch_scc1 A_T0_8S
A_T0_8R:
    s_cmp_eq_u32 s75, 0
    s_cbranch_scc1 A_T0_8H
    s_setprio 0
A_T0_8H:
    v_mfma_f32_32x32x16_bf16 v[32:47], v[72:75], v[60:63], 0
    v_exp_f32 v16, v16
    v_exp_f32 v17, v17
    v_exp_f32 v18, v18
    v_exp_f32 v19, v19
    v_exp_f32 v20, v20
    s_sub_u32 m0, s69, 32
    s_mov_b64 exec, 1
    global_load_lds_dword v1, s[38:39] offset:32
    s_mov_b64 exec, -1
    v_mfma_f32_32x32x16_bf16 v[208:223], v[88:91], v[52:55], v[208:223]
    v_exp_f32 v21, v21
    v_exp_f32 v22, v22
    v_exp_f32 v23, v23
    v_cvt_pk_bf16_f32 v48, v16, v17
    v_cvt_pk_bf16_f32 v49, v18, v19
    v_cvt_pk_bf16_f32 v50, v20, v21
    v_cvt_pk_bf16_f32 v51, v22, v23
    v_mfma_f32_32x32x8_bf16 v[32:47], v[82:83], v[66:67], v[32:47]
    v_exp_f32 v24, v24
    v_exp_f32 v25, v25
    v_exp_f32 v26, v26
    v_exp_f32 v27, v27
    v_exp_f32 v28, v28
    v_mfma_f32_32x32x16_bf16 v[192:207], v[92:95], v[48:51], v[192:207]
    v_exp_f32 v29, v29
    v_exp_f32 v30, v30
    v_exp_f32 v31, v31
    v_cvt_pk_bf16_f32 v52, v24, v25
    v_cvt_pk_bf16_f32 v53, v26, v27
    v_cvt_pk_bf16_f32 v54, v28, v29
    v_cvt_pk_bf16_f32 v55, v30, v31
    s_waitcnt lgkmcnt(0)
    v_exp_f32 v32, v32
    v_exp_f32 v33, v33
    v_exp_f32 v34, v34
    v_exp_f32 v35, v35
    v_exp_f32 v36, v36
    v_mfma_f32_32x32x16_bf16 v[192:207], v[96:99], v[52:55], v[192:207]
    v_exp_f32 v37, v37
    v_exp_f32 v38, v38
    v_exp_f32 v39, v39
    v_cvt_pk_bf16_f32 v48, v32, v33
    v_cvt_pk_bf16_f32 v49, v34, v35
    v_cvt_pk_bf16_f32 v50, v36, v37
    v_cvt_pk_bf16_f32 v51, v38, v39
    v_exp_f32 v40, v40
    v_exp_f32 v41, v41
    v_exp_f32 v42, v42
    v_exp_f32 v43, v43
    v_exp_f32 v44, v44
    v_mfma_f32_32x32x16_bf16 v[208:223], v[92:95], v[48:51], v[208:223]
    v_exp_f32 v45, v45
    v_exp_f32 v46, v46
    v_exp_f32 v47, v47
    v_cvt_pk_bf16_f32 v52, v40, v41
    v_cvt_pk_bf16_f32 v53, v42, v43
    v_cvt_pk_bf16_f32 v54, v44, v45
    v_cvt_pk_bf16_f32 v55, v46, v47
    s_setprio 2
    s_nop 0
    v_mfma_f32_32x32x16_bf16 v[208:223], v[96:99], v[52:55], v[208:223]
    s_mul_i32 s72, s5, 10240
    s_add_u32 s72, s72, s32
    s_lshl_b32 s71, s2, 7
    s_waitcnt vmcnt(1)
    s_nop 9
    ds_write_b128 v126, v[208:211] offset:0
    ds_write_b128 v126, v[212:215] offset:1024
    ds_write_b128 v126, v[216:219] offset:2048
    ds_write_b32 v128, v220
    s_waitcnt lgkmcnt(0)
    s_barrier
    ds_read_b32 v220, v129
    ds_read_b128 v[208:211], v127 offset:0
    ds_read_b128 v[212:215], v127 offset:1024
    ds_read_b128 v[216:219], v127 offset:2048
    s_mov_b32 s6, 0x21800000
    s_mov_b32 s7, 0x6c800000
    s_waitcnt lgkmcnt(3)
    v_add_f32 v24, v204, v220
    v_rcp_f32 v26, v24
    v_cmp_nlt_f32 vcc, s6, v24
    v_cmp_ngt_f32 s[74:75], s7, v24
    s_waitcnt lgkmcnt(0)
    v_pk_add_f32 v[84:85], v[192:193], v[208:209]
    v_pk_add_f32 v[86:87], v[194:195], v[210:211]
    v_pk_add_f32 v[88:89], v[196:197], v[212:213]
    v_pk_add_f32 v[90:91], v[198:199], v[214:215]
    v_pk_add_f32 v[92:93], v[200:201], v[216:217]
    v_pk_add_f32 v[94:95], v[202:203], v[218:219]
    s_or_b64 vcc, vcc, s[74:75]
    s_cbranch_scc1 FB0
FB_RET0:
    v_mul_f32 v26, v26, v12
    s_mul_i32 s6, s90, 5120
    v_add_u32 v13, s6, v1
    v_pk_mul_f32 v[84:85], v[84:85], v[26:27] op_sel_hi:[1,0]
    v_pk_mul_f32 v[86:87], v[86:87], v[26:27] op_sel_hi:[1,0]
    v_pk_mul_f32 v[88:89], v[88:89], v[26:27] op_sel_hi:[1,0]
    v_pk_mul_f32 v[90:91], v[90:91], v[26:27] op_sel_hi:[1,0]
    v_pk_mul_f32 v[92:93], v[92:93], v[26:27] op_sel_hi:[1,0]
    v_pk_mul_f32 v[94:95], v[94:95], v[26:27] op_sel_hi:[1,0]
    v_cvt_pk_bf16_f32 v48, v84, v85
    v_cvt_pk_bf16_f32 v49, v86, v87
    v_cvt_pk_bf16_f32 v50, v88, v89
    v_cvt_pk_bf16_f32 v51, v90, v91
    v_cvt_pk_bf16_f32 v52, v92, v93
    v_cvt_pk_bf16_f32 v53, v94, v95
    buffer_store_dwordx4 v[48:51], v130, s[20:23], s72 offen sc1
    buffer_store_dwordx2 v[52:53], v131, s[20:23], s72 offen sc1
    s_cmp_eq_u32 s3, 3
    s_cselect_b32 s6, 37376, 0
    v_add_u32 v14, s6, v13
    v_mov_b32 v15, v13
    v_lshrrev_b32 v21, 16, v236
    v_or_b32 v236, v236, v21
    v_and_b32 v212, v232, v236
    v_and_b32 v213, v233, v236
    v_and_b32 v214, v234, v236
    v_and_b32 v215, v235, v236
    v_add_u32 v16, 65536, v224
    v_add_u32 v17, 65536, v225
    v_add_u32 v18, 131072, v224
    v_add_u32 v19, 131072, v225
    s_mul_i32 s73, s4, 81920
    s_mul_i32 s6, s5, 160
    s_add_u32 s73, s73, s6
    s_lshl_b32 s79, s37, 13
    v_and_b32 v2, 7, v0
    v_lshlrev_b32 v3, 12, v2
    v_min_u32 v2, 4, v2
    v_lshlrev_b32 v2, 2, v2
    v_add_u32 v2, 163600, v2
    v_and_b32 v4, 3, v0
    v_lshlrev_b32 v4, 2, v4
    v_add_u32 v4, 163648, v4
    v_mov_b32 v5, 163476
    v_mov_b32 v6, 1
    v_add_u32 v13, 117504, v13
    s_and_b32 s76, s71, 0xf80
    s_add_u32 s76, s76, 9502720
    s_mul_i32 s6, s3, 3072
    s_add_u32 s6, s6, 24576
    v_and_b32 v8, 15, v0
    v_mul_u32_u24 v8, 160, v8
    v_lshrrev_b32 v9, 4, v0
    v_mad_u32_u24 v8, v9, 40, v8
    v_add_u32 v8, s6, v8
    v_add_u32 v9, s6, v1
    s_mul_i32 s6, s3, 20480
    v_add_u32 v20, 0, v0
    v_mul_u32_u24 v21, 0x199a, v20
    v_lshrrev_b32 v21, 16, v21
    v_mul_u32_u24 v22, 1120, v21
    v_lshl_add_u32 v10, v20, 4, v22
    v_add_u32 v10, s6, v10
    v_add_u32 v20, 64, v0
    v_mul_u32_u24 v21, 0x199a, v20
    v_lshrrev_b32 v21, 16, v21
    v_mul_u32_u24 v22, 1120, v21
    v_lshl_add_u32 v11, v20, 4, v22
    v_add_u32 v11, s6, v11
    v_add_u32 v20, 128, v0
    v_mul_u32_u24 v21, 0x199a, v20
    v_lshrrev_b32 v21, 16, v21
    v_mul_u32_u24 v22, 1120, v21
    v_lshl_add_u32 v12, v20, 4, v22
    v_add_u32 v12, s6, v12
    v_lshrrev_b32 v20, 5, v0
    v_lshl_or_b32 v12, v20, 30, v12
    s_waitcnt vmcnt(0)
    v_mov_b32 v20, 163476
    v_mov_b32 v21, 1
    s_mov_b64 exec, 1
    ds_add_rtn_u32 v22, v20, v21
    v_mov_b32 v20, 9502720
    v_mov_b32 v21, s36
    s_waitcnt lgkmcnt(0)
    v_cmp_eq_u32 vcc, 7, v22
    s_nop 0
    s_cbranch_vccz PUB_48
    buffer_store_dword v21, v20, s[20:23], s71 offen sc1
PUB_48:
    s_mov_b64 exec, -1
    s_setprio 0
    s_cmp_eq_u32 s3, 0
    s_cbranch_scc1 T_P0
    v_subrev_u32 v23, 16, v4
    s_mov_b32 s7, 0x40000
LP_49:
    s_sleep 1
    ds_read_b32 v7, v23 offset:0
    s_sub_u32 s7, s7, 1
    s_waitcnt lgkmcnt(0)
    v_cmp_gt_u32 vcc, 1, v7
    s_cbranch_scc1 LPD_50
    s_cbranch_vccnz LP_49
LPD_50:
    ds_write_b128 v15, v[140:143] offset:40704
    ds_write_b128 v15, v[144:147] offset:41728
    ds_write_b128 v15, v[148:151] offset:42752
    ds_write_b128 v15, v[152:155] offset:43776
    ds_write_b128 v15, v[156:159] offset:44800
    ds_write_b128 v14, v[160:163] offset:8448
    ds_write_b128 v14, v[164:167] offset:9472
    ds_write_b128 v14, v[168:171] offset:10496
    ds_write_b128 v14, v[172:175] offset:11520
    ds_write_b128 v14, v[176:179] offset:12544
    s_mov_b32 s7, 0x40000
LP_51:
    s_sleep 1
    ds_read_b32 v7, v5 offset:0
    s_sub_u32 s7, s7, 1
    s_waitcnt lgkmcnt(0)
    v_cmp_gt_u32 vcc, 8, v7
    s_cbranch_scc1 LPD_52
    s_cbranch_vccnz LP_51
LPD_52:
    ds_write_b128 v13, v[180:183] offset:0
    ds_write_b128 v13, v[184:187] offset:1024
    ds_write_b128 v13, v[188:191] offset:2048
    ds_write_b128 v13, v[100:103] offset:3072
    ds_write_b128 v13, v[104:107] offset:4096
    ds_write_b128 v13, v[108:111] offset:20480
    ds_write_b128 v13, v[112:115] offset:21504
    ds_write_b128 v13, v[240:243] offset:22528
    ds_write_b128 v13, v[244:247] offset:23552
    ds_write_b128 v13, v[248:251] offset:24576
    ds_write_b32 v120, v6 offset:80
    s_mov_b32 s7, 0x40000
LP_53:
    s_sleep 1
    ds_read_b32 v7, v5 offset:140
    s_sub_u32 s7, s7, 1
    s_waitcnt lgkmcnt(0)
    v_cmp_gt_u32 vcc, 1, v7
    s_cbranch_scc1 LPD_54
    s_cbranch_vccnz LP_53
LPD_54:
    s_branch T_NP
T_P0:
    s_setprio 2
    s_mov_b32 s7, 0x40000
LP_55:
    s_sleep 1
    ds_read_b32 v7, v5 offset:0
    s_sub_u32 s7, s7, 1
    s_waitcnt lgkmcnt(0)
    v_cmp_gt_u32 vcc, 8, v7
    s_cbranch_scc1 LPD_56
    s_cbranch_vccnz LP_55
LPD_56:
    s_mov_b32 s7, 0x4000
    s_mov_b64 exec, 0xff
T_SP:
    buffer_load_dword v21, v3, s[20:23], s76 offen sc1
    s_waitcnt vmcnt(0)
    v_cmp_ne_u32 vcc, s36, v21
    s_sub_u32 s7, s7, 1
    s_cbranch_scc1 T_SPD
    s_cbranch_vccz T_SPD
    s_mov_b64 exec, vcc
    s_sleep 1
    s_branch T_SP
T_SPD:
    s_mov_b64 exec, -1
    ds_write_b32 v5, v6 offset:140
T_NP:
    s_add_u32 s80, s79, s32
    s_add_u32 s81, s80, 4096
    buffer_load_dwordx4 v[24:27], v230, s[20:23], s80 offen sc1
    buffer_load_dwordx4 v[28:31], v230, s[20:23], s81 offen sc1
    s_add_u32 s79, s79, 8192
    s_cmp_eq_u32 s79, 81920
    s_cselect_b32 s79, 0, s79
    s_add_u32 s80, s79, s32
    s_add_u32 s81, s80, 4096
    buffer_load_dwordx4 v[32:35], v230, s[20:23], s80 offen sc1
    buffer_load_dwordx4 v[36:39], v230, s[20:23], s81 offen sc1
    s_add_u32 s79, s79, 8192
    s_cmp_eq_u32 s79, 81920
    s_cselect_b32 s79, 0, s79
    s_add_u32 s80, s79, s32
    s_add_u32 s81, s80, 4096
    buffer_load_dwordx4 v[40:43], v230, s[20:23], s80 offen sc1
    buffer_load_dwordx4 v[44:47], v230, s[20:23], s81 offen sc1
    s_add_u32 s79, s79, 8192
    s_cmp_eq_u32 s79, 81920
    s_cselect_b32 s79, 0, s79
    s_add_u32 s80, s79, s32
    s_add_u32 s81, s80, 4096
    buffer_load_dwordx4 v[48:51], v230, s[20:23], s80 offen sc1
    buffer_load_dwordx4 v[52:55], v230, s[20:23], s81 offen sc1
    s_add_u32 s79, s79, 8192
    s_cmp_eq_u32 s79, 81920
    s_cselect_b32 s79, 0, s79
    s_cmp_lg_u32 s3, 0
    s_cbranch_scc1 T_NA
    s_setprio 0
    v_subrev_u32 v23, 16, v4
    s_mov_b32 s7, 0x40000
LP_57:
    s_sleep 1
    ds_read_b32 v7, v23 offset:0
    s_sub_u32 s7, s7, 1
    s_waitcnt lgkmcnt(0)
    v_cmp_gt_u32 vcc, 1, v7
    s_cbranch_scc1 LPD_58
    s_cbranch_vccnz LP_57
LPD_58:
    ds_write_b128 v15, v[140:143] offset:40704
    ds_write_b128 v15, v[144:147] offset:41728
    ds_write_b128 v15, v[148:151] offset:42752
    ds_write_b128 v15, v[152:155] offset:43776
    ds_write_b128 v15, v[156:159] offset:44800
    ds_write_b128 v14, v[160:163] offset:8448
    ds_write_b128 v14, v[164:167] offset:9472
    ds_write_b128 v14, v[168:171] offset:10496
    ds_write_b128 v14, v[172:175] offset:11520
    ds_write_b128 v14, v[176:179] offset:12544
    ds_write_b128 v13, v[180:183] offset:0
    ds_write_b128 v13, v[184:187] offset:1024
    ds_write_b128 v13, v[188:191] offset:2048
    ds_write_b128 v13, v[100:103] offset:3072
    ds_write_b128 v13, v[104:107] offset:4096
    ds_write_b128 v13, v[108:111] offset:20480
    ds_write_b128 v13, v[112:115] offset:21504
    ds_write_b128 v13, v[240:243] offset:22528
    ds_write_b128 v13, v[244:247] offset:23552
    ds_write_b128 v13, v[248:251] offset:24576
    ds_write_b32 v120, v6 offset:80
T_NA:
    s_mov_b32 s7, 0x40000
LP_59:
    s_sleep 1
    ds_read_b32 v7, v2 offset:0
    s_sub_u32 s7, s7, 1
    s_waitcnt lgkmcnt(0)
    v_cmp_gt_u32 vcc, 1, v7
    s_cbranch_scc1 LPD_60
    s_cbranch_vccnz LP_59
LPD_60:
    ds_read_b64_tr_b16 v[124:125], v224 offset:40704
    ds_read_b64_tr_b16 v[126:127], v225 offset:40704
    ds_read_b64_tr_b16 v[128:129], v224 offset:40712
    ds_read_b64_tr_b16 v[130:131], v225 offset:40712
    ds_read_b64_tr_b16 v[132:133], v224 offset:40720
    ds_read_b64_tr_b16 v[134:135], v225 offset:40720
    ds_read_b64_tr_b16 v[136:137], v224 offset:40728
    ds_read_b64_tr_b16 v[138:139], v225 offset:40728
    ds_read_b64_tr_b16 v[140:141], v224 offset:40736
    ds_read_b64_tr_b16 v[142:143], v225 offset:40736
    ds_read_b64_tr_b16 v[144:145], v224 offset:45824
    ds_read_b64_tr_b16 v[146:147], v225 offset:45824
    ds_read_b64_tr_b16 v[148:149], v224 offset:45832
    ds_read_b64_tr_b16 v[150:151], v225 offset:45832
    ds_read_b64_tr_b16 v[152:153], v224 offset:45840
    ds_read_b64_tr_b16 v[154:155], v225 offset:45840
    ds_read_b64_tr_b16 v[156:157], v224 offset:45848
    ds_read_b64_tr_b16 v[158:159], v225 offset:45848
    ds_read_b64_tr_b16 v[160:161], v224 offset:45856
    ds_read_b64_tr_b16 v[162:163], v225 offset:45856
    s_waitcnt vmcnt(7) lgkmcnt(10)
    v_mfma_f32_16x16x32_bf16 v[104:107], v[124:127], v[24:27], 0
    ds_read_b64_tr_b16 v[164:165], v224 offset:50944
    ds_read_b64_tr_b16 v[166:167], v225 offset:50944
    s_add_u32 s80, s79, s32
    s_add_u32 s81, s80, 4096
    buffer_load_dwordx4 v[56:59], v230, s[20:23], s80 offen sc1
    v_mfma_f32_16x16x32_bf16 v[108:111], v[128:131], v[24:27], 0
    ds_read_b64_tr_b16 v[168:169], v224 offset:50952
    ds_read_b64_tr_b16 v[170:171], v225 offset:50952
    v_mfma_f32_16x16x32_bf16 v[112:115], v[132:135], v[24:27], 0
    ds_read_b64_tr_b16 v[172:173], v224 offset:50960
    ds_read_b64_tr_b16 v[174:175], v225 offset:50960
    buffer_load_dwordx4 v[60:63], v230, s[20:23], s81 offen sc1
    s_add_u32 s79, s79, 8192
    s_cmp_eq_u32 s79, 81920
    s_cselect_b32 s79, 0, s79
    v_mfma_f32_16x16x32_bf16 v[116:119], v[136:139], v[24:27], 0
    ds_read_b64_tr_b16 v[176:177], v224 offset:50968
    ds_read_b64_tr_b16 v[178:179], v225 offset:50968
    v_mfma_f32_16x16x32_bf16 v[120:123], v[140:143], v[24:27], 0
    ds_read_b64_tr_b16 v[180:181], v224 offset:50976
    ds_read_b64_tr_b16 v[182:183], v225 offset:50976
    s_waitcnt vmcnt(8) lgkmcnt(10)
    v_mfma_f32_16x16x32_bf16 v[104:107], v[144:147], v[28:31], v[104:107]
    ds_read_b64_tr_b16 v[124:125], v224 offset:56064
    ds_read_b64_tr_b16 v[126:127], v225 offset:56064
    s_add_u32 s80, s79, s32
    s_add_u32 s81, s80, 4096
    buffer_load_dwordx4 v[64:67], v230, s[20:23], s80 offen sc1
    v_mfma_f32_16x16x32_bf16 v[108:111], v[148:151], v[28:31], v[108:111]
    ds_read_b64_tr_b16 v[128:129], v224 offset:56072
    ds_read_b64_tr_b16 v[130:131], v225 offset:56072
    v_mfma_f32_16x16x32_bf16 v[112:115], v[152:155], v[28:31], v[112:115]
    ds_read_b64_tr_b16 v[132:133], v224 offset:56080
    ds_read_b64_tr_b16 v[134:135], v225 offset:56080
    buffer_load_dwordx4 v[68:71], v230, s[20:23], s81 offen sc1
    s_add_u32 s79, s79, 8192
    s_cmp_eq_u32 s79, 81920
    s_cselect_b32 s79, 0, s79
    v_mfma_f32_16x16x32_bf16 v[116:119], v[156:159], v[28:31], v[116:119]
    ds_read_b64_tr_b16 v[136:137], v224 offset:56088
    ds_read_b64_tr_b16 v[138:139], v225 offset:56088
    v_mfma_f32_16x16x32_bf16 v[120:123], v[160:163], v[28:31], v[120:123]
    ds_read_b64_tr_b16 v[140:141], v224 offset:56096
    ds_read_b64_tr_b16 v[142:143], v225 offset:56096
    s_waitcnt vmcnt(9) lgkmcnt(10)
    v_mfma_f32_16x16x32_bf16 v[104:107], v[164:167], v[32:35], v[104:107]
    ds_read_b64_tr_b16 v[144:145], v224 offset:8448
    ds_read_b64_tr_b16 v[146:147], v225 offset:8448
    s_add_u32 s80, s79, s32
    s_add_u32 s81, s80, 4096
    buffer_load_dwordx4 v[72:75], v230, s[20:23], s80 offen sc1
    v_mfma_f32_16x16x32_bf16 v[108:111], v[168:171], v[32:35], v[108:111]
    ds_read_b64_tr_b16 v[148:149], v224 offset:8456
    ds_read_b64_tr_b16 v[150:151], v225 offset:8456
    v_mfma_f32_16x16x32_bf16 v[112:115], v[172:175], v[32:35], v[112:115]
    ds_read_b64_tr_b16 v[152:153], v224 offset:8464
    ds_read_b64_tr_b16 v[154:155], v225 offset:8464
    buffer_load_dwordx4 v[76:79], v230, s[20:23], s81 offen sc1
    s_add_u32 s79, s79, 8192
    s_cmp_eq_u32 s79, 81920
    s_cselect_b32 s79, 0, s79
    v_mfma_f32_16x16x32_bf16 v[116:119], v[176:179], v[32:35], v[116:119]
    ds_read_b64_tr_b16 v[156:157], v224 offset:8472
    ds_read_b64_tr_b16 v[158:159], v225 offset:8472
    v_mfma_f32_16x16x32_bf16 v[120:123], v[180:183], v[32:35], v[120:123]
    ds_read_b64_tr_b16 v[160:161], v224 offset:8480
    ds_read_b64_tr_b16 v[162:163], v225 offset:8480
    s_waitcnt vmcnt(10) lgkmcnt(10)
    v_mfma_f32_16x16x32_bf16 v[104:107], v[124:127], v[36:39], v[104:107]
    ds_read_b64_tr_b16 v[164:165], v224 offset:13568
    ds_read_b64_tr_b16 v[166:167], v225 offset:13568
    s_add_u32 s80, s79, s32
    s_add_u32 s81, s80, 4096
    buffer_load_dwordx4 v[80:83], v230, s[20:23], s80 offen sc1
    v_mfma_f32_16x16x32_bf16 v[108:111], v[128:131], v[36:39], v[108:111]
    ds_read_b64_tr_b16 v[168:169], v224 offset:13576
    ds_read_b64_tr_b16 v[170:171], v225 offset:13576
    v_mfma_f32_16x16x32_bf16 v[112:115], v[132:135], v[36:39], v[112:115]
    ds_read_b64_tr_b16 v[172:173], v224 offset:13584
    ds_read_b64_tr_b16 v[174:175], v225 offset:13584
    buffer_load_dwordx4 v[84:87], v230, s[20:23], s81 offen sc1
    s_add_u32 s79, s79, 8192
    s_cmp_eq_u32 s79, 81920
    s_cselect_b32 s79, 0, s79
    v_mfma_f32_16x16x32_bf16 v[116:119], v[136:139], v[36:39], v[116:119]
    ds_read_b64_tr_b16 v[176:177], v224 offset:13592
    ds_read_b64_tr_b16 v[178:179], v225 offset:13592
    v_mfma_f32_16x16x32_bf16 v[120:123], v[140:143], v[36:39], v[120:123]
    ds_read_b64_tr_b16 v[180:181], v224 offset:13600
    ds_read_b64_tr_b16 v[182:183], v225 offset:13600
    s_waitcnt vmcnt(11) lgkmcnt(10)
    v_mfma_f32_16x16x32_bf16 v[104:107], v[144:147], v[40:43], v[104:107]
    ds_read_b64_tr_b16 v[124:125], v224 offset:18688
    ds_read_b64_tr_b16 v[126:127], v225 offset:18688
    s_add_u32 s80, s79, s32
    s_add_u32 s81, s80, 4096
    buffer_load_dwordx4 v[88:91], v230, s[20:23], s80 offen sc1
    v_mfma_f32_16x16x32_bf16 v[108:111], v[148:151], v[40:43], v[108:111]
    ds_read_b64_tr_b16 v[128:129], v224 offset:18696
    ds_read_b64_tr_b16 v[130:131], v225 offset:18696
    v_mfma_f32_16x16x32_bf16 v[112:115], v[152:155], v[40:43], v[112:115]
    ds_read_b64_tr_b16 v[132:133], v224 offset:18704
    ds_read_b64_tr_b16 v[134:135], v225 offset:18704
    buffer_load_dwordx4 v[92:95], v230, s[20:23], s81 offen sc1
    s_add_u32 s79, s79, 8192
    s_cmp_eq_u32 s79, 81920
    s_cselect_b32 s79, 0, s79
    v_mfma_f32_16x16x32_bf16 v[116:119], v[156:159], v[40:43], v[116:119]
    ds_read_b64_tr_b16 v[136:137], v224 offset:18712
    ds_read_b64_tr_b16 v[138:139], v225 offset:18712
    v_mfma_f32_16x16x32_bf16 v[120:123], v[160:163], v[40:43], v[120:123]
    ds_read_b64_tr_b16 v[140:141], v224 offset:18720
    ds_read_b64_tr_b16 v[142:143], v225 offset:18720
    s_waitcnt vmcnt(12) lgkmcnt(10)
    v_mfma_f32_16x16x32_bf16 v[104:107], v[164:167], v[44:47], v[104:107]
    ds_read_b64_tr_b16 v[144:145], v224 offset:61184
    ds_read_b64_tr_b16 v[146:147], v225 offset:61184
    s_add_u32 s80, s79, s32
    s_add_u32 s81, s80, 4096
    buffer_load_dwordx4 v[96:99], v230, s[20:23], s80 offen sc1
    v_mfma_f32_16x16x32_bf16 v[108:111], v[168:171], v[44:47], v[108:111]
    ds_read_b64_tr_b16 v[148:149], v224 offset:61192
    ds_read_b64_tr_b16 v[150:151], v225 offset:61192
    v_mfma_f32_16x16x32_bf16 v[112:115], v[172:175], v[44:47], v[112:115]
    ds_read_b64_tr_b16 v[152:153], v224 offset:61200
    ds_read_b64_tr_b16 v[154:155], v225 offset:61200
    buffer_load_dwordx4 v[100:103], v230, s[20:23], s81 offen sc1
    s_add_u32 s79, s79, 8192
    s_cmp_eq_u32 s79, 81920
    s_cselect_b32 s79, 0, s79
    v_mfma_f32_16x16x32_bf16 v[116:119], v[176:179], v[44:47], v[116:119]
    ds_read_b64_tr_b16 v[156:157], v224 offset:61208
    ds_read_b64_tr_b16 v[158:159], v225 offset:61208
    v_mfma_f32_16x16x32_bf16 v[120:123], v[180:183], v[44:47], v[120:123]
    ds_read_b64_tr_b16 v[160:161], v224 offset:61216
    ds_read_b64_tr_b16 v[162:163], v225 offset:61216
    s_waitcnt vmcnt(13) lgkmcnt(10)
    v_mfma_f32_16x16x32_bf16 v[104:107], v[124:127], v[48:51], v[104:107]
    ds_read_b64_tr_b16 v[164:165], v16 offset:51968
    ds_read_b64_tr_b16 v[166:167], v17 offset:51968
    v_mfma_f32_16x16x32_bf16 v[108:111], v[128:131], v[48:51], v[108:111]
    ds_read_b64_tr_b16 v[168:169], v16 offset:51976
    ds_read_b64_tr_b16 v[170:171], v17 offset:51976
    v_mfma_f32_16x16x32_bf16 v[112:115], v[132:135], v[48:51], v[112:115]
    ds_read_b64_tr_b16 v[172:173], v16 offset:51984
    ds_read_b64_tr_b16 v[174:175], v17 offset:51984
    v_mfma_f32_16x16x32_bf16 v[116:119], v[136:139], v[48:51], v[116:119]
    ds_read_b64_tr_b16 v[176:177], v16 offset:51992
    ds_read_b64_tr_b16 v[178:179], v17 offset:51992
    v_mfma_f32_16x16x32_bf16 v[120:123], v[140:143], v[48:51], v[120:123]
    ds_read_b64_tr_b16 v[180:181], v16 offset:52000
    ds_read_b64_tr_b16 v[182:183], v17 offset:52000
    s_waitcnt vmcnt(12) lgkmcnt(10)
    v_mfma_f32_16x16x32_bf16 v[104:107], v[144:147], v[52:55], v[104:107]
    ds_read_b64_tr_b16 v[124:125], v16 offset:57088
    ds_read_b64_tr_b16 v[126:127], v17 offset:57088
    v_mfma_f32_16x16x32_bf16 v[108:111], v[148:151], v[52:55], v[108:111]
    ds_read_b64_tr_b16 v[128:129], v16 offset:57096
    ds_read_b64_tr_b16 v[130:131], v17 offset:57096
    v_mfma_f32_16x16x32_bf16 v[112:115], v[152:155], v[52:55], v[112:115]
    ds_read_b64_tr_b16 v[132:133], v16 offset:57104
    ds_read_b64_tr_b16 v[134:135], v17 offset:57104
    v_mfma_f32_16x16x32_bf16 v[116:119], v[156:159], v[52:55], v[116:119]
    ds_read_b64_tr_b16 v[136:137], v16 offset:57112
    ds_read_b64_tr_b16 v[138:139], v17 offset:57112
    v_mfma_f32_16x16x32_bf16 v[120:123], v[160:163], v[52:55], v[120:123]
    ds_read_b64_tr_b16 v[140:141], v16 offset:57120
    ds_read_b64_tr_b16 v[142:143], v17 offset:57120
    s_waitcnt vmcnt(11) lgkmcnt(10)
    v_mfma_f32_16x16x32_bf16 v[104:107], v[164:167], v[56:59], v[104:107]
    ds_read_b64_tr_b16 v[144:145], v16 offset:62208
    ds_read_b64_tr_b16 v[146:147], v17 offset:62208
    v_mfma_f32_16x16x32_bf16 v[108:111], v[168:171], v[56:59], v[108:111]
    ds_read_b64_tr_b16 v[148:149], v16 offset:62216
    ds_read_b64_tr_b16 v[150:151], v17 offset:62216
    v_mfma_f32_16x16x32_bf16 v[112:115], v[172:175], v[56:59], v[112:115]
    ds_read_b64_tr_b16 v[152:153], v16 offset:62224
    ds_read_b64_tr_b16 v[154:155], v17 offset:62224
    v_mfma_f32_16x16x32_bf16 v[116:119], v[176:179], v[56:59], v[116:119]
    ds_read_b64_tr_b16 v[156:157], v16 offset:62232
    ds_read_b64_tr_b16 v[158:159], v17 offset:62232
    v_mfma_f32_16x16x32_bf16 v[120:123], v[180:183], v[56:59], v[120:123]
    ds_read_b64_tr_b16 v[160:161], v16 offset:62240
    ds_read_b64_tr_b16 v[162:163], v17 offset:62240
    s_waitcnt vmcnt(10) lgkmcnt(10)
    v_mfma_f32_16x16x32_bf16 v[104:107], v[124:127], v[60:63], v[104:107]
    ds_read_b64_tr_b16 v[164:165], v18 offset:1792
    ds_read_b64_tr_b16 v[166:167], v19 offset:1792
    v_mfma_f32_16x16x32_bf16 v[108:111], v[128:131], v[60:63], v[108:111]
    ds_read_b64_tr_b16 v[168:169], v18 offset:1800
    ds_read_b64_tr_b16 v[170:171], v19 offset:1800
    v_mfma_f32_16x16x32_bf16 v[112:115], v[132:135], v[60:63], v[112:115]
    ds_read_b64_tr_b16 v[172:173], v18 offset:1808
    ds_read_b64_tr_b16 v[174:175], v19 offset:1808
    v_mfma_f32_16x16x32_bf16 v[116:119], v[136:139], v[60:63], v[116:119]
    ds_read_b64_tr_b16 v[176:177], v18 offset:1816
    ds_read_b64_tr_b16 v[178:179], v19 offset:1816
    v_mfma_f32_16x16x32_bf16 v[120:123], v[140:143], v[60:63], v[120:123]
    ds_read_b64_tr_b16 v[180:181], v18 offset:1824
    ds_read_b64_tr_b16 v[182:183], v19 offset:1824
    s_waitcnt vmcnt(9) lgkmcnt(10)
    v_mfma_f32_16x16x32_bf16 v[104:107], v[144:147], v[64:67], v[104:107]
    ds_read_b64_tr_b16 v[124:125], v18 offset:6912
    ds_read_b64_tr_b16 v[126:127], v19 offset:6912
    v_mfma_f32_16x16x32_bf16 v[108:111], v[148:151], v[64:67], v[108:111]
    ds_read_b64_tr_b16 v[128:129], v18 offset:6920
    ds_read_b64_tr_b16 v[130:131], v19 offset:6920
    v_mfma_f32_16x16x32_bf16 v[112:115], v[152:155], v[64:67], v[112:115]
    ds_read_b64_tr_b16 v[132:133], v18 offset:6928
    ds_read_b64_tr_b16 v[134:135], v19 offset:6928
    v_mfma_f32_16x16x32_bf16 v[116:119], v[156:159], v[64:67], v[116:119]
    ds_read_b64_tr_b16 v[136:137], v18 offset:6936
    ds_read_b64_tr_b16 v[138:139], v19 offset:6936
    v_mfma_f32_16x16x32_bf16 v[120:123], v[160:163], v[64:67], v[120:123]
    ds_read_b64_tr_b16 v[140:141], v18 offset:6944
    ds_read_b64_tr_b16 v[142:143], v19 offset:6944
    s_waitcnt vmcnt(8) lgkmcnt(10)
    v_mfma_f32_16x16x32_bf16 v[104:107], v[164:167], v[68:71], v[104:107]
    ds_read_b64_tr_b16 v[144:145], v18 offset:12032
    ds_read_b64_tr_b16 v[146:147], v19 offset:12032
    v_mfma_f32_16x16x32_bf16 v[108:111], v[168:171], v[68:71], v[108:111]
    ds_read_b64_tr_b16 v[148:149], v18 offset:12040
    ds_read_b64_tr_b16 v[150:151], v19 offset:12040
    v_mfma_f32_16x16x32_bf16 v[112:115], v[172:175], v[68:71], v[112:115]
    ds_read_b64_tr_b16 v[152:153], v18 offset:12048
    ds_read_b64_tr_b16 v[154:155], v19 offset:12048
    v_mfma_f32_16x16x32_bf16 v[116:119], v[176:179], v[68:71], v[116:119]
    ds_read_b64_tr_b16 v[156:157], v18 offset:12056
    ds_read_b64_tr_b16 v[158:159], v19 offset:12056
    v_mfma_f32_16x16x32_bf16 v[120:123], v[180:183], v[68:71], v[120:123]
    ds_read_b64_tr_b16 v[160:161], v18 offset:12064
    ds_read_b64_tr_b16 v[162:163], v19 offset:12064
    s_waitcnt vmcnt(7) lgkmcnt(10)
    v_mfma_f32_16x16x32_bf16 v[104:107], v[124:127], v[72:75], v[104:107]
    ds_read_b64_tr_b16 v[164:165], v18 offset:17152
    ds_read_b64_tr_b16 v[166:167], v19 offset:17152
    v_mfma_f32_16x16x32_bf16 v[108:111], v[128:131], v[72:75], v[108:111]
    ds_read_b64_tr_b16 v[168:169], v18 offset:17160
    ds_read_b64_tr_b16 v[170:171], v19 offset:17160
    v_mfma_f32_16x16x32_bf16 v[112:115], v[132:135], v[72:75], v[112:115]
    ds_read_b64_tr_b16 v[172:173], v18 offset:17168
    ds_read_b64_tr_b16 v[174:175], v19 offset:17168
    v_mfma_f32_16x16x32_bf16 v[116:119], v[136:139], v[72:75], v[116:119]
    ds_read_b64_tr_b16 v[176:177], v18 offset:17176
    ds_read_b64_tr_b16 v[178:179], v19 offset:17176
    v_mfma_f32_16x16x32_bf16 v[120:123], v[140:143], v[72:75], v[120:123]
    ds_read_b64_tr_b16 v[180:181], v18 offset:17184
    ds_read_b64_tr_b16 v[182:183], v19 offset:17184
    s_waitcnt vmcnt(6) lgkmcnt(10)
    ds_read_b32 v7, v4
    v_mfma_f32_16x16x32_bf16 v[104:107], v[144:147], v[76:79], v[104:107]
    ds_read_b64_tr_b16 v[124:125], v18 offset:22272
    ds_read_b64_tr_b16 v[126:127], v19 offset:22272
    v_mfma_f32_16x16x32_bf16 v[108:111], v[148:151], v[76:79], v[108:111]
    ds_read_b64_tr_b16 v[128:129], v18 offset:22280
    ds_read_b64_tr_b16 v[130:131], v19 offset:22280
    v_mfma_f32_16x16x32_bf16 v[112:115], v[152:155], v[76:79], v[112:115]
    ds_read_b64_tr_b16 v[132:133], v18 offset:22288
    ds_read_b64_tr_b16 v[134:135], v19 offset:22288
    v_mfma_f32_16x16x32_bf16 v[116:119], v[156:159], v[76:79], v[116:119]
    ds_read_b64_tr_b16 v[136:137], v18 offset:22296
    ds_read_b64_tr_b16 v[138:139], v19 offset:22296
    v_mfma_f32_16x16x32_bf16 v[120:123], v[160:163], v[76:79], v[120:123]
    ds_read_b64_tr_b16 v[140:141], v18 offset:22304
    ds_read_b64_tr_b16 v[142:143], v19 offset:22304
    s_waitcnt vmcnt(5) lgkmcnt(10)
    v_cmp_gt_u32 vcc, 1, v7
    s_nop 0
    s_cbranch_vccz CK_61
    s_mov_b32 s7, 0x40000
LP_62:
    ds_read_b32 v7, v4 offset:0
    s_sub_u32 s7, s7, 1
    s_waitcnt lgkmcnt(0)
    v_cmp_gt_u32 vcc, 1, v7
    s_cbranch_scc1 LPD_63
    s_cbranch_vccnz LP_62
LPD_63:
CK_61:
    v_mfma_f32_16x16x32_bf16 v[104:107], v[164:167], v[80:83], v[104:107]
    ds_read_b64_tr_b16 v[144:145], v16 offset:7424
    ds_read_b64_tr_b16 v[146:147], v17 offset:7424
    v_mfma_f32_16x16x32_bf16 v[108:111], v[168:171], v[80:83], v[108:111]
    ds_read_b64_tr_b16 v[148:149], v16 offset:7432
    ds_read_b64_tr_b16 v[150:151], v17 offset:7432
    v_mfma_f32_16x16x32_bf16 v[112:115], v[172:175], v[80:83], v[112:115]
    ds_read_b64_tr_b16 v[152:153], v16 offset:7440
    ds_read_b64_tr_b16 v[154:155], v17 offset:7440
    v_mfma_f32_16x16x32_bf16 v[116:119], v[176:179], v[80:83], v[116:119]
    ds_read_b64_tr_b16 v[156:157], v16 offset:7448
    ds_read_b64_tr_b16 v[158:159], v17 offset:7448
    v_mfma_f32_16x16x32_bf16 v[120:123], v[180:183], v[80:83], v[120:123]
    ds_read_b64_tr_b16 v[160:161], v16 offset:7456
    ds_read_b64_tr_b16 v[162:163], v17 offset:7456
    s_waitcnt vmcnt(4) lgkmcnt(10)
    v_mfma_f32_16x16x32_bf16 v[104:107], v[124:127], v[84:87], v[104:107]
    ds_read_b64_tr_b16 v[164:165], v16 offset:12544
    ds_read_b64_tr_b16 v[166:167], v17 offset:12544
    v_mfma_f32_16x16x32_bf16 v[108:111], v[128:131], v[84:87], v[108:111]
    ds_read_b64_tr_b16 v[168:169], v16 offset:12552
    ds_read_b64_tr_b16 v[170:171], v17 offset:12552
    v_mfma_f32_16x16x32_bf16 v[112:115], v[132:135], v[84:87], v[112:115]
    ds_read_b64_tr_b16 v[172:173], v16 offset:12560
    ds_read_b64_tr_b16 v[174:175], v17 offset:12560
    v_mfma_f32_16x16x32_bf16 v[116:119], v[136:139], v[84:87], v[116:119]
    ds_read_b64_tr_b16 v[176:177], v16 offset:12568
    ds_read_b64_tr_b16 v[178:179], v17 offset:12568
    v_mfma_f32_16x16x32_bf16 v[120:123], v[140:143], v[84:87], v[120:123]
    ds_read_b64_tr_b16 v[180:181], v16 offset:12576
    ds_read_b64_tr_b16 v[182:183], v17 offset:12576
    s_waitcnt vmcnt(3) lgkmcnt(10)
    ds_read_b32 v7, v231
    v_mfma_f32_16x16x32_bf16 v[104:107], v[144:147], v[88:91], v[104:107]
    ds_read_b64_tr_b16 v[124:125], v16 offset:17664
    ds_read_b64_tr_b16 v[126:127], v17 offset:17664
    v_mfma_f32_16x16x32_bf16 v[108:111], v[148:151], v[88:91], v[108:111]
    ds_read_b64_tr_b16 v[128:129], v16 offset:17672
    ds_read_b64_tr_b16 v[130:131], v17 offset:17672
    v_mfma_f32_16x16x32_bf16 v[112:115], v[152:155], v[88:91], v[112:115]
    ds_read_b64_tr_b16 v[132:133], v16 offset:17680
    ds_read_b64_tr_b16 v[134:135], v17 offset:17680
    v_mfma_f32_16x16x32_bf16 v[116:119], v[156:159], v[88:91], v[116:119]
    ds_read_b64_tr_b16 v[136:137], v16 offset:17688
    ds_read_b64_tr_b16 v[138:139], v17 offset:17688
    v_mfma_f32_16x16x32_bf16 v[120:123], v[160:163], v[88:91], v[120:123]
    ds_read_b64_tr_b16 v[140:141], v16 offset:17696
    ds_read_b64_tr_b16 v[142:143], v17 offset:17696
    s_waitcnt vmcnt(2) lgkmcnt(10)
    v_mfma_f32_16x16x32_bf16 v[104:107], v[164:167], v[92:95], v[104:107]
    ds_read_b64_tr_b16 v[144:145], v16 offset:22784
    ds_read_b64_tr_b16 v[146:147], v17 offset:22784
    v_mfma_f32_16x16x32_bf16 v[108:111], v[168:171], v[92:95], v[108:111]
    ds_read_b64_tr_b16 v[148:149], v16 offset:22792
    ds_read_b64_tr_b16 v[150:151], v17 offset:22792
    v_mfma_f32_16x16x32_bf16 v[112:115], v[172:175], v[92:95], v[112:115]
    ds_read_b64_tr_b16 v[152:153], v16 offset:22800
    ds_read_b64_tr_b16 v[154:155], v17 offset:22800
    v_mfma_f32_16x16x32_bf16 v[116:119], v[176:179], v[92:95], v[116:119]
    ds_read_b64_tr_b16 v[156:157], v16 offset:22808
    ds_read_b64_tr_b16 v[158:159], v17 offset:22808
    v_mfma_f32_16x16x32_bf16 v[120:123], v[180:183], v[92:95], v[120:123]
    ds_read_b64_tr_b16 v[160:161], v16 offset:22816
    ds_read_b64_tr_b16 v[162:163], v17 offset:22816
    s_waitcnt vmcnt(1) lgkmcnt(10)
    v_cmp_gt_u32 vcc, 1, v7
    s_nop 0
    s_cbranch_vccz CK_64
    s_mov_b32 s7, 0x40000
LP_65:
    ds_read_b32 v7, v231 offset:0
    s_sub_u32 s7, s7, 1
    s_waitcnt lgkmcnt(0)
    v_cmp_gt_u32 vcc, 1, v7
    s_cbranch_scc1 LPD_66
    s_cbranch_vccnz LP_65
LPD_66:
CK_64:
    ds_read_b128 v[192:195], v226 offset:0
    ds_read_b128 v[196:199], v227 offset:512
    ds_read_b128 v[200:203], v226 offset:1024
    ds_read_b128 v[204:207], v227 offset:1536
    ds_read_b128 v[208:211], v226 offset:2048
    v_mfma_f32_16x16x32_bf16 v[104:107], v[124:127], v[96:99], v[104:107]
    v_mfma_f32_16x16x32_bf16 v[108:111], v[128:131], v[96:99], v[108:111]
    v_mfma_f32_16x16x32_bf16 v[112:115], v[132:135], v[96:99], v[112:115]
    v_mfma_f32_16x16x32_bf16 v[116:119], v[136:139], v[96:99], v[116:119]
    v_mfma_f32_16x16x32_bf16 v[120:123], v[140:143], v[96:99], v[120:123]
    s_waitcnt vmcnt(0) lgkmcnt(5)
    v_mfma_f32_16x16x32_bf16 v[104:107], v[144:147], v[100:103], v[104:107]
    v_mfma_f32_16x16x32_bf16 v[108:111], v[148:151], v[100:103], v[108:111]
    v_mfma_f32_16x16x32_bf16 v[112:115], v[152:155], v[100:103], v[112:115]
    v_mfma_f32_16x16x32_bf16 v[116:119], v[156:159], v[100:103], v[116:119]
    v_mfma_f32_16x16x32_bf16 v[120:123], v[160:163], v[100:103], v[120:123]
    s_waitcnt lgkmcnt(0)
    v_mfma_f32_16x16x32_bf16 v[104:107], v[192:195], v[212:215], v[104:107]
    v_mfma_f32_16x16x32_bf16 v[108:111], v[196:199], v[212:215], v[108:111]
    v_mfma_f32_16x16x32_bf16 v[112:115], v[200:203], v[212:215], v[112:115]
    v_mfma_f32_16x16x32_bf16 v[116:119], v[204:207], v[212:215], v[116:119]
    v_mfma_f32_16x16x32_bf16 v[120:123], v[208:211], v[212:215], v[120:123]
    s_nop 3
    v_cvt_pk_bf16_f32 v24, v104, v105
    v_cvt_pk_bf16_f32 v25, v106, v107
    v_cvt_pk_bf16_f32 v26, v108, v109
    v_cvt_pk_bf16_f32 v27, v110, v111
    v_cvt_pk_bf16_f32 v28, v112, v113
    v_cvt_pk_bf16_f32 v29, v114, v115
    v_cvt_pk_bf16_f32 v30, v116, v117
    v_cvt_pk_bf16_f32 v31, v118, v119
    v_cvt_pk_bf16_f32 v32, v120, v121
    v_cvt_pk_bf16_f32 v33, v122, v123
    ds_write_b64 v8, v[24:25] offset:0
    ds_write_b64 v8, v[26:27] offset:8
    ds_write_b64 v8, v[28:29] offset:16
    ds_write_b64 v8, v[30:31] offset:24
    ds_write_b64 v8, v[32:33] offset:32
    ds_read_b128 v[36:39], v9 offset:0
    ds_read_b128 v[40:43], v9 offset:1024
    ds_read_b128 v[44:47], v9 offset:2048
    s_waitcnt lgkmcnt(2)
    buffer_store_dwordx4 v[36:39], v10, s[28:31], s73 offen
    s_waitcnt lgkmcnt(1)
    buffer_store_dwordx4 v[40:43], v11, s[28:31], s73 offen
    s_waitcnt lgkmcnt(0)
    buffer_store_dwordx4 v[44:47], v12, s[28:31], s73 offen
    s_endpgm
.p2align 6
A_ENTRY1:
    s_mov_b32 s33, 0x40000
    s_waitcnt lgkmcnt(0)
    v_mfma_f32_32x32x16_bf16 v[32:47], v[68:71], v[60:63], 0
    v_exp_f32 v16, v16
    v_exp_f32 v17, v17
    v_exp_f32 v18, v18
    v_exp_f32 v19, v19
    v_exp_f32 v20, v20
    s_mov_b32 s6, 110848
    s_add_u32 s34, s38, s6
    s_addc_u32 s35, s39, 0
    global_load_dwordx4 v[132:135], v1, s[34:35] offset:0
    global_load_dwordx4 v[136:139], v1, s[34:35] offset:1024
    v_mov_b32 v144, 0
    v_mov_b32 v145, 0
    v_mov_b32 v146, 0
    v_mov_b32 v147, 0
    v_min_u32 v142, 35, v0
    v_lshlrev_b32 v142, 4, v142
    s_mul_i32 s6, s90, 576
    s_add_u32 s6, s6, 72960
    v_add_u32 v142, s6, v142
    v_exp_f32 v21, v21
    v_exp_f32 v22, v22
    v_exp_f32 v23, v23
    v_cvt_pk_bf16_f32 v48, v16, v17
    v_cvt_pk_bf16_f32 v49, v18, v19
    v_cvt_pk_bf16_f32 v50, v20, v21
    v_cvt_pk_bf16_f32 v51, v22, v23
    ds_read_b128 v[72:75], v2 offset:1024
    v_mfma_f32_32x32x8_bf16 v[32:47], v[76:77], v[66:67], v[32:47]
    v_exp_f32 v24, v24
    v_exp_f32 v25, v25
    v_exp_f32 v26, v26
    v_exp_f32 v27, v27
    v_exp_f32 v28, v28
    s_and_b32 s6, s2, 1
    s_lshr_b32 s81, s2, 1
    s_mul_i32 s81, s81, 5
    s_lshl_b32 s6, s6, 1
    s_add_u32 s81, s81, s6
    s_mul_i32 s81, s81, 4224
    s_add_u32 s81, s81, 2621566
    s_mul_i32 s82, s90, 896
    s_add_u32 s82, s82, s81
    s_mul_i32 s83, s90, 1008
    v_mfma_f32_32x32x16_bf16 v[192:207], v[84:87], v[48:51], 0
    v_exp_f32 v29, v29
    v_exp_f32 v30, v30
    v_exp_f32 v31, v31
    v_cvt_pk_bf16_f32 v52, v24, v25
    v_cvt_pk_bf16_f32 v53, v26, v27
    v_cvt_pk_bf16_f32 v54, v28, v29
    v_cvt_pk_bf16_f32 v55, v30, v31
    s_waitcnt lgkmcnt(0)
    v_mfma_f32_32x32x16_bf16 v[16:31], v[72:75], v[56:59], 0
    v_exp_f32 v32, v32
    v_exp_f32 v33, v33
    v_exp_f32 v34, v34
    v_exp_f32 v35, v35
    v_exp_f32 v36, v36
    ds_write_b128 v142, v[144:147] offset:0
    v_mfma_f32_32x32x16_bf16 v[192:207], v[88:91], v[52:55], v[192:207]
    v_exp_f32 v37, v37
    v_exp_f32 v38, v38
    v_exp_f32 v39, v39
    v_cvt_pk_bf16_f32 v48, v32, v33
    v_cvt_pk_bf16_f32 v49, v34, v35
    v_cvt_pk_bf16_f32 v50, v36, v37
    v_cvt_pk_bf16_f32 v51, v38, v39
    ds_read_b128 v[92:95], v3 offset:4416
    ds_read_b128 v[96:99], v3 offset:5088
    v_mfma_f32_32x32x8_bf16 v[16:31], v[78:79], v[64:65], v[16:31]
    v_exp_f32 v40, v40
    v_exp_f32 v41, v41
    v_exp_f32 v42, v42
    v_exp_f32 v43, v43
    v_exp_f32 v44, v44
    ds_write_b128 v142, v[144:147] offset:7424
    v_mfma_f32_32x32x16_bf16 v[208:223], v[84:87], v[48:51], 0
    v_exp_f32 v45, v45
    v_exp_f32 v46, v46
    v_exp_f32 v47, v47
    v_cvt_pk_bf16_f32 v52, v40, v41
    v_cvt_pk_bf16_f32 v53, v42, v43
    v_cvt_pk_bf16_f32 v54, v44, v45
    v_cvt_pk_bf16_f32 v55, v46, v47
    s_waitcnt lgkmcnt(0)
    v_mfma_f32_32x32x16_bf16 v[32:47], v[72:75], v[60:63], 0
    v_exp_f32 v16, v16
    v_exp_f32 v17, v17
    v_exp_f32 v18, v18
    v_exp_f32 v19, v19
    v_exp_f32 v20, v20
    ds_write_b128 v142, v[144:147] offset:14848
    v_mfma_f32_32x32x16_bf16 v[208:223], v[88:91], v[52:55], v[208:223]
    v_exp_f32 v21, v21
    v_exp_f32 v22, v22
    v_exp_f32 v23, v23
    v_cvt_pk_bf16_f32 v48, v16, v17
    v_cvt_pk_bf16_f32 v49, v18, v19
    v_cvt_pk_bf16_f32 v50, v20, v21
    v_cvt_pk_bf16_f32 v51, v22, v23
    ds_read_b128 v[68:71], v2 offset:6144
    ds_read_b128 v[80:83], v2 offset:8192
    v_mfma_f32_32x32x8_bf16 v[32:47], v[78:79], v[66:67], v[32:47]
    v_exp_f32 v24, v24
    v_exp_f32 v25, v25
    v_exp_f32 v26, v26
    v_exp_f32 v27, v27
    v_exp_f32 v28, v28
    ds_write_b128 v142, v[144:147] offset:22272
    v_mfma_f32_32x32x16_bf16 v[192:207], v[92:95], v[48:51], v[192:207]
    v_exp_f32 v29, v29
    v_exp_f32 v30, v30
    v_exp_f32 v31, v31
    v_cvt_pk_bf16_f32 v52, v24, v25
    v_cvt_pk_bf16_f32 v53, v26, v27
    v_cvt_pk_bf16_f32 v54, v28, v29
    v_cvt_pk_bf16_f32 v55, v30, v31
    s_waitcnt lgkmcnt(0)
    v_mfma_f32_32x32x16_bf16 v[16:31], v[68:71], v[56:59], 0
    v_exp_f32 v32, v32
    v_exp_f32 v33, v33
    v_exp_f32 v34, v34
    v_exp_f32 v35, v35
    v_exp_f32 v36, v36
    ds_write_b128 v142, v[144:147] offset:29696
    v_mfma_f32_32x32x16_bf16 v[192:207], v[96:99], v[52:55], v[192:207]
    v_exp_f32 v37, v37
    v_exp_f32 v38, v38
    v_exp_f32 v39, v39
    v_cvt_pk_bf16_f32 v48, v32, v33
    v_cvt_pk_bf16_f32 v49, v34, v35
    v_cvt_pk_bf16_f32 v50, v36, v37
    v_cvt_pk_bf16_f32 v51, v38, v39
    ds_read_b128 v[84:87], v3 offset:9216
    ds_read_b128 v[88:91], v3 offset:9888
    v_mfma_f32_32x32x8_bf16 v[16:31], v[80:81], v[64:65], v[16:31]
    v_exp_f32 v40, v40
    v_exp_f32 v41, v41
    v_exp_f32 v42, v42
    v_exp_f32 v43, v43
    v_exp_f32 v44, v44
    ds_write_b128 v142, v[144:147] offset:37120
    v_mfma_f32_32x32x16_bf16 v[208:223], v[92:95], v[48:51], v[208:223]
    v_exp_f32 v45, v45
    v_exp_f32 v46, v46
    v_exp_f32 v47, v47
    v_cvt_pk_bf16_f32 v52, v40, v41
    v_cvt_pk_bf16_f32 v53, v42, v43
    v_cvt_pk_bf16_f32 v54, v44, v45
    v_cvt_pk_bf16_f32 v55, v46, v47
    s_waitcnt lgkmcnt(0)
    v_mfma_f32_32x32x16_bf16 v[32:47], v[68:71], v[60:63], 0
    v_exp_f32 v16, v16
    v_exp_f32 v17, v17
    v_exp_f32 v18, v18
    v_exp_f32 v19, v19
    v_exp_f32 v20, v20
    v_mfma_f32_32x32x16_bf16 v[208:223], v[96:99], v[52:55], v[208:223]
    v_exp_f32 v21, v21
    v_exp_f32 v22, v22
    v_exp_f32 v23, v23
    v_cvt_pk_bf16_f32 v48, v16, v17
    v_cvt_pk_bf16_f32 v49, v18, v19
    v_cvt_pk_bf16_f32 v50, v20, v21
    v_cvt_pk_bf16_f32 v51, v22, v23
    ds_read_b128 v[72:75], v2 offset:7168
    v_mfma_f32_32x32x8_bf16 v[32:47], v[80:81], v[66:67], v[32:47]
    v_exp_f32 v24, v24
    v_exp_f32 v25, v25
    v_exp_f32 v26, v26
    v_exp_f32 v27, v27
    v_exp_f32 v28, v28
    v_mfma_f32_32x32x16_bf16 v[192:207], v[84:87], v[48:51], v[192:207]
    v_exp_f32 v29, v29
    v_exp_f32 v30, v30
    v_exp_f32 v31, v31
    v_cvt_pk_bf16_f32 v52, v24, v25
    v_cvt_pk_bf16_f32 v53, v26, v27
    v_cvt_pk_bf16_f32 v54, v28, v29
    v_cvt_pk_bf16_f32 v55, v30, v31
    s_waitcnt lgkmcnt(0)
    v_mfma_f32_32x32x16_bf16 v[16:31], v[72:75], v[56:59], 0
    v_exp_f32 v32, v32
    v_exp_f32 v33, v33
    v_exp_f32 v34, v34
    v_exp_f32 v35, v35
    v_exp_f32 v36, v36
    v_mfma_f32_32x32x16_bf16 v[192:207], v[88:91], v[52:55], v[192:207]
    v_exp_f32 v37, v37
    v_exp_f32 v38, v38
    v_exp_f32 v39, v39
    v_cvt_pk_bf16_f32 v48, v32, v33
    v_cvt_pk_bf16_f32 v49, v34, v35
    v_cvt_pk_bf16_f32 v50, v36, v37
    v_cvt_pk_bf16_f32 v51, v38, v39
    ds_read_b128 v[92:95], v3 offset:10560
    ds_read_b128 v[96:99], v3 offset:11232
    ds_read_b32 v10, v117
    v_mfma_f32_32x32x8_bf16 v[16:31], v[82:83], v[64:65], v[16:31]
    v_exp_f32 v40, v40
    v_exp_f32 v41, v41
    v_exp_f32 v42, v42
    v_exp_f32 v43, v43
    v_exp_f32 v44, v44
    v_mfma_f32_32x32x16_bf16 v[208:223], v[84:87], v[48:51], v[208:223]
    v_exp_f32 v45, v45
    v_exp_f32 v46, v46
    v_exp_f32 v47, v47
    v_cvt_pk_bf16_f32 v52, v40, v41
    v_cvt_pk_bf16_f32 v53, v42, v43
    v_cvt_pk_bf16_f32 v54, v44, v45
    v_cvt_pk_bf16_f32 v55, v46, v47
    s_waitcnt lgkmcnt(0)
A_T1_1:
    v_cmp_gt_u32 vcc, 1, v10
    v_cmp_ge_u32 s[74:75], 1, v10
    s_setprio 1
    s_cmp_lg_u32 vcc_lo, 0
    s_cbranch_scc1 A_T1_1S
A_T1_1R:
    s_cmp_eq_u32 s75, 0
    s_cbranch_scc1 A_T1_1H
    s_setprio 1
A_T1_1H:
    v_mfma_f32_32x32x16_bf16 v[32:47], v[72:75], v[60:63], 0
    v_exp_f32 v16, v16
    v_exp_f32 v17, v17
    v_exp_f32 v18, v18
    v_exp_f32 v19, v19
    v_exp_f32 v20, v20
    s_add_u32 m0, s94, 142080
    s_add_u32 s70, s93, 24576
    buffer_load_dwordx4 v1, s[20:23], s70 offen sc1 lds
    buffer_load_dwordx4 v1, s[20:23], s70 offen offset:1024 sc1 lds
    v_mfma_f32_32x32x16_bf16 v[208:223], v[88:91], v[52:55], v[208:223]
    v_exp_f32 v21, v21
    v_exp_f32 v22, v22
    v_exp_f32 v23, v23
    v_cvt_pk_bf16_f32 v48, v16, v17
    v_cvt_pk_bf16_f32 v49, v18, v19
    v_cvt_pk_bf16_f32 v50, v20, v21
    v_cvt_pk_bf16_f32 v51, v22, v23
    ds_read_b128 v[68:71], v4 offset:0
    ds_read_b128 v[76:79], v4 offset:2048
    v_mfma_f32_32x32x8_bf16 v[32:47], v[82:83], v[66:67], v[32:47]
    v_exp_f32 v24, v24
    v_exp_f32 v25, v25
    v_exp_f32 v26, v26
    v_exp_f32 v27, v27
    v_exp_f32 v28, v28
    buffer_load_dwordx4 v1, s[20:23], s70 offen offset:2048 sc1 lds
    s_sub_u32 m0, s69, 4
    s_mov_b64 exec, 1
    global_load_lds_dword v1, s[38:39] offset:4
    s_mov_b64 exec, -1
    v_mfma_f32_32x32x16_bf16 v[192:207], v[92:95], v[48:51], v[192:207]
    v_exp_f32 v29, v29
    v_exp_f32 v30, v30
    v_exp_f32 v31, v31
    v_cvt_pk_bf16_f32 v52, v24, v25
    v_cvt_pk_bf16_f32 v53, v26, v27
    v_cvt_pk_bf16_f32 v54, v28, v29
    v_cvt_pk_bf16_f32 v55, v30, v31
    s_waitcnt lgkmcnt(0)
    v_mfma_f32_32x32x16_bf16 v[16:31], v[68:71], v[56:59], 0
    v_exp_f32 v32, v32
    v_exp_f32 v33, v33
    v_exp_f32 v34, v34
    v_exp_f32 v35, v35
    v_exp_f32 v36, v36
    v_mfma_f32_32x32x16_bf16 v[192:207], v[96:99], v[52:55], v[192:207]
    v_exp_f32 v37, v37
    v_exp_f32 v38, v38
    v_exp_f32 v39, v39
    v_cvt_pk_bf16_f32 v48, v32, v33
    v_cvt_pk_bf16_f32 v49, v34, v35
    v_cvt_pk_bf16_f32 v50, v36, v37
    v_cvt_pk_bf16_f32 v51, v38, v39
    ds_read_b128 v[84:87], v5 offset:3072
    ds_read_b128 v[88:91], v5 offset:3744
    v_mfma_f32_32x32x8_bf16 v[16:31], v[76:77], v[64:65], v[16:31]
    v_exp_f32 v40, v40
    v_exp_f32 v41, v41
    v_exp_f32 v42, v42
    v_exp_f32 v43, v43
    v_exp_f32 v44, v44
    v_mfma_f32_32x32x16_bf16 v[208:223], v[92:95], v[48:51], v[208:223]
    v_exp_f32 v45, v45
    v_exp_f32 v46, v46
    v_exp_f32 v47, v47
    v_cvt_pk_bf16_f32 v52, v40, v41
    v_cvt_pk_bf16_f32 v53, v42, v43
    v_cvt_pk_bf16_f32 v54, v44, v45
    v_cvt_pk_bf16_f32 v55, v46, v47
    s_waitcnt lgkmcnt(0)
    v_mfma_f32_32x32x16_bf16 v[32:47], v[68:71], v[60:63], 0
    v_exp_f32 v16, v16
    v_exp_f32 v17, v17
    v_exp_f32 v18, v18
    v_exp_f32 v19, v19
    v_exp_f32 v20, v20
    v_mfma_f32_32x32x16_bf16 v[208:223], v[96:99], v[52:55], v[208:223]
    v_exp_f32 v21, v21
    v_exp_f32 v22, v22
    v_exp_f32 v23, v23
    v_cvt_pk_bf16_f32 v48, v16, v17
    v_cvt_pk_bf16_f32 v49, v18, v19
    v_cvt_pk_bf16_f32 v50, v20, v21
    v_cvt_pk_bf16_f32 v51, v22, v23
    ds_read_b128 v[72:75], v4 offset:1024
    v_mfma_f32_32x32x8_bf16 v[32:47], v[76:77], v[66:67], v[32:47]
    v_exp_f32 v24, v24
    v_exp_f32 v25, v25
    v_exp_f32 v26, v26
    v_exp_f32 v27, v27
    v_exp_f32 v28, v28
    v_mfma_f32_32x32x16_bf16 v[192:207], v[84:87], v[48:51], v[192:207]
    v_exp_f32 v29, v29
    v_exp_f32 v30, v30
    v_exp_f32 v31, v31
    v_cvt_pk_bf16_f32 v52, v24, v25
    v_cvt_pk_bf16_f32 v53, v26, v27
    v_cvt_pk_bf16_f32 v54, v28, v29
    v_cvt_pk_bf16_f32 v55, v30, v31
    s_waitcnt lgkmcnt(0)
    v_mfma_f32_32x32x16_bf16 v[16:31], v[72:75], v[56:59], 0
    v_exp_f32 v32, v32
    v_exp_f32 v33, v33
    v_exp_f32 v34, v34
    v_exp_f32 v35, v35
    v_exp_f32 v36, v36
    v_mfma_f32_32x32x16_bf16 v[192:207], v[88:91], v[52:55], v[192:207]
    v_exp_f32 v37, v37
    v_exp_f32 v38, v38
    v_exp_f32 v39, v39
    v_cvt_pk_bf16_f32 v48, v32, v33
    v_cvt_pk_bf16_f32 v49, v34, v35
    v_cvt_pk_bf16_f32 v50, v36, v37
    v_cvt_pk_bf16_f32 v51, v38, v39
    ds_read_b128 v[92:95], v5 offset:4416
    ds_read_b128 v[96:99], v5 offset:5088
    v_mfma_f32_32x32x8_bf16 v[16:31], v[78:79], v[64:65], v[16:31]
    v_exp_f32 v40, v40
    v_exp_f32 v41, v41
    v_exp_f32 v42, v42
    v_exp_f32 v43, v43
    v_exp_f32 v44, v44
    v_mfma_f32_32x32x16_bf16 v[208:223], v[84:87], v[48:51], v[208:223]
    v_exp_f32 v45, v45
    v_exp_f32 v46, v46
    v_exp_f32 v47, v47
    v_cvt_pk_bf16_f32 v52, v40, v41
    v_cvt_pk_bf16_f32 v53, v42, v43
    v_cvt_pk_bf16_f32 v54, v44, v45
    v_cvt_pk_bf16_f32 v55, v46, v47
    s_waitcnt lgkmcnt(0)
    v_mfma_f32_32x32x16_bf16 v[32:47], v[72:75], v[60:63], 0
    v_exp_f32 v16, v16
    v_exp_f32 v17, v17
    v_exp_f32 v18, v18
    v_exp_f32 v19, v19
    v_exp_f32 v20, v20
    v_mfma_f32_32x32x16_bf16 v[208:223], v[88:91], v[52:55], v[208:223]
    v_exp_f32 v21, v21
    v_exp_f32 v22, v22
    v_exp_f32 v23, v23
    v_cvt_pk_bf16_f32 v48, v16, v17
    v_cvt_pk_bf16_f32 v49, v18, v19
    v_cvt_pk_bf16_f32 v50, v20, v21
    v_cvt_pk_bf16_f32 v51, v22, v23
    ds_read_b128 v[68:71], v4 offset:6144
    ds_read_b128 v[80:83], v4 offset:8192
    v_mfma_f32_32x32x8_bf16 v[32:47], v[78:79], v[66:67], v[32:47]
    v_exp_f32 v24, v24
    v_exp_f32 v25, v25
    v_exp_f32 v26, v26
    v_exp_f32 v27, v27
    v_exp_f32 v28, v28
    v_mfma_f32_32x32x16_bf16 v[192:207], v[92:95], v[48:51], v[192:207]
    v_exp_f32 v29, v29
    v_exp_f32 v30, v30
    v_exp_f32 v31, v31
    v_cvt_pk_bf16_f32 v52, v24, v25
    v_cvt_pk_bf16_f32 v53, v26, v27
    v_cvt_pk_bf16_f32 v54, v28, v29
    v_cvt_pk_bf16_f32 v55, v30, v31
    s_waitcnt lgkmcnt(0)
    v_mfma_f32_32x32x16_bf16 v[16:31], v[68:71], v[56:59], 0
    v_exp_f32 v32, v32
    v_exp_f32 v33, v33
    v_exp_f32 v34, v34
    v_exp_f32 v35, v35
    v_exp_f32 v36, v36
    v_mfma_f32_32x32x16_bf16 v[192:207], v[96:99], v[52:55], v[192:207]
    v_exp_f32 v37, v37
    v_exp_f32 v38, v38
    v_exp_f32 v39, v39
    v_cvt_pk_bf16_f32 v48, v32, v33
    v_cvt_pk_bf16_f32 v49, v34, v35
    v_cvt_pk_bf16_f32 v50, v36, v37
    v_cvt_pk_bf16_f32 v51, v38, v39
    ds_read_b128 v[84:87], v5 offset:9216
    ds_read_b128 v[88:91], v5 offset:9888
    v_mfma_f32_32x32x8_bf16 v[16:31], v[80:81], v[64:65], v[16:31]
    v_exp_f32 v40, v40
    v_exp_f32 v41, v41
    v_exp_f32 v42, v42
    v_exp_f32 v43, v43
    v_exp_f32 v44, v44
    v_mfma_f32_32x32x16_bf16 v[208:223], v[92:95], v[48:51], v[208:223]
    v_exp_f32 v45, v45
    v_exp_f32 v46, v46
    v_exp_f32 v47, v47
    v_cvt_pk_bf16_f32 v52, v40, v41
    v_cvt_pk_bf16_f32 v53, v42, v43
    v_cvt_pk_bf16_f32 v54, v44, v45
    v_cvt_pk_bf16_f32 v55, v46, v47
    s_waitcnt lgkmcnt(0)
    v_mfma_f32_32x32x16_bf16 v[32:47], v[68:71], v[60:63], 0
    v_exp_f32 v16, v16
    v_exp_f32 v17, v17
    v_exp_f32 v18, v18
    v_exp_f32 v19, v19
    v_exp_f32 v20, v20
    v_lshlrev_b32 v141, 6, v0
    s_mov_b32 s72, 9461760
    buffer_load_dwordx4 v[148:151], v141, s[20:23], s72 offen sc1
    v_mfma_f32_32x32x16_bf16 v[208:223], v[96:99], v[52:55], v[208:223]
    v_exp_f32 v21, v21
    v_exp_f32 v22, v22
    v_exp_f32 v23, v23
    v_cvt_pk_bf16_f32 v48, v16, v17
    v_cvt_pk_bf16_f32 v49, v18, v19
    v_cvt_pk_bf16_f32 v50, v20, v21
    v_cvt_pk_bf16_f32 v51, v22, v23
    ds_read_b128 v[72:75], v4 offset:7168
    v_mfma_f32_32x32x8_bf16 v[32:47], v[80:81], v[66:67], v[32:47]
    v_exp_f32 v24, v24
    v_exp_f32 v25, v25
    v_exp_f32 v26, v26
    v_exp_f32 v27, v27
    v_exp_f32 v28, v28
    v_mfma_f32_32x32x16_bf16 v[192:207], v[84:87], v[48:51], v[192:207]
    v_exp_f32 v29, v29
    v_exp_f32 v30, v30
    v_exp_f32 v31, v31
    v_cvt_pk_bf16_f32 v52, v24, v25
    v_cvt_pk_bf16_f32 v53, v26, v27
    v_cvt_pk_bf16_f32 v54, v28, v29
    v_cvt_pk_bf16_f32 v55, v30, v31
    s_waitcnt lgkmcnt(0)
    v_mfma_f32_32x32x16_bf16 v[16:31], v[72:75], v[56:59], 0
    v_exp_f32 v32, v32
    v_exp_f32 v33, v33
    v_exp_f32 v34, v34
    v_exp_f32 v35, v35
    v_exp_f32 v36, v36
    v_mfma_f32_32x32x16_bf16 v[192:207], v[88:91], v[52:55], v[192:207]
    v_exp_f32 v37, v37
    v_exp_f32 v38, v38
    v_exp_f32 v39, v39
    v_cvt_pk_bf16_f32 v48, v32, v33
    v_cvt_pk_bf16_f32 v49, v34, v35
    v_cvt_pk_bf16_f32 v50, v36, v37
    v_cvt_pk_bf16_f32 v51, v38, v39
    ds_read_b128 v[92:95], v5 offset:10560
    ds_read_b128 v[96:99], v5 offset:11232
    ds_read_b32 v10, v117
    v_mfma_f32_32x32x8_bf16 v[16:31], v[82:83], v[64:65], v[16:31]
    v_exp_f32 v40, v40
    v_exp_f32 v41, v41
    v_exp_f32 v42, v42
    v_exp_f32 v43, v43
    v_exp_f32 v44, v44
    v_mfma_f32_32x32x16_bf16 v[208:223], v[84:87], v[48:51], v[208:223]
    v_exp_f32 v45, v45
    v_exp_f32 v46, v46
    v_exp_f32 v47, v47
    v_cvt_pk_bf16_f32 v52, v40, v41
    v_cvt_pk_bf16_f32 v53, v42, v43
    v_cvt_pk_bf16_f32 v54, v44, v45
    v_cvt_pk_bf16_f32 v55, v46, v47
    s_waitcnt lgkmcnt(0)
A_T1_2:
    v_cmp_gt_u32 vcc, 2, v10
    v_cmp_ge_u32 s[74:75], 2, v10
    s_setprio 1
    s_cmp_lg_u32 vcc_lo, 0
    s_cbranch_scc1 A_T1_2S
A_T1_2R:
    s_cmp_eq_u32 s75, 0
    s_cbranch_scc1 A_T1_2H
    s_setprio 1
A_T1_2H:
    v_mfma_f32_32x32x16_bf16 v[32:47], v[72:75], v[60:63], 0
    v_exp_f32 v16, v16
    v_exp_f32 v17, v17
    v_exp_f32 v18, v18
    v_exp_f32 v19, v19
    v_exp_f32 v20, v20
    s_add_u32 m0, s94, 60672
    s_add_u32 s70, s93, 36864
    buffer_load_dwordx4 v1, s[20:23], s70 offen sc1 lds
    buffer_load_dwordx4 v1, s[20:23], s70 offen offset:1024 sc1 lds
    v_mfma_f32_32x32x16_bf16 v[208:223], v[88:91], v[52:55], v[208:223]
    v_exp_f32 v21, v21
    v_exp_f32 v22, v22
    v_exp_f32 v23, v23
    v_cvt_pk_bf16_f32 v48, v16, v17
    v_cvt_pk_bf16_f32 v49, v18, v19
    v_cvt_pk_bf16_f32 v50, v20, v21
    v_cvt_pk_bf16_f32 v51, v22, v23
    ds_read_b128 v[68:71], v6 offset:0
    ds_read_b128 v[76:79], v6 offset:2048
    v_mfma_f32_32x32x8_bf16 v[32:47], v[82:83], v[66:67], v[32:47]
    v_exp_f32 v24, v24
    v_exp_f32 v25, v25
    v_exp_f32 v26, v26
    v_exp_f32 v27, v27
    v_exp_f32 v28, v28
    buffer_load_dwordx4 v1, s[20:23], s70 offen offset:2048 sc1 lds
    s_sub_u32 m0, s69, 8
    s_mov_b64 exec, 1
    global_load_lds_dword v1, s[38:39] offset:8
    s_mov_b64 exec, -1
    v_mfma_f32_32x32x16_bf16 v[192:207], v[92:95], v[48:51], v[192:207]
    v_exp_f32 v29, v29
    v_exp_f32 v30, v30
    v_exp_f32 v31, v31
    v_cvt_pk_bf16_f32 v52, v24, v25
    v_cvt_pk_bf16_f32 v53, v26, v27
    v_cvt_pk_bf16_f32 v54, v28, v29
    v_cvt_pk_bf16_f32 v55, v30, v31
    s_waitcnt lgkmcnt(0)
    v_mfma_f32_32x32x16_bf16 v[16:31], v[68:71], v[56:59], 0
    v_exp_f32 v32, v32
    v_exp_f32 v33, v33
    v_exp_f32 v34, v34
    v_exp_f32 v35, v35
    v_exp_f32 v36, v36
    s_waitcnt vmcnt(4)
A_F3:
    v_xor_b32 v148, s36, v148
    v_xor_b32 v149, s36, v149
    v_xor_b32 v150, s36, v150
    v_xor_b32 v151, s36, v151
    v_or3_b32 v148, v148, v149, v150
    v_or_b32 v148, v148, v151
    v_cmp_ne_u32 vcc, 0, v148
    s_lshl_b32 s6, s2, 3
    s_add_u32 s6, s6, s3
    s_cbranch_vccnz A_F3S
A_F3R:
    s_cmp_eq_u32 s6, 7
    s_cbranch_scc1 A_EP
A_EPR:
    v_mfma_f32_32x32x16_bf16 v[192:207], v[96:99], v[52:55], v[192:207]
    v_exp_f32 v37, v37
    v_exp_f32 v38, v38
    v_exp_f32 v39, v39
    v_cvt_pk_bf16_f32 v48, v32, v33
    v_cvt_pk_bf16_f32 v49, v34, v35
    v_cvt_pk_bf16_f32 v50, v36, v37
    v_cvt_pk_bf16_f32 v51, v38, v39
    ds_read_b128 v[84:87], v7 offset:3072
    ds_read_b128 v[88:91], v7 offset:3744
    v_mfma_f32_32x32x8_bf16 v[16:31], v[76:77], v[64:65], v[16:31]
    v_exp_f32 v40, v40
    v_exp_f32 v41, v41
    v_exp_f32 v42, v42
    v_exp_f32 v43, v43
    v_exp_f32 v44, v44
    s_add_u32 m0, s83, 75264
    s_add_u32 s6, s82, 0
    s_mov_b32 exec_hi, 0x7fffffff
    buffer_load_dwordx4 v137, s[20:23], s6 offen sc1 lds
    s_mov_b32 exec_hi, -1
    v_mfma_f32_32x32x16_bf16 v[208:223], v[92:95], v[48:51], v[208:223]
    v_exp_f32 v45, v45
    v_exp_f32 v46, v46
    v_exp_f32 v47, v47
    v_cvt_pk_bf16_f32 v52, v40, v41
    v_cvt_pk_bf16_f32 v53, v42, v43
    v_cvt_pk_bf16_f32 v54, v44, v45
    v_cvt_pk_bf16_f32 v55, v46, v47
    s_waitcnt lgkmcnt(0)
    v_mfma_f32_32x32x16_bf16 v[32:47], v[68:71], v[60:63], 0
    v_exp_f32 v16, v16
    v_exp_f32 v17, v17
    v_exp_f32 v18, v18
    v_exp_f32 v19, v19
    v_exp_f32 v20, v20
    s_add_u32 m0, s83, 82688
    s_add_u32 s6, s82, 2
    s_mov_b32 exec_hi, 0x7fffffff
    buffer_load_dwordx4 v137, s[20:23], s6 offen sc1 lds
    s_mov_b32 exec_hi, -1
    v_mfma_f32_32x32x16_bf16 v[208:223], v[96:99], v[52:55], v[208:223]
    v_exp_f32 v21, v21
    v_exp_f32 v22, v22
    v_exp_f32 v23, v23
    v_cvt_pk_bf16_f32 v48, v16, v17
    v_cvt_pk_bf16_f32 v49, v18, v19
    v_cvt_pk_bf16_f32 v50, v20, v21
    v_cvt_pk_bf16_f32 v51, v22, v23
    ds_read_b128 v[72:75], v6 offset:1024
    v_mfma_f32_32x32x8_bf16 v[32:47], v[76:77], v[66:67], v[32:47]
    v_exp_f32 v24, v24
    v_exp_f32 v25, v25
    v_exp_f32 v26, v26
    v_exp_f32 v27, v27
    v_exp_f32 v28, v28
    v_mfma_f32_32x32x16_bf16 v[192:207], v[84:87], v[48:51], v[192:207]
    v_exp_f32 v29, v29
    v_exp_f32 v30, v30
    v_exp_f32 v31, v31
    v_cvt_pk_bf16_f32 v52, v24, v25
    v_cvt_pk_bf16_f32 v53, v26, v27
    v_cvt_pk_bf16_f32 v54, v28, v29
    v_cvt_pk_bf16_f32 v55, v30, v31
    s_waitcnt lgkmcnt(0)
    v_mfma_f32_32x32x16_bf16 v[16:31], v[72:75], v[56:59], 0
    v_exp_f32 v32, v32
    v_exp_f32 v33, v33
    v_exp_f32 v34, v34
    v_exp_f32 v35, v35
    v_exp_f32 v36, v36
    s_add_u32 m0, s83, 90112
    s_add_u32 s6, s82, 4224
    s_mov_b32 exec_hi, 0x7fffffff
    buffer_load_dwordx4 v137, s[20:23], s6 offen sc1 lds
    s_mov_b32 exec_hi, -1
    v_mfma_f32_32x32x16_bf16 v[192:207], v[88:91], v[52:55], v[192:207]
    v_exp_f32 v37, v37
    v_exp_f32 v38, v38
    v_exp_f32 v39, v39
    v_cvt_pk_bf16_f32 v48, v32, v33
    v_cvt_pk_bf16_f32 v49, v34, v35
    v_cvt_pk_bf16_f32 v50, v36, v37
    v_cvt_pk_bf16_f32 v51, v38, v39
    ds_read_b128 v[92:95], v7 offset:4416
    ds_read_b128 v[96:99], v7 offset:5088
    v_mfma_f32_32x32x8_bf16 v[16:31], v[78:79], v[64:65], v[16:31]
    v_exp_f32 v40, v40
    v_exp_f32 v41, v41
    v_exp_f32 v42, v42
    v_exp_f32 v43, v43
    v_exp_f32 v44, v44
    v_mfma_f32_32x32x16_bf16 v[208:223], v[84:87], v[48:51], v[208:223]
    v_exp_f32 v45, v45
    v_exp_f32 v46, v46
    v_exp_f32 v47, v47
    v_cvt_pk_bf16_f32 v52, v40, v41
    v_cvt_pk_bf16_f32 v53, v42, v43
    v_cvt_pk_bf16_f32 v54, v44, v45
    v_cvt_pk_bf16_f32 v55, v46, v47
    s_waitcnt lgkmcnt(0)
    v_mfma_f32_32x32x16_bf16 v[32:47], v[72:75], v[60:63], 0
    v_exp_f32 v16, v16
    v_exp_f32 v17, v17
    v_exp_f32 v18, v18
    v_exp_f32 v19, v19
    v_exp_f32 v20, v20
    s_add_u32 m0, s83, 97536
    s_add_u32 s6, s82, 4226
    s_mov_b32 exec_hi, 0x7fffffff
    buffer_load_dwordx4 v137, s[20:23], s6 offen sc1 lds
    s_mov_b32 exec_hi, -1
    v_mfma_f32_32x32x16_bf16 v[208:223], v[88:91], v[52:55], v[208:223]
    v_exp_f32 v21, v21
    v_exp_f32 v22, v22
    v_exp_f32 v23, v23
    v_cvt_pk_bf16_f32 v48, v16, v17
    v_cvt_pk_bf16_f32 v49, v18, v19
    v_cvt_pk_bf16_f32 v50, v20, v21
    v_cvt_pk_bf16_f32 v51, v22, v23
    ds_read_b128 v[68:71], v6 offset:6144
    ds_read_b128 v[80:83], v6 offset:8192
    v_mfma_f32_32x32x8_bf16 v[32:47], v[78:79], v[66:67], v[32:47]
    v_exp_f32 v24, v24
    v_exp_f32 v25, v25
    v_exp_f32 v26, v26
    v_exp_f32 v27, v27
    v_exp_f32 v28, v28
    v_mfma_f32_32x32x16_bf16 v[192:207], v[92:95], v[48:51], v[192:207]
    v_exp_f32 v29, v29
    v_exp_f32 v30, v30
    v_exp_f32 v31, v31
    v_cvt_pk_bf16_f32 v52, v24, v25
    v_cvt_pk_bf16_f32 v53, v26, v27
    v_cvt_pk_bf16_f32 v54, v28, v29
    v_cvt_pk_bf16_f32 v55, v30, v31
    s_waitcnt lgkmcnt(0)
    v_mfma_f32_32x32x16_bf16 v[16:31], v[68:71], v[56:59], 0
    v_exp_f32 v32, v32
    v_exp_f32 v33, v33
    v_exp_f32 v34, v34
    v_exp_f32 v35, v35
    v_exp_f32 v36, v36
    s_add_u32 m0, s83, 104960
    s_add_u32 s6, s82, 8448
    s_mov_b32 exec_hi, 0x7fffffff
    buffer_load_dwordx4 v137, s[20:23], s6 offen sc1 lds
    s_mov_b32 exec_hi, -1
    v_mfma_f32_32x32x16_bf16 v[192:207], v[96:99], v[52:55], v[192:207]
    v_exp_f32 v37, v37
    v_exp_f32 v38, v38
    v_exp_f32 v39, v39
    v_cvt_pk_bf16_f32 v48, v32, v33
    v_cvt_pk_bf16_f32 v49, v34, v35
    v_cvt_pk_bf16_f32 v50, v36, v37
    v_cvt_pk_bf16_f32 v51, v38, v39
    ds_read_b128 v[84:87], v7 offset:9216
    ds_read_b128 v[88:91], v7 offset:9888
    v_mfma_f32_32x32x8_bf16 v[16:31], v[80:81], v[64:65], v[16:31]
    v_exp_f32 v40, v40
    v_exp_f32 v41, v41
    v_exp_f32 v42, v42
    v_exp_f32 v43, v43
    v_exp_f32 v44, v44
    v_mfma_f32_32x32x16_bf16 v[208:223], v[92:95], v[48:51], v[208:223]
    v_exp_f32 v45, v45
    v_exp_f32 v46, v46
    v_exp_f32 v47, v47
    v_cvt_pk_bf16_f32 v52, v40, v41
    v_cvt_pk_bf16_f32 v53, v42, v43
    v_cvt_pk_bf16_f32 v54, v44, v45
    v_cvt_pk_bf16_f32 v55, v46, v47
    s_waitcnt lgkmcnt(0)
    v_mfma_f32_32x32x16_bf16 v[32:47], v[68:71], v[60:63], 0
    v_exp_f32 v16, v16
    v_exp_f32 v17, v17
    v_exp_f32 v18, v18
    v_exp_f32 v19, v19
    v_exp_f32 v20, v20
    s_add_u32 m0, s83, 112384
    s_add_u32 s6, s82, 8450
    s_mov_b32 exec_hi, 0x7fffffff
    buffer_load_dwordx4 v137, s[20:23], s6 offen sc1 lds
    s_mov_b32 exec_hi, -1
    v_mfma_f32_32x32x16_bf16 v[208:223], v[96:99], v[52:55], v[208:223]
    v_exp_f32 v21, v21
    v_exp_f32 v22, v22
    v_exp_f32 v23, v23
    v_cvt_pk_bf16_f32 v48, v16, v17
    v_cvt_pk_bf16_f32 v49, v18, v19
    v_cvt_pk_bf16_f32 v50, v20, v21
    v_cvt_pk_bf16_f32 v51, v22, v23
    ds_read_b128 v[72:75], v6 offset:7168
    v_mfma_f32_32x32x8_bf16 v[32:47], v[80:81], v[66:67], v[32:47]
    v_exp_f32 v24, v24
    v_exp_f32 v25, v25
    v_exp_f32 v26, v26
    v_exp_f32 v27, v27
    v_exp_f32 v28, v28
    v_mfma_f32_32x32x16_bf16 v[192:207], v[84:87], v[48:51], v[192:207]
    v_exp_f32 v29, v29
    v_exp_f32 v30, v30
    v_exp_f32 v31, v31
    v_cvt_pk_bf16_f32 v52, v24, v25
    v_cvt_pk_bf16_f32 v53, v26, v27
    v_cvt_pk_bf16_f32 v54, v28, v29
    v_cvt_pk_bf16_f32 v55, v30, v31
    s_waitcnt lgkmcnt(0)
    v_mfma_f32_32x32x16_bf16 v[16:31], v[72:75], v[56:59], 0
    v_exp_f32 v32, v32
    v_exp_f32 v33, v33
    v_exp_f32 v34, v34
    v_exp_f32 v35, v35
    v_exp_f32 v36, v36
    s_mov_b32 s7, s90
    s_mul_i32 s6, s7, 7424
    s_add_u32 m0, s6, 79296
    s_mul_i32 s6, s7, 2112
    s_and_b32 s7, s7, 1
    s_mul_i32 s7, s7, 2110
    s_sub_u32 s6, s6, s7
    s_add_u32 s6, s6, s81
    s_add_u32 s6, s6, 3584
    s_mov_b32 exec_hi, 0x7fffffff
    buffer_load_dwordx4 v137, s[20:23], s6 offen sc1 lds
    s_mov_b32 exec_hi, -1
    v_mfma_f32_32x32x16_bf16 v[192:207], v[88:91], v[52:55], v[192:207]
    v_exp_f32 v37, v37
    v_exp_f32 v38, v38
    v_exp_f32 v39, v39
    v_cvt_pk_bf16_f32 v48, v32, v33
    v_cvt_pk_bf16_f32 v49, v34, v35
    v_cvt_pk_bf16_f32 v50, v36, v37
    v_cvt_pk_bf16_f32 v51, v38, v39
    ds_read_b128 v[92:95], v7 offset:10560
    ds_read_b128 v[96:99], v7 offset:11232
    ds_read_b32 v10, v117
    v_mfma_f32_32x32x8_bf16 v[16:31], v[82:83], v[64:65], v[16:31]
    v_exp_f32 v40, v40
    v_exp_f32 v41, v41
    v_exp_f32 v42, v42
    v_exp_f32 v43, v43
    v_exp_f32 v44, v44
    s_add_u32 s7, s90, 4
    s_min_u32 s7, s7, 5
    s_mul_i32 s6, s7, 7424
    s_add_u32 m0, s6, 79296
    s_mul_i32 s6, s7, 2112
    s_and_b32 s7, s7, 1
    s_mul_i32 s7, s7, 2110
    s_sub_u32 s6, s6, s7
    s_add_u32 s6, s6, s81
    s_add_u32 s6, s6, 3584
    s_mov_b32 exec_hi, 0x7fffffff
    buffer_load_dwordx4 v137, s[20:23], s6 offen sc1 lds
    s_mov_b32 exec_hi, -1
    v_mfma_f32_32x32x16_bf16 v[208:223], v[84:87], v[48:51], v[208:223]
    v_exp_f32 v45, v45
    v_exp_f32 v46, v46
    v_exp_f32 v47, v47
    v_cvt_pk_bf16_f32 v52, v40, v41
    v_cvt_pk_bf16_f32 v53, v42, v43
    v_cvt_pk_bf16_f32 v54, v44, v45
    v_cvt_pk_bf16_f32 v55, v46, v47
    s_waitcnt lgkmcnt(0)
A_T1_3:
    v_cmp_gt_u32 vcc, 3, v10
    v_cmp_ge_u32 s[74:75], 3, v10
    s_setprio 1
    s_cmp_lg_u32 vcc_lo, 0
    s_cbranch_scc1 A_T1_3S
A_T1_3R:
    s_cmp_eq_u32 s75, 0
    s_cbranch_scc1 A_T1_3H
    s_setprio 1
A_T1_3H:
    v_mfma_f32_32x32x16_bf16 v[32:47], v[72:75], v[60:63], 0
    v_exp_f32 v16, v16
    v_exp_f32 v17, v17
    v_exp_f32 v18, v18
    v_exp_f32 v19, v19
    v_exp_f32 v20, v20
    s_add_u32 m0, s94, 8448
    s_add_u32 s70, s93, 49152
    buffer_load_dwordx4 v1, s[20:23], s70 offen sc1 lds
    buffer_load_dwordx4 v1, s[20:23], s70 offen offset:1024 sc1 lds
    v_mfma_f32_32x32x16_bf16 v[208:223], v[88:91], v[52:55], v[208:223]
    v_exp_f32 v21, v21
    v_exp_f32 v22, v22
    v_exp_f32 v23, v23
    v_cvt_pk_bf16_f32 v48, v16, v17
    v_cvt_pk_bf16_f32 v49, v18, v19
    v_cvt_pk_bf16_f32 v50, v20, v21
    v_cvt_pk_bf16_f32 v51, v22, v23
    ds_read_b128 v[68:71], v2 offset:0
    ds_read_b128 v[76:79], v2 offset:2048
    v_mfma_f32_32x32x8_bf16 v[32:47], v[82:83], v[66:67], v[32:47]
    v_exp_f32 v24, v24
    v_exp_f32 v25, v25
    v_exp_f32 v26, v26
    v_exp_f32 v27, v27
    v_exp_f32 v28, v28
    buffer_load_dwordx4 v1, s[20:23], s70 offen offset:2048 sc1 lds
    s_sub_u32 m0, s69, 12
    s_mov_b64 exec, 1
    global_load_lds_dword v1, s[38:39] offset:12
    s_mov_b64 exec, -1
    v_mfma_f32_32x32x16_bf16 v[192:207], v[92:95], v[48:51], v[192:207]
    v_exp_f32 v29, v29
    v_exp_f32 v30, v30
    v_exp_f32 v31, v31
    v_cvt_pk_bf16_f32 v52, v24, v25
    v_cvt_pk_bf16_f32 v53, v26, v27
    v_cvt_pk_bf16_f32 v54, v28, v29
    v_cvt_pk_bf16_f32 v55, v30, v31
    s_waitcnt lgkmcnt(0)
    v_mfma_f32_32x32x16_bf16 v[16:31], v[68:71], v[56:59], 0
    v_exp_f32 v32, v32
    v_exp_f32 v33, v33
    v_exp_f32 v34, v34
    v_exp_f32 v35, v35
    v_exp_f32 v36, v36
    s_lshl_b32 s72, s4, 8
    s_add_u32 s72, s72, 9379840
    buffer_load_dword v12, v121, s[20:23], s72 offen sc1
    v_mfma_f32_32x32x16_bf16 v[192:207], v[96:99], v[52:55], v[192:207]
    v_exp_f32 v37, v37
    v_exp_f32 v38, v38
    v_exp_f32 v39, v39
    v_cvt_pk_bf16_f32 v48, v32, v33
    v_cvt_pk_bf16_f32 v49, v34, v35
    v_cvt_pk_bf16_f32 v50, v36, v37
    v_cvt_pk_bf16_f32 v51, v38, v39
    ds_read_b128 v[84:87], v3 offset:3072
    ds_read_b128 v[88:91], v3 offset:3744
    v_mfma_f32_32x32x8_bf16 v[16:31], v[76:77], v[64:65], v[16:31]
    v_exp_f32 v40, v40
    v_exp_f32 v41, v41
    v_exp_f32 v42, v42
    v_exp_f32 v43, v43
    v_exp_f32 v44, v44
    v_mfma_f32_32x32x16_bf16 v[208:223], v[92:95], v[48:51], v[208:223]
    v_exp_f32 v45, v45
    v_exp_f32 v46, v46
    v_exp_f32 v47, v47
    v_cvt_pk_bf16_f32 v52, v40, v41
    v_cvt_pk_bf16_f32 v53, v42, v43
    v_cvt_pk_bf16_f32 v54, v44, v45
    v_cvt_pk_bf16_f32 v55, v46, v47
    s_waitcnt lgkmcnt(0)
    v_mfma_f32_32x32x16_bf16 v[32:47], v[68:71], v[60:63], 0
    v_exp_f32 v16, v16
    v_exp_f32 v17, v17
    v_exp_f32 v18, v18
    v_exp_f32 v19, v19
    v_exp_f32 v20, v20
    s_and_b32 s73, s2, 0xf8
    s_add_u32 s73, s73, s3
    s_mul_i32 s73, s73, 3200
    v_min_u32 v8, 24, v0
    v_lshlrev_b32 v8, 7, v8
    buffer_load_dword v9, v8, s[24:27], s73 offen
    v_mfma_f32_32x32x16_bf16 v[208:223], v[96:99], v[52:55], v[208:223]
    v_exp_f32 v21, v21
    v_exp_f32 v22, v22
    v_exp_f32 v23, v23
    v_cvt_pk_bf16_f32 v48, v16, v17
    v_cvt_pk_bf16_f32 v49, v18, v19
    v_cvt_pk_bf16_f32 v50, v20, v21
    v_cvt_pk_bf16_f32 v51, v22, v23
    ds_read_b128 v[72:75], v2 offset:1024
    v_mfma_f32_32x32x8_bf16 v[32:47], v[76:77], v[66:67], v[32:47]
    v_exp_f32 v24, v24
    v_exp_f32 v25, v25
    v_exp_f32 v26, v26
    v_exp_f32 v27, v27
    v_exp_f32 v28, v28
    v_mfma_f32_32x32x16_bf16 v[192:207], v[84:87], v[48:51], v[192:207]
    v_exp_f32 v29, v29
    v_exp_f32 v30, v30
    v_exp_f32 v31, v31
    v_cvt_pk_bf16_f32 v52, v24, v25
    v_cvt_pk_bf16_f32 v53, v26, v27
    v_cvt_pk_bf16_f32 v54, v28, v29
    v_cvt_pk_bf16_f32 v55, v30, v31
    s_waitcnt lgkmcnt(0)
    v_mfma_f32_32x32x16_bf16 v[16:31], v[72:75], v[56:59], 0
    v_exp_f32 v32, v32
    v_exp_f32 v33, v33
    v_exp_f32 v34, v34
    v_exp_f32 v35, v35
    v_exp_f32 v36, v36
    s_lshl_b32 s7, s3, 11
    s_add_u32 s6, s7, 94464
    s_add_u32 s34, s38, s6
    s_addc_u32 s35, s39, 0
    global_load_dwordx4 v[124:127], v1, s[34:35] offset:0
    global_load_dwordx4 v[128:131], v1, s[34:35] offset:1024
    v_mfma_f32_32x32x16_bf16 v[192:207], v[88:91], v[52:55], v[192:207]
    v_exp_f32 v37, v37
    v_exp_f32 v38, v38
    v_exp_f32 v39, v39
    v_cvt_pk_bf16_f32 v48, v32, v33
    v_cvt_pk_bf16_f32 v49, v34, v35
    v_cvt_pk_bf16_f32 v50, v36, v37
    v_cvt_pk_bf16_f32 v51, v38, v39
    ds_read_b128 v[92:95], v3 offset:4416
    ds_read_b128 v[96:99], v3 offset:5088
    v_mfma_f32_32x32x8_bf16 v[16:31], v[78:79], v[64:65], v[16:31]
    v_exp_f32 v40, v40
    v_exp_f32 v41, v41
    v_exp_f32 v42, v42
    v_exp_f32 v43, v43
    v_exp_f32 v44, v44
    v_mfma_f32_32x32x16_bf16 v[208:223], v[84:87], v[48:51], v[208:223]
    v_exp_f32 v45, v45
    v_exp_f32 v46, v46
    v_exp_f32 v47, v47
    v_cvt_pk_bf16_f32 v52, v40, v41
    v_cvt_pk_bf16_f32 v53, v42, v43
    v_cvt_pk_bf16_f32 v54, v44, v45
    v_cvt_pk_bf16_f32 v55, v46, v47
    s_waitcnt lgkmcnt(0)
    v_mfma_f32_32x32x16_bf16 v[32:47], v[72:75], v[60:63], 0
    v_exp_f32 v16, v16
    v_exp_f32 v17, v17
    v_exp_f32 v18, v18
    v_exp_f32 v19, v19
    v_exp_f32 v20, v20
    v_mfma_f32_32x32x16_bf16 v[208:223], v[88:91], v[52:55], v[208:223]
    v_exp_f32 v21, v21
    v_exp_f32 v22, v22
    v_exp_f32 v23, v23
    v_cvt_pk_bf16_f32 v48, v16, v17
    v_cvt_pk_bf16_f32 v49, v18, v19
    v_cvt_pk_bf16_f32 v50, v20, v21
    v_cvt_pk_bf16_f32 v51, v22, v23
    ds_read_b128 v[68:71], v2 offset:6144
    ds_read_b128 v[80:83], v2 offset:8192
    v_mfma_f32_32x32x8_bf16 v[32:47], v[78:79], v[66:67], v[32:47]
    v_exp_f32 v24, v24
    v_exp_f32 v25, v25
    v_exp_f32 v26, v26
    v_exp_f32 v27, v27
    v_exp_f32 v28, v28
    v_mfma_f32_32x32x16_bf16 v[192:207], v[92:95], v[48:51], v[192:207]
    v_exp_f32 v29, v29
    v_exp_f32 v30, v30
    v_exp_f32 v31, v31
    v_cvt_pk_bf16_f32 v52, v24, v25
    v_cvt_pk_bf16_f32 v53, v26, v27
    v_cvt_pk_bf16_f32 v54, v28, v29
    v_cvt_pk_bf16_f32 v55, v30, v31
    s_waitcnt lgkmcnt(0)
    v_mfma_f32_32x32x16_bf16 v[16:31], v[68:71], v[56:59], 0
    v_exp_f32 v32, v32
    v_exp_f32 v33, v33
    v_exp_f32 v34, v34
    v_exp_f32 v35, v35
    v_exp_f32 v36, v36
    v_mfma_f32_32x32x16_bf16 v[192:207], v[96:99], v[52:55], v[192:207]
    v_exp_f32 v37, v37
    v_exp_f32 v38, v38
    v_exp_f32 v39, v39
    v_cvt_pk_bf16_f32 v48, v32, v33
    v_cvt_pk_bf16_f32 v49, v34, v35
    v_cvt_pk_bf16_f32 v50, v36, v37
    v_cvt_pk_bf16_f32 v51, v38, v39
    ds_read_b128 v[84:87], v3 offset:9216
    ds_read_b128 v[88:91], v3 offset:9888
    v_mfma_f32_32x32x8_bf16 v[16:31], v[80:81], v[64:65], v[16:31]
    v_exp_f32 v40, v40
    v_exp_f32 v41, v41
    v_exp_f32 v42, v42
    v_exp_f32 v43, v43
    v_exp_f32 v44, v44
    v_mfma_f32_32x32x16_bf16 v[208:223], v[92:95], v[48:51], v[208:223]
    v_exp_f32 v45, v45
    v_exp_f32 v46, v46
    v_exp_f32 v47, v47
    v_cvt_pk_bf16_f32 v52, v40, v41
    v_cvt_pk_bf16_f32 v53, v42, v43
    v_cvt_pk_bf16_f32 v54, v44, v45
    v_cvt_pk_bf16_f32 v55, v46, v47
    s_waitcnt lgkmcnt(0)
    v_mfma_f32_32x32x16_bf16 v[32:47], v[68:71], v[60:63], 0
    v_exp_f32 v16, v16
    v_exp_f32 v17, v17
    v_exp_f32 v18, v18
    v_exp_f32 v19, v19
    v_exp_f32 v20, v20
    v_mfma_f32_32x32x16_bf16 v[208:223], v[96:99], v[52:55], v[208:223]
    v_exp_f32 v21, v21
    v_exp_f32 v22, v22
    v_exp_f32 v23, v23
    v_cvt_pk_bf16_f32 v48, v16, v17
    v_cvt_pk_bf16_f32 v49, v18, v19
    v_cvt_pk_bf16_f32 v50, v20, v21
    v_cvt_pk_bf16_f32 v51, v22, v23
    ds_read_b128 v[72:75], v2 offset:7168
    v_mfma_f32_32x32x8_bf16 v[32:47], v[80:81], v[66:67], v[32:47]
    v_exp_f32 v24, v24
    v_exp_f32 v25, v25
    v_exp_f32 v26, v26
    v_exp_f32 v27, v27
    v_exp_f32 v28, v28
    v_mfma_f32_32x32x16_bf16 v[192:207], v[84:87], v[48:51], v[192:207]
    v_exp_f32 v29, v29
    v_exp_f32 v30, v30
    v_exp_f32 v31, v31
    v_cvt_pk_bf16_f32 v52, v24, v25
    v_cvt_pk_bf16_f32 v53, v26, v27
    v_cvt_pk_bf16_f32 v54, v28, v29
    v_cvt_pk_bf16_f32 v55, v30, v31
    s_waitcnt lgkmcnt(0)
    v_mfma_f32_32x32x16_bf16 v[16:31], v[72:75], v[56:59], 0
    v_exp_f32 v32, v32
    v_exp_f32 v33, v33
    v_exp_f32 v34, v34
    v_exp_f32 v35, v35
    v_exp_f32 v36, v36
    v_mfma_f32_32x32x16_bf16 v[192:207], v[88:91], v[52:55], v[192:207]
    v_exp_f32 v37, v37
    v_exp_f32 v38, v38
    v_exp_f32 v39, v39
    v_cvt_pk_bf16_f32 v48, v32, v33
    v_cvt_pk_bf16_f32 v49, v34, v35
    v_cvt_pk_bf16_f32 v50, v36, v37
    v_cvt_pk_bf16_f32 v51, v38, v39
    ds_read_b128 v[92:95], v3 offset:10560
    ds_read_b128 v[96:99], v3 offset:11232
    ds_read_b32 v10, v117
    v_mfma_f32_32x32x8_bf16 v[16:31], v[82:83], v[64:65], v[16:31]
    v_exp_f32 v40, v40
    v_exp_f32 v41, v41
    v_exp_f32 v42, v42
    v_exp_f32 v43, v43
    v_exp_f32 v44, v44
    v_mfma_f32_32x32x16_bf16 v[208:223], v[84:87], v[48:51], v[208:223]
    v_exp_f32 v45, v45
    v_exp_f32 v46, v46
    v_exp_f32 v47, v47
    v_cvt_pk_bf16_f32 v52, v40, v41
    v_cvt_pk_bf16_f32 v53, v42, v43
    v_cvt_pk_bf16_f32 v54, v44, v45
    v_cvt_pk_bf16_f32 v55, v46, v47
    s_waitcnt lgkmcnt(0)
A_T1_4:
    v_cmp_gt_u32 vcc, 4, v10
    v_cmp_ge_u32 s[74:75], 4, v10
    s_setprio 1
    s_cmp_lg_u32 vcc_lo, 0
    s_cbranch_scc1 A_T1_4S
A_T1_4R:
    s_cmp_eq_u32 s75, 0
    s_cbranch_scc1 A_T1_4H
    s_setprio 1
A_T1_4H:
    ds_read_b64 v[100:101], v244 offset:0
    ds_read_b64 v[102:103], v244 offset:8
    ds_read_b128 v[104:107], v245 offset:0
    ds_read_b64 v[108:109], v246 offset:0
    ds_read_b64 v[110:111], v246 offset:8
    ds_read_b128 v[112:115], v247 offset:0
    s_waitcnt lgkmcnt(0)
    v_mfma_f32_32x32x16_bf16 v[32:47], v[72:75], v[60:63], 0
    v_exp_f32 v16, v16
    v_exp_f32 v17, v17
    v_exp_f32 v18, v18
    s_add_u32 m0, s94, 142080
    s_add_u32 s70, s93, 61440
    buffer_load_dwordx4 v1, s[20:23], s70 offen sc1 lds
    buffer_load_dwordx4 v1, s[20:23], s70 offen offset:1024 sc1 lds
    v_mfma_f32_32x32x16_bf16 v[224:239], v[100:103], v[104:107], 0
    v_exp_f32 v19, v19
    v_exp_f32 v20, v20
    v_exp_f32 v21, v21
    ds_read_b64 v[100:101], v244 offset:32
    ds_read_b64 v[102:103], v244 offset:40
    ds_read_b128 v[104:107], v245 offset:32
    v_mfma_f32_32x32x16_bf16 v[208:223], v[88:91], v[52:55], v[208:223]
    v_exp_f32 v22, v22
    v_exp_f32 v23, v23
    v_cvt_pk_bf16_f32 v48, v16, v17
    v_cvt_pk_bf16_f32 v49, v18, v19
    ds_read_b128 v[68:71], v4 offset:0
    ds_read_b128 v[76:79], v4 offset:2048
    v_mfma_f32_32x32x16_bf16 v[176:191], v[108:111], v[112:115], 0
    v_cvt_pk_bf16_f32 v50, v20, v21
    v_cvt_pk_bf16_f32 v51, v22, v23
    v_exp_f32 v24, v24
    v_exp_f32 v25, v25
    ds_read_b64 v[108:109], v246 offset:32
    ds_read_b64 v[110:111], v246 offset:40
    ds_read_b128 v[112:115], v247 offset:32
    v_mfma_f32_32x32x8_bf16 v[32:47], v[82:83], v[66:67], v[32:47]
    v_exp_f32 v26, v26
    v_exp_f32 v27, v27
    v_exp_f32 v28, v28
    buffer_load_dwordx4 v1, s[20:23], s70 offen offset:2048 sc1 lds
    s_sub_u32 m0, s69, 16
    s_mov_b64 exec, 1
    global_load_lds_dword v1, s[38:39] offset:16
    s_mov_b64 exec, -1
    v_mfma_f32_32x32x16_bf16 v[192:207], v[92:95], v[48:51], v[192:207]
    v_exp_f32 v29, v29
    v_exp_f32 v30, v30
    v_exp_f32 v31, v31
    v_cvt_pk_bf16_f32 v52, v24, v25
    v_cvt_pk_bf16_f32 v53, v26, v27
    v_cvt_pk_bf16_f32 v54, v28, v29
    v_cvt_pk_bf16_f32 v55, v30, v31
    s_waitcnt lgkmcnt(0)
    v_mfma_f32_32x32x16_bf16 v[16:31], v[68:71], v[56:59], 0
    v_exp_f32 v32, v32
    v_exp_f32 v33, v33
    v_exp_f32 v34, v34
    v_mfma_f32_32x32x16_bf16 v[224:239], v[100:103], v[104:107], v[224:239]
    v_exp_f32 v35, v35
    v_exp_f32 v36, v36
    v_exp_f32 v37, v37
    ds_read_b64 v[100:101], v244 offset:64
    ds_read_b64 v[102:103], v244 offset:72
    ds_read_b128 v[104:107], v245 offset:64
    v_mfma_f32_32x32x16_bf16 v[192:207], v[96:99], v[52:55], v[192:207]
    v_exp_f32 v38, v38
    v_exp_f32 v39, v39
    v_cvt_pk_bf16_f32 v48, v32, v33
    v_cvt_pk_bf16_f32 v49, v34, v35
    ds_read_b128 v[84:87], v5 offset:3072
    ds_read_b128 v[88:91], v5 offset:3744
    v_mfma_f32_32x32x16_bf16 v[176:191], v[108:111], v[112:115], v[176:191]
    v_cvt_pk_bf16_f32 v50, v36, v37
    v_cvt_pk_bf16_f32 v51, v38, v39
    v_exp_f32 v40, v40
    v_exp_f32 v41, v41
    ds_read_b64 v[108:109], v246 offset:64
    ds_read_b64 v[110:111], v246 offset:72
    ds_read_b128 v[112:115], v247 offset:64
    v_mfma_f32_32x32x8_bf16 v[16:31], v[76:77], v[64:65], v[16:31]
    v_exp_f32 v42, v42
    v_exp_f32 v43, v43
    v_exp_f32 v44, v44
    v_mfma_f32_32x32x16_bf16 v[208:223], v[92:95], v[48:51], v[208:223]
    v_exp_f32 v45, v45
    v_exp_f32 v46, v46
    v_exp_f32 v47, v47
    v_cvt_pk_bf16_f32 v52, v40, v41
    v_cvt_pk_bf16_f32 v53, v42, v43
    v_cvt_pk_bf16_f32 v54, v44, v45
    v_cvt_pk_bf16_f32 v55, v46, v47
    s_waitcnt lgkmcnt(0)
    v_mfma_f32_32x32x16_bf16 v[32:47], v[68:71], v[60:63], 0
    v_exp_f32 v16, v16
    v_exp_f32 v17, v17
    v_exp_f32 v18, v18
    v_mfma_f32_32x32x16_bf16 v[224:239], v[100:103], v[104:107], v[224:239]
    v_exp_f32 v19, v19
    v_exp_f32 v20, v20
    v_exp_f32 v21, v21
    ds_read_b64 v[100:101], v244 offset:96
    ds_read_b64 v[102:103], v244 offset:104
    ds_read_b128 v[104:107], v245 offset:96
    v_mfma_f32_32x32x16_bf16 v[208:223], v[96:99], v[52:55], v[208:223]
    v_exp_f32 v22, v22
    v_exp_f32 v23, v23
    v_cvt_pk_bf16_f32 v48, v16, v17
    v_cvt_pk_bf16_f32 v49, v18, v19
    ds_read_b128 v[72:75], v4 offset:1024
    v_mfma_f32_32x32x16_bf16 v[176:191], v[108:111], v[112:115], v[176:191]
    v_cvt_pk_bf16_f32 v50, v20, v21
    v_cvt_pk_bf16_f32 v51, v22, v23
    v_exp_f32 v24, v24
    v_exp_f32 v25, v25
    ds_read_b64 v[108:109], v246 offset:96
    ds_read_b64 v[110:111], v246 offset:104
    ds_read_b128 v[112:115], v247 offset:96
    v_mfma_f32_32x32x8_bf16 v[32:47], v[76:77], v[66:67], v[32:47]
    v_exp_f32 v26, v26
    v_exp_f32 v27, v27
    v_exp_f32 v28, v28
    v_mfma_f32_32x32x16_bf16 v[192:207], v[84:87], v[48:51], v[192:207]
    v_exp_f32 v29, v29
    v_exp_f32 v30, v30
    v_exp_f32 v31, v31
    v_cvt_pk_bf16_f32 v52, v24, v25
    v_cvt_pk_bf16_f32 v53, v26, v27
    v_cvt_pk_bf16_f32 v54, v28, v29
    v_cvt_pk_bf16_f32 v55, v30, v31
    s_waitcnt lgkmcnt(0)
    v_mfma_f32_32x32x16_bf16 v[16:31], v[72:75], v[56:59], 0
    v_exp_f32 v32, v32
    v_exp_f32 v33, v33
    v_exp_f32 v34, v34
    v_mfma_f32_32x32x16_bf16 v[224:239], v[100:103], v[104:107], v[224:239]
    v_exp_f32 v35, v35
    v_exp_f32 v36, v36
    v_exp_f32 v37, v37
    ds_read_b64 v[100:101], v244 offset:128
    ds_read_b64 v[102:103], v244 offset:136
    ds_read_b128 v[104:107], v245 offset:144
    v_mfma_f32_32x32x16_bf16 v[192:207], v[88:91], v[52:55], v[192:207]
    v_exp_f32 v38, v38
    v_exp_f32 v39, v39
    v_cvt_pk_bf16_f32 v48, v32, v33
    v_cvt_pk_bf16_f32 v49, v34, v35
    ds_read_b128 v[92:95], v5 offset:4416
    ds_read_b128 v[96:99], v5 offset:5088
    v_mfma_f32_32x32x16_bf16 v[176:191], v[108:111], v[112:115], v[176:191]
    v_cvt_pk_bf16_f32 v50, v36, v37
    v_cvt_pk_bf16_f32 v51, v38, v39
    v_exp_f32 v40, v40
    v_exp_f32 v41, v41
    ds_read_b64 v[108:109], v246 offset:128
    ds_read_b64 v[110:111], v246 offset:136
    ds_read_b128 v[112:115], v247 offset:144
    v_mfma_f32_32x32x8_bf16 v[16:31], v[78:79], v[64:65], v[16:31]
    v_exp_f32 v42, v42
    v_exp_f32 v43, v43
    v_exp_f32 v44, v44
    v_mfma_f32_32x32x16_bf16 v[208:223], v[84:87], v[48:51], v[208:223]
    v_exp_f32 v45, v45
    v_exp_f32 v46, v46
    v_exp_f32 v47, v47
    v_cvt_pk_bf16_f32 v52, v40, v41
    v_cvt_pk_bf16_f32 v53, v42, v43
    v_cvt_pk_bf16_f32 v54, v44, v45
    v_cvt_pk_bf16_f32 v55, v46, v47
    s_waitcnt lgkmcnt(0)
    v_mfma_f32_32x32x16_bf16 v[32:47], v[72:75], v[60:63], 0
    v_exp_f32 v16, v16
    v_exp_f32 v17, v17
    v_exp_f32 v18, v18
    v_mfma_f32_32x32x16_bf16 v[224:239], v[100:103], v[104:107], v[224:239]
    v_exp_f32 v19, v19
    v_exp_f32 v20, v20
    v_exp_f32 v21, v21
    ds_read_b64 v[100:101], v244 offset:160
    ds_read_b64 v[102:103], v244 offset:168
    ds_read_b128 v[104:107], v245 offset:176
    v_mfma_f32_32x32x16_bf16 v[208:223], v[88:91], v[52:55], v[208:223]
    v_exp_f32 v22, v22
    v_exp_f32 v23, v23
    v_cvt_pk_bf16_f32 v48, v16, v17
    v_cvt_pk_bf16_f32 v49, v18, v19
    ds_read_b128 v[68:71], v4 offset:6144
    ds_read_b128 v[80:83], v4 offset:8192
    v_mfma_f32_32x32x16_bf16 v[176:191], v[108:111], v[112:115], v[176:191]
    v_cvt_pk_bf16_f32 v50, v20, v21
    v_cvt_pk_bf16_f32 v51, v22, v23
    v_exp_f32 v24, v24
    v_exp_f32 v25, v25
    ds_read_b64 v[108:109], v246 offset:160
    ds_read_b64 v[110:111], v246 offset:168
    ds_read_b128 v[112:115], v247 offset:176
    v_mfma_f32_32x32x8_bf16 v[32:47], v[78:79], v[66:67], v[32:47]
    v_exp_f32 v26, v26
    v_exp_f32 v27, v27
    v_exp_f32 v28, v28
    v_mfma_f32_32x32x16_bf16 v[192:207], v[92:95], v[48:51], v[192:207]
    v_exp_f32 v29, v29
    v_exp_f32 v30, v30
    v_exp_f32 v31, v31
    v_cvt_pk_bf16_f32 v52, v24, v25
    v_cvt_pk_bf16_f32 v53, v26, v27
    v_cvt_pk_bf16_f32 v54, v28, v29
    v_cvt_pk_bf16_f32 v55, v30, v31
    s_waitcnt lgkmcnt(0)
    v_mfma_f32_32x32x16_bf16 v[16:31], v[68:71], v[56:59], 0
    v_exp_f32 v32, v32
    v_exp_f32 v33, v33
    v_exp_f32 v34, v34
    v_mfma_f32_32x32x16_bf16 v[224:239], v[100:103], v[104:107], v[224:239]
    v_exp_f32 v35, v35
    v_exp_f32 v36, v36
    v_exp_f32 v37, v37
    ds_read_b64 v[100:101], v244 offset:192
    ds_read_b64 v[102:103], v244 offset:200
    ds_read_b128 v[104:107], v245 offset:208
    v_mfma_f32_32x32x16_bf16 v[192:207], v[96:99], v[52:55], v[192:207]
    v_exp_f32 v38, v38
    v_exp_f32 v39, v39
    v_cvt_pk_bf16_f32 v48, v32, v33
    v_cvt_pk_bf16_f32 v49, v34, v35
    ds_read_b128 v[84:87], v5 offset:9216
    ds_read_b128 v[88:91], v5 offset:9888
    v_mfma_f32_32x32x16_bf16 v[176:191], v[108:111], v[112:115], v[176:191]
    v_cvt_pk_bf16_f32 v50, v36, v37
    v_cvt_pk_bf16_f32 v51, v38, v39
    v_exp_f32 v40, v40
    v_exp_f32 v41, v41
    ds_read_b64 v[108:109], v246 offset:192
    ds_read_b64 v[110:111], v246 offset:200
    ds_read_b128 v[112:115], v247 offset:208
    v_mfma_f32_32x32x8_bf16 v[16:31], v[80:81], v[64:65], v[16:31]
    v_exp_f32 v42, v42
    v_exp_f32 v43, v43
    v_exp_f32 v44, v44
    v_mfma_f32_32x32x16_bf16 v[208:223], v[92:95], v[48:51], v[208:223]
    v_exp_f32 v45, v45
    v_exp_f32 v46, v46
    v_exp_f32 v47, v47
    v_cvt_pk_bf16_f32 v52, v40, v41
    v_cvt_pk_bf16_f32 v53, v42, v43
    v_cvt_pk_bf16_f32 v54, v44, v45
    v_cvt_pk_bf16_f32 v55, v46, v47
    s_waitcnt lgkmcnt(0)
    v_mfma_f32_32x32x16_bf16 v[32:47], v[68:71], v[60:63], 0
    v_exp_f32 v16, v16
    v_exp_f32 v17, v17
    v_exp_f32 v18, v18
    v_mfma_f32_32x32x16_bf16 v[224:239], v[100:103], v[104:107], v[224:239]
    v_exp_f32 v19, v19
    v_exp_f32 v20, v20
    v_exp_f32 v21, v21
    ds_read_b64 v[100:101], v244 offset:224
    ds_read_b64 v[102:103], v244 offset:232
    ds_read_b128 v[104:107], v245 offset:240
    v_mfma_f32_32x32x16_bf16 v[208:223], v[96:99], v[52:55], v[208:223]
    v_exp_f32 v22, v22
    v_exp_f32 v23, v23
    v_cvt_pk_bf16_f32 v48, v16, v17
    v_cvt_pk_bf16_f32 v49, v18, v19
    ds_read_b128 v[72:75], v4 offset:7168
    v_mfma_f32_32x32x16_bf16 v[176:191], v[108:111], v[112:115], v[176:191]
    v_cvt_pk_bf16_f32 v50, v20, v21
    v_cvt_pk_bf16_f32 v51, v22, v23
    v_exp_f32 v24, v24
    v_exp_f32 v25, v25
    ds_read_b64 v[108:109], v246 offset:224
    ds_read_b64 v[110:111], v246 offset:232
    ds_read_b128 v[112:115], v247 offset:240
    v_mfma_f32_32x32x8_bf16 v[32:47], v[80:81], v[66:67], v[32:47]
    v_exp_f32 v26, v26
    v_exp_f32 v27, v27
    v_exp_f32 v28, v28
    v_mfma_f32_32x32x16_bf16 v[192:207], v[84:87], v[48:51], v[192:207]
    v_exp_f32 v29, v29
    v_exp_f32 v30, v30
    v_exp_f32 v31, v31
    v_cvt_pk_bf16_f32 v52, v24, v25
    v_cvt_pk_bf16_f32 v53, v26, v27
    v_cvt_pk_bf16_f32 v54, v28, v29
    v_cvt_pk_bf16_f32 v55, v30, v31
    s_waitcnt lgkmcnt(0)
    v_mfma_f32_32x32x16_bf16 v[16:31], v[72:75], v[56:59], 0
    v_exp_f32 v32, v32
    v_exp_f32 v33, v33
    v_exp_f32 v34, v34
    v_mfma_f32_32x32x16_bf16 v[224:239], v[100:103], v[104:107], v[224:239]
    v_exp_f32 v35, v35
    v_exp_f32 v36, v36
    v_exp_f32 v37, v37
    ds_read_b64 v[100:101], v244 offset:256
    ds_read_b64 v[102:103], v244 offset:264
    ds_read_b128 v[104:107], v245 offset:288
    v_mfma_f32_32x32x16_bf16 v[192:207], v[88:91], v[52:55], v[192:207]
    v_exp_f32 v38, v38
    v_exp_f32 v39, v39
    v_cvt_pk_bf16_f32 v48, v32, v33
    v_cvt_pk_bf16_f32 v49, v34, v35
    ds_read_b128 v[92:95], v5 offset:10560
    ds_read_b128 v[96:99], v5 offset:11232
    ds_read_b32 v10, v117
    v_mfma_f32_32x32x16_bf16 v[176:191], v[108:111], v[112:115], v[176:191]
    v_cvt_pk_bf16_f32 v50, v36, v37
    v_cvt_pk_bf16_f32 v51, v38, v39
    v_exp_f32 v40, v40
    v_exp_f32 v41, v41
    ds_read_b64 v[108:109], v246 offset:256
    ds_read_b64 v[110:111], v246 offset:264
    ds_read_b128 v[112:115], v247 offset:288
    v_mfma_f32_32x32x8_bf16 v[16:31], v[82:83], v[64:65], v[16:31]
    v_exp_f32 v42, v42
    v_exp_f32 v43, v43
    v_exp_f32 v44, v44
    v_mfma_f32_32x32x16_bf16 v[208:223], v[84:87], v[48:51], v[208:223]
    v_exp_f32 v45, v45
    v_exp_f32 v46, v46
    v_exp_f32 v47, v47
    v_cvt_pk_bf16_f32 v52, v40, v41
    v_cvt_pk_bf16_f32 v53, v42, v43
    v_cvt_pk_bf16_f32 v54, v44, v45
    v_cvt_pk_bf16_f32 v55, v46, v47
    s_waitcnt lgkmcnt(0)
A_T1_5:
    v_cmp_gt_u32 vcc, 5, v10
    v_cmp_ge_u32 s[74:75], 5, v10
    s_setprio 1
    s_cmp_lg_u32 vcc_lo, 0
    s_cbranch_scc1 A_T1_5S
A_T1_5R:
    s_cmp_eq_u32 s75, 0
    s_cbranch_scc1 A_T1_5H
    s_setprio 1
A_T1_5H:
    v_mfma_f32_32x32x16_bf16 v[32:47], v[72:75], v[60:63], 0
    v_exp_f32 v16, v16
    v_exp_f32 v17, v17
    v_exp_f32 v18, v18
    s_add_u32 m0, s94, 60672
    s_add_u32 s70, s93, 73728
    buffer_load_dwordx4 v1, s[20:23], s70 offen sc1 lds
    buffer_load_dwordx4 v1, s[20:23], s70 offen offset:1024 sc1 lds
    v_mfma_f32_32x32x16_bf16 v[224:239], v[100:103], v[104:107], v[224:239]
    v_exp_f32 v19, v19
    v_exp_f32 v20, v20
    v_exp_f32 v21, v21
    ds_read_b64 v[100:101], v244 offset:288
    ds_read_b64 v[102:103], v244 offset:296
    ds_read_b128 v[104:107], v245 offset:320
    v_mfma_f32_32x32x16_bf16 v[208:223], v[88:91], v[52:55], v[208:223]
    v_exp_f32 v22, v22
    v_exp_f32 v23, v23
    v_cvt_pk_bf16_f32 v48, v16, v17
    v_cvt_pk_bf16_f32 v49, v18, v19
    ds_read_b128 v[68:71], v6 offset:0
    ds_read_b128 v[76:79], v6 offset:2048
    v_mfma_f32_32x32x16_bf16 v[176:191], v[108:111], v[112:115], v[176:191]
    v_cvt_pk_bf16_f32 v50, v20, v21
    v_cvt_pk_bf16_f32 v51, v22, v23
    v_exp_f32 v24, v24
    v_exp_f32 v25, v25
    ds_read_b64 v[108:109], v246 offset:288
    ds_read_b64 v[110:111], v246 offset:296
    ds_read_b128 v[112:115], v247 offset:320
    v_mfma_f32_32x32x8_bf16 v[32:47], v[82:83], v[66:67], v[32:47]
    v_exp_f32 v26, v26
    v_exp_f32 v27, v27
    v_exp_f32 v28, v28
    buffer_load_dwordx4 v1, s[20:23], s70 offen offset:2048 sc1 lds
    s_sub_u32 m0, s69, 20
    s_mov_b64 exec, 1
    global_load_lds_dword v1, s[38:39] offset:20
    s_mov_b64 exec, -1
    v_mfma_f32_32x32x16_bf16 v[192:207], v[92:95], v[48:51], v[192:207]
    v_exp_f32 v29, v29
    v_exp_f32 v30, v30
    v_exp_f32 v31, v31
    v_cvt_pk_bf16_f32 v52, v24, v25
    v_cvt_pk_bf16_f32 v53, v26, v27
    v_cvt_pk_bf16_f32 v54, v28, v29
    v_cvt_pk_bf16_f32 v55, v30, v31
    s_waitcnt lgkmcnt(0)
    v_mfma_f32_32x32x16_bf16 v[16:31], v[68:71], v[56:59], 0
    v_exp_f32 v32, v32
    v_exp_f32 v33, v33
    v_exp_f32 v34, v34
    v_mfma_f32_32x32x16_bf16 v[224:239], v[100:103], v[104:107], v[224:239]
    v_exp_f32 v35, v35
    v_exp_f32 v36, v36
    v_exp_f32 v37, v37
    ds_read_b64 v[100:101], v244 offset:320
    ds_read_b64 v[102:103], v244 offset:328
    ds_read_b128 v[104:107], v245 offset:352
    v_mfma_f32_32x32x16_bf16 v[192:207], v[96:99], v[52:55], v[192:207]
    v_exp_f32 v38, v38
    v_exp_f32 v39, v39
    v_cvt_pk_bf16_f32 v48, v32, v33
    v_cvt_pk_bf16_f32 v49, v34, v35
    ds_read_b128 v[84:87], v7 offset:3072
    ds_read_b128 v[88:91], v7 offset:3744
    v_mfma_f32_32x32x16_bf16 v[176:191], v[108:111], v[112:115], v[176:191]
    v_cvt_pk_bf16_f32 v50, v36, v37
    v_cvt_pk_bf16_f32 v51, v38, v39
    v_exp_f32 v40, v40
    v_exp_f32 v41, v41
    ds_read_b64 v[108:109], v246 offset:320
    ds_read_b64 v[110:111], v246 offset:328
    ds_read_b128 v[112:115], v247 offset:352
    v_mfma_f32_32x32x8_bf16 v[16:31], v[76:77], v[64:65], v[16:31]
    v_exp_f32 v42, v42
    v_exp_f32 v43, v43
    v_exp_f32 v44, v44
    v_mfma_f32_32x32x16_bf16 v[208:223], v[92:95], v[48:51], v[208:223]
    v_exp_f32 v45, v45
    v_exp_f32 v46, v46
    v_exp_f32 v47, v47
    v_cvt_pk_bf16_f32 v52, v40, v41
    v_cvt_pk_bf16_f32 v53, v42, v43
    v_cvt_pk_bf16_f32 v54, v44, v45
    v_cvt_pk_bf16_f32 v55, v46, v47
    s_waitcnt lgkmcnt(0)
    v_mfma_f32_32x32x16_bf16 v[32:47], v[68:71], v[60:63], 0
    v_exp_f32 v16, v16
    v_exp_f32 v17, v17
    v_exp_f32 v18, v18
    v_mfma_f32_32x32x16_bf16 v[224:239], v[100:103], v[104:107], v[224:239]
    v_exp_f32 v19, v19
    v_exp_f32 v20, v20
    v_exp_f32 v21, v21
    ds_read_b64 v[100:101], v244 offset:352
    ds_read_b64 v[102:103], v244 offset:360
    ds_read_b128 v[104:107], v245 offset:384
    v_mfma_f32_32x32x16_bf16 v[208:223], v[96:99], v[52:55], v[208:223]
    v_exp_f32 v22, v22
    v_exp_f32 v23, v23
    v_cvt_pk_bf16_f32 v48, v16, v17
    v_cvt_pk_bf16_f32 v49, v18, v19
    ds_read_b128 v[72:75], v6 offset:1024
    v_mfma_f32_32x32x16_bf16 v[176:191], v[108:111], v[112:115], v[176:191]
    v_cvt_pk_bf16_f32 v50, v20, v21
    v_cvt_pk_bf16_f32 v51, v22, v23
    v_exp_f32 v24, v24
    v_exp_f32 v25, v25
    ds_read_b64 v[108:109], v246 offset:352
    ds_read_b64 v[110:111], v246 offset:360
    ds_read_b128 v[112:115], v247 offset:384
    v_mfma_f32_32x32x8_bf16 v[32:47], v[76:77], v[66:67], v[32:47]
    v_exp_f32 v26, v26
    v_exp_f32 v27, v27
    v_exp_f32 v28, v28
    v_mfma_f32_32x32x16_bf16 v[192:207], v[84:87], v[48:51], v[192:207]
    v_exp_f32 v29, v29
    v_exp_f32 v30, v30
    v_exp_f32 v31, v31
    v_cvt_pk_bf16_f32 v52, v24, v25
    v_cvt_pk_bf16_f32 v53, v26, v27
    v_cvt_pk_bf16_f32 v54, v28, v29
    v_cvt_pk_bf16_f32 v55, v30, v31
    s_waitcnt lgkmcnt(0)
    v_mfma_f32_32x32x16_bf16 v[16:31], v[72:75], v[56:59], 0
    v_exp_f32 v32, v32
    v_exp_f32 v33, v33
    v_exp_f32 v34, v34
    v_mfma_f32_32x32x16_bf16 v[224:239], v[100:103], v[104:107], v[224:239]
    v_exp_f32 v35, v35
    v_exp_f32 v36, v36
    v_exp_f32 v37, v37
    ds_read_b64 v[100:101], v244 offset:384
    ds_read_b64 v[102:103], v244 offset:392
    ds_read_b128 v[104:107], v245 offset:432
    v_mfma_f32_32x32x16_bf16 v[192:207], v[88:91], v[52:55], v[192:207]
    v_exp_f32 v38, v38
    v_exp_f32 v39, v39
    v_cvt_pk_bf16_f32 v48, v32, v33
    v_cvt_pk_bf16_f32 v49, v34, v35
    ds_read_b128 v[92:95], v7 offset:4416
    ds_read_b128 v[96:99], v7 offset:5088
    v_mfma_f32_32x32x16_bf16 v[176:191], v[108:111], v[112:115], v[176:191]
    v_cvt_pk_bf16_f32 v50, v36, v37
    v_cvt_pk_bf16_f32 v51, v38, v39
    v_exp_f32 v40, v40
    v_exp_f32 v41, v41
    ds_read_b64 v[108:109], v246 offset:384
    ds_read_b64 v[110:111], v246 offset:392
    ds_read_b128 v[112:115], v247 offset:432
    v_mfma_f32_32x32x8_bf16 v[16:31], v[78:79], v[64:65], v[16:31]
    v_exp_f32 v42, v42
    v_exp_f32 v43, v43
    v_exp_f32 v44, v44
    v_mfma_f32_32x32x16_bf16 v[208:223], v[84:87], v[48:51], v[208:223]
    v_exp_f32 v45, v45
    v_exp_f32 v46, v46
    v_exp_f32 v47, v47
    v_cvt_pk_bf16_f32 v52, v40, v41
    v_cvt_pk_bf16_f32 v53, v42, v43
    v_cvt_pk_bf16_f32 v54, v44, v45
    v_cvt_pk_bf16_f32 v55, v46, v47
    s_waitcnt lgkmcnt(0)
    v_mfma_f32_32x32x16_bf16 v[32:47], v[72:75], v[60:63], 0
    v_exp_f32 v16, v16
    v_exp_f32 v17, v17
    v_exp_f32 v18, v18
    v_mfma_f32_32x32x16_bf16 v[224:239], v[100:103], v[104:107], v[224:239]
    v_exp_f32 v19, v19
    v_exp_f32 v20, v20
    v_exp_f32 v21, v21
    ds_read_b64 v[100:101], v244 offset:416
    ds_read_b64 v[102:103], v244 offset:424
    ds_read_b128 v[104:107], v245 offset:464
    v_mfma_f32_32x32x16_bf16 v[208:223], v[88:91], v[52:55], v[208:223]
    v_exp_f32 v22, v22
    v_exp_f32 v23, v23
    v_cvt_pk_bf16_f32 v48, v16, v17
    v_cvt_pk_bf16_f32 v49, v18, v19
    ds_read_b128 v[68:71], v6 offset:6144
    ds_read_b128 v[80:83], v6 offset:8192
    v_mfma_f32_32x32x16_bf16 v[176:191], v[108:111], v[112:115], v[176:191]
    v_cvt_pk_bf16_f32 v50, v20, v21
    v_cvt_pk_bf16_f32 v51, v22, v23
    v_exp_f32 v24, v24
    v_exp_f32 v25, v25
    ds_read_b64 v[108:109], v246 offset:416
    ds_read_b64 v[110:111], v246 offset:424
    ds_read_b128 v[112:115], v247 offset:464
    v_mfma_f32_32x32x8_bf16 v[32:47], v[78:79], v[66:67], v[32:47]
    v_exp_f32 v26, v26
    v_exp_f32 v27, v27
    v_exp_f32 v28, v28
    v_mfma_f32_32x32x16_bf16 v[192:207], v[92:95], v[48:51], v[192:207]
    v_exp_f32 v29, v29
    v_exp_f32 v30, v30
    v_exp_f32 v31, v31
    v_cvt_pk_bf16_f32 v52, v24, v25
    v_cvt_pk_bf16_f32 v53, v26, v27
    v_cvt_pk_bf16_f32 v54, v28, v29
    v_cvt_pk_bf16_f32 v55, v30, v31
    s_waitcnt lgkmcnt(0)
    v_mfma_f32_32x32x16_bf16 v[16:31], v[68:71], v[56:59], 0
    v_exp_f32 v32, v32
    v_exp_f32 v33, v33
    v_exp_f32 v34, v34
    v_mfma_f32_32x32x16_bf16 v[224:239], v[100:103], v[104:107], v[224:239]
    v_exp_f32 v35, v35
    v_exp_f32 v36, v36
    v_exp_f32 v37, v37
    ds_read_b64 v[100:101], v244 offset:448
    ds_read_b64 v[102:103], v244 offset:456
    ds_read_b128 v[104:107], v245 offset:496
    v_mfma_f32_32x32x16_bf16 v[192:207], v[96:99], v[52:55], v[192:207]
    v_exp_f32 v38, v38
    v_exp_f32 v39, v39
    v_cvt_pk_bf16_f32 v48, v32, v33
    v_cvt_pk_bf16_f32 v49, v34, v35
    ds_read_b128 v[84:87], v7 offset:9216
    ds_read_b128 v[88:91], v7 offset:9888
    v_mfma_f32_32x32x16_bf16 v[176:191], v[108:111], v[112:115], v[176:191]
    v_cvt_pk_bf16_f32 v50, v36, v37
    v_cvt_pk_bf16_f32 v51, v38, v39
    v_exp_f32 v40, v40
    v_exp_f32 v41, v41
    ds_read_b64 v[108:109], v246 offset:448
    ds_read_b64 v[110:111], v246 offset:456
    ds_read_b128 v[112:115], v247 offset:496
    v_mfma_f32_32x32x8_bf16 v[16:31], v[80:81], v[64:65], v[16:31]
    v_exp_f32 v42, v42
    v_exp_f32 v43, v43
    v_exp_f32 v44, v44
    v_mfma_f32_32x32x16_bf16 v[208:223], v[92:95], v[48:51], v[208:223]
    v_exp_f32 v45, v45
    v_exp_f32 v46, v46
    v_exp_f32 v47, v47
    v_cvt_pk_bf16_f32 v52, v40, v41
    v_cvt_pk_bf16_f32 v53, v42, v43
    v_cvt_pk_bf16_f32 v54, v44, v45
    v_cvt_pk_bf16_f32 v55, v46, v47
    s_waitcnt lgkmcnt(0)
    v_mfma_f32_32x32x16_bf16 v[32:47], v[68:71], v[60:63], 0
    v_exp_f32 v16, v16
    v_exp_f32 v17, v17
    v_exp_f32 v18, v18
    v_mfma_f32_32x32x16_bf16 v[224:239], v[100:103], v[104:107], v[224:239]
    v_exp_f32 v19, v19
    v_exp_f32 v20, v20
    v_exp_f32 v21, v21
    ds_read_b64 v[100:101], v244 offset:480
    ds_read_b64 v[102:103], v244 offset:488
    ds_read_b128 v[104:107], v245 offset:528
    v_mfma_f32_32x32x16_bf16 v[208:223], v[96:99], v[52:55], v[208:223]
    v_exp_f32 v22, v22
    v_exp_f32 v23, v23
    v_cvt_pk_bf16_f32 v48, v16, v17
    v_cvt_pk_bf16_f32 v49, v18, v19
    ds_read_b128 v[72:75], v6 offset:7168
    v_mfma_f32_32x32x16_bf16 v[176:191], v[108:111], v[112:115], v[176:191]
    v_cvt_pk_bf16_f32 v50, v20, v21
    v_cvt_pk_bf16_f32 v51, v22, v23
    v_exp_f32 v24, v24
    v_exp_f32 v25, v25
    ds_read_b64 v[108:109], v246 offset:480
    ds_read_b64 v[110:111], v246 offset:488
    ds_read_b128 v[112:115], v247 offset:528
    v_mfma_f32_32x32x8_bf16 v[32:47], v[80:81], v[66:67], v[32:47]
    v_exp_f32 v26, v26
    v_exp_f32 v27, v27
    v_exp_f32 v28, v28
    v_mfma_f32_32x32x16_bf16 v[192:207], v[84:87], v[48:51], v[192:207]
    v_exp_f32 v29, v29
    v_exp_f32 v30, v30
    v_exp_f32 v31, v31
    v_cvt_pk_bf16_f32 v52, v24, v25
    v_cvt_pk_bf16_f32 v53, v26, v27
    v_cvt_pk_bf16_f32 v54, v28, v29
    v_cvt_pk_bf16_f32 v55, v30, v31
    s_waitcnt lgkmcnt(0)
    v_mfma_f32_32x32x16_bf16 v[16:31], v[72:75], v[56:59], 0
    v_exp_f32 v32, v32
    v_exp_f32 v33, v33
    v_exp_f32 v34, v34
    v_mfma_f32_32x32x16_bf16 v[224:239], v[100:103], v[104:107], v[224:239]
    v_exp_f32 v35, v35
    v_exp_f32 v36, v36
    v_exp_f32 v37, v37
    ds_read_b64 v[100:101], v244 offset:512
    ds_read_b64 v[102:103], v244 offset:520
    ds_read_b128 v[104:107], v245 offset:576
    v_mfma_f32_32x32x16_bf16 v[192:207], v[88:91], v[52:55], v[192:207]
    v_exp_f32 v38, v38
    v_exp_f32 v39, v39
    v_cvt_pk_bf16_f32 v48, v32, v33
    v_cvt_pk_bf16_f32 v49, v34, v35
    ds_read_b128 v[92:95], v7 offset:10560
    ds_read_b128 v[96:99], v7 offset:11232
    ds_read_b32 v10, v117
    v_mfma_f32_32x32x16_bf16 v[176:191], v[108:111], v[112:115], v[176:191]
    v_cvt_pk_bf16_f32 v50, v36, v37
    v_cvt_pk_bf16_f32 v51, v38, v39
    v_exp_f32 v40, v40
    v_exp_f32 v41, v41
    ds_read_b64 v[108:109], v246 offset:512
    ds_read_b64 v[110:111], v246 offset:520
    ds_read_b128 v[112:115], v247 offset:576
    v_mfma_f32_32x32x8_bf16 v[16:31], v[82:83], v[64:65], v[16:31]
    v_exp_f32 v42, v42
    v_exp_f32 v43, v43
    v_exp_f32 v44, v44
    v_mfma_f32_32x32x16_bf16 v[208:223], v[84:87], v[48:51], v[208:223]
    v_exp_f32 v45, v45
    v_exp_f32 v46, v46
    v_exp_f32 v47, v47
    v_cvt_pk_bf16_f32 v52, v40, v41
    v_cvt_pk_bf16_f32 v53, v42, v43
    v_cvt_pk_bf16_f32 v54, v44, v45
    v_cvt_pk_bf16_f32 v55, v46, v47
    s_waitcnt lgkmcnt(0)
A_T1_6:
    v_cmp_gt_u32 vcc, 6, v10
    v_cmp_ge_u32 s[74:75], 6, v10
    s_setprio 1
    s_cmp_lg_u32 vcc_lo, 0
    s_cbranch_scc1 A_T1_6S
A_T1_6R:
    s_cmp_eq_u32 s75, 0
    s_cbranch_scc1 A_T1_6H
    s_setprio 1
A_T1_6H:
    v_mfma_f32_32x32x16_bf16 v[32:47], v[72:75], v[60:63], 0
    v_exp_f32 v16, v16
    v_exp_f32 v17, v17
    v_exp_f32 v18, v18
    s_add_u32 m0, s94, 8448
    s_add_u32 s70, s93, 86016
    buffer_load_dwordx4 v1, s[20:23], s70 offen sc1 lds
    buffer_load_dwordx4 v1, s[20:23], s70 offen offset:1024 sc1 lds
    v_mfma_f32_32x32x16_bf16 v[224:239], v[100:103], v[104:107], v[224:239]
    v_exp_f32 v19, v19
    v_exp_f32 v20, v20
    v_exp_f32 v21, v21
    ds_read_b64 v[100:101], v244 offset:544
    ds_read_b64 v[102:103], v244 offset:552
    ds_read_b128 v[104:107], v245 offset:608
    v_mfma_f32_32x32x16_bf16 v[208:223], v[88:91], v[52:55], v[208:223]
    v_exp_f32 v22, v22
    v_exp_f32 v23, v23
    v_cvt_pk_bf16_f32 v48, v16, v17
    v_cvt_pk_bf16_f32 v49, v18, v19
    ds_read_b128 v[68:71], v2 offset:0
    ds_read_b128 v[76:79], v2 offset:2048
    v_mfma_f32_32x32x16_bf16 v[176:191], v[108:111], v[112:115], v[176:191]
    v_cvt_pk_bf16_f32 v50, v20, v21
    v_cvt_pk_bf16_f32 v51, v22, v23
    v_exp_f32 v24, v24
    v_exp_f32 v25, v25
    ds_read_b64 v[108:109], v246 offset:544
    ds_read_b64 v[110:111], v246 offset:552
    ds_read_b128 v[112:115], v247 offset:608
    v_mfma_f32_32x32x8_bf16 v[32:47], v[82:83], v[66:67], v[32:47]
    v_exp_f32 v26, v26
    v_exp_f32 v27, v27
    v_exp_f32 v28, v28
    buffer_load_dwordx4 v1, s[20:23], s70 offen offset:2048 sc1 lds
    s_sub_u32 m0, s69, 24
    s_mov_b64 exec, 1
    global_load_lds_dword v1, s[38:39] offset:24
    s_mov_b64 exec, -1
    v_mfma_f32_32x32x16_bf16 v[192:207], v[92:95], v[48:51], v[192:207]
    v_exp_f32 v29, v29
    v_exp_f32 v30, v30
    v_exp_f32 v31, v31
    v_cvt_pk_bf16_f32 v52, v24, v25
    v_cvt_pk_bf16_f32 v53, v26, v27
    v_cvt_pk_bf16_f32 v54, v28, v29
    v_cvt_pk_bf16_f32 v55, v30, v31
    s_waitcnt lgkmcnt(0)
    v_mfma_f32_32x32x16_bf16 v[16:31], v[68:71], v[56:59], 0
    v_exp_f32 v32, v32
    v_exp_f32 v33, v33
    v_exp_f32 v34, v34
    s_waitcnt vmcnt(37)
    buffer_load_dwordx4 v[140:143], v132, s[24:27], s78 offen
    v_mfma_f32_32x32x16_bf16 v[224:239], v[100:103], v[104:107], v[224:239]
    v_exp_f32 v35, v35
    v_exp_f32 v36, v36
    v_exp_f32 v37, v37
    ds_read_b64 v[100:101], v244 offset:576
    ds_read_b64 v[102:103], v244 offset:584
    ds_read_b128 v[104:107], v245 offset:640
    v_mfma_f32_32x32x16_bf16 v[192:207], v[96:99], v[52:55], v[192:207]
    v_exp_f32 v38, v38
    v_exp_f32 v39, v39
    v_cvt_pk_bf16_f32 v48, v32, v33
    v_cvt_pk_bf16_f32 v49, v34, v35
    ds_read_b128 v[84:87], v3 offset:3072
    ds_read_b128 v[88:91], v3 offset:3744
    v_mfma_f32_32x32x16_bf16 v[176:191], v[108:111], v[112:115], v[176:191]
    v_cvt_pk_bf16_f32 v50, v36, v37
    v_cvt_pk_bf16_f32 v51, v38, v39
    v_exp_f32 v40, v40
    v_exp_f32 v41, v41
    ds_read_b64 v[108:109], v246 offset:576
    ds_read_b64 v[110:111], v246 offset:584
    ds_read_b128 v[112:115], v247 offset:640
    v_mfma_f32_32x32x8_bf16 v[16:31], v[76:77], v[64:65], v[16:31]
    v_exp_f32 v42, v42
    v_exp_f32 v43, v43
    v_exp_f32 v44, v44
    v_mfma_f32_32x32x16_bf16 v[208:223], v[92:95], v[48:51], v[208:223]
    v_exp_f32 v45, v45
    v_exp_f32 v46, v46
    v_exp_f32 v47, v47
    v_cvt_pk_bf16_f32 v52, v40, v41
    v_cvt_pk_bf16_f32 v53, v42, v43
    v_cvt_pk_bf16_f32 v54, v44, v45
    v_cvt_pk_bf16_f32 v55, v46, v47
    s_waitcnt lgkmcnt(0)
    v_mfma_f32_32x32x16_bf16 v[32:47], v[68:71], v[60:63], 0
    v_exp_f32 v16, v16
    v_exp_f32 v17, v17
    v_exp_f32 v18, v18
    buffer_load_dwordx4 v[144:147], v133, s[24:27], s78 offen
    v_mfma_f32_32x32x16_bf16 v[224:239], v[100:103], v[104:107], v[224:239]
    v_exp_f32 v19, v19
    v_exp_f32 v20, v20
    v_exp_f32 v21, v21
    ds_read_b64 v[100:101], v244 offset:608
    ds_read_b64 v[102:103], v244 offset:616
    ds_read_b128 v[104:107], v245 offset:672
    v_mfma_f32_32x32x16_bf16 v[208:223], v[96:99], v[52:55], v[208:223]
    v_exp_f32 v22, v22
    v_exp_f32 v23, v23
    v_cvt_pk_bf16_f32 v48, v16, v17
    v_cvt_pk_bf16_f32 v49, v18, v19
    ds_read_b128 v[72:75], v2 offset:1024
    v_mfma_f32_32x32x16_bf16 v[176:191], v[108:111], v[112:115], v[176:191]
    v_cvt_pk_bf16_f32 v50, v20, v21
    v_cvt_pk_bf16_f32 v51, v22, v23
    v_exp_f32 v24, v24
    v_exp_f32 v25, v25
    ds_read_b64 v[108:109], v246 offset:608
    ds_read_b64 v[110:111], v246 offset:616
    ds_read_b128 v[112:115], v247 offset:672
    v_mfma_f32_32x32x8_bf16 v[32:47], v[76:77], v[66:67], v[32:47]
    v_exp_f32 v26, v26
    v_exp_f32 v27, v27
    v_exp_f32 v28, v28
    v_mfma_f32_32x32x16_bf16 v[192:207], v[84:87], v[48:51], v[192:207]
    v_exp_f32 v29, v29
    v_exp_f32 v30, v30
    v_exp_f32 v31, v31
    v_cvt_pk_bf16_f32 v52, v24, v25
    v_cvt_pk_bf16_f32 v53, v26, v27
    v_cvt_pk_bf16_f32 v54, v28, v29
    v_cvt_pk_bf16_f32 v55, v30, v31
    s_waitcnt lgkmcnt(0)
    v_mfma_f32_32x32x16_bf16 v[16:31], v[72:75], v[56:59], 0
    v_exp_f32 v32, v32
    v_exp_f32 v33, v33
    v_exp_f32 v34, v34
    buffer_load_dwordx4 v[148:151], v134, s[24:27], s78 offen
    v_mfma_f32_32x32x16_bf16 v[224:239], v[100:103], v[104:107], v[224:239]
    v_exp_f32 v35, v35
    v_exp_f32 v36, v36
    v_exp_f32 v37, v37
    ds_read_b64 v[100:101], v244 offset:640
    ds_read_b64 v[102:103], v244 offset:648
    ds_read_b128 v[104:107], v245 offset:720
    v_mfma_f32_32x32x16_bf16 v[192:207], v[88:91], v[52:55], v[192:207]
    v_exp_f32 v38, v38
    v_exp_f32 v39, v39
    v_cvt_pk_bf16_f32 v48, v32, v33
    v_cvt_pk_bf16_f32 v49, v34, v35
    ds_read_b128 v[92:95], v3 offset:4416
    ds_read_b128 v[96:99], v3 offset:5088
    v_mfma_f32_32x32x16_bf16 v[176:191], v[108:111], v[112:115], v[176:191]
    v_cvt_pk_bf16_f32 v50, v36, v37
    v_cvt_pk_bf16_f32 v51, v38, v39
    v_exp_f32 v40, v40
    v_exp_f32 v41, v41
    ds_read_b64 v[108:109], v246 offset:640
    ds_read_b64 v[110:111], v246 offset:648
    ds_read_b128 v[112:115], v247 offset:720
    v_mfma_f32_32x32x8_bf16 v[16:31], v[78:79], v[64:65], v[16:31]
    v_exp_f32 v42, v42
    v_exp_f32 v43, v43
    v_exp_f32 v44, v44
    v_mfma_f32_32x32x16_bf16 v[208:223], v[84:87], v[48:51], v[208:223]
    v_exp_f32 v45, v45
    v_exp_f32 v46, v46
    v_exp_f32 v47, v47
    v_cvt_pk_bf16_f32 v52, v40, v41
    v_cvt_pk_bf16_f32 v53, v42, v43
    v_cvt_pk_bf16_f32 v54, v44, v45
    v_cvt_pk_bf16_f32 v55, v46, v47
    s_waitcnt lgkmcnt(0)
    v_mfma_f32_32x32x16_bf16 v[32:47], v[72:75], v[60:63], 0
    v_exp_f32 v16, v16
    v_exp_f32 v17, v17
    v_exp_f32 v18, v18
    buffer_load_dwordx4 v[152:155], v135, s[24:27], s78 offen
    v_mfma_f32_32x32x16_bf16 v[224:239], v[100:103], v[104:107], v[224:239]
    v_exp_f32 v19, v19
    v_exp_f32 v20, v20
    v_exp_f32 v21, v21
    ds_read_b64 v[100:101], v244 offset:672
    ds_read_b64 v[102:103], v244 offset:680
    ds_read_b128 v[104:107], v245 offset:752
    v_mfma_f32_32x32x16_bf16 v[208:223], v[88:91], v[52:55], v[208:223]
    v_exp_f32 v22, v22
    v_exp_f32 v23, v23
    v_cvt_pk_bf16_f32 v48, v16, v17
    v_cvt_pk_bf16_f32 v49, v18, v19
    ds_read_b128 v[68:71], v2 offset:6144
    ds_read_b128 v[80:83], v2 offset:8192
    v_mfma_f32_32x32x16_bf16 v[176:191], v[108:111], v[112:115], v[176:191]
    v_cvt_pk_bf16_f32 v50, v20, v21
    v_cvt_pk_bf16_f32 v51, v22, v23
    v_exp_f32 v24, v24
    v_exp_f32 v25, v25
    ds_read_b64 v[108:109], v246 offset:672
    ds_read_b64 v[110:111], v246 offset:680
    ds_read_b128 v[112:115], v247 offset:752
    v_mfma_f32_32x32x8_bf16 v[32:47], v[78:79], v[66:67], v[32:47]
    v_exp_f32 v26, v26
    v_exp_f32 v27, v27
    v_exp_f32 v28, v28
    v_mfma_f32_32x32x16_bf16 v[192:207], v[92:95], v[48:51], v[192:207]
    v_exp_f32 v29, v29
    v_exp_f32 v30, v30
    v_exp_f32 v31, v31
    v_cvt_pk_bf16_f32 v52, v24, v25
    v_cvt_pk_bf16_f32 v53, v26, v27
    v_cvt_pk_bf16_f32 v54, v28, v29
    v_cvt_pk_bf16_f32 v55, v30, v31
    s_waitcnt lgkmcnt(0)
    v_mfma_f32_32x32x16_bf16 v[16:31], v[68:71], v[56:59], 0
    v_exp_f32 v32, v32
    v_exp_f32 v33, v33
    v_exp_f32 v34, v34
    buffer_load_dwordx4 v[156:159], v136, s[24:27], s78 offen
    s_add_u32 s78, s78, 163840
    s_sub_u32 s6, s78, 819200
    s_cmp_lt_u32 s78, 819200
    s_cselect_b32 s78, s78, s6
    v_mfma_f32_32x32x16_bf16 v[224:239], v[100:103], v[104:107], v[224:239]
    v_exp_f32 v35, v35
    v_exp_f32 v36, v36
    v_exp_f32 v37, v37
    ds_read_b64 v[100:101], v244 offset:704
    ds_read_b64 v[102:103], v244 offset:712
    ds_read_b128 v[104:107], v245 offset:784
    v_mfma_f32_32x32x16_bf16 v[192:207], v[96:99], v[52:55], v[192:207]
    v_exp_f32 v38, v38
    v_exp_f32 v39, v39
    v_cvt_pk_bf16_f32 v48, v32, v33
    v_cvt_pk_bf16_f32 v49, v34, v35
    ds_read_b128 v[84:87], v3 offset:9216
    ds_read_b128 v[88:91], v3 offset:9888
    v_mfma_f32_32x32x16_bf16 v[176:191], v[108:111], v[112:115], v[176:191]
    v_cvt_pk_bf16_f32 v50, v36, v37
    v_cvt_pk_bf16_f32 v51, v38, v39
    v_exp_f32 v40, v40
    v_exp_f32 v41, v41
    ds_read_b64 v[108:109], v246 offset:704
    ds_read_b64 v[110:111], v246 offset:712
    ds_read_b128 v[112:115], v247 offset:784
    v_mfma_f32_32x32x8_bf16 v[16:31], v[80:81], v[64:65], v[16:31]
    v_exp_f32 v42, v42
    v_exp_f32 v43, v43
    v_exp_f32 v44, v44
    v_mfma_f32_32x32x16_bf16 v[208:223], v[92:95], v[48:51], v[208:223]
    v_exp_f32 v45, v45
    v_exp_f32 v46, v46
    v_exp_f32 v47, v47
    v_cvt_pk_bf16_f32 v52, v40, v41
    v_cvt_pk_bf16_f32 v53, v42, v43
    v_cvt_pk_bf16_f32 v54, v44, v45
    v_cvt_pk_bf16_f32 v55, v46, v47
    s_waitcnt lgkmcnt(0)
    v_mfma_f32_32x32x16_bf16 v[32:47], v[68:71], v[60:63], 0
    v_exp_f32 v16, v16
    v_exp_f32 v17, v17
    v_exp_f32 v18, v18
    v_mfma_f32_32x32x16_bf16 v[224:239], v[100:103], v[104:107], v[224:239]
    v_exp_f32 v19, v19
    v_exp_f32 v20, v20
    v_exp_f32 v21, v21
    ds_read_b64 v[100:101], v244 offset:736
    ds_read_b64 v[102:103], v244 offset:744
    ds_read_b128 v[104:107], v245 offset:816
    v_mfma_f32_32x32x16_bf16 v[208:223], v[96:99], v[52:55], v[208:223]
    v_exp_f32 v22, v22
    v_exp_f32 v23, v23
    v_cvt_pk_bf16_f32 v48, v16, v17
    v_cvt_pk_bf16_f32 v49, v18, v19
    ds_read_b128 v[72:75], v2 offset:7168
    v_mfma_f32_32x32x16_bf16 v[176:191], v[108:111], v[112:115], v[176:191]
    v_cvt_pk_bf16_f32 v50, v20, v21
    v_cvt_pk_bf16_f32 v51, v22, v23
    v_exp_f32 v24, v24
    v_exp_f32 v25, v25
    ds_read_b64 v[108:109], v246 offset:736
    ds_read_b64 v[110:111], v246 offset:744
    ds_read_b128 v[112:115], v247 offset:816
    v_mfma_f32_32x32x8_bf16 v[32:47], v[80:81], v[66:67], v[32:47]
    v_exp_f32 v26, v26
    v_exp_f32 v27, v27
    v_exp_f32 v28, v28
    v_mfma_f32_32x32x16_bf16 v[192:207], v[84:87], v[48:51], v[192:207]
    v_exp_f32 v29, v29
    v_exp_f32 v30, v30
    v_exp_f32 v31, v31
    v_cvt_pk_bf16_f32 v52, v24, v25
    v_cvt_pk_bf16_f32 v53, v26, v27
    v_cvt_pk_bf16_f32 v54, v28, v29
    v_cvt_pk_bf16_f32 v55, v30, v31
    s_waitcnt lgkmcnt(0)
    v_mfma_f32_32x32x16_bf16 v[16:31], v[72:75], v[56:59], 0
    v_exp_f32 v32, v32
    v_exp_f32 v33, v33
    v_exp_f32 v34, v34
    v_mfma_f32_32x32x16_bf16 v[224:239], v[100:103], v[104:107], v[224:239]
    v_exp_f32 v35, v35
    v_exp_f32 v36, v36
    v_exp_f32 v37, v37
    ds_read_b64 v[100:101], v244 offset:768
    ds_read_b64 v[102:103], v244 offset:776
    ds_read_b128 v[104:107], v245 offset:864
    v_mfma_f32_32x32x16_bf16 v[192:207], v[88:91], v[52:55], v[192:207]
    v_exp_f32 v38, v38
    v_exp_f32 v39, v39
    v_cvt_pk_bf16_f32 v48, v32, v33
    v_cvt_pk_bf16_f32 v49, v34, v35
    ds_read_b128 v[92:95], v3 offset:10560
    ds_read_b128 v[96:99], v3 offset:11232
    ds_read_b32 v10, v117
    v_mfma_f32_32x32x16_bf16 v[176:191], v[108:111], v[112:115], v[176:191]
    v_cvt_pk_bf16_f32 v50, v36, v37
    v_cvt_pk_bf16_f32 v51, v38, v39
    v_exp_f32 v40, v40
    v_exp_f32 v41, v41
    ds_read_b64 v[108:109], v246 offset:768
    ds_read_b64 v[110:111], v246 offset:776
    ds_read_b128 v[112:115], v247 offset:864
    v_mfma_f32_32x32x8_bf16 v[16:31], v[82:83], v[64:65], v[16:31]
    v_exp_f32 v42, v42
    v_exp_f32 v43, v43
    v_exp_f32 v44, v44
    v_mfma_f32_32x32x16_bf16 v[208:223], v[84:87], v[48:51], v[208:223]
    v_exp_f32 v45, v45
    v_exp_f32 v46, v46
    v_exp_f32 v47, v47
    v_cvt_pk_bf16_f32 v52, v40, v41
    v_cvt_pk_bf16_f32 v53, v42, v43
    v_cvt_pk_bf16_f32 v54, v44, v45
    v_cvt_pk_bf16_f32 v55, v46, v47
    s_waitcnt lgkmcnt(0)
A_T1_7:
    v_cmp_gt_u32 vcc, 7, v10
    v_cmp_ge_u32 s[74:75], 7, v10
    s_setprio 1
    s_cmp_lg_u32 vcc_lo, 0
    s_cbranch_scc1 A_T1_7S
A_T1_7R:
    s_cmp_eq_u32 s75, 0
    s_cbranch_scc1 A_T1_7H
    s_setprio 1
A_T1_7H:
    v_mfma_f32_32x32x16_bf16 v[32:47], v[72:75], v[60:63], 0
    v_exp_f32 v16, v16
    v_exp_f32 v17, v17
    v_exp_f32 v18, v18
    s_sub_u32 m0, s69, 28
    s_mov_b64 exec, 1
    global_load_lds_dword v1, s[38:39] offset:28
    s_mov_b64 exec, -1
    v_mfma_f32_32x32x16_bf16 v[224:239], v[100:103], v[104:107], v[224:239]
    v_exp_f32 v19, v19
    v_exp_f32 v20, v20
    v_exp_f32 v21, v21
    ds_read_b64 v[100:101], v244 offset:800
    ds_read_b64 v[102:103], v244 offset:808
    ds_read_b128 v[104:107], v245 offset:896
    v_mfma_f32_32x32x16_bf16 v[208:223], v[88:91], v[52:55], v[208:223]
    v_exp_f32 v22, v22
    v_exp_f32 v23, v23
    v_cvt_pk_bf16_f32 v48, v16, v17
    v_cvt_pk_bf16_f32 v49, v18, v19
    ds_read_b128 v[68:71], v4 offset:0
    ds_read_b128 v[76:79], v4 offset:2048
    v_mfma_f32_32x32x16_bf16 v[176:191], v[108:111], v[112:115], v[176:191]
    v_cvt_pk_bf16_f32 v50, v20, v21
    v_cvt_pk_bf16_f32 v51, v22, v23
    v_exp_f32 v24, v24
    v_exp_f32 v25, v25
    ds_read_b64 v[108:109], v246 offset:800
    ds_read_b64 v[110:111], v246 offset:808
    ds_read_b128 v[112:115], v247 offset:896
    v_mfma_f32_32x32x8_bf16 v[32:47], v[82:83], v[66:67], v[32:47]
    v_exp_f32 v26, v26
    v_exp_f32 v27, v27
    v_exp_f32 v28, v28
    v_mfma_f32_32x32x16_bf16 v[192:207], v[92:95], v[48:51], v[192:207]
    v_exp_f32 v29, v29
    v_exp_f32 v30, v30
    v_exp_f32 v31, v31
    v_cvt_pk_bf16_f32 v52, v24, v25
    v_cvt_pk_bf16_f32 v53, v26, v27
    v_cvt_pk_bf16_f32 v54, v28, v29
    v_cvt_pk_bf16_f32 v55, v30, v31
    s_waitcnt lgkmcnt(0)
    v_mfma_f32_32x32x16_bf16 v[16:31], v[68:71], v[56:59], 0
    v_exp_f32 v32, v32
    v_exp_f32 v33, v33
    v_exp_f32 v34, v34
    v_mfma_f32_32x32x16_bf16 v[224:239], v[100:103], v[104:107], v[224:239]
    v_exp_f32 v35, v35
    v_exp_f32 v36, v36
    v_exp_f32 v37, v37
    ds_read_b64 v[100:101], v244 offset:832
    ds_read_b64 v[102:103], v244 offset:840
    ds_read_b128 v[104:107], v245 offset:928
    v_mfma_f32_32x32x16_bf16 v[192:207], v[96:99], v[52:55], v[192:207]
    v_exp_f32 v38, v38
    v_exp_f32 v39, v39
    v_cvt_pk_bf16_f32 v48, v32, v33
    v_cvt_pk_bf16_f32 v49, v34, v35
    ds_read_b128 v[84:87], v5 offset:3072
    ds_read_b128 v[88:91], v5 offset:3744
    v_mfma_f32_32x32x16_bf16 v[176:191], v[108:111], v[112:115], v[176:191]
    v_cvt_pk_bf16_f32 v50, v36, v37
    v_cvt_pk_bf16_f32 v51, v38, v39
    v_exp_f32 v40, v40
    v_exp_f32 v41, v41
    ds_read_b64 v[108:109], v246 offset:832
    ds_read_b64 v[110:111], v246 offset:840
    ds_read_b128 v[112:115], v247 offset:928
    v_mfma_f32_32x32x8_bf16 v[16:31], v[76:77], v[64:65], v[16:31]
    v_exp_f32 v42, v42
    v_exp_f32 v43, v43
    v_exp_f32 v44, v44
    v_mfma_f32_32x32x16_bf16 v[208:223], v[92:95], v[48:51], v[208:223]
    v_exp_f32 v45, v45
    v_exp_f32 v46, v46
    v_exp_f32 v47, v47
    v_cvt_pk_bf16_f32 v52, v40, v41
    v_cvt_pk_bf16_f32 v53, v42, v43
    v_cvt_pk_bf16_f32 v54, v44, v45
    v_cvt_pk_bf16_f32 v55, v46, v47
    s_waitcnt lgkmcnt(0)
    v_mfma_f32_32x32x16_bf16 v[32:47], v[68:71], v[60:63], 0
    v_exp_f32 v16, v16
    v_exp_f32 v17, v17
    v_exp_f32 v18, v18
    v_mfma_f32_32x32x16_bf16 v[224:239], v[100:103], v[104:107], v[224:239]
    v_exp_f32 v19, v19
    v_exp_f32 v20, v20
    v_exp_f32 v21, v21
    ds_read_b64 v[100:101], v244 offset:864
    ds_read_b64 v[102:103], v244 offset:872
    ds_read_b128 v[104:107], v245 offset:960
    v_mfma_f32_32x32x16_bf16 v[208:223], v[96:99], v[52:55], v[208:223]
    v_exp_f32 v22, v22
    v_exp_f32 v23, v23
    v_cvt_pk_bf16_f32 v48, v16, v17
    v_cvt_pk_bf16_f32 v49, v18, v19
    ds_read_b128 v[72:75], v4 offset:1024
    v_mfma_f32_32x32x16_bf16 v[176:191], v[108:111], v[112:115], v[176:191]
    v_cvt_pk_bf16_f32 v50, v20, v21
    v_cvt_pk_bf16_f32 v51, v22, v23
    v_exp_f32 v24, v24
    v_exp_f32 v25, v25
    ds_read_b64 v[108:109], v246 offset:864
    ds_read_b64 v[110:111], v246 offset:872
    ds_read_b128 v[112:115], v247 offset:960
    v_mfma_f32_32x32x8_bf16 v[32:47], v[76:77], v[66:67], v[32:47]
    v_exp_f32 v26, v26
    v_exp_f32 v27, v27
    v_exp_f32 v28, v28
    v_mfma_f32_32x32x16_bf16 v[192:207], v[84:87], v[48:51], v[192:207]
    v_exp_f32 v29, v29
    v_exp_f32 v30, v30
    v_exp_f32 v31, v31
    v_cvt_pk_bf16_f32 v52, v24, v25
    v_cvt_pk_bf16_f32 v53, v26, v27
    v_cvt_pk_bf16_f32 v54, v28, v29
    v_cvt_pk_bf16_f32 v55, v30, v31
    s_waitcnt lgkmcnt(0)
    v_mfma_f32_32x32x16_bf16 v[16:31], v[72:75], v[56:59], 0
    v_exp_f32 v32, v32
    v_exp_f32 v33, v33
    v_exp_f32 v34, v34
    v_mfma_f32_32x32x16_bf16 v[224:239], v[100:103], v[104:107], v[224:239]
    v_exp_f32 v35, v35
    v_exp_f32 v36, v36
    v_exp_f32 v37, v37
    ds_read_b64 v[100:101], v244 offset:896
    ds_read_b64 v[102:103], v244 offset:904
    ds_read_b128 v[104:107], v245 offset:1008
    v_mfma_f32_32x32x16_bf16 v[192:207], v[88:91], v[52:55], v[192:207]
    v_exp_f32 v38, v38
    v_exp_f32 v39, v39
    v_cvt_pk_bf16_f32 v48, v32, v33
    v_cvt_pk_bf16_f32 v49, v34, v35
    ds_read_b128 v[92:95], v5 offset:4416
    ds_read_b128 v[96:99], v5 offset:5088
    v_mfma_f32_32x32x16_bf16 v[176:191], v[108:111], v[112:115], v[176:191]
    v_cvt_pk_bf16_f32 v50, v36, v37
    v_cvt_pk_bf16_f32 v51, v38, v39
    v_exp_f32 v40, v40
    v_exp_f32 v41, v41
    ds_read_b64 v[108:109], v246 offset:896
    ds_read_b64 v[110:111], v246 offset:904
    ds_read_b128 v[112:115], v247 offset:1008
    v_mfma_f32_32x32x8_bf16 v[16:31], v[78:79], v[64:65], v[16:31]
    v_exp_f32 v42, v42
    v_exp_f32 v43, v43
    v_exp_f32 v44, v44
    v_mfma_f32_32x32x16_bf16 v[208:223], v[84:87], v[48:51], v[208:223]
    v_exp_f32 v45, v45
    v_exp_f32 v46, v46
    v_exp_f32 v47, v47
    v_cvt_pk_bf16_f32 v52, v40, v41
    v_cvt_pk_bf16_f32 v53, v42, v43
    v_cvt_pk_bf16_f32 v54, v44, v45
    v_cvt_pk_bf16_f32 v55, v46, v47
    s_waitcnt lgkmcnt(0)
    v_mfma_f32_32x32x16_bf16 v[32:47], v[72:75], v[60:63], 0
    v_exp_f32 v16, v16
    v_exp_f32 v17, v17
    v_exp_f32 v18, v18
    v_mfma_f32_32x32x16_bf16 v[224:239], v[100:103], v[104:107], v[224:239]
    v_exp_f32 v19, v19
    v_exp_f32 v20, v20
    v_exp_f32 v21, v21
    ds_read_b64 v[100:101], v244 offset:928
    ds_read_b64 v[102:103], v244 offset:936
    ds_read_b128 v[104:107], v245 offset:1040
    v_mfma_f32_32x32x16_bf16 v[208:223], v[88:91], v[52:55], v[208:223]
    v_exp_f32 v22, v22
    v_exp_f32 v23, v23
    v_cvt_pk_bf16_f32 v48, v16, v17
    v_cvt_pk_bf16_f32 v49, v18, v19
    ds_read_b128 v[68:71], v4 offset:6144
    ds_read_b128 v[80:83], v4 offset:8192
    v_mfma_f32_32x32x16_bf16 v[176:191], v[108:111], v[112:115], v[176:191]
    v_cvt_pk_bf16_f32 v50, v20, v21
    v_cvt_pk_bf16_f32 v51, v22, v23
    v_exp_f32 v24, v24
    v_exp_f32 v25, v25
    ds_read_b64 v[108:109], v246 offset:928
    ds_read_b64 v[110:111], v246 offset:936
    ds_read_b128 v[112:115], v247 offset:1040
    v_mfma_f32_32x32x8_bf16 v[32:47], v[78:79], v[66:67], v[32:47]
    v_exp_f32 v26, v26
    v_exp_f32 v27, v27
    v_exp_f32 v28, v28
    v_mfma_f32_32x32x16_bf16 v[192:207], v[92:95], v[48:51], v[192:207]
    v_exp_f32 v29, v29
    v_exp_f32 v30, v30
    v_exp_f32 v31, v31
    v_cvt_pk_bf16_f32 v52, v24, v25
    v_cvt_pk_bf16_f32 v53, v26, v27
    v_cvt_pk_bf16_f32 v54, v28, v29
    v_cvt_pk_bf16_f32 v55, v30, v31
    s_waitcnt lgkmcnt(0)
    v_mfma_f32_32x32x16_bf16 v[16:31], v[68:71], v[56:59], 0
    v_exp_f32 v32, v32
    v_exp_f32 v33, v33
    v_exp_f32 v34, v34
    v_mfma_f32_32x32x16_bf16 v[224:239], v[100:103], v[104:107], v[224:239]
    v_exp_f32 v35, v35
    v_exp_f32 v36, v36
    v_exp_f32 v37, v37
    ds_read_b64 v[100:101], v244 offset:960
    ds_read_b64 v[102:103], v244 offset:968
    ds_read_b128 v[104:107], v245 offset:1072
    v_mfma_f32_32x32x16_bf16 v[192:207], v[96:99], v[52:55], v[192:207]
    v_exp_f32 v38, v38
    v_exp_f32 v39, v39
    v_cvt_pk_bf16_f32 v48, v32, v33
    v_cvt_pk_bf16_f32 v49, v34, v35
    ds_read_b128 v[84:87], v5 offset:9216
    ds_read_b128 v[88:91], v5 offset:9888
    v_mfma_f32_32x32x16_bf16 v[176:191], v[108:111], v[112:115], v[176:191]
    v_cvt_pk_bf16_f32 v50, v36, v37
    v_cvt_pk_bf16_f32 v51, v38, v39
    v_exp_f32 v40, v40
    v_exp_f32 v41, v41
    ds_read_b64 v[108:109], v246 offset:960
    ds_read_b64 v[110:111], v246 offset:968
    ds_read_b128 v[112:115], v247 offset:1072
    v_mfma_f32_32x32x8_bf16 v[16:31], v[80:81], v[64:65], v[16:31]
    v_exp_f32 v42, v42
    v_exp_f32 v43, v43
    v_exp_f32 v44, v44
    v_mfma_f32_32x32x16_bf16 v[208:223], v[92:95], v[48:51], v[208:223]
    v_exp_f32 v45, v45
    v_exp_f32 v46, v46
    v_exp_f32 v47, v47
    v_cvt_pk_bf16_f32 v52, v40, v41
    v_cvt_pk_bf16_f32 v53, v42, v43
    v_cvt_pk_bf16_f32 v54, v44, v45
    v_cvt_pk_bf16_f32 v55, v46, v47
    s_waitcnt lgkmcnt(0)
    v_mfma_f32_32x32x16_bf16 v[32:47], v[68:71], v[60:63], 0
    v_exp_f32 v16, v16
    v_exp_f32 v17, v17
    v_exp_f32 v18, v18
    v_mfma_f32_32x32x16_bf16 v[224:239], v[100:103], v[104:107], v[224:239]
    v_exp_f32 v19, v19
    v_exp_f32 v20, v20
    v_exp_f32 v21, v21
    ds_read_b64 v[100:101], v244 offset:992
    ds_read_b64 v[102:103], v244 offset:1000
    ds_read_b128 v[104:107], v245 offset:1104
    v_mfma_f32_32x32x16_bf16 v[208:223], v[96:99], v[52:55], v[208:223]
    v_exp_f32 v22, v22
    v_exp_f32 v23, v23
    v_cvt_pk_bf16_f32 v48, v16, v17
    v_cvt_pk_bf16_f32 v49, v18, v19
    ds_read_b128 v[72:75], v4 offset:7168
    v_mfma_f32_32x32x16_bf16 v[176:191], v[108:111], v[112:115], v[176:191]
    v_cvt_pk_bf16_f32 v50, v20, v21
    v_cvt_pk_bf16_f32 v51, v22, v23
    v_exp_f32 v24, v24
    v_exp_f32 v25, v25
    ds_read_b64 v[108:109], v246 offset:992
    ds_read_b64 v[110:111], v246 offset:1000
    ds_read_b128 v[112:115], v247 offset:1104
    v_mfma_f32_32x32x8_bf16 v[32:47], v[80:81], v[66:67], v[32:47]
    v_exp_f32 v26, v26
    v_exp_f32 v27, v27
    v_exp_f32 v28, v28
    v_mfma_f32_32x32x16_bf16 v[192:207], v[84:87], v[48:51], v[192:207]
    v_exp_f32 v29, v29
    v_exp_f32 v30, v30
    v_exp_f32 v31, v31
    v_cvt_pk_bf16_f32 v52, v24, v25
    v_cvt_pk_bf16_f32 v53, v26, v27
    v_cvt_pk_bf16_f32 v54, v28, v29
    v_cvt_pk_bf16_f32 v55, v30, v31
    s_waitcnt lgkmcnt(0)
    v_mfma_f32_32x32x16_bf16 v[16:31], v[72:75], v[56:59], 0
    v_exp_f32 v32, v32
    v_exp_f32 v33, v33
    v_exp_f32 v34, v34
    v_mfma_f32_32x32x16_bf16 v[224:239], v[100:103], v[104:107], v[224:239]
    v_exp_f32 v35, v35
    v_exp_f32 v36, v36
    v_exp_f32 v37, v37
    ds_read_b64 v[100:101], v244 offset:1024
    ds_read_b64 v[102:103], v244 offset:1032
    ds_read_b128 v[104:107], v245 offset:1152
    v_mfma_f32_32x32x16_bf16 v[192:207], v[88:91], v[52:55], v[192:207]
    v_exp_f32 v38, v38
    v_exp_f32 v39, v39
    v_cvt_pk_bf16_f32 v48, v32, v33
    v_cvt_pk_bf16_f32 v49, v34, v35
    ds_read_b128 v[92:95], v5 offset:10560
    ds_read_b128 v[96:99], v5 offset:11232
    ds_read_b32 v10, v117
    v_mfma_f32_32x32x16_bf16 v[176:191], v[108:111], v[112:115], v[176:191]
    v_cvt_pk_bf16_f32 v50, v36, v37
    v_cvt_pk_bf16_f32 v51, v38, v39
    v_exp_f32 v40, v40
    v_exp_f32 v41, v41
    ds_read_b64 v[108:109], v246 offset:1024
    ds_read_b64 v[110:111], v246 offset:1032
    ds_read_b128 v[112:115], v247 offset:1152
    v_mfma_f32_32x32x8_bf16 v[16:31], v[82:83], v[64:65], v[16:31]
    v_exp_f32 v42, v42
    v_exp_f32 v43, v43
    v_exp_f32 v44, v44
    v_mfma_f32_32x32x16_bf16 v[208:223], v[84:87], v[48:51], v[208:223]
    v_exp_f32 v45, v45
    v_exp_f32 v46, v46
    v_exp_f32 v47, v47
    v_cvt_pk_bf16_f32 v52, v40, v41
    v_cvt_pk_bf16_f32 v53, v42, v43
    v_cvt_pk_bf16_f32 v54, v44, v45
    v_cvt_pk_bf16_f32 v55, v46, v47
    s_waitcnt lgkmcnt(0)
A_T1_8:
    v_cmp_gt_u32 vcc, 8, v10
    v_cmp_ge_u32 s[74:75], 8, v10
    s_setprio 1
    s_cmp_lg_u32 vcc_lo, 0
    s_cbranch_scc1 A_T1_8S
A_T1_8R:
    s_cmp_eq_u32 s75, 0
    s_cbranch_scc1 A_T1_8H
    s_setprio 1
A_T1_8H:
    v_mfma_f32_32x32x16_bf16 v[32:47], v[72:75], v[60:63], 0
    v_exp_f32 v16, v16
    v_exp_f32 v17, v17
    v_exp_f32 v18, v18
    s_sub_u32 m0, s69, 32
    s_mov_b64 exec, 1
    global_load_lds_dword v1, s[38:39] offset:32
    s_mov_b64 exec, -1
    v_mfma_f32_32x32x16_bf16 v[224:239], v[100:103], v[104:107], v[224:239]
    v_exp_f32 v19, v19
    v_exp_f32 v20, v20
    v_exp_f32 v21, v21
    ds_read_b64 v[100:101], v244 offset:1056
    ds_read_b64 v[102:103], v244 offset:1064
    ds_read_b128 v[104:107], v245 offset:1184
    v_mfma_f32_32x32x16_bf16 v[208:223], v[88:91], v[52:55], v[208:223]
    v_exp_f32 v22, v22
    v_exp_f32 v23, v23
    v_cvt_pk_bf16_f32 v48, v16, v17
    v_cvt_pk_bf16_f32 v49, v18, v19
    v_mfma_f32_32x32x16_bf16 v[176:191], v[108:111], v[112:115], v[176:191]
    v_cvt_pk_bf16_f32 v50, v20, v21
    v_cvt_pk_bf16_f32 v51, v22, v23
    v_exp_f32 v24, v24
    v_exp_f32 v25, v25
    ds_read_b64 v[108:109], v246 offset:1056
    ds_read_b64 v[110:111], v246 offset:1064
    ds_read_b128 v[112:115], v247 offset:1184
    v_mfma_f32_32x32x8_bf16 v[32:47], v[82:83], v[66:67], v[32:47]
    v_exp_f32 v26, v26
    v_exp_f32 v27, v27
    v_exp_f32 v28, v28
    v_mfma_f32_32x32x16_bf16 v[192:207], v[92:95], v[48:51], v[192:207]
    v_exp_f32 v29, v29
    v_exp_f32 v30, v30
    v_exp_f32 v31, v31
    v_cvt_pk_bf16_f32 v52, v24, v25
    v_cvt_pk_bf16_f32 v53, v26, v27
    v_cvt_pk_bf16_f32 v54, v28, v29
    v_cvt_pk_bf16_f32 v55, v30, v31
    s_waitcnt lgkmcnt(0)
    v_exp_f32 v32, v32
    v_exp_f32 v33, v33
    v_exp_f32 v34, v34
    v_mfma_f32_32x32x16_bf16 v[224:239], v[100:103], v[104:107], v[224:239]
    v_exp_f32 v35, v35
    v_exp_f32 v36, v36
    v_exp_f32 v37, v37
    v_mfma_f32_32x32x16_bf16 v[192:207], v[96:99], v[52:55], v[192:207]
    v_exp_f32 v38, v38
    v_exp_f32 v39, v39
    v_cvt_pk_bf16_f32 v48, v32, v33
    v_cvt_pk_bf16_f32 v49, v34, v35
    v_mfma_f32_32x32x16_bf16 v[176:191], v[108:111], v[112:115], v[176:191]
    v_cvt_pk_bf16_f32 v50, v36, v37
    v_cvt_pk_bf16_f32 v51, v38, v39
    v_exp_f32 v40, v40
    v_exp_f32 v41, v41
    v_exp_f32 v42, v42
    v_exp_f32 v43, v43
    v_exp_f32 v44, v44
    v_mfma_f32_32x32x16_bf16 v[208:223], v[92:95], v[48:51], v[208:223]
    v_exp_f32 v45, v45
    v_exp_f32 v46, v46
    v_exp_f32 v47, v47
    v_cvt_pk_bf16_f32 v52, v40, v41
    v_cvt_pk_bf16_f32 v53, v42, v43
    v_cvt_pk_bf16_f32 v54, v44, v45
    v_cvt_pk_bf16_f32 v55, v46, v47
    s_setprio 1
    s_nop 0
    v_mfma_f32_32x32x16_bf16 v[208:223], v[96:99], v[52:55], v[208:223]
    s_mul_i32 s72, s5, 10240
    s_add_u32 s72, s72, s32
    s_lshl_b32 s71, s2, 7
    s_waitcnt vmcnt(1)
    s_nop 1
    ds_write_b128 v126, v[192:195] offset:0
    ds_write_b128 v126, v[196:199] offset:1024
    ds_write_b128 v126, v[200:203] offset:2048
    ds_write_b32 v128, v204
    s_setprio 0
    s_setprio 1
    s_waitcnt lgkmcnt(0)
    s_barrier
    ds_read_b32 v204, v129
    ds_read_b128 v[192:195], v127 offset:0
    ds_read_b128 v[196:199], v127 offset:1024
    ds_read_b128 v[200:203], v127 offset:2048
    s_mov_b32 s6, 0x21800000
    s_mov_b32 s7, 0x6c800000
    s_waitcnt lgkmcnt(3)
    v_add_f32 v24, v220, v204
    v_rcp_f32 v26, v24
    v_cmp_nlt_f32 vcc, s6, v24
    v_cmp_ngt_f32 s[74:75], s7, v24
    s_waitcnt lgkmcnt(0)
    v_pk_add_f32 v[84:85], v[208:209], v[192:193]
    v_pk_add_f32 v[86:87], v[210:211], v[194:195]
    v_pk_add_f32 v[88:89], v[212:213], v[196:197]
    v_pk_add_f32 v[90:91], v[214:215], v[198:199]
    v_pk_add_f32 v[92:93], v[216:217], v[200:201]
    v_pk_add_f32 v[94:95], v[218:219], v[202:203]
    s_or_b64 vcc, vcc, s[74:75]
    s_cbranch_scc1 FB1
FB_RET1:
    v_mul_f32 v26, v26, v12
    s_mul_i32 s6, s90, 5120
    v_add_u32 v13, s6, v1
    v_pk_mul_f32 v[84:85], v[84:85], v[26:27] op_sel_hi:[1,0]
    v_pk_mul_f32 v[86:87], v[86:87], v[26:27] op_sel_hi:[1,0]
    v_pk_mul_f32 v[88:89], v[88:89], v[26:27] op_sel_hi:[1,0]
    v_pk_mul_f32 v[90:91], v[90:91], v[26:27] op_sel_hi:[1,0]
    v_pk_mul_f32 v[92:93], v[92:93], v[26:27] op_sel_hi:[1,0]
    v_pk_mul_f32 v[94:95], v[94:95], v[26:27] op_sel_hi:[1,0]
    v_cvt_pk_bf16_f32 v48, v84, v85
    v_cvt_pk_bf16_f32 v49, v86, v87
    v_cvt_pk_bf16_f32 v50, v88, v89
    v_cvt_pk_bf16_f32 v51, v90, v91
    v_cvt_pk_bf16_f32 v52, v92, v93
    v_cvt_pk_bf16_f32 v53, v94, v95
    buffer_store_dwordx4 v[48:51], v130, s[20:23], s72 offen sc1
    buffer_store_dwordx2 v[52:53], v131, s[20:23], s72 offen sc1
    ds_read_b64 v[72:73], v244 offset:1088
    ds_read_b64 v[74:75], v244 offset:1096
    ds_read_b128 v[76:79], v245 offset:1216
    ds_read_b64 v[80:81], v246 offset:1088
    ds_read_b64 v[82:83], v246 offset:1096
    ds_read_b128 v[84:87], v247 offset:1216
    ds_read_b64 v[88:89], v244 offset:1120
    ds_read_b64 v[90:91], v244 offset:1128
    ds_read_b128 v[92:95], v245 offset:1248
    ds_read_b64 v[96:97], v246 offset:1120
    ds_read_b64 v[98:99], v246 offset:1128
    ds_read_b128 v[100:103], v247 offset:1248
    s_waitcnt lgkmcnt(9)
    v_mfma_f32_32x32x16_bf16 v[224:239], v[72:75], v[76:79], v[224:239]
    ds_read_b64 v[56:57], v244 offset:1152
    ds_read_b64 v[58:59], v244 offset:1160
    ds_read_b128 v[60:63], v245 offset:1296
    s_waitcnt lgkmcnt(9)
    v_mfma_f32_32x32x16_bf16 v[176:191], v[80:83], v[84:87], v[176:191]
    ds_read_b64 v[64:65], v246 offset:1152
    ds_read_b64 v[66:67], v246 offset:1160
    ds_read_b128 v[68:71], v247 offset:1296
    s_waitcnt lgkmcnt(9)
    v_mfma_f32_32x32x16_bf16 v[224:239], v[88:91], v[92:95], v[224:239]
    ds_read_b64 v[72:73], v244 offset:1184
    ds_read_b64 v[74:75], v244 offset:1192
    ds_read_b128 v[76:79], v245 offset:1328
    s_waitcnt lgkmcnt(9)
    v_mfma_f32_32x32x16_bf16 v[176:191], v[96:99], v[100:103], v[176:191]
    ds_read_b64 v[80:81], v246 offset:1184
    ds_read_b64 v[82:83], v246 offset:1192
    ds_read_b128 v[84:87], v247 offset:1328
    s_waitcnt lgkmcnt(9)
    v_mfma_f32_32x32x16_bf16 v[224:239], v[56:59], v[60:63], v[224:239]
    ds_read_b64 v[88:89], v244 offset:1216
    ds_read_b64 v[90:91], v244 offset:1224
    ds_read_b128 v[92:95], v245 offset:1360
    s_waitcnt lgkmcnt(9)
    v_mfma_f32_32x32x16_bf16 v[176:191], v[64:67], v[68:71], v[176:191]
    ds_read_b64 v[96:97], v246 offset:1216
    ds_read_b64 v[98:99], v246 offset:1224
    ds_read_b128 v[100:103], v247 offset:1360
    s_waitcnt lgkmcnt(9)
    v_mfma_f32_32x32x16_bf16 v[224:239], v[72:75], v[76:79], v[224:239]
    ds_read_b64 v[56:57], v244 offset:1248
    ds_read_b64 v[58:59], v244 offset:1256
    ds_read_b128 v[60:63], v245 offset:1392
    s_waitcnt lgkmcnt(9)
    v_mfma_f32_32x32x16_bf16 v[176:191], v[80:83], v[84:87], v[176:191]
    ds_read_b64 v[64:65], v246 offset:1248
    ds_read_b64 v[66:67], v246 offset:1256
    ds_read_b128 v[68:71], v247 offset:1392
    s_waitcnt lgkmcnt(9)
    v_mfma_f32_32x32x16_bf16 v[224:239], v[88:91], v[92:95], v[224:239]
    ds_read_b64 v[72:73], v244 offset:1280
    ds_read_b64 v[74:75], v244 offset:1288
    ds_read_b128 v[76:79], v245 offset:1440
    s_waitcnt lgkmcnt(9)
    v_mfma_f32_32x32x16_bf16 v[176:191], v[96:99], v[100:103], v[176:191]
    ds_read_b64 v[80:81], v246 offset:1280
    ds_read_b64 v[82:83], v246 offset:1288
    ds_read_b128 v[84:87], v247 offset:1440
    s_waitcnt lgkmcnt(9)
    v_mfma_f32_32x32x16_bf16 v[224:239], v[56:59], v[60:63], v[224:239]
    ds_read_b64 v[88:89], v244 offset:1312
    ds_read_b64 v[90:91], v244 offset:1320
    ds_read_b128 v[92:95], v245 offset:1472
    s_waitcnt lgkmcnt(9)
    v_mfma_f32_32x32x16_bf16 v[176:191], v[64:67], v[68:71], v[176:191]
    ds_read_b64 v[96:97], v246 offset:1312
    ds_read_b64 v[98:99], v246 offset:1320
    ds_read_b128 v[100:103], v247 offset:1472
    s_waitcnt lgkmcnt(9)
    v_mfma_f32_32x32x16_bf16 v[224:239], v[72:75], v[76:79], v[224:239]
    ds_read_b64 v[56:57], v244 offset:1344
    ds_read_b64 v[58:59], v244 offset:1352
    ds_read_b128 v[60:63], v245 offset:1504
    s_waitcnt lgkmcnt(9)
    v_mfma_f32_32x32x16_bf16 v[176:191], v[80:83], v[84:87], v[176:191]
    ds_read_b64 v[64:65], v246 offset:1344
    ds_read_b64 v[66:67], v246 offset:1352
    ds_read_b128 v[68:71], v247 offset:1504
    s_waitcnt lgkmcnt(9)
    v_mfma_f32_32x32x16_bf16 v[224:239], v[88:91], v[92:95], v[224:239]
    ds_read_b64 v[72:73], v244 offset:1376
    ds_read_b64 v[74:75], v244 offset:1384
    ds_read_b128 v[76:79], v245 offset:1536
    s_waitcnt lgkmcnt(9)
    v_mfma_f32_32x32x16_bf16 v[176:191], v[96:99], v[100:103], v[176:191]
    ds_read_b64 v[80:81], v246 offset:1376
    ds_read_b64 v[82:83], v246 offset:1384
    ds_read_b128 v[84:87], v247 offset:1536
    s_waitcnt lgkmcnt(9)
    v_mfma_f32_32x32x16_bf16 v[224:239], v[56:59], v[60:63], v[224:239]
    ds_read_b64 v[88:89], v244 offset:1408
    ds_read_b64 v[90:91], v244 offset:1416
    ds_read_b128 v[92:95], v245 offset:1584
    s_waitcnt lgkmcnt(9)
    v_mfma_f32_32x32x16_bf16 v[176:191], v[64:67], v[68:71], v[176:191]
    ds_read_b64 v[96:97], v246 offset:1408
    ds_read_b64 v[98:99], v246 offset:1416
    ds_read_b128 v[100:103], v247 offset:1584
    s_waitcnt lgkmcnt(9)
    v_mfma_f32_32x32x16_bf16 v[224:239], v[72:75], v[76:79], v[224:239]
    ds_read_b64 v[56:57], v244 offset:1440
    ds_read_b64 v[58:59], v244 offset:1448
    ds_read_b128 v[60:63], v245 offset:1616
    s_waitcnt lgkmcnt(9)
    v_mfma_f32_32x32x16_bf16 v[176:191], v[80:83], v[84:87], v[176:191]
    ds_read_b64 v[64:65], v246 offset:1440
    ds_read_b64 v[66:67], v246 offset:1448
    ds_read_b128 v[68:71], v247 offset:1616
    s_waitcnt lgkmcnt(9)
    v_mfma_f32_32x32x16_bf16 v[224:239], v[88:91], v[92:95], v[224:239]
    ds_read_b64 v[72:73], v244 offset:1472
    ds_read_b64 v[74:75], v244 offset:1480
    ds_read_b128 v[76:79], v245 offset:1648
    s_waitcnt lgkmcnt(9)
    v_mfma_f32_32x32x16_bf16 v[176:191], v[96:99], v[100:103], v[176:191]
    ds_read_b64 v[80:81], v246 offset:1472
    ds_read_b64 v[82:83], v246 offset:1480
    ds_read_b128 v[84:87], v247 offset:1648
    s_waitcnt vmcnt(0)
    v_mov_b32 v20, 163476
    v_mov_b32 v21, 1
    s_mov_b64 exec, 1
    ds_add_rtn_u32 v22, v20, v21
    v_mov_b32 v20, 9502720
    v_mov_b32 v21, s36
    s_waitcnt lgkmcnt(0)
    v_cmp_eq_u32 vcc, 7, v22
    s_nop 0
    s_cbranch_vccz PUB_67
    buffer_store_dword v21, v20, s[20:23], s71 offen sc1
PUB_67:
    s_mov_b64 exec, -1
    s_waitcnt lgkmcnt(9)
    v_mfma_f32_32x32x16_bf16 v[224:239], v[56:59], v[60:63], v[224:239]
    ds_read_b64 v[88:89], v244 offset:1504
    ds_read_b64 v[90:91], v244 offset:1512
    ds_read_b128 v[92:95], v245 offset:1680
    s_waitcnt lgkmcnt(9)
    v_mfma_f32_32x32x16_bf16 v[176:191], v[64:67], v[68:71], v[176:191]
    ds_read_b64 v[96:97], v246 offset:1504
    ds_read_b64 v[98:99], v246 offset:1512
    ds_read_b128 v[100:103], v247 offset:1680
    s_waitcnt lgkmcnt(9)
    v_mfma_f32_32x32x16_bf16 v[224:239], v[72:75], v[76:79], v[224:239]
    ds_read_b64 v[56:57], v244 offset:1536
    ds_read_b64 v[58:59], v244 offset:1544
    ds_read_b128 v[60:63], v245 offset:1728
    s_waitcnt lgkmcnt(9)
    v_mfma_f32_32x32x16_bf16 v[176:191], v[80:83], v[84:87], v[176:191]
    ds_read_b64 v[64:65], v246 offset:1536
    ds_read_b64 v[66:67], v246 offset:1544
    ds_read_b128 v[68:71], v247 offset:1728
    s_waitcnt lgkmcnt(9)
    v_mfma_f32_32x32x16_bf16 v[224:239], v[88:91], v[92:95], v[224:239]
    ds_read_b64 v[72:73], v244 offset:1568
    ds_read_b64 v[74:75], v244 offset:1576
    ds_read_b128 v[76:79], v245 offset:1760
    s_waitcnt lgkmcnt(9)
    v_mfma_f32_32x32x16_bf16 v[176:191], v[96:99], v[100:103], v[176:191]
    ds_read_b64 v[80:81], v246 offset:1568
    ds_read_b64 v[82:83], v246 offset:1576
    ds_read_b128 v[84:87], v247 offset:1760
    s_waitcnt lgkmcnt(9)
    v_mfma_f32_32x32x16_bf16 v[224:239], v[56:59], v[60:63], v[224:239]
    ds_read_b64 v[88:89], v244 offset:1600
    ds_read_b64 v[90:91], v244 offset:1608
    ds_read_b128 v[92:95], v245 offset:1792
    s_waitcnt lgkmcnt(9)
    v_mfma_f32_32x32x16_bf16 v[176:191], v[64:67], v[68:71], v[176:191]
    ds_read_b64 v[96:97], v246 offset:1600
    ds_read_b64 v[98:99], v246 offset:1608
    ds_read_b128 v[100:103], v247 offset:1792
    s_waitcnt lgkmcnt(9)
    v_mfma_f32_32x32x16_bf16 v[224:239], v[72:75], v[76:79], v[224:239]
    ds_read_b64 v[56:57], v244 offset:1632
    ds_read_b64 v[58:59], v244 offset:1640
    ds_read_b128 v[60:63], v245 offset:1824
    s_waitcnt lgkmcnt(9)
    v_mfma_f32_32x32x16_bf16 v[176:191], v[80:83], v[84:87], v[176:191]
    ds_read_b64 v[64:65], v246 offset:1632
    ds_read_b64 v[66:67], v246 offset:1640
    ds_read_b128 v[68:71], v247 offset:1824
    s_waitcnt lgkmcnt(9)
    v_mfma_f32_32x32x16_bf16 v[224:239], v[88:91], v[92:95], v[224:239]
    ds_read_b64 v[72:73], v244 offset:1664
    ds_read_b64 v[74:75], v244 offset:1672
    ds_read_b128 v[76:79], v245 offset:1872
    s_waitcnt lgkmcnt(9)
    v_mfma_f32_32x32x16_bf16 v[176:191], v[96:99], v[100:103], v[176:191]
    ds_read_b64 v[80:81], v246 offset:1664
    ds_read_b64 v[82:83], v246 offset:1672
    ds_read_b128 v[84:87], v247 offset:1872
    s_waitcnt lgkmcnt(9)
    v_mfma_f32_32x32x16_bf16 v[224:239], v[56:59], v[60:63], v[224:239]
    ds_read_b64 v[88:89], v244 offset:1696
    ds_read_b64 v[90:91], v244 offset:1704
    ds_read_b128 v[92:95], v245 offset:1904
    s_waitcnt lgkmcnt(9)
    v_mfma_f32_32x32x16_bf16 v[176:191], v[64:67], v[68:71], v[176:191]
    ds_read_b64 v[96:97], v246 offset:1696
    ds_read_b64 v[98:99], v246 offset:1704
    ds_read_b128 v[100:103], v247 offset:1904
    s_waitcnt lgkmcnt(9)
    v_mfma_f32_32x32x16_bf16 v[224:239], v[72:75], v[76:79], v[224:239]
    ds_read_b64 v[56:57], v244 offset:1728
    ds_read_b64 v[58:59], v244 offset:1736
    ds_read_b128 v[60:63], v245 offset:1936
    s_waitcnt lgkmcnt(9)
    v_mfma_f32_32x32x16_bf16 v[176:191], v[80:83], v[84:87], v[176:191]
    ds_read_b64 v[64:65], v246 offset:1728
    ds_read_b64 v[66:67], v246 offset:1736
    ds_read_b128 v[68:71], v247 offset:1936
    s_waitcnt lgkmcnt(9)
    v_mfma_f32_32x32x16_bf16 v[224:239], v[88:91], v[92:95], v[224:239]
    ds_read_b64 v[72:73], v244 offset:1760
    ds_read_b64 v[74:75], v244 offset:1768
    ds_read_b128 v[76:79], v245 offset:1968
    s_waitcnt lgkmcnt(9)
    v_mfma_f32_32x32x16_bf16 v[176:191], v[96:99], v[100:103], v[176:191]
    ds_read_b64 v[80:81], v246 offset:1760
    ds_read_b64 v[82:83], v246 offset:1768
    ds_read_b128 v[84:87], v247 offset:1968
    s_waitcnt lgkmcnt(9)
    v_mfma_f32_32x32x16_bf16 v[224:239], v[56:59], v[60:63], v[224:239]
    ds_read_b64 v[88:89], v244 offset:1792
    ds_read_b64 v[90:91], v244 offset:1800
    ds_read_b128 v[92:95], v245 offset:2016
    s_waitcnt lgkmcnt(9)
    v_mfma_f32_32x32x16_bf16 v[176:191], v[64:67], v[68:71], v[176:191]
    ds_read_b64 v[96:97], v246 offset:1792
    ds_read_b64 v[98:99], v246 offset:1800
    ds_read_b128 v[100:103], v247 offset:2016
    s_waitcnt lgkmcnt(9)
    v_mfma_f32_32x32x16_bf16 v[224:239], v[72:75], v[76:79], v[224:239]
    ds_read_b64 v[56:57], v244 offset:1824
    ds_read_b64 v[58:59], v244 offset:1832
    ds_read_b128 v[60:63], v245 offset:2048
    s_waitcnt lgkmcnt(9)
    v_mfma_f32_32x32x16_bf16 v[176:191], v[80:83], v[84:87], v[176:191]
    ds_read_b64 v[64:65], v246 offset:1824
    ds_read_b64 v[66:67], v246 offset:1832
    ds_read_b128 v[68:71], v247 offset:2048
    s_waitcnt lgkmcnt(9)
    v_mfma_f32_32x32x16_bf16 v[224:239], v[88:91], v[92:95], v[224:239]
    ds_read_b64 v[72:73], v244 offset:1856
    ds_read_b64 v[74:75], v244 offset:1864
    ds_read_b128 v[76:79], v245 offset:2080
    s_waitcnt lgkmcnt(9)
    v_mfma_f32_32x32x16_bf16 v[176:191], v[96:99], v[100:103], v[176:191]
    ds_read_b64 v[80:81], v246 offset:1856
    ds_read_b64 v[82:83], v246 offset:1864
    ds_read_b128 v[84:87], v247 offset:2080
    s_waitcnt lgkmcnt(9)
    v_mfma_f32_32x32x16_bf16 v[224:239], v[56:59], v[60:63], v[224:239]
    ds_read_b64 v[88:89], v244 offset:1888
    ds_read_b64 v[90:91], v244 offset:1896
    ds_read_b128 v[92:95], v245 offset:2112
    s_waitcnt lgkmcnt(9)
    v_mfma_f32_32x32x16_bf16 v[176:191], v[64:67], v[68:71], v[176:191]
    ds_read_b64 v[96:97], v246 offset:1888
    ds_read_b64 v[98:99], v246 offset:1896
    ds_read_b128 v[100:103], v247 offset:2112
    s_waitcnt lgkmcnt(9)
    v_mfma_f32_32x32x16_bf16 v[224:239], v[72:75], v[76:79], v[224:239]
    ds_read_b64 v[56:57], v244 offset:1920
    ds_read_b64 v[58:59], v244 offset:1928
    ds_read_b128 v[60:63], v245 offset:2160
    s_waitcnt lgkmcnt(9)
    v_mfma_f32_32x32x16_bf16 v[176:191], v[80:83], v[84:87], v[176:191]
    ds_read_b64 v[64:65], v246 offset:1920
    ds_read_b64 v[66:67], v246 offset:1928
    ds_read_b128 v[68:71], v247 offset:2160
    s_waitcnt lgkmcnt(9)
    v_mfma_f32_32x32x16_bf16 v[224:239], v[88:91], v[92:95], v[224:239]
    ds_read_b64 v[72:73], v244 offset:1952
    ds_read_b64 v[74:75], v244 offset:1960
    ds_read_b128 v[76:79], v245 offset:2192
    s_waitcnt lgkmcnt(9)
    v_mfma_f32_32x32x16_bf16 v[176:191], v[96:99], v[100:103], v[176:191]
    ds_read_b64 v[80:81], v246 offset:1952
    ds_read_b64 v[82:83], v246 offset:1960
    ds_read_b128 v[84:87], v247 offset:2192
    s_waitcnt lgkmcnt(9)
    v_mfma_f32_32x32x16_bf16 v[224:239], v[56:59], v[60:63], v[224:239]
    ds_read_b64 v[88:89], v244 offset:1984
    ds_read_b64 v[90:91], v244 offset:1992
    ds_read_b128 v[92:95], v245 offset:2224
    s_waitcnt lgkmcnt(9)
    v_mfma_f32_32x32x16_bf16 v[176:191], v[64:67], v[68:71], v[176:191]
    ds_read_b64 v[96:97], v246 offset:1984
    ds_read_b64 v[98:99], v246 offset:1992
    ds_read_b128 v[100:103], v247 offset:2224
    s_waitcnt lgkmcnt(9)
    v_mfma_f32_32x32x16_bf16 v[224:239], v[72:75], v[76:79], v[224:239]
    ds_read_b64 v[56:57], v244 offset:2016
    ds_read_b64 v[58:59], v244 offset:2024
    ds_read_b128 v[60:63], v245 offset:2256
    s_waitcnt lgkmcnt(9)
    v_mfma_f32_32x32x16_bf16 v[176:191], v[80:83], v[84:87], v[176:191]
    ds_read_b64 v[64:65], v246 offset:2016
    ds_read_b64 v[66:67], v246 offset:2024
    ds_read_b128 v[68:71], v247 offset:2256
    s_waitcnt lgkmcnt(9)
    v_mfma_f32_32x32x16_bf16 v[224:239], v[88:91], v[92:95], v[224:239]
    s_waitcnt lgkmcnt(6)
    v_mfma_f32_32x32x16_bf16 v[176:191], v[96:99], v[100:103], v[176:191]
    s_waitcnt lgkmcnt(3)
    v_mfma_f32_32x32x16_bf16 v[224:239], v[56:59], v[60:63], v[224:239]
    s_waitcnt lgkmcnt(0)
    v_mfma_f32_32x32x16_bf16 v[176:191], v[64:67], v[68:71], v[176:191]
    s_setprio 3
    v_mov_b32 v6, 1
    ds_write_b32 v120, v6 offset:96
    v_and_b32 v4, 3, v0
    v_lshlrev_b32 v4, 2, v4
    v_add_u32 v4, 163632, v4
    v_add_u32 v13, 72960, v13
    s_nop 5
    s_cmp_eq_u32 s101, 1
    s_cbranch_scc0 T_TWO
    v_pk_add_f32 v[224:225], v[224:225], v[176:177]
    v_pk_add_f32 v[226:227], v[226:227], v[178:179]
    v_pk_add_f32 v[228:229], v[228:229], v[180:181]
    v_pk_add_f32 v[230:231], v[230:231], v[182:183]
    v_pk_add_f32 v[232:233], v[232:233], v[184:185]
    v_pk_add_f32 v[234:235], v[234:235], v[186:187]
    v_pk_add_f32 v[236:237], v[236:237], v[188:189]
    v_pk_add_f32 v[238:239], v[238:239], v[190:191]
    s_branch T_ONE
T_TWO:
    v_cvt_pk_bf16_f32 v32, v176, v177
    v_cvt_pk_bf16_f32 v33, v178, v179
    ds_write_b64 v124, v[32:33] offset:0
    v_cvt_pk_bf16_f32 v34, v180, v181
    v_cvt_pk_bf16_f32 v35, v182, v183
    ds_write_b64 v124, v[34:35] offset:16
    v_cvt_pk_bf16_f32 v36, v184, v185
    v_cvt_pk_bf16_f32 v37, v186, v187
    ds_write_b64 v124, v[36:37] offset:32
    v_cvt_pk_bf16_f32 v38, v188, v189
    v_cvt_pk_bf16_f32 v39, v190, v191
    ds_write_b64 v124, v[38:39] offset:48
    ds_read_b128 v[40:43], v125
    ds_read_b128 v[44:47], v125 offset:1152
T_ONE:
    v_cvt_pk_bf16_f32 v68, v224, v225
    v_cvt_pk_bf16_f32 v69, v226, v227
    ds_write_b64 v124, v[68:69] offset:0
    v_cvt_pk_bf16_f32 v70, v228, v229
    v_cvt_pk_bf16_f32 v71, v230, v231
    ds_write_b64 v124, v[70:71] offset:16
    v_cvt_pk_bf16_f32 v72, v232, v233
    v_cvt_pk_bf16_f32 v73, v234, v235
    ds_write_b64 v124, v[72:73] offset:32
    v_cvt_pk_bf16_f32 v74, v236, v237
    v_cvt_pk_bf16_f32 v75, v238, v239
    ds_write_b64 v124, v[74:75] offset:48
    ds_read_b128 v[76:79], v125
    ds_read_b128 v[80:83], v125 offset:1152
    s_waitcnt lgkmcnt(0)
    buffer_store_dwordx4 v[76:79], v1, s[20:23], s95 offen sc1
    buffer_store_dwordx4 v[80:83], v1, s[20:23], s95 offen offset:1024 sc1
    s_cmp_eq_u32 s101, 1
    s_cbranch_scc1 T_ONE2
    buffer_store_dwordx4 v[40:43], v1, s[20:23], s100 offen sc1
    buffer_store_dwordx4 v[44:47], v1, s[20:23], s100 offen offset:1024 sc1
T_ONE2:
    s_waitcnt vmcnt(0)
    v_mov_b32 v20, 163484
    v_mov_b32 v21, 1
    s_mov_b64 exec, 1
    ds_add_rtn_u32 v22, v20, v21
    v_mov_b32 v20, 9535488
    v_mov_b32 v21, s36
    s_waitcnt lgkmcnt(0)
    v_cmp_eq_u32 vcc, 3, v22
    s_nop 0
    s_cbranch_vccz PUB_68
    buffer_store_dword v21, v20, s[20:23], s71 offen sc1
PUB_68:
    s_mov_b64 exec, -1
    s_mov_b32 s7, 0x40000
LP_69:
    ds_read_b32 v7, v4 offset:0
    s_sub_u32 s7, s7, 1
    s_waitcnt lgkmcnt(0)
    v_cmp_gt_u32 vcc, 1, v7
    s_cbranch_scc1 LPD_70
    s_cbranch_vccnz LP_69
LPD_70:
    ds_write_b128 v13, v[140:143] offset:0
    ds_write_b128 v13, v[144:147] offset:1024
    ds_write_b128 v13, v[148:151] offset:2048
    ds_write_b128 v13, v[152:155] offset:3072
    ds_write_b128 v13, v[156:159] offset:4096
    ds_write_b32 v120, v6 offset:112
    s_waitcnt lgkmcnt(0)
    s_cmp_lg_u32 s3, 4
    s_cbranch_scc1 T_FIN
    v_lshrrev_b32 v24, 3, v0
    v_mul_u32_u24 v25, 4224, v24
    v_xor_b32 v21, v0, v24
    v_and_b32 v21, 7, v21
    v_lshl_add_u32 v24, v21, 4, v25
    s_mul_i32 s6, s5, 337920
    s_lshl_b32 s7, s4, 7
    s_add_u32 s6, s6, s7
    s_add_u32 s75, s6, 5767168
    v_lshlrev_b32 v20, 7, v0
    s_lshl_b32 s76, s5, 12
    s_add_u32 s76, s76, 9535488
    s_mov_b32 s7, 0x4000
    s_mov_b32 s83, 163488
    s_mov_b32 exec_hi, 0
T_GP:
    buffer_load_dword v28, v20, s[20:23], s76 offen sc1
    s_waitcnt vmcnt(0)
    v_cmp_ne_u32 vcc, s36, v28
    s_sub_u32 s7, s7, 1
    s_cbranch_scc1 T_GPD
    s_cbranch_vccz T_GPD
    s_mov_b64 exec, vcc
    s_sleep 1
    s_branch T_GP
T_GPD:
    s_mov_b64 exec, -1
    s_mov_b32 m0, 102400
    s_nop 0
    buffer_load_dwordx4 v24, s[20:23], s75 offen sc1 lds
    s_add_u32 m0, m0, 1024
    s_add_u32 s75, s75, 33792
    buffer_load_dwordx4 v24, s[20:23], s75 offen sc1 lds
    s_add_u32 m0, m0, 1024
    s_add_u32 s75, s75, 33792
    buffer_load_dwordx4 v24, s[20:23], s75 offen sc1 lds
    s_add_u32 m0, m0, 1024
    s_add_u32 s75, s75, 33792
    buffer_load_dwordx4 v24, s[20:23], s75 offen sc1 lds
    s_add_u32 m0, m0, 1024
    s_add_u32 s75, s75, 33792
    buffer_load_dwordx4 v24, s[20:23], s75 offen sc1 lds
    s_add_u32 m0, m0, 1024
    s_add_u32 s75, s75, 33792
    buffer_load_dwordx4 v24, s[20:23], s75 offen sc1 lds
    s_add_u32 m0, m0, 1024
    s_add_u32 s75, s75, 33792
    buffer_load_dwordx4 v24, s[20:23], s75 offen sc1 lds
    s_add_u32 m0, m0, 1024
    s_add_u32 s75, s75, 33792
    buffer_load_dwordx4 v24, s[20:23], s75 offen sc1 lds
    s_add_u32 m0, m0, 1024
    s_add_u32 s75, s75, 33792
    buffer_load_dwordx4 v24, s[20:23], s75 offen sc1 lds
    s_add_u32 m0, m0, 1024
    s_add_u32 s75, s75, 33792
    buffer_load_dwordx4 v24, s[20:23], s75 offen sc1 lds
    s_add_u32 m0, s83, 0
    s_mov_b64 exec, 1
    global_load_lds_dword v1, s[38:39]
    s_mov_b64 exec, -1
    s_waitcnt vmcnt(0)
T_FIN:
K_END:
    s_endpgm
A_U2:
    s_add_u32 s6, s77, 33792
    buffer_store_dwordx4 v[132:135], v114, s[20:23], s77 offen sc1
    buffer_store_dwordx4 v[136:139], v114, s[20:23], s6 offen sc1
    s_branch A_U2R
A_U3:
    v_mov_b32 v108, 0
    v_mov_b32 v109, 0
    v_mov_b32 v110, 0
    v_mov_b32 v111, 0
    s_add_u32 s6, s76, -128
    buffer_store_dwordx4 v[108:111], v114, s[20:23], s6 offen sc1
    s_add_u32 s6, s76, 33664
    buffer_store_dwordx4 v[108:111], v114, s[20:23], s6 offen sc1
    s_add_u32 s6, s77, -128
    buffer_store_dwordx4 v[108:111], v114, s[20:23], s6 offen sc1
    s_add_u32 s6, s77, 33664
    buffer_store_dwordx4 v[108:111], v114, s[20:23], s6 offen sc1
    s_branch A_U3R
A_T0_1S:
    s_sub_u32 s33, s33, 1
    s_cbranch_scc1 A_T0_1R
    s_setprio 0
    ds_read_b32 v10, v117
    s_waitcnt lgkmcnt(0)
    s_branch A_T0_1
A_T0_2S:
    s_sub_u32 s33, s33, 1
    s_cbranch_scc1 A_T0_2R
    s_setprio 0
    ds_read_b32 v10, v117
    s_waitcnt lgkmcnt(0)
    s_branch A_T0_2
A_T0_3S:
    s_sub_u32 s33, s33, 1
    s_cbranch_scc1 A_T0_3R
    s_setprio 0
    ds_read_b32 v10, v117
    s_waitcnt lgkmcnt(0)
    s_branch A_T0_3
A_T0_4S:
    s_sub_u32 s33, s33, 1
    s_cbranch_scc1 A_T0_4R
    s_setprio 0
    ds_read_b32 v10, v117
    s_waitcnt lgkmcnt(0)
    s_branch A_T0_4
A_T0_5S:
    s_sub_u32 s33, s33, 1
    s_cbranch_scc1 A_T0_5R
    s_setprio 0
    ds_read_b32 v10, v117
    s_waitcnt lgkmcnt(0)
    s_branch A_T0_5
A_T0_6S:
    s_sub_u32 s33, s33, 1
    s_cbranch_scc1 A_T0_6R
    s_setprio 0
    ds_read_b32 v10, v117
    s_waitcnt lgkmcnt(0)
    s_branch A_T0_6
A_T0_7S:
    s_sub_u32 s33, s33, 1
    s_cbranch_scc1 A_T0_7R
    s_setprio 0
    ds_read_b32 v10, v117
    s_waitcnt lgkmcnt(0)
    s_branch A_T0_7
A_T0_8S:
    s_sub_u32 s33, s33, 1
    s_cbranch_scc1 A_T0_8R
    s_setprio 0
    ds_read_b32 v10, v117
    s_waitcnt lgkmcnt(0)
    s_branch A_T0_8
A_T1_1S:
    s_sub_u32 s33, s33, 1
    s_cbranch_scc1 A_T1_1R
    s_setprio 0
    ds_read_b32 v10, v117
    s_waitcnt lgkmcnt(0)
    s_branch A_T1_1
A_T1_2S:
    s_sub_u32 s33, s33, 1
    s_cbranch_scc1 A_T1_2R
    s_setprio 0
    ds_read_b32 v10, v117
    s_waitcnt lgkmcnt(0)
    s_branch A_T1_2
A_F3S:
    s_sub_u32 s33, s33, 64
    s_cbranch_scc1 A_F3R
    s_sleep 6
    buffer_load_dwordx4 v[148:151], v141, s[20:23], s72 offen sc1
    s_waitcnt vmcnt(0)
    s_branch A_F3
A_EP:
    v_mov_b32 v143, s36
    s_mov_b32 s6, 9453568
    buffer_store_dword v143, v144, s[20:23], s6 offen sc1
    s_branch A_EPR
A_T1_3S:
    s_sub_u32 s33, s33, 1
    s_cbranch_scc1 A_T1_3R
    s_setprio 0
    ds_read_b32 v10, v117
    s_waitcnt lgkmcnt(0)
    s_branch A_T1_3
A_T1_4S:
    s_sub_u32 s33, s33, 1
    s_cbranch_scc1 A_T1_4R
    s_setprio 0
    ds_read_b32 v10, v117
    s_waitcnt lgkmcnt(0)
    s_branch A_T1_4
A_T1_5S:
    s_sub_u32 s33, s33, 1
    s_cbranch_scc1 A_T1_5R
    s_setprio 0
    ds_read_b32 v10, v117
    s_waitcnt lgkmcnt(0)
    s_branch A_T1_5
A_T1_6S:
    s_sub_u32 s33, s33, 1
    s_cbranch_scc1 A_T1_6R
    s_setprio 0
    ds_read_b32 v10, v117
    s_waitcnt lgkmcnt(0)
    s_branch A_T1_6
A_T1_7S:
    s_sub_u32 s33, s33, 1
    s_cbranch_scc1 A_T1_7R
    s_setprio 0
    ds_read_b32 v10, v117
    s_waitcnt lgkmcnt(0)
    s_branch A_T1_7
A_T1_8S:
    s_sub_u32 s33, s33, 1
    s_cbranch_scc1 A_T1_8R
    s_setprio 0
    ds_read_b32 v10, v117
    s_waitcnt lgkmcnt(0)
    s_branch A_T1_8
FB1:
    v_mov_b32 v56, v60
    v_mov_b32 v57, v61
    v_mov_b32 v58, v62
    v_mov_b32 v59, v63
    v_mov_b32 v64, v66
    v_mov_b32 v65, v67
FB0:
    v_cndmask_b32 v64, v64, 0, s[86:87]
    v_mov_b32 v80, 0xff800000
    s_mov_b32 s74, 9175040
FB_L1:
    buffer_load_dwordx4 v[68:71], v1, s[20:23], s74 offen offset:0 sc1
    buffer_load_dwordx4 v[72:75], v1, s[20:23], s74 offen offset:1024 sc1
    buffer_load_dwordx4 v[76:79], v1, s[20:23], s74 offen offset:2048 sc1
    s_waitcnt vmcnt(0)
    v_mfma_f32_32x32x16_bf16 v[16:31], v[68:71], v[56:59], 0
    v_mfma_f32_32x32x8_bf16 v[16:31], v[76:77], v[64:65], v[16:31]
    s_nop 11
    v_max3_f32 v80, v80, v16, v17
    v_max3_f32 v80, v80, v18, v19
    v_max3_f32 v80, v80, v20, v21
    v_max3_f32 v80, v80, v22, v23
    v_max3_f32 v80, v80, v24, v25
    v_max3_f32 v80, v80, v26, v27
    v_max3_f32 v80, v80, v28, v29
    v_max3_f32 v80, v80, v30, v31
    v_mfma_f32_32x32x16_bf16 v[16:31], v[72:75], v[56:59], 0
    v_mfma_f32_32x32x8_bf16 v[16:31], v[78:79], v[64:65], v[16:31]
    s_nop 11
    v_max3_f32 v80, v80, v16, v17
    v_max3_f32 v80, v80, v18, v19
    v_max3_f32 v80, v80, v20, v21
    v_max3_f32 v80, v80, v22, v23
    v_max3_f32 v80, v80, v24, v25
    v_max3_f32 v80, v80, v26, v27
    v_max3_f32 v80, v80, v28, v29
    v_max3_f32 v80, v80, v30, v31
    s_add_u32 s74, s74, 6144
    s_cmp_lt_u32 s74, 9371648
    s_cbranch_scc1 FB_L1
    v_mov_b32 v81, v80
    s_nop 1
    v_permlane32_swap_b32 v80, v81
    s_nop 0
    v_max_f32 v80, v80, v81
    v_mov_b32 v81, v80
    v_cvt_pk_bf16_f32 v81, v81, v81
    v_lshlrev_b32 v81, 16, v81
    v_sub_f32 v80, v80, v81
    v_mov_b32 v82, v80
    v_cvt_pk_bf16_f32 v82, v82, v82
    v_lshlrev_b32 v82, 16, v82
    v_sub_f32 v80, v80, v82
    v_cvt_pk_bf16_f32 v81, -v81, -v82
    v_cvt_pk_bf16_f32 v80, -v80, 0
    v_cndmask_b32 v64, v64, v81, s[86:87]
    v_cndmask_b32 v65, v65, v80, s[86:87]
    v_mov_b32 v192, 0
    v_mov_b32 v193, 0
    v_mov_b32 v194, 0
    v_mov_b32 v195, 0
    v_mov_b32 v196, 0
    v_mov_b32 v197, 0
    v_mov_b32 v198, 0
    v_mov_b32 v199, 0
    v_mov_b32 v200, 0
    v_mov_b32 v201, 0
    v_mov_b32 v202, 0
    v_mov_b32 v203, 0
    v_mov_b32 v204, 0
    v_mov_b32 v205, 0
    v_mov_b32 v206, 0
    v_mov_b32 v207, 0
    s_mov_b32 s74, 9175040
FB_L2:
    buffer_load_dwordx4 v[68:71], v1, s[20:23], s74 offen offset:0 sc1
    buffer_load_dwordx4 v[72:75], v1, s[20:23], s74 offen offset:1024 sc1
    buffer_load_dwordx4 v[76:79], v1, s[20:23], s74 offen offset:2048 sc1
    s_add_u32 s75, s74, 3072
    buffer_load_dwordx4 v[32:35], v116, s[20:23], s75 offen offset:0 sc1
    buffer_load_dwordx4 v[36:39], v116, s[20:23], s75 offen offset:672 sc1
    buffer_load_dwordx4 v[40:43], v116, s[20:23], s75 offen offset:1344 sc1
    buffer_load_dwordx4 v[44:47], v116, s[20:23], s75 offen offset:2016 sc1
    s_waitcnt vmcnt(0)
    v_mfma_f32_32x32x16_bf16 v[16:31], v[68:71], v[56:59], 0
    v_mfma_f32_32x32x8_bf16 v[16:31], v[76:77], v[64:65], v[16:31]
    s_nop 11
    v_exp_f32 v16, v16
    v_exp_f32 v17, v17
    v_exp_f32 v18, v18
    v_exp_f32 v19, v19
    v_exp_f32 v20, v20
    v_exp_f32 v21, v21
    v_exp_f32 v22, v22
    v_exp_f32 v23, v23
    v_exp_f32 v24, v24
    v_exp_f32 v25, v25
    v_exp_f32 v26, v26
    v_exp_f32 v27, v27
    v_exp_f32 v28, v28
    v_exp_f32 v29, v29
    v_exp_f32 v30, v30
    v_exp_f32 v31, v31
    v_cvt_pk_bf16_f32 v48, v16, v17
    v_cvt_pk_bf16_f32 v49, v18, v19
    v_cvt_pk_bf16_f32 v50, v20, v21
    v_cvt_pk_bf16_f32 v51, v22, v23
    v_cvt_pk_bf16_f32 v52, v24, v25
    v_cvt_pk_bf16_f32 v53, v26, v27
    v_cvt_pk_bf16_f32 v54, v28, v29
    v_cvt_pk_bf16_f32 v55, v30, v31
    s_nop 1
    v_mfma_f32_32x32x16_bf16 v[192:207], v[32:35], v[48:51], v[192:207]
    v_mfma_f32_32x32x16_bf16 v[192:207], v[36:39], v[52:55], v[192:207]
    v_mfma_f32_32x32x16_bf16 v[16:31], v[72:75], v[56:59], 0
    v_mfma_f32_32x32x8_bf16 v[16:31], v[78:79], v[64:65], v[16:31]
    s_nop 11
    v_exp_f32 v16, v16
    v_exp_f32 v17, v17
    v_exp_f32 v18, v18
    v_exp_f32 v19, v19
    v_exp_f32 v20, v20
    v_exp_f32 v21, v21
    v_exp_f32 v22, v22
    v_exp_f32 v23, v23
    v_exp_f32 v24, v24
    v_exp_f32 v25, v25
    v_exp_f32 v26, v26
    v_exp_f32 v27, v27
    v_exp_f32 v28, v28
    v_exp_f32 v29, v29
    v_exp_f32 v30, v30
    v_exp_f32 v31, v31
    v_cvt_pk_bf16_f32 v48, v16, v17
    v_cvt_pk_bf16_f32 v49, v18, v19
    v_cvt_pk_bf16_f32 v50, v20, v21
    v_cvt_pk_bf16_f32 v51, v22, v23
    v_cvt_pk_bf16_f32 v52, v24, v25
    v_cvt_pk_bf16_f32 v53, v26, v27
    v_cvt_pk_bf16_f32 v54, v28, v29
    v_cvt_pk_bf16_f32 v55, v30, v31
    s_nop 1
    v_mfma_f32_32x32x16_bf16 v[192:207], v[40:43], v[48:51], v[192:207]
    v_mfma_f32_32x32x16_bf16 v[192:207], v[44:47], v[52:55], v[192:207]
    s_add_u32 s74, s74, 6144
    s_cmp_lt_u32 s74, 9371648
    s_cbranch_scc1 FB_L2
    s_nop 9
    v_rcp_f32 v26, v204
    v_mov_b32 v84, v192
    v_mov_b32 v85, v193
    v_mov_b32 v86, v194
    v_mov_b32 v87, v195
    v_mov_b32 v88, v196
    v_mov_b32 v89, v197
    v_mov_b32 v90, v198
    v_mov_b32 v91, v199
    v_mov_b32 v92, v200
    v_mov_b32 v93, v201
    v_mov_b32 v94, v202
    v_mov_b32 v95, v203
    s_cmp_eq_u32 s88, 0
    s_cbranch_scc1 FB_RET0
    s_branch FB_RET1
IMG_END:
.fill 64, 4, 0xbf800000
.section .rodata,"a"
.p2align 6
.amdhsa_kernel gated_mix__ssm_conv_s4d__grouped_kv_mqa__prompt_kernel
  .amdhsa_next_free_vgpr 256
  .amdhsa_next_free_sgpr 102
  .amdhsa_accum_offset 256
  .amdhsa_group_segment_fixed_size 0
  .amdhsa_kernarg_size 128
  .amdhsa_user_sgpr_count 2
  .amdhsa_user_sgpr_kernarg_segment_ptr 1
  .amdhsa_system_sgpr_workgroup_id_x 1
.end_amdhsa_kernel
```
